```python
import torch

def _softmax(x, axis=-1):
    return torch.softmax(x, dim=axis)
def _gelu(x):
    return torch.nn.functional.gelu(x, approximate="tanh")
def _silu(x):
    return torch.nn.functional.silu(x)
def _sigmoid(x):
    return torch.sigmoid(x)
def _layernorm(x, axis=-1, eps=1e-5):
    m = x.mean(dim=axis, keepdim=True)
    v = x.var(dim=axis, keepdim=True, unbiased=False)
    return (x - m) / torch.sqrt(v + eps)
def _scatter_add(tgt, idx, src, axis=0):
    return tgt.clone().index_add_(axis, idx, src)
def _segment_sum(src, seg, n):
    out = torch.zeros((n,) + src.shape[1:], dtype=src.dtype)
    return out.index_add_(0, seg, src)
def _pad(x, pw):
    flat = tuple(v for pair in reversed(pw) for v in pair)
    return torch.nn.functional.pad(x, flat)

kernel_name = 'concat_heads__softmax_full_mha__compressed_kv_cla__prompt'

def setup_inputs():

    _w = (lambda a: (lambda t: t.to(torch.bfloat16) if t.is_floating_point() else t)(torch.as_tensor(a)))
    def _A_setup():
        B, S, D = 1, 2048, 448
        return {
            "x": _w((lambda *s: torch.randn(*s, dtype=torch.bfloat16) * 0.4)(B, S, D)),
            "wqkv": _w((lambda *s: torch.randn(*s, dtype=torch.bfloat16) * 0.4)(D, 3 * D)),
            "wo": _w((lambda *s: torch.randn(*s, dtype=torch.bfloat16) * 0.05)(D, D)),
        }
    _A_in = _A_setup()

    def _B_setup():
        B, H, Sq, Sk, D, M = 1, 16, 2048, 2048, 256, 448
        Dc = 4 * D
        return {
            "x": _w((lambda *s: torch.randn(*s, dtype=torch.bfloat16) * 0.2)(B, Sq, M)),
            "c_kv": _w((lambda *s: torch.randn(*s, dtype=torch.bfloat16) * 1.6)(B, Sk, Dc)),
            "w_q": _w((lambda *s: torch.randn(*s, dtype=torch.bfloat16) * 3.2)(M, H, D) * (M ** -0.5)),
            "w_uk": _w((lambda *s: torch.randn(*s, dtype=torch.bfloat16) * 3.2)(Dc, H, D) * (Dc ** -0.5)),
            "w_uv": _w((lambda *s: torch.randn(*s, dtype=torch.bfloat16) * 1.6)(Dc, H, D) * (Dc ** -0.5)),
            "w_o": _w((lambda *s: torch.randn(*s, dtype=torch.bfloat16) * 1.6)(H, D, M) * ((H * D) ** -0.5)),
        }
    _B_in = _B_setup()

    return {
        "A_x": _A_in["x"],
        "A_wqkv": _A_in["wqkv"],
        "A_wo": _A_in["wo"],
        "B_x": _B_in["x"],
        "B_c_kv": _B_in["c_kv"],
        "B_w_q": _B_in["w_q"],
        "B_w_uk": _B_in["w_uk"],
        "B_w_uv": _B_in["w_uv"],
        "B_w_o": _B_in["w_o"],
    }

def reference(A_x, A_wqkv, A_wo, B_x, B_c_kv, B_w_q, B_w_uk, B_w_uv, B_w_o):
    def _A_ref(x, wqkv, wo):
        B, S, D = x.shape
        H = 16; Dh = D // H
        qkv = (lambda x, *d: x.permute(*d))((x @ wqkv).reshape(B, S, 3, H, Dh), 2, 0, 3, 1, 4)
        q, k, v = qkv[0], qkv[1], qkv[2]
        scale = Dh ** -0.5
        scores = torch.einsum("bhqd,bhkd->bhqk", q, k) * scale
        p = _softmax(scores, axis=-1)
        o = torch.einsum("bhqk,bhkd->bhqd", p, v)
        return (lambda x, *d: x.permute(*d))(o, 0, 2, 1, 3).reshape(B, S, D) @ wo

    def _B_ref(x, c_kv, w_q, w_uk, w_uv, w_o):
        B, Sq, M = x.shape[0], x.shape[1], x.shape[2]
        Sk = c_kv.shape[1]
        H, D = w_q.shape[1], w_q.shape[2]
        q = torch.einsum("bqm,mhd->bhqd", x, w_q)
        k = torch.einsum("bkc,chd->bhkd", c_kv, w_uk)
        v = torch.einsum("bkc,chd->bhkd", c_kv, w_uv)
        scores = torch.einsum("bhqd,bhkd->bhqk", q, k) * (D ** -0.5)
        off = Sk - Sq
        qi = torch.arange(Sq)[:, None]
        kj = torch.arange(Sk)[None, :]
        cmask = kj <= (qi + off)
        scores = torch.where(cmask[None, None], scores, -1e9)
        p = _softmax(scores, axis=-1)
        ctx = torch.einsum("bhqk,bhkd->bhqd", p, v)
        return torch.einsum("bhqd,hdm->bqm", ctx, w_o)

    a = _A_ref(A_x, A_wqkv, A_wo)
    b = _B_ref(B_x, B_c_kv, B_w_q, B_w_uk, B_w_uv, B_w_o)
    return torch.concatenate([a, b], axis=-1)
```

```asm
; @launch grid=(256,1,1) block=(256,1,1) lds=163840
.amdgcn_target "amdgcn-amd-amdhsa--gfx950"
.text
.globl concat_heads__softmax_full_mha__compressed_kv_cla__prompt_kernel
.p2align 8
.type concat_heads__softmax_full_mha__compressed_kv_cla__prompt_kernel,@function
concat_heads__softmax_full_mha__compressed_kv_cla__prompt_kernel:
s_cmp_ge_u32 s2, 256
s_cbranch_scc1 mega_kernel_exit
s_load_dwordx4 s[44:47], s[0:1], 24
s_load_dwordx4 s[48:51], s[0:1], 40
s_load_dwordx2 s[52:53], s[0:1], 56
s_load_dwordx4 s[40:43], s[0:1], 0
s_load_dwordx2 s[12:13], s[0:1], 88
v_lshrrev_b32 v2, 6, v0
v_and_b32 v1, 63, v0
s_mov_b32 s7, 0x20000
v_readfirstlane_b32 s20, v2
s_mov_b32 s11, 0x20000
s_mov_b32 s15, 0x20000
s_mov_b32 s71, 0x20000
s_mov_b32 s14, 113246208
s_and_b32 s54, s2, 7
s_lshr_b32 s55, s2, 3
s_and_b32 s56, s55, 1
s_lshl_b32 s57, s54, 1
s_add_u32 s56, s56, s57
s_lshl_b32 s24, s20, 13
s_add_u32 s25, s24, 65536
s_lshr_b32 s66, s20, 1
s_and_b32 s67, s20, 1
s_mov_b32 s32, 2048
s_mov_b32 s33, 8192
s_mov_b32 s34, 64
v_lshrrev_b32 v2, 3, v1
s_lshl_b32 s61, s20, 6
v_add_u32 v2, s61, v2
v_mul_lo_u32 v2, v2, s32
v_and_b32 v3, 7, v1
v_lshrrev_b32 v4, 4, v1
v_xor_b32 v3, v3, v4
v_lshlrev_b32 v3, 4, v3
v_xor_b32 v5, 64, v3
v_add_u32 v16, v2, v3
v_add_u32 v5, v2, v5
s_lshl_b32 s61, s32, 3
s_mov_b32 s64, 0
s_add_u32 s64, s64, s61
s_sub_u32 s65, s64, 1024
v_add_u32 v17, s65, v5
s_add_u32 s64, s64, s61
s_sub_u32 s65, s64, 2048
v_add_u32 v18, s65, v16
s_add_u32 s64, s64, s61
s_sub_u32 s65, s64, 3072
v_add_u32 v19, s65, v5
s_add_u32 s64, s64, s61
s_sub_u32 s65, s64, 0
v_add_u32 v20, s65, v16
s_add_u32 s64, s64, s61
s_sub_u32 s65, s64, 1024
v_add_u32 v21, s65, v5
s_add_u32 s64, s64, s61
s_sub_u32 s65, s64, 2048
v_add_u32 v22, s65, v16
s_add_u32 s64, s64, s61
s_sub_u32 s65, s64, 3072
v_add_u32 v23, s65, v5
s_mov_b32 s18, 0
v_lshrrev_b32 v2, 5, v1
s_lshl_b32 s61, s20, 4
v_add_u32 v3, s61, v2
v_mul_lo_u32 v3, v3, s33
v_bfe_u32 v4, v1, 1, 4
v_xor_b32 v4, v4, v2
v_and_b32 v5, 1, v4
v_lshlrev_b32 v5, 5, v5
v_and_b32 v6, 1, v1
v_lshl_add_u32 v5, v6, 4, v5
v_add_u32 v3, v3, v5
v_lshrrev_b32 v4, 1, v4
v_xor_b32 v5, 0, v4
v_mul_lo_u32 v5, v5, s34
v_add_u32 v6, v3, v5
v_xor_b32 v5, 1, v4
v_mul_lo_u32 v5, v5, s34
v_add_u32 v7, v3, v5
v_xor_b32 v5, 2, v4
v_mul_lo_u32 v5, v5, s34
v_add_u32 v8, v3, v5
v_xor_b32 v5, 3, v4
v_mul_lo_u32 v5, v5, s34
v_add_u32 v9, v3, v5
s_lshl_b32 s61, s33, 1
s_mov_b32 s64, 0
s_sub_u32 s65, s64, 0
v_add_u32 v24, s65, v6
s_add_u32 s64, s64, s61
s_sub_u32 s65, s64, 1024
v_add_u32 v25, s65, v7
s_add_u32 s64, s64, s61
s_sub_u32 s65, s64, 2048
v_add_u32 v26, s65, v6
s_add_u32 s64, s64, s61
s_sub_u32 s65, s64, 3072
v_add_u32 v27, s65, v7
s_add_u32 s64, s64, s61
s_sub_u32 s65, s64, 0
v_add_u32 v28, s65, v8
s_add_u32 s64, s64, s61
s_sub_u32 s65, s64, 1024
v_add_u32 v29, s65, v9
s_add_u32 s64, s64, s61
s_sub_u32 s65, s64, 2048
v_add_u32 v30, s65, v8
s_add_u32 s64, s64, s61
s_sub_u32 s65, s64, 3072
v_add_u32 v31, s65, v9
s_lshl_b32 s23, s33, 6
s_mov_b32 s19, 0
s_waitcnt lgkmcnt(0)
s_lshr_b32 s3, s55, 2
s_sub_u32 s3, 7, s3
s_lshl_b32 s61, s3, 19
s_add_u32 s4, s46, s61
s_addc_u32 s5, s47, 0
s_sub_u32 s16, 4194304, s61
s_mov_b32 s32, 2048
s_bitcmp1_b32 s55, 1
s_cselect_b32 s8, s52, s50
s_cselect_b32 s9, s53, s51
s_lshl_b32 s61, s56, 9
s_add_u32 s8, s8, s61
s_addc_u32 s9, s9, 0
s_sub_u32 s17, 8388608, s61
s_mov_b32 s33, 8192
s_mov_b32 s34, 64
s_mov_b32 s6, s16
s_mov_b32 s10, s17
s_load_dwordx2 s[52:53], s[0:1], 80
s_add_u32 m0, s24, 0
s_nop 0
buffer_load_dwordx4 v16, s[4:7], s18 offen offset:0 lds
buffer_load_dwordx4 v17, s[4:7], s18 offen offset:1024 lds
buffer_load_dwordx4 v18, s[4:7], s18 offen offset:2048 lds
buffer_load_dwordx4 v19, s[4:7], s18 offen offset:3072 lds
s_add_u32 m0, s24, 4096
s_nop 0
buffer_load_dwordx4 v20, s[4:7], s18 offen offset:0 lds
buffer_load_dwordx4 v21, s[4:7], s18 offen offset:1024 lds
buffer_load_dwordx4 v22, s[4:7], s18 offen offset:2048 lds
buffer_load_dwordx4 v23, s[4:7], s18 offen offset:3072 lds
s_add_u32 m0, s25, 0
s_nop 0
buffer_load_dwordx4 v24, s[8:11], s19 offen offset:0 lds
buffer_load_dwordx4 v25, s[8:11], s19 offen offset:1024 lds
buffer_load_dwordx4 v26, s[8:11], s19 offen offset:2048 lds
buffer_load_dwordx4 v27, s[8:11], s19 offen offset:3072 lds
s_add_u32 m0, s25, 4096
s_nop 0
buffer_load_dwordx4 v28, s[8:11], s19 offen offset:0 lds
buffer_load_dwordx4 v29, s[8:11], s19 offen offset:1024 lds
buffer_load_dwordx4 v30, s[8:11], s19 offen offset:2048 lds
buffer_load_dwordx4 v31, s[8:11], s19 offen offset:3072 lds
s_add_u32 s18, s18, 128
s_add_u32 s19, s19, s23
s_add_u32 m0, s25, 32768
s_nop 0
buffer_load_dwordx4 v24, s[8:11], s19 offen offset:0 lds
buffer_load_dwordx4 v25, s[8:11], s19 offen offset:1024 lds
buffer_load_dwordx4 v26, s[8:11], s19 offen offset:2048 lds
buffer_load_dwordx4 v27, s[8:11], s19 offen offset:3072 lds
s_add_u32 m0, s25, 36864
s_nop 0
buffer_load_dwordx4 v28, s[8:11], s19 offen offset:0 lds
buffer_load_dwordx4 v29, s[8:11], s19 offen offset:1024 lds
buffer_load_dwordx4 v30, s[8:11], s19 offen offset:2048 lds
buffer_load_dwordx4 v31, s[8:11], s19 offen offset:3072 lds
s_add_u32 m0, s24, 32768
s_nop 0
buffer_load_dwordx4 v16, s[4:7], s18 offen offset:0 lds
buffer_load_dwordx4 v17, s[4:7], s18 offen offset:1024 lds
buffer_load_dwordx4 v18, s[4:7], s18 offen offset:2048 lds
buffer_load_dwordx4 v19, s[4:7], s18 offen offset:3072 lds
s_add_u32 m0, s24, 36864
s_nop 0
buffer_load_dwordx4 v20, s[4:7], s18 offen offset:0 lds
buffer_load_dwordx4 v21, s[4:7], s18 offen offset:1024 lds
buffer_load_dwordx4 v22, s[4:7], s18 offen offset:2048 lds
buffer_load_dwordx4 v23, s[4:7], s18 offen offset:3072 lds
s_add_u32 s18, s18, 128
s_add_u32 s19, s19, s23
s_and_b32 s76, s55, 3
s_lshl_b32 s76, s76, 6
s_and_b32 s61, s20, 1
s_cmp_ge_u32 s20, 2
s_cbranch_scc1 mega_kernel_pf0_w
s_mov_b32 s68, s4
s_mov_b32 s69, s5
s_mov_b32 s75, s16
s_mov_b32 s73, 128
s_add_u32 s64, 31, 1
s_mul_i32 s64, s64, s61
s_add_u32 s64, s64, s76
v_and_b32 v46, 31, v1
v_add_u32 v46, s64, v46
v_mul_lo_u32 v46, v46, s32
s_branch mega_kernel_pf0_d
mega_kernel_pf0_w:
s_mov_b32 s68, s8
s_mov_b32 s69, s9
s_mov_b32 s75, s17
s_lshl_b32 s73, s33, 6
s_lshl_b32 s64, s3, 3
s_lshl_b32 s61, s61, 2
s_add_u32 s64, s64, s61
v_bfe_u32 v46, v1, 2, 2
v_add_u32 v46, s64, v46
v_mul_lo_u32 v46, v46, s33
v_and_b32 v2, 3, v1
v_lshl_add_u32 v46, v2, 7, v46
mega_kernel_pf0_d:
s_mov_b32 s70, s75
s_mov_b32 s72, 0
buffer_load_dword v45, v46, s[68:71], s72 offen
s_add_u32 s72, s72, s73
buffer_load_dword v45, v46, s[68:71], s72 offen
s_add_u32 s72, s72, s73
buffer_load_dword v45, v46, s[68:71], s72 offen
s_add_u32 s72, s72, s73
buffer_load_dword v45, v46, s[68:71], s72 offen
v_lshrrev_b32 v4, 4, v1
v_and_b32 v2, 15, v1
v_lshrrev_b32 v3, 1, v2
v_xor_b32 v3, v3, v4
v_lshlrev_b32 v3, 4, v3
v_lshl_add_u32 v3, v2, 7, v3
s_lshl_b32 s61, s66, 14
v_add_u32 v32, s61, v3
v_xor_b32 v33, 64, v32
v_lshrrev_b32 v3, 2, v2
v_lshl_add_u32 v5, v4, 3, v3
v_lshlrev_b32 v5, 9, v5
v_and_b32 v6, 1, v4
v_lshl_add_u32 v6, v6, 2, v3
v_lshl_add_u32 v5, v6, 5, v5
v_and_b32 v6, 3, v1
v_lshl_add_u32 v5, v6, 3, v5
s_lshl_b32 s61, s67, 8
s_add_u32 s61, s61, 65536
v_add_u32 v34, s61, v5
v_xor_b32 v35, 32, v34
v_xor_b32 v36, 64, v34
v_xor_b32 v37, 96, v34
v_xor_b32 v38, 128, v34
v_xor_b32 v39, 160, v34
v_xor_b32 v40, 192, v34
v_xor_b32 v41, 224, v34
s_mov_b32 s38, 17
s_mov_b32 s35, 0
s_mov_b32 s78, 1.0
v_mov_b32 v43, -1
s_mov_b32 s39, 14
s_cmp_ge_u32 s55, 26
s_cbranch_scc1 mega_kernel_jobA
s_mov_b32 s89, 0
s_lshr_b32 s57, s55, 1
s_sub_u32 s64, 15, s57
s_and_b32 s57, s57, 7
s_mov_b32 s76, 0
s_mov_b32 s77, 63
s_mul_i32 s61, s64, 114688
s_add_u32 s40, s44, s61
s_addc_u32 s41, s45, 0
s_mov_b32 s42, 114688
s_lshl_b32 s61, s56, 9
s_add_u32 s44, s48, s61
s_addc_u32 s45, s49, 0
s_sub_u32 s48, 3670016, s61
s_mov_b32 s43, 8192
s_mov_b32 s49, 64
s_lshl_b32 s3, s56, 2
s_branch mega_kernel_dec_done
mega_kernel_jobA:
s_mov_b32 s89, 1
s_mov_b32 s3, 64
s_mov_b32 s57, s54
s_sub_u32 s64, s55, 26
s_and_b32 s76, s64, 3
s_lshl_b32 s76, s76, 6
s_mov_b32 s77, 31
s_mul_i32 s61, s64, 448
s_add_u32 s44, s42, s61
s_addc_u32 s45, s43, 0
s_sub_u32 s48, 1204224, s61
s_mul_i32 s61, s57, 229376
s_add_u32 s40, s40, s61
s_addc_u32 s41, s41, 0
s_sub_u32 s42, 1835008, s61
s_mov_b32 s43, 2688
s_mov_b32 s49, 56
s_lshl_b32 s58, s64, 20
s_add_u32 s58, s58, 67108864
s_lshl_b32 s61, s57, 14
s_add_u32 s58, s58, s61
s_lshl_b32 s61, s66, 13
s_add_u32 s58, s58, s61
s_lshl_b32 s61, s67, 19
s_add_u32 s58, s58, s61
s_mov_b32 s35, 1
s_mov_b32 s60, 256
s_mov_b32 s63, 1
s_mov_b32 s59, 131072
s_mov_b32 s62, 2048
s_cmp_ge_u32 s64, 4
s_cbranch_scc1 mega_kernel_dec_done
s_mov_b32 s63, 0
s_mov_b32 s59, 2048
s_mov_b32 s62, 131072
s_mov_b32 s78, 0x3e8b97f6
s_cmp_lt_u32 s64, 2
s_cbranch_scc1 mega_kernel_dec_done
s_mov_b32 s78, 1.0
s_mov_b32 s35, 2
s_mov_b32 s60, 128
mega_kernel_dec_done:
s_cmp_eq_u32 s2, 255
s_cbranch_scc0 mega_kernel_noclr
v_and_b32 v2, 31, v1
v_lshlrev_b32 v2, 7, v2
v_add_u32 v2, 117440512, v2
v_mov_b32 v3, 0
global_store_dword v2, v3, s[12:13] sc0 sc1
mega_kernel_noclr:
s_mov_b32 s50, 896
s_and_b32 s61, s20, 1
s_cmp_ge_u32 s20, 2
s_cbranch_scc1 mega_kernel_pfw_w
s_mov_b32 s80, s40
s_mov_b32 s81, s41
s_mov_b32 s82, s42
s_mov_b32 s87, 128
s_add_u32 s64, s77, 1
s_mul_i32 s64, s64, s61
s_add_u32 s64, s64, s76
v_and_b32 v47, s77, v1
v_add_u32 v47, s64, v47
v_mul_lo_u32 v47, v47, s50
s_branch mega_kernel_pfw_d
mega_kernel_pfw_w:
s_mov_b32 s80, s44
s_mov_b32 s81, s45
s_mov_b32 s82, s48
s_lshl_b32 s87, s43, 6
s_lshl_b32 s64, s57, 3
s_lshl_b32 s61, s61, 2
s_add_u32 s64, s64, s61
v_bfe_u32 v47, v1, 2, 2
v_add_u32 v47, s64, v47
v_mul_lo_u32 v47, v47, s43
v_and_b32 v2, 3, v1
v_lshl_add_u32 v47, v2, 7, v47
mega_kernel_pfw_d:
s_mov_b32 s82, s82
s_mov_b32 s83, 0x20000
s_mul_i32 s86, s87, -5
s_lshr_b32 s61, s55, 2
s_sub_u32 s61, 7, s61
s_lshl_b32 s61, s61, 17
s_lshl_b32 s26, s56, 20
s_add_u32 s26, s26, s61
s_lshl_b32 s61, s66, 16
s_add_u32 s26, s26, s61
s_mov_b32 s79, 0
v_lshlrev_b32 v42, 4, v1
s_bitcmp1_b32 s55, 1
s_cbranch_scc1 mega_kernel_e0_v
s_mov_b32 s37, 0
s_mov_b32 s27, 16384
s_mov_b32 s28, 8192
s_mov_b32 s29, 1024
s_lshl_b32 s61, s67, 12
s_branch mega_kernel_e0_d
mega_kernel_e0_v:
s_mov_b32 s37, 1
s_mov_b32 s27, 2048
s_mov_b32 s28, 1024
s_mov_b32 s29, 16384
s_add_u32 s26, s26, 16777216
s_lshl_b32 s61, s67, 13
mega_kernel_e0_d:
s_add_u32 s26, s26, s61
s_mov_b32 s21, 2
v_mov_b32 v10, 0
v_mov_b32 v11, 0
v_mov_b32 v12, 0
v_mov_b32 v13, 0
s_nop 1
v_mfma_f32_32x32x16_bf16 v[64:79], v[10:13], v[10:13], 0
v_mfma_f32_32x32x16_bf16 v[80:95], v[10:13], v[10:13], 0
v_mfma_f32_32x32x16_bf16 v[96:111], v[10:13], v[10:13], 0
v_mfma_f32_32x32x16_bf16 v[112:127], v[10:13], v[10:13], 0
v_mfma_f32_32x32x16_bf16 v[128:143], v[10:13], v[10:13], 0
v_mfma_f32_32x32x16_bf16 v[144:159], v[10:13], v[10:13], 0
v_mfma_f32_32x32x16_bf16 v[160:175], v[10:13], v[10:13], 0
v_mfma_f32_32x32x16_bf16 v[176:191], v[10:13], v[10:13], 0
v_mfma_f32_32x32x16_bf16 v[192:207], v[10:13], v[10:13], 0
v_mfma_f32_32x32x16_bf16 v[208:223], v[10:13], v[10:13], 0
v_mfma_f32_32x32x16_bf16 v[224:239], v[10:13], v[10:13], 0
v_mfma_f32_32x32x16_bf16 v[240:255], v[10:13], v[10:13], 0
v_mfma_f32_32x32x16_bf16 a[128:143], v[10:13], v[10:13], 0
v_mfma_f32_32x32x16_bf16 a[144:159], v[10:13], v[10:13], 0
v_mfma_f32_32x32x16_bf16 a[160:175], v[10:13], v[10:13], 0
v_mfma_f32_32x32x16_bf16 a[176:191], v[10:13], v[10:13], 0
s_cmp_eq_u32 s37, 0
s_cbranch_scc0 mega_kernel_t1_entry
mega_kernel_t0_entry:
s_waitcnt vmcnt(20) lgkmcnt(0)
s_barrier
ds_read_b128 a[192:195], v32 offset:0
ds_read_b128 a[196:199], v33 offset:0
ds_read_b128 a[200:203], v32 offset:2048
ds_read_b128 a[204:207], v33 offset:2048
ds_read_b128 a[208:211], v32 offset:4096
ds_read_b128 a[212:215], v33 offset:4096
ds_read_b128 a[216:219], v32 offset:6144
ds_read_b128 a[220:223], v33 offset:6144
ds_read_b64_tr_b16 a[0:1], v34 offset:0
ds_read_b64_tr_b16 a[2:3], v34 offset:2048
ds_read_b64_tr_b16 a[4:5], v34 offset:16384
ds_read_b64_tr_b16 a[6:7], v34 offset:18432
ds_read_b64_tr_b16 a[8:9], v35 offset:0
ds_read_b64_tr_b16 a[10:11], v35 offset:2048
ds_read_b64_tr_b16 a[12:13], v35 offset:16384
ds_read_b64_tr_b16 a[14:15], v35 offset:18432
ds_read_b64_tr_b16 a[16:17], v36 offset:0
ds_read_b64_tr_b16 a[18:19], v36 offset:2048
ds_read_b64_tr_b16 a[20:21], v36 offset:16384
ds_read_b64_tr_b16 a[22:23], v36 offset:18432
ds_read_b64_tr_b16 a[24:25], v37 offset:0
ds_read_b64_tr_b16 a[26:27], v37 offset:2048
ds_read_b64_tr_b16 a[28:29], v37 offset:16384
ds_read_b64_tr_b16 a[30:31], v37 offset:18432
ds_read_b64_tr_b16 a[32:33], v38 offset:0
ds_read_b64_tr_b16 a[34:35], v38 offset:2048
ds_read_b64_tr_b16 a[36:37], v38 offset:16384
ds_read_b64_tr_b16 a[38:39], v38 offset:18432
ds_read_b64_tr_b16 a[40:41], v39 offset:0
ds_read_b64_tr_b16 a[42:43], v39 offset:2048
ds_read_b64_tr_b16 a[44:45], v39 offset:16384
ds_read_b64_tr_b16 a[46:47], v39 offset:18432
ds_read_b64_tr_b16 a[48:49], v40 offset:0
ds_read_b64_tr_b16 a[50:51], v40 offset:2048
ds_read_b64_tr_b16 a[52:53], v40 offset:16384
ds_read_b64_tr_b16 a[54:55], v40 offset:18432
ds_read_b64_tr_b16 a[56:57], v41 offset:0
ds_read_b64_tr_b16 a[58:59], v41 offset:2048
ds_read_b64_tr_b16 a[60:61], v41 offset:16384
ds_read_b64_tr_b16 a[62:63], v41 offset:18432
mega_kernel_t0_bz:
s_waitcnt lgkmcnt(0)
v_mfma_f32_16x16x32_bf16 v[64:67], a[0:3], a[192:195], v[64:67]
ds_read_b128 a[224:227], v32 offset:8192
v_mfma_f32_16x16x32_bf16 v[64:67], a[4:7], a[196:199], v[64:67]
v_mfma_f32_16x16x32_bf16 v[68:71], a[8:11], a[192:195], v[68:71]
v_mfma_f32_16x16x32_bf16 v[68:71], a[12:15], a[196:199], v[68:71]
ds_read_b128 a[228:231], v33 offset:8192
v_mfma_f32_16x16x32_bf16 v[72:75], a[16:19], a[192:195], v[72:75]
v_mfma_f32_16x16x32_bf16 v[72:75], a[20:23], a[196:199], v[72:75]
v_mfma_f32_16x16x32_bf16 v[76:79], a[24:27], a[192:195], v[76:79]
v_mfma_f32_16x16x32_bf16 v[76:79], a[28:31], a[196:199], v[76:79]
buffer_load_dword v45, v46, s[68:71], s72 offen
v_mfma_f32_16x16x32_bf16 v[80:83], a[32:35], a[192:195], v[80:83]
ds_read_b128 a[232:235], v32 offset:10240
v_mfma_f32_16x16x32_bf16 v[80:83], a[36:39], a[196:199], v[80:83]
s_add_u32 s72, s72, s73
v_mfma_f32_16x16x32_bf16 v[84:87], a[40:43], a[192:195], v[84:87]
v_mfma_f32_16x16x32_bf16 v[84:87], a[44:47], a[196:199], v[84:87]
v_mfma_f32_16x16x32_bf16 v[88:91], a[48:51], a[192:195], v[88:91]
v_mfma_f32_16x16x32_bf16 v[88:91], a[52:55], a[196:199], v[88:91]
ds_read_b128 a[236:239], v33 offset:10240
v_mfma_f32_16x16x32_bf16 v[92:95], a[56:59], a[192:195], v[92:95]
v_mfma_f32_16x16x32_bf16 v[92:95], a[60:63], a[196:199], v[92:95]
buffer_load_dword v45, v47, s[80:83], s86 offen
v_mfma_f32_16x16x32_bf16 v[96:99], a[0:3], a[200:203], v[96:99]
v_mfma_f32_16x16x32_bf16 v[96:99], a[4:7], a[204:207], v[96:99]
s_add_u32 s86, s86, s87
v_mfma_f32_16x16x32_bf16 v[100:103], a[8:11], a[200:203], v[100:103]
ds_read_b128 a[240:243], v32 offset:12288
v_mfma_f32_16x16x32_bf16 v[100:103], a[12:15], a[204:207], v[100:103]
v_mfma_f32_16x16x32_bf16 v[104:107], a[16:19], a[200:203], v[104:107]
v_mfma_f32_16x16x32_bf16 v[104:107], a[20:23], a[204:207], v[104:107]
v_mfma_f32_16x16x32_bf16 v[108:111], a[24:27], a[200:203], v[108:111]
v_mfma_f32_16x16x32_bf16 v[108:111], a[28:31], a[204:207], v[108:111]
ds_read_b128 a[244:247], v33 offset:12288
v_mfma_f32_16x16x32_bf16 v[112:115], a[32:35], a[200:203], v[112:115]
v_mfma_f32_16x16x32_bf16 v[112:115], a[36:39], a[204:207], v[112:115]
v_mfma_f32_16x16x32_bf16 v[116:119], a[40:43], a[200:203], v[116:119]
v_mfma_f32_16x16x32_bf16 v[116:119], a[44:47], a[204:207], v[116:119]
v_mfma_f32_16x16x32_bf16 v[120:123], a[48:51], a[200:203], v[120:123]
ds_read_b128 a[248:251], v32 offset:14336
v_mfma_f32_16x16x32_bf16 v[120:123], a[52:55], a[204:207], v[120:123]
v_mfma_f32_16x16x32_bf16 v[124:127], a[56:59], a[200:203], v[124:127]
v_mfma_f32_16x16x32_bf16 v[124:127], a[60:63], a[204:207], v[124:127]
v_mfma_f32_16x16x32_bf16 v[128:131], a[0:3], a[208:211], v[128:131]
v_mfma_f32_16x16x32_bf16 v[128:131], a[4:7], a[212:215], v[128:131]
ds_read_b128 a[252:255], v33 offset:14336
v_mfma_f32_16x16x32_bf16 v[132:135], a[8:11], a[208:211], v[132:135]
v_mfma_f32_16x16x32_bf16 v[132:135], a[12:15], a[212:215], v[132:135]
v_mfma_f32_16x16x32_bf16 v[136:139], a[16:19], a[208:211], v[136:139]
v_mfma_f32_16x16x32_bf16 v[136:139], a[20:23], a[212:215], v[136:139]
v_mfma_f32_16x16x32_bf16 v[140:143], a[24:27], a[208:211], v[140:143]
v_mfma_f32_16x16x32_bf16 v[140:143], a[28:31], a[212:215], v[140:143]
v_mfma_f32_16x16x32_bf16 v[144:147], a[32:35], a[208:211], v[144:147]
v_mfma_f32_16x16x32_bf16 v[144:147], a[36:39], a[212:215], v[144:147]
v_mfma_f32_16x16x32_bf16 v[148:151], a[40:43], a[208:211], v[148:151]
v_mfma_f32_16x16x32_bf16 v[148:151], a[44:47], a[212:215], v[148:151]
v_mfma_f32_16x16x32_bf16 v[152:155], a[48:51], a[208:211], v[152:155]
v_mfma_f32_16x16x32_bf16 v[152:155], a[52:55], a[212:215], v[152:155]
v_mfma_f32_16x16x32_bf16 v[156:159], a[56:59], a[208:211], v[156:159]
v_mfma_f32_16x16x32_bf16 v[156:159], a[60:63], a[212:215], v[156:159]
v_mfma_f32_16x16x32_bf16 v[160:163], a[0:3], a[216:219], v[160:163]
v_mfma_f32_16x16x32_bf16 v[160:163], a[4:7], a[220:223], v[160:163]
v_mfma_f32_16x16x32_bf16 v[164:167], a[8:11], a[216:219], v[164:167]
v_mfma_f32_16x16x32_bf16 v[164:167], a[12:15], a[220:223], v[164:167]
v_mfma_f32_16x16x32_bf16 v[168:171], a[16:19], a[216:219], v[168:171]
v_mfma_f32_16x16x32_bf16 v[168:171], a[20:23], a[220:223], v[168:171]
v_mfma_f32_16x16x32_bf16 v[172:175], a[24:27], a[216:219], v[172:175]
v_mfma_f32_16x16x32_bf16 v[172:175], a[28:31], a[220:223], v[172:175]
v_mfma_f32_16x16x32_bf16 v[176:179], a[32:35], a[216:219], v[176:179]
v_mfma_f32_16x16x32_bf16 v[176:179], a[36:39], a[220:223], v[176:179]
v_mfma_f32_16x16x32_bf16 v[180:183], a[40:43], a[216:219], v[180:183]
v_mfma_f32_16x16x32_bf16 v[180:183], a[44:47], a[220:223], v[180:183]
v_mfma_f32_16x16x32_bf16 v[184:187], a[48:51], a[216:219], v[184:187]
v_mfma_f32_16x16x32_bf16 v[184:187], a[52:55], a[220:223], v[184:187]
v_mfma_f32_16x16x32_bf16 v[188:191], a[56:59], a[216:219], v[188:191]
s_cmp_eq_u32 s21, s39
v_mfma_f32_16x16x32_bf16 v[188:191], a[60:63], a[220:223], v[188:191]
s_waitcnt vmcnt(2) lgkmcnt(0)
s_barrier
v_mfma_f32_16x16x32_bf16 v[192:195], a[0:3], a[224:227], v[192:195]
s_cbranch_scc1 mega_kernel_t0_hk0
mega_kernel_t0_hkr0:
v_mfma_f32_16x16x32_bf16 v[192:195], a[4:7], a[228:231], v[192:195]
s_add_u32 m0, s25, 0
ds_read_b128 a[192:195], v32 offset:32768
v_mfma_f32_16x16x32_bf16 v[196:199], a[8:11], a[224:227], v[196:199]
buffer_load_dwordx4 v24, s[8:11], s19 offen offset:0 lds
v_mfma_f32_16x16x32_bf16 v[196:199], a[12:15], a[228:231], v[196:199]
ds_read_b128 a[196:199], v33 offset:32768
v_mfma_f32_16x16x32_bf16 v[200:203], a[16:19], a[224:227], v[200:203]
ds_read_b64_tr_b16 a[64:65], v34 offset:32768
v_mfma_f32_16x16x32_bf16 v[200:203], a[20:23], a[228:231], v[200:203]
ds_read_b64_tr_b16 a[66:67], v34 offset:34816
v_mfma_f32_16x16x32_bf16 v[204:207], a[24:27], a[224:227], v[204:207]
buffer_load_dwordx4 v25, s[8:11], s19 offen offset:1024 lds
v_mfma_f32_16x16x32_bf16 v[204:207], a[28:31], a[228:231], v[204:207]
ds_read_b64_tr_b16 a[68:69], v34 offset:49152
v_mfma_f32_16x16x32_bf16 v[208:211], a[32:35], a[224:227], v[208:211]
ds_read_b64_tr_b16 a[70:71], v34 offset:51200
v_mfma_f32_16x16x32_bf16 v[208:211], a[36:39], a[228:231], v[208:211]
ds_read_b64_tr_b16 a[72:73], v35 offset:32768
v_mfma_f32_16x16x32_bf16 v[212:215], a[40:43], a[224:227], v[212:215]
buffer_load_dwordx4 v26, s[8:11], s19 offen offset:2048 lds
v_mfma_f32_16x16x32_bf16 v[212:215], a[44:47], a[228:231], v[212:215]
ds_read_b64_tr_b16 a[74:75], v35 offset:34816
v_mfma_f32_16x16x32_bf16 v[216:219], a[48:51], a[224:227], v[216:219]
ds_read_b64_tr_b16 a[76:77], v35 offset:49152
v_mfma_f32_16x16x32_bf16 v[216:219], a[52:55], a[228:231], v[216:219]
ds_read_b64_tr_b16 a[78:79], v35 offset:51200
v_mfma_f32_16x16x32_bf16 v[220:223], a[56:59], a[224:227], v[220:223]
buffer_load_dwordx4 v27, s[8:11], s19 offen offset:3072 lds
v_mfma_f32_16x16x32_bf16 v[220:223], a[60:63], a[228:231], v[220:223]
ds_read_b64_tr_b16 a[80:81], v36 offset:32768
v_mfma_f32_16x16x32_bf16 v[224:227], a[0:3], a[232:235], v[224:227]
ds_read_b64_tr_b16 a[82:83], v36 offset:34816
v_mfma_f32_16x16x32_bf16 v[224:227], a[4:7], a[236:239], v[224:227]
s_add_u32 m0, s25, 4096
ds_read_b64_tr_b16 a[84:85], v36 offset:49152
v_mfma_f32_16x16x32_bf16 v[228:231], a[8:11], a[232:235], v[228:231]
buffer_load_dwordx4 v28, s[8:11], s19 offen offset:0 lds
v_mfma_f32_16x16x32_bf16 v[228:231], a[12:15], a[236:239], v[228:231]
ds_read_b64_tr_b16 a[86:87], v36 offset:51200
v_mfma_f32_16x16x32_bf16 v[232:235], a[16:19], a[232:235], v[232:235]
ds_read_b64_tr_b16 a[88:89], v37 offset:32768
v_mfma_f32_16x16x32_bf16 v[232:235], a[20:23], a[236:239], v[232:235]
ds_read_b64_tr_b16 a[90:91], v37 offset:34816
v_mfma_f32_16x16x32_bf16 v[236:239], a[24:27], a[232:235], v[236:239]
buffer_load_dwordx4 v29, s[8:11], s19 offen offset:1024 lds
v_mfma_f32_16x16x32_bf16 v[236:239], a[28:31], a[236:239], v[236:239]
ds_read_b64_tr_b16 a[92:93], v37 offset:49152
v_mfma_f32_16x16x32_bf16 v[240:243], a[32:35], a[232:235], v[240:243]
ds_read_b64_tr_b16 a[94:95], v37 offset:51200
v_mfma_f32_16x16x32_bf16 v[240:243], a[36:39], a[236:239], v[240:243]
ds_read_b64_tr_b16 a[96:97], v38 offset:32768
v_mfma_f32_16x16x32_bf16 v[244:247], a[40:43], a[232:235], v[244:247]
buffer_load_dwordx4 v30, s[8:11], s19 offen offset:2048 lds
v_mfma_f32_16x16x32_bf16 v[244:247], a[44:47], a[236:239], v[244:247]
ds_read_b64_tr_b16 a[98:99], v38 offset:34816
v_mfma_f32_16x16x32_bf16 v[248:251], a[48:51], a[232:235], v[248:251]
ds_read_b64_tr_b16 a[100:101], v38 offset:49152
v_mfma_f32_16x16x32_bf16 v[248:251], a[52:55], a[236:239], v[248:251]
ds_read_b64_tr_b16 a[102:103], v38 offset:51200
v_mfma_f32_16x16x32_bf16 v[252:255], a[56:59], a[232:235], v[252:255]
buffer_load_dwordx4 v31, s[8:11], s19 offen offset:3072 lds
v_mfma_f32_16x16x32_bf16 v[252:255], a[60:63], a[236:239], v[252:255]
ds_read_b64_tr_b16 a[104:105], v39 offset:32768
v_mfma_f32_16x16x32_bf16 a[128:131], a[0:3], a[240:243], a[128:131]
ds_read_b64_tr_b16 a[106:107], v39 offset:34816
v_mfma_f32_16x16x32_bf16 a[128:131], a[4:7], a[244:247], a[128:131]
s_add_u32 m0, s24, 0
s_add_u32 s19, s19, s23
ds_read_b64_tr_b16 a[108:109], v39 offset:49152
v_mfma_f32_16x16x32_bf16 a[132:135], a[8:11], a[240:243], a[132:135]
buffer_load_dwordx4 v16, s[4:7], s18 offen offset:0 lds
v_mfma_f32_16x16x32_bf16 a[132:135], a[12:15], a[244:247], a[132:135]
ds_read_b64_tr_b16 a[110:111], v39 offset:51200
v_mfma_f32_16x16x32_bf16 a[136:139], a[16:19], a[240:243], a[136:139]
ds_read_b64_tr_b16 a[112:113], v40 offset:32768
v_mfma_f32_16x16x32_bf16 a[136:139], a[20:23], a[244:247], a[136:139]
ds_read_b64_tr_b16 a[114:115], v40 offset:34816
v_mfma_f32_16x16x32_bf16 a[140:143], a[24:27], a[240:243], a[140:143]
buffer_load_dwordx4 v17, s[4:7], s18 offen offset:1024 lds
v_mfma_f32_16x16x32_bf16 a[140:143], a[28:31], a[244:247], a[140:143]
ds_read_b64_tr_b16 a[116:117], v40 offset:49152
v_mfma_f32_16x16x32_bf16 a[144:147], a[32:35], a[240:243], a[144:147]
ds_read_b64_tr_b16 a[118:119], v40 offset:51200
v_mfma_f32_16x16x32_bf16 a[144:147], a[36:39], a[244:247], a[144:147]
ds_read_b64_tr_b16 a[120:121], v41 offset:32768
v_mfma_f32_16x16x32_bf16 a[148:151], a[40:43], a[240:243], a[148:151]
buffer_load_dwordx4 v18, s[4:7], s18 offen offset:2048 lds
v_mfma_f32_16x16x32_bf16 a[148:151], a[44:47], a[244:247], a[148:151]
ds_read_b64_tr_b16 a[122:123], v41 offset:34816
v_mfma_f32_16x16x32_bf16 a[152:155], a[48:51], a[240:243], a[152:155]
ds_read_b64_tr_b16 a[124:125], v41 offset:49152
v_mfma_f32_16x16x32_bf16 a[152:155], a[52:55], a[244:247], a[152:155]
ds_read_b64_tr_b16 a[126:127], v41 offset:51200
v_mfma_f32_16x16x32_bf16 a[156:159], a[56:59], a[240:243], a[156:159]
buffer_load_dwordx4 v19, s[4:7], s18 offen offset:3072 lds
v_mfma_f32_16x16x32_bf16 a[156:159], a[60:63], a[244:247], a[156:159]
ds_read_b128 a[200:203], v32 offset:34816
v_mfma_f32_16x16x32_bf16 a[160:163], a[0:3], a[248:251], a[160:163]
ds_read_b128 a[204:207], v33 offset:34816
v_mfma_f32_16x16x32_bf16 a[160:163], a[4:7], a[252:255], a[160:163]
s_add_u32 m0, s24, 4096
ds_read_b128 a[208:211], v32 offset:36864
v_mfma_f32_16x16x32_bf16 a[164:167], a[8:11], a[248:251], a[164:167]
buffer_load_dwordx4 v20, s[4:7], s18 offen offset:0 lds
v_mfma_f32_16x16x32_bf16 a[164:167], a[12:15], a[252:255], a[164:167]
ds_read_b128 a[212:215], v33 offset:36864
v_mfma_f32_16x16x32_bf16 a[168:171], a[16:19], a[248:251], a[168:171]
ds_read_b128 a[216:219], v32 offset:38912
v_mfma_f32_16x16x32_bf16 a[168:171], a[20:23], a[252:255], a[168:171]
ds_read_b128 a[220:223], v33 offset:38912
v_mfma_f32_16x16x32_bf16 a[172:175], a[24:27], a[248:251], a[172:175]
buffer_load_dwordx4 v21, s[4:7], s18 offen offset:1024 lds
v_mfma_f32_16x16x32_bf16 a[172:175], a[28:31], a[252:255], a[172:175]
v_mfma_f32_16x16x32_bf16 a[176:179], a[32:35], a[248:251], a[176:179]
v_mfma_f32_16x16x32_bf16 a[176:179], a[36:39], a[252:255], a[176:179]
v_mfma_f32_16x16x32_bf16 a[180:183], a[40:43], a[248:251], a[180:183]
buffer_load_dwordx4 v22, s[4:7], s18 offen offset:2048 lds
v_mfma_f32_16x16x32_bf16 a[180:183], a[44:47], a[252:255], a[180:183]
v_mfma_f32_16x16x32_bf16 a[184:187], a[48:51], a[248:251], a[184:187]
v_mfma_f32_16x16x32_bf16 a[184:187], a[52:55], a[252:255], a[184:187]
buffer_load_dwordx4 v23, s[4:7], s18 offen offset:3072 lds
v_mfma_f32_16x16x32_bf16 a[188:191], a[56:59], a[248:251], a[188:191]
s_add_u32 s18, s18, 128
s_cmp_eq_u32 s21, s38
v_mfma_f32_16x16x32_bf16 a[188:191], a[60:63], a[252:255], a[188:191]
s_cbranch_scc1 mega_kernel_t0_epi
s_add_u32 s21, s21, 1
s_waitcnt lgkmcnt(0)
v_mfma_f32_16x16x32_bf16 v[64:67], a[64:67], a[192:195], v[64:67]
ds_read_b128 a[224:227], v32 offset:40960
v_mfma_f32_16x16x32_bf16 v[64:67], a[68:71], a[196:199], v[64:67]
v_mfma_f32_16x16x32_bf16 v[68:71], a[72:75], a[192:195], v[68:71]
v_mfma_f32_16x16x32_bf16 v[68:71], a[76:79], a[196:199], v[68:71]
ds_read_b128 a[228:231], v33 offset:40960
v_mfma_f32_16x16x32_bf16 v[72:75], a[80:83], a[192:195], v[72:75]
v_mfma_f32_16x16x32_bf16 v[72:75], a[84:87], a[196:199], v[72:75]
v_mfma_f32_16x16x32_bf16 v[76:79], a[88:91], a[192:195], v[76:79]
v_mfma_f32_16x16x32_bf16 v[76:79], a[92:95], a[196:199], v[76:79]
buffer_load_dword v45, v46, s[68:71], s72 offen
v_mfma_f32_16x16x32_bf16 v[80:83], a[96:99], a[192:195], v[80:83]
ds_read_b128 a[232:235], v32 offset:43008
v_mfma_f32_16x16x32_bf16 v[80:83], a[100:103], a[196:199], v[80:83]
s_add_u32 s72, s72, s73
v_mfma_f32_16x16x32_bf16 v[84:87], a[104:107], a[192:195], v[84:87]
v_mfma_f32_16x16x32_bf16 v[84:87], a[108:111], a[196:199], v[84:87]
v_mfma_f32_16x16x32_bf16 v[88:91], a[112:115], a[192:195], v[88:91]
v_mfma_f32_16x16x32_bf16 v[88:91], a[116:119], a[196:199], v[88:91]
ds_read_b128 a[236:239], v33 offset:43008
v_mfma_f32_16x16x32_bf16 v[92:95], a[120:123], a[192:195], v[92:95]
v_mfma_f32_16x16x32_bf16 v[92:95], a[124:127], a[196:199], v[92:95]
buffer_load_dword v45, v47, s[80:83], s86 offen
v_mfma_f32_16x16x32_bf16 v[96:99], a[64:67], a[200:203], v[96:99]
v_mfma_f32_16x16x32_bf16 v[96:99], a[68:71], a[204:207], v[96:99]
s_add_u32 s86, s86, s87
v_mfma_f32_16x16x32_bf16 v[100:103], a[72:75], a[200:203], v[100:103]
ds_read_b128 a[240:243], v32 offset:45056
v_mfma_f32_16x16x32_bf16 v[100:103], a[76:79], a[204:207], v[100:103]
v_mfma_f32_16x16x32_bf16 v[104:107], a[80:83], a[200:203], v[104:107]
v_mfma_f32_16x16x32_bf16 v[104:107], a[84:87], a[204:207], v[104:107]
v_mfma_f32_16x16x32_bf16 v[108:111], a[88:91], a[200:203], v[108:111]
v_mfma_f32_16x16x32_bf16 v[108:111], a[92:95], a[204:207], v[108:111]
ds_read_b128 a[244:247], v33 offset:45056
v_mfma_f32_16x16x32_bf16 v[112:115], a[96:99], a[200:203], v[112:115]
v_mfma_f32_16x16x32_bf16 v[112:115], a[100:103], a[204:207], v[112:115]
v_mfma_f32_16x16x32_bf16 v[116:119], a[104:107], a[200:203], v[116:119]
v_mfma_f32_16x16x32_bf16 v[116:119], a[108:111], a[204:207], v[116:119]
v_mfma_f32_16x16x32_bf16 v[120:123], a[112:115], a[200:203], v[120:123]
ds_read_b128 a[248:251], v32 offset:47104
v_mfma_f32_16x16x32_bf16 v[120:123], a[116:119], a[204:207], v[120:123]
v_mfma_f32_16x16x32_bf16 v[124:127], a[120:123], a[200:203], v[124:127]
v_mfma_f32_16x16x32_bf16 v[124:127], a[124:127], a[204:207], v[124:127]
v_mfma_f32_16x16x32_bf16 v[128:131], a[64:67], a[208:211], v[128:131]
v_mfma_f32_16x16x32_bf16 v[128:131], a[68:71], a[212:215], v[128:131]
ds_read_b128 a[252:255], v33 offset:47104
v_mfma_f32_16x16x32_bf16 v[132:135], a[72:75], a[208:211], v[132:135]
v_mfma_f32_16x16x32_bf16 v[132:135], a[76:79], a[212:215], v[132:135]
v_mfma_f32_16x16x32_bf16 v[136:139], a[80:83], a[208:211], v[136:139]
v_mfma_f32_16x16x32_bf16 v[136:139], a[84:87], a[212:215], v[136:139]
v_mfma_f32_16x16x32_bf16 v[140:143], a[88:91], a[208:211], v[140:143]
v_mfma_f32_16x16x32_bf16 v[140:143], a[92:95], a[212:215], v[140:143]
v_mfma_f32_16x16x32_bf16 v[144:147], a[96:99], a[208:211], v[144:147]
v_mfma_f32_16x16x32_bf16 v[144:147], a[100:103], a[212:215], v[144:147]
v_mfma_f32_16x16x32_bf16 v[148:151], a[104:107], a[208:211], v[148:151]
v_mfma_f32_16x16x32_bf16 v[148:151], a[108:111], a[212:215], v[148:151]
v_mfma_f32_16x16x32_bf16 v[152:155], a[112:115], a[208:211], v[152:155]
v_mfma_f32_16x16x32_bf16 v[152:155], a[116:119], a[212:215], v[152:155]
v_mfma_f32_16x16x32_bf16 v[156:159], a[120:123], a[208:211], v[156:159]
v_mfma_f32_16x16x32_bf16 v[156:159], a[124:127], a[212:215], v[156:159]
v_mfma_f32_16x16x32_bf16 v[160:163], a[64:67], a[216:219], v[160:163]
v_mfma_f32_16x16x32_bf16 v[160:163], a[68:71], a[220:223], v[160:163]
v_mfma_f32_16x16x32_bf16 v[164:167], a[72:75], a[216:219], v[164:167]
v_mfma_f32_16x16x32_bf16 v[164:167], a[76:79], a[220:223], v[164:167]
v_mfma_f32_16x16x32_bf16 v[168:171], a[80:83], a[216:219], v[168:171]
v_mfma_f32_16x16x32_bf16 v[168:171], a[84:87], a[220:223], v[168:171]
v_mfma_f32_16x16x32_bf16 v[172:175], a[88:91], a[216:219], v[172:175]
v_mfma_f32_16x16x32_bf16 v[172:175], a[92:95], a[220:223], v[172:175]
v_mfma_f32_16x16x32_bf16 v[176:179], a[96:99], a[216:219], v[176:179]
v_mfma_f32_16x16x32_bf16 v[176:179], a[100:103], a[220:223], v[176:179]
v_mfma_f32_16x16x32_bf16 v[180:183], a[104:107], a[216:219], v[180:183]
v_mfma_f32_16x16x32_bf16 v[180:183], a[108:111], a[220:223], v[180:183]
v_mfma_f32_16x16x32_bf16 v[184:187], a[112:115], a[216:219], v[184:187]
v_mfma_f32_16x16x32_bf16 v[184:187], a[116:119], a[220:223], v[184:187]
v_mfma_f32_16x16x32_bf16 v[188:191], a[120:123], a[216:219], v[188:191]
s_cmp_eq_u32 s21, s39
v_mfma_f32_16x16x32_bf16 v[188:191], a[124:127], a[220:223], v[188:191]
s_waitcnt vmcnt(2) lgkmcnt(0)
s_barrier
v_mfma_f32_16x16x32_bf16 v[192:195], a[64:67], a[224:227], v[192:195]
s_cbranch_scc1 mega_kernel_t0_hk1
mega_kernel_t0_hkr1:
v_mfma_f32_16x16x32_bf16 v[192:195], a[68:71], a[228:231], v[192:195]
s_add_u32 m0, s25, 32768
ds_read_b128 a[192:195], v32 offset:0
v_mfma_f32_16x16x32_bf16 v[196:199], a[72:75], a[224:227], v[196:199]
buffer_load_dwordx4 v24, s[8:11], s19 offen offset:0 lds
v_mfma_f32_16x16x32_bf16 v[196:199], a[76:79], a[228:231], v[196:199]
ds_read_b128 a[196:199], v33 offset:0
v_mfma_f32_16x16x32_bf16 v[200:203], a[80:83], a[224:227], v[200:203]
ds_read_b64_tr_b16 a[0:1], v34 offset:0
v_mfma_f32_16x16x32_bf16 v[200:203], a[84:87], a[228:231], v[200:203]
ds_read_b64_tr_b16 a[2:3], v34 offset:2048
v_mfma_f32_16x16x32_bf16 v[204:207], a[88:91], a[224:227], v[204:207]
buffer_load_dwordx4 v25, s[8:11], s19 offen offset:1024 lds
v_mfma_f32_16x16x32_bf16 v[204:207], a[92:95], a[228:231], v[204:207]
ds_read_b64_tr_b16 a[4:5], v34 offset:16384
v_mfma_f32_16x16x32_bf16 v[208:211], a[96:99], a[224:227], v[208:211]
ds_read_b64_tr_b16 a[6:7], v34 offset:18432
v_mfma_f32_16x16x32_bf16 v[208:211], a[100:103], a[228:231], v[208:211]
ds_read_b64_tr_b16 a[8:9], v35 offset:0
v_mfma_f32_16x16x32_bf16 v[212:215], a[104:107], a[224:227], v[212:215]
buffer_load_dwordx4 v26, s[8:11], s19 offen offset:2048 lds
v_mfma_f32_16x16x32_bf16 v[212:215], a[108:111], a[228:231], v[212:215]
ds_read_b64_tr_b16 a[10:11], v35 offset:2048
v_mfma_f32_16x16x32_bf16 v[216:219], a[112:115], a[224:227], v[216:219]
ds_read_b64_tr_b16 a[12:13], v35 offset:16384
v_mfma_f32_16x16x32_bf16 v[216:219], a[116:119], a[228:231], v[216:219]
ds_read_b64_tr_b16 a[14:15], v35 offset:18432
v_mfma_f32_16x16x32_bf16 v[220:223], a[120:123], a[224:227], v[220:223]
buffer_load_dwordx4 v27, s[8:11], s19 offen offset:3072 lds
v_mfma_f32_16x16x32_bf16 v[220:223], a[124:127], a[228:231], v[220:223]
ds_read_b64_tr_b16 a[16:17], v36 offset:0
v_mfma_f32_16x16x32_bf16 v[224:227], a[64:67], a[232:235], v[224:227]
ds_read_b64_tr_b16 a[18:19], v36 offset:2048
v_mfma_f32_16x16x32_bf16 v[224:227], a[68:71], a[236:239], v[224:227]
s_add_u32 m0, s25, 36864
ds_read_b64_tr_b16 a[20:21], v36 offset:16384
v_mfma_f32_16x16x32_bf16 v[228:231], a[72:75], a[232:235], v[228:231]
buffer_load_dwordx4 v28, s[8:11], s19 offen offset:0 lds
v_mfma_f32_16x16x32_bf16 v[228:231], a[76:79], a[236:239], v[228:231]
ds_read_b64_tr_b16 a[22:23], v36 offset:18432
v_mfma_f32_16x16x32_bf16 v[232:235], a[80:83], a[232:235], v[232:235]
ds_read_b64_tr_b16 a[24:25], v37 offset:0
v_mfma_f32_16x16x32_bf16 v[232:235], a[84:87], a[236:239], v[232:235]
ds_read_b64_tr_b16 a[26:27], v37 offset:2048
v_mfma_f32_16x16x32_bf16 v[236:239], a[88:91], a[232:235], v[236:239]
buffer_load_dwordx4 v29, s[8:11], s19 offen offset:1024 lds
v_mfma_f32_16x16x32_bf16 v[236:239], a[92:95], a[236:239], v[236:239]
ds_read_b64_tr_b16 a[28:29], v37 offset:16384
v_mfma_f32_16x16x32_bf16 v[240:243], a[96:99], a[232:235], v[240:243]
ds_read_b64_tr_b16 a[30:31], v37 offset:18432
v_mfma_f32_16x16x32_bf16 v[240:243], a[100:103], a[236:239], v[240:243]
ds_read_b64_tr_b16 a[32:33], v38 offset:0
v_mfma_f32_16x16x32_bf16 v[244:247], a[104:107], a[232:235], v[244:247]
buffer_load_dwordx4 v30, s[8:11], s19 offen offset:2048 lds
v_mfma_f32_16x16x32_bf16 v[244:247], a[108:111], a[236:239], v[244:247]
ds_read_b64_tr_b16 a[34:35], v38 offset:2048
v_mfma_f32_16x16x32_bf16 v[248:251], a[112:115], a[232:235], v[248:251]
ds_read_b64_tr_b16 a[36:37], v38 offset:16384
v_mfma_f32_16x16x32_bf16 v[248:251], a[116:119], a[236:239], v[248:251]
ds_read_b64_tr_b16 a[38:39], v38 offset:18432
v_mfma_f32_16x16x32_bf16 v[252:255], a[120:123], a[232:235], v[252:255]
buffer_load_dwordx4 v31, s[8:11], s19 offen offset:3072 lds
v_mfma_f32_16x16x32_bf16 v[252:255], a[124:127], a[236:239], v[252:255]
ds_read_b64_tr_b16 a[40:41], v39 offset:0
v_mfma_f32_16x16x32_bf16 a[128:131], a[64:67], a[240:243], a[128:131]
ds_read_b64_tr_b16 a[42:43], v39 offset:2048
v_mfma_f32_16x16x32_bf16 a[128:131], a[68:71], a[244:247], a[128:131]
s_add_u32 m0, s24, 32768
s_add_u32 s19, s19, s23
ds_read_b64_tr_b16 a[44:45], v39 offset:16384
v_mfma_f32_16x16x32_bf16 a[132:135], a[72:75], a[240:243], a[132:135]
buffer_load_dwordx4 v16, s[4:7], s18 offen offset:0 lds
v_mfma_f32_16x16x32_bf16 a[132:135], a[76:79], a[244:247], a[132:135]
ds_read_b64_tr_b16 a[46:47], v39 offset:18432
v_mfma_f32_16x16x32_bf16 a[136:139], a[80:83], a[240:243], a[136:139]
ds_read_b64_tr_b16 a[48:49], v40 offset:0
v_mfma_f32_16x16x32_bf16 a[136:139], a[84:87], a[244:247], a[136:139]
ds_read_b64_tr_b16 a[50:51], v40 offset:2048
v_mfma_f32_16x16x32_bf16 a[140:143], a[88:91], a[240:243], a[140:143]
buffer_load_dwordx4 v17, s[4:7], s18 offen offset:1024 lds
v_mfma_f32_16x16x32_bf16 a[140:143], a[92:95], a[244:247], a[140:143]
ds_read_b64_tr_b16 a[52:53], v40 offset:16384
v_mfma_f32_16x16x32_bf16 a[144:147], a[96:99], a[240:243], a[144:147]
ds_read_b64_tr_b16 a[54:55], v40 offset:18432
v_mfma_f32_16x16x32_bf16 a[144:147], a[100:103], a[244:247], a[144:147]
ds_read_b64_tr_b16 a[56:57], v41 offset:0
v_mfma_f32_16x16x32_bf16 a[148:151], a[104:107], a[240:243], a[148:151]
buffer_load_dwordx4 v18, s[4:7], s18 offen offset:2048 lds
v_mfma_f32_16x16x32_bf16 a[148:151], a[108:111], a[244:247], a[148:151]
ds_read_b64_tr_b16 a[58:59], v41 offset:2048
v_mfma_f32_16x16x32_bf16 a[152:155], a[112:115], a[240:243], a[152:155]
ds_read_b64_tr_b16 a[60:61], v41 offset:16384
v_mfma_f32_16x16x32_bf16 a[152:155], a[116:119], a[244:247], a[152:155]
ds_read_b64_tr_b16 a[62:63], v41 offset:18432
v_mfma_f32_16x16x32_bf16 a[156:159], a[120:123], a[240:243], a[156:159]
buffer_load_dwordx4 v19, s[4:7], s18 offen offset:3072 lds
v_mfma_f32_16x16x32_bf16 a[156:159], a[124:127], a[244:247], a[156:159]
ds_read_b128 a[200:203], v32 offset:2048
v_mfma_f32_16x16x32_bf16 a[160:163], a[64:67], a[248:251], a[160:163]
ds_read_b128 a[204:207], v33 offset:2048
v_mfma_f32_16x16x32_bf16 a[160:163], a[68:71], a[252:255], a[160:163]
s_add_u32 m0, s24, 36864
ds_read_b128 a[208:211], v32 offset:4096
v_mfma_f32_16x16x32_bf16 a[164:167], a[72:75], a[248:251], a[164:167]
buffer_load_dwordx4 v20, s[4:7], s18 offen offset:0 lds
v_mfma_f32_16x16x32_bf16 a[164:167], a[76:79], a[252:255], a[164:167]
ds_read_b128 a[212:215], v33 offset:4096
v_mfma_f32_16x16x32_bf16 a[168:171], a[80:83], a[248:251], a[168:171]
ds_read_b128 a[216:219], v32 offset:6144
v_mfma_f32_16x16x32_bf16 a[168:171], a[84:87], a[252:255], a[168:171]
ds_read_b128 a[220:223], v33 offset:6144
v_mfma_f32_16x16x32_bf16 a[172:175], a[88:91], a[248:251], a[172:175]
buffer_load_dwordx4 v21, s[4:7], s18 offen offset:1024 lds
v_mfma_f32_16x16x32_bf16 a[172:175], a[92:95], a[252:255], a[172:175]
v_mfma_f32_16x16x32_bf16 a[176:179], a[96:99], a[248:251], a[176:179]
v_mfma_f32_16x16x32_bf16 a[176:179], a[100:103], a[252:255], a[176:179]
v_mfma_f32_16x16x32_bf16 a[180:183], a[104:107], a[248:251], a[180:183]
buffer_load_dwordx4 v22, s[4:7], s18 offen offset:2048 lds
v_mfma_f32_16x16x32_bf16 a[180:183], a[108:111], a[252:255], a[180:183]
v_mfma_f32_16x16x32_bf16 a[184:187], a[112:115], a[248:251], a[184:187]
v_mfma_f32_16x16x32_bf16 a[184:187], a[116:119], a[252:255], a[184:187]
buffer_load_dwordx4 v23, s[4:7], s18 offen offset:3072 lds
v_mfma_f32_16x16x32_bf16 a[188:191], a[120:123], a[248:251], a[188:191]
s_add_u32 s18, s18, 128
s_cmp_eq_u32 s21, s38
v_mfma_f32_16x16x32_bf16 a[188:191], a[124:127], a[252:255], a[188:191]
s_cbranch_scc1 mega_kernel_t0_epi
s_add_u32 s21, s21, 1
s_branch mega_kernel_t0_bz
mega_kernel_t0_hk0:
s_cmp_eq_u32 s21, 14
s_cbranch_scc0 mega_kernel_t0_h0_b
s_mov_b32 s86, 0
s_mov_b32 s70, 0
s_mov_b32 s39, 16
s_branch mega_kernel_t0_hkr0
mega_kernel_t0_h0_b:
s_cmp_eq_u32 s89, 0
s_cbranch_scc0 mega_kernel_t0_h0_far
s_mov_b32 s8, s44
s_mov_b32 s9, s45
s_mov_b32 s10, s48
s_mov_b32 s6, 0
s_mov_b32 s19, 0
s_branch mega_kernel_t0_hkr0
mega_kernel_t0_epi:
s_cmp_eq_u32 s89, 0
s_cbranch_scc0 mega_kernel_t0_epi2
s_waitcnt lgkmcnt(0)
s_load_dwordx2 s[68:69], s[0:1], 24
s_load_dwordx2 s[48:49], s[0:1], 64
s_load_dwordx2 s[50:51], s[0:1], 16
s_lshl_b32 s18, s20, 13
s_lshr_b32 s41, s55, 1
s_sub_u32 s41, 15, s41
s_mul_i32 s61, s41, 114688
s_mov_b32 s70, 172032
s_lshl_b32 s25, s20, 12
s_add_u32 s25, s25, 32768
s_mov_b32 s65, 57344
v_lshrrev_b32 v2, 3, v1
s_lshl_b32 s64, s20, 5
v_add_u32 v2, s64, v2
v_mul_u32_u24 v2, 896, v2
v_and_b32 v3, 7, v1
v_lshrrev_b32 v4, 4, v1
v_xor_b32 v3, v3, v4
v_lshlrev_b32 v3, 4, v3
v_xor_b32 v4, 64, v3
v_add_u32 v14, v2, v3
v_add_u32 v4, v2, v4
v_add_u32 v15, 6144, v4
v_add_u32 v59, 12288, v14
v_add_u32 v61, 18432, v4
s_waitcnt lgkmcnt(0)
s_add_u32 s68, s68, s61
s_addc_u32 s69, s69, 0
s_sub_u32 s68, s68, 57344
s_subb_u32 s69, s69, 0
s_add_u32 m0, s25, 98304
s_nop 0
buffer_load_dwordx4 v14, s[68:71], s65 offen offset:0 lds
buffer_load_dwordx4 v15, s[68:71], s65 offen offset:1024 lds
buffer_load_dwordx4 v59, s[68:71], s65 offen offset:2048 lds
buffer_load_dwordx4 v61, s[68:71], s65 offen offset:3072 lds
s_add_u32 s65, s65, 128
s_add_u32 m0, s25, 114688
s_nop 0
buffer_load_dwordx4 v14, s[68:71], s65 offen offset:0 lds
buffer_load_dwordx4 v15, s[68:71], s65 offen offset:1024 lds
buffer_load_dwordx4 v59, s[68:71], s65 offen offset:2048 lds
buffer_load_dwordx4 v61, s[68:71], s65 offen offset:3072 lds
s_add_u32 s65, s65, 128
s_mul_i32 s86, s87, 3
buffer_load_dword v45, v47, s[80:83], s86 offen
s_add_u32 s86, s86, s87
buffer_load_dword v45, v47, s[80:83], s86 offen
s_add_u32 s86, s86, s87
buffer_load_dword v45, v47, s[80:83], s86 offen
s_add_u32 s86, s86, s87
buffer_load_dword v45, v47, s[80:83], s86 offen
s_add_u32 s86, s86, s87
v_mov_b32 v10, 0
v_mov_b32 v11, 0
v_mov_b32 v12, 0
v_mov_b32 v13, 0
v_cvt_pk_bf16_f32 v192, v192, v193
v_cvt_pk_bf16_f32 v193, v194, v195
v_cvt_pk_bf16_f32 v194, v196, v197
v_cvt_pk_bf16_f32 v195, v198, v199
v_cvt_pk_bf16_f32 v196, v200, v201
v_cvt_pk_bf16_f32 v197, v202, v203
v_cvt_pk_bf16_f32 v198, v204, v205
v_cvt_pk_bf16_f32 v199, v206, v207
v_cvt_pk_bf16_f32 v200, v208, v209
v_cvt_pk_bf16_f32 v201, v210, v211
v_cvt_pk_bf16_f32 v202, v212, v213
v_cvt_pk_bf16_f32 v203, v214, v215
v_cvt_pk_bf16_f32 v204, v216, v217
v_cvt_pk_bf16_f32 v205, v218, v219
v_cvt_pk_bf16_f32 v206, v220, v221
v_cvt_pk_bf16_f32 v207, v222, v223
v_cvt_pk_bf16_f32 v208, v224, v225
v_cvt_pk_bf16_f32 v209, v226, v227
v_cvt_pk_bf16_f32 v210, v228, v229
v_cvt_pk_bf16_f32 v211, v230, v231
v_cvt_pk_bf16_f32 v212, v232, v233
v_cvt_pk_bf16_f32 v213, v234, v235
v_cvt_pk_bf16_f32 v214, v236, v237
v_cvt_pk_bf16_f32 v215, v238, v239
v_cvt_pk_bf16_f32 v216, v240, v241
v_cvt_pk_bf16_f32 v217, v242, v243
v_cvt_pk_bf16_f32 v218, v244, v245
v_cvt_pk_bf16_f32 v219, v246, v247
v_cvt_pk_bf16_f32 v220, v248, v249
v_cvt_pk_bf16_f32 v221, v250, v251
v_cvt_pk_bf16_f32 v222, v252, v253
v_cvt_pk_bf16_f32 v223, v254, v255
v_accvgpr_read_b32 v2, a128
v_accvgpr_read_b32 v3, a129
v_accvgpr_read_b32 v4, a130
v_accvgpr_read_b32 v5, a131
v_accvgpr_read_b32 v6, a132
v_accvgpr_read_b32 v7, a133
v_accvgpr_read_b32 v8, a134
v_accvgpr_read_b32 v9, a135
v_cvt_pk_bf16_f32 v224, v2, v3
v_cvt_pk_bf16_f32 v225, v4, v5
v_cvt_pk_bf16_f32 v226, v6, v7
v_cvt_pk_bf16_f32 v227, v8, v9
v_accvgpr_read_b32 v2, a136
v_accvgpr_read_b32 v3, a137
v_accvgpr_read_b32 v4, a138
v_accvgpr_read_b32 v5, a139
v_accvgpr_read_b32 v6, a140
v_accvgpr_read_b32 v7, a141
v_accvgpr_read_b32 v8, a142
v_accvgpr_read_b32 v9, a143
v_cvt_pk_bf16_f32 v228, v2, v3
v_cvt_pk_bf16_f32 v229, v4, v5
v_cvt_pk_bf16_f32 v230, v6, v7
v_cvt_pk_bf16_f32 v231, v8, v9
v_accvgpr_read_b32 v2, a144
v_accvgpr_read_b32 v3, a145
v_accvgpr_read_b32 v4, a146
v_accvgpr_read_b32 v5, a147
v_accvgpr_read_b32 v6, a148
v_accvgpr_read_b32 v7, a149
v_accvgpr_read_b32 v8, a150
v_accvgpr_read_b32 v9, a151
v_cvt_pk_bf16_f32 v232, v2, v3
v_cvt_pk_bf16_f32 v233, v4, v5
v_cvt_pk_bf16_f32 v234, v6, v7
v_cvt_pk_bf16_f32 v235, v8, v9
v_accvgpr_read_b32 v2, a152
v_accvgpr_read_b32 v3, a153
v_accvgpr_read_b32 v4, a154
v_accvgpr_read_b32 v5, a155
v_accvgpr_read_b32 v6, a156
v_accvgpr_read_b32 v7, a157
v_accvgpr_read_b32 v8, a158
v_accvgpr_read_b32 v9, a159
v_cvt_pk_bf16_f32 v236, v2, v3
v_cvt_pk_bf16_f32 v237, v4, v5
v_cvt_pk_bf16_f32 v238, v6, v7
v_cvt_pk_bf16_f32 v239, v8, v9
v_accvgpr_read_b32 v2, a160
v_accvgpr_read_b32 v3, a161
v_accvgpr_read_b32 v4, a162
v_accvgpr_read_b32 v5, a163
v_accvgpr_read_b32 v6, a164
v_accvgpr_read_b32 v7, a165
v_accvgpr_read_b32 v8, a166
v_accvgpr_read_b32 v9, a167
v_cvt_pk_bf16_f32 v240, v2, v3
v_cvt_pk_bf16_f32 v241, v4, v5
v_cvt_pk_bf16_f32 v242, v6, v7
v_cvt_pk_bf16_f32 v243, v8, v9
v_accvgpr_read_b32 v2, a168
v_accvgpr_read_b32 v3, a169
v_accvgpr_read_b32 v4, a170
v_accvgpr_read_b32 v5, a171
v_accvgpr_read_b32 v6, a172
v_accvgpr_read_b32 v7, a173
v_accvgpr_read_b32 v8, a174
v_accvgpr_read_b32 v9, a175
v_cvt_pk_bf16_f32 v244, v2, v3
v_cvt_pk_bf16_f32 v245, v4, v5
v_cvt_pk_bf16_f32 v246, v6, v7
v_cvt_pk_bf16_f32 v247, v8, v9
v_accvgpr_read_b32 v2, a176
v_accvgpr_read_b32 v3, a177
v_accvgpr_read_b32 v4, a178
v_accvgpr_read_b32 v5, a179
v_accvgpr_read_b32 v6, a180
v_accvgpr_read_b32 v7, a181
v_accvgpr_read_b32 v8, a182
v_accvgpr_read_b32 v9, a183
v_cvt_pk_bf16_f32 v248, v2, v3
v_cvt_pk_bf16_f32 v249, v4, v5
v_cvt_pk_bf16_f32 v250, v6, v7
v_cvt_pk_bf16_f32 v251, v8, v9
v_accvgpr_read_b32 v2, a184
v_accvgpr_read_b32 v3, a185
v_accvgpr_read_b32 v4, a186
v_accvgpr_read_b32 v5, a187
v_accvgpr_read_b32 v6, a188
v_accvgpr_read_b32 v7, a189
v_accvgpr_read_b32 v8, a190
v_accvgpr_read_b32 v9, a191
v_cvt_pk_bf16_f32 v252, v2, v3
v_cvt_pk_bf16_f32 v253, v4, v5
v_cvt_pk_bf16_f32 v254, v6, v7
v_cvt_pk_bf16_f32 v255, v8, v9
v_mfma_f32_32x32x16_bf16 a[128:143], v[10:13], v[10:13], 0
v_cvt_pk_bf16_f32 v191, v190, v191
v_cvt_pk_bf16_f32 v190, v188, v189
v_cvt_pk_bf16_f32 v189, v186, v187
v_cvt_pk_bf16_f32 v188, v184, v185
v_cvt_pk_bf16_f32 v187, v182, v183
v_cvt_pk_bf16_f32 v186, v180, v181
v_cvt_pk_bf16_f32 v185, v178, v179
v_cvt_pk_bf16_f32 v184, v176, v177
v_mfma_f32_32x32x16_bf16 a[144:159], v[10:13], v[10:13], 0
v_cvt_pk_bf16_f32 v183, v174, v175
v_cvt_pk_bf16_f32 v182, v172, v173
v_cvt_pk_bf16_f32 v181, v170, v171
v_cvt_pk_bf16_f32 v180, v168, v169
v_cvt_pk_bf16_f32 v179, v166, v167
v_cvt_pk_bf16_f32 v178, v164, v165
v_cvt_pk_bf16_f32 v177, v162, v163
v_cvt_pk_bf16_f32 v176, v160, v161
v_mfma_f32_32x32x16_bf16 a[160:175], v[10:13], v[10:13], 0
v_cvt_pk_bf16_f32 v175, v158, v159
v_cvt_pk_bf16_f32 v174, v156, v157
v_cvt_pk_bf16_f32 v173, v154, v155
v_cvt_pk_bf16_f32 v172, v152, v153
v_cvt_pk_bf16_f32 v171, v150, v151
v_cvt_pk_bf16_f32 v170, v148, v149
v_cvt_pk_bf16_f32 v169, v146, v147
v_cvt_pk_bf16_f32 v168, v144, v145
v_mfma_f32_32x32x16_bf16 a[176:191], v[10:13], v[10:13], 0
v_cvt_pk_bf16_f32 v167, v142, v143
v_cvt_pk_bf16_f32 v166, v140, v141
v_cvt_pk_bf16_f32 v165, v138, v139
v_cvt_pk_bf16_f32 v164, v136, v137
v_cvt_pk_bf16_f32 v163, v134, v135
v_cvt_pk_bf16_f32 v162, v132, v133
v_cvt_pk_bf16_f32 v161, v130, v131
v_cvt_pk_bf16_f32 v160, v128, v129
v_mfma_f32_32x32x16_bf16 a[192:207], v[10:13], v[10:13], 0
v_cvt_pk_bf16_f32 v128, v64, v65
v_cvt_pk_bf16_f32 v129, v66, v67
v_cvt_pk_bf16_f32 v130, v68, v69
v_cvt_pk_bf16_f32 v131, v70, v71
v_cvt_pk_bf16_f32 v132, v72, v73
v_cvt_pk_bf16_f32 v133, v74, v75
v_cvt_pk_bf16_f32 v134, v76, v77
v_cvt_pk_bf16_f32 v135, v78, v79
v_mfma_f32_32x32x16_bf16 a[208:223], v[10:13], v[10:13], 0
v_cvt_pk_bf16_f32 v136, v80, v81
v_cvt_pk_bf16_f32 v137, v82, v83
v_cvt_pk_bf16_f32 v138, v84, v85
v_cvt_pk_bf16_f32 v139, v86, v87
v_cvt_pk_bf16_f32 v140, v88, v89
v_cvt_pk_bf16_f32 v141, v90, v91
v_cvt_pk_bf16_f32 v142, v92, v93
v_cvt_pk_bf16_f32 v143, v94, v95
v_mfma_f32_32x32x16_bf16 a[224:239], v[10:13], v[10:13], 0
v_cvt_pk_bf16_f32 v144, v96, v97
v_cvt_pk_bf16_f32 v145, v98, v99
v_cvt_pk_bf16_f32 v146, v100, v101
v_cvt_pk_bf16_f32 v147, v102, v103
v_cvt_pk_bf16_f32 v148, v104, v105
v_cvt_pk_bf16_f32 v149, v106, v107
v_cvt_pk_bf16_f32 v150, v108, v109
v_cvt_pk_bf16_f32 v151, v110, v111
v_mfma_f32_32x32x16_bf16 a[240:255], v[10:13], v[10:13], 0
v_cvt_pk_bf16_f32 v152, v112, v113
v_cvt_pk_bf16_f32 v153, v114, v115
v_cvt_pk_bf16_f32 v154, v116, v117
v_cvt_pk_bf16_f32 v155, v118, v119
v_cvt_pk_bf16_f32 v156, v120, v121
v_cvt_pk_bf16_f32 v157, v122, v123
v_cvt_pk_bf16_f32 v158, v124, v125
v_cvt_pk_bf16_f32 v159, v126, v127
s_mov_b32 s43, 8192
s_mov_b32 s44, 0
s_mov_b32 s73, s29
s_lshl_b32 s74, s29, 1
s_mov_b32 s76, s28
s_mov_b32 s72, 0
s_add_u32 s75, s74, s73
s_add_u32 s77, s76, s73
s_add_u32 s78, s76, s74
s_add_u32 s79, s76, s75
s_branch mega_kernel_qproj
mega_kernel_t1_entry:
s_waitcnt vmcnt(20) lgkmcnt(0)
s_barrier
ds_read_b128 a[192:195], v32 offset:0
ds_read_b128 a[196:199], v33 offset:0
ds_read_b128 a[200:203], v32 offset:2048
ds_read_b128 a[204:207], v33 offset:2048
ds_read_b128 a[208:211], v32 offset:4096
ds_read_b128 a[212:215], v33 offset:4096
ds_read_b128 a[216:219], v32 offset:6144
ds_read_b128 a[220:223], v33 offset:6144
ds_read_b64_tr_b16 a[0:1], v34 offset:0
ds_read_b64_tr_b16 a[2:3], v34 offset:2048
ds_read_b64_tr_b16 a[4:5], v34 offset:16384
ds_read_b64_tr_b16 a[6:7], v34 offset:18432
ds_read_b64_tr_b16 a[8:9], v35 offset:0
ds_read_b64_tr_b16 a[10:11], v35 offset:2048
ds_read_b64_tr_b16 a[12:13], v35 offset:16384
ds_read_b64_tr_b16 a[14:15], v35 offset:18432
ds_read_b64_tr_b16 a[16:17], v36 offset:0
ds_read_b64_tr_b16 a[18:19], v36 offset:2048
ds_read_b64_tr_b16 a[20:21], v36 offset:16384
ds_read_b64_tr_b16 a[22:23], v36 offset:18432
ds_read_b64_tr_b16 a[24:25], v37 offset:0
ds_read_b64_tr_b16 a[26:27], v37 offset:2048
ds_read_b64_tr_b16 a[28:29], v37 offset:16384
ds_read_b64_tr_b16 a[30:31], v37 offset:18432
ds_read_b64_tr_b16 a[32:33], v38 offset:0
ds_read_b64_tr_b16 a[34:35], v38 offset:2048
ds_read_b64_tr_b16 a[36:37], v38 offset:16384
ds_read_b64_tr_b16 a[38:39], v38 offset:18432
ds_read_b64_tr_b16 a[40:41], v39 offset:0
ds_read_b64_tr_b16 a[42:43], v39 offset:2048
ds_read_b64_tr_b16 a[44:45], v39 offset:16384
ds_read_b64_tr_b16 a[46:47], v39 offset:18432
ds_read_b64_tr_b16 a[48:49], v40 offset:0
ds_read_b64_tr_b16 a[50:51], v40 offset:2048
ds_read_b64_tr_b16 a[52:53], v40 offset:16384
ds_read_b64_tr_b16 a[54:55], v40 offset:18432
ds_read_b64_tr_b16 a[56:57], v41 offset:0
ds_read_b64_tr_b16 a[58:59], v41 offset:2048
ds_read_b64_tr_b16 a[60:61], v41 offset:16384
ds_read_b64_tr_b16 a[62:63], v41 offset:18432
mega_kernel_t1_bz:
s_waitcnt lgkmcnt(0)
v_mfma_f32_16x16x32_bf16 v[64:67], a[192:195], a[0:3], v[64:67]
ds_read_b128 a[224:227], v32 offset:8192
v_mfma_f32_16x16x32_bf16 v[64:67], a[196:199], a[4:7], v[64:67]
v_mfma_f32_16x16x32_bf16 v[68:71], a[192:195], a[8:11], v[68:71]
v_mfma_f32_16x16x32_bf16 v[68:71], a[196:199], a[12:15], v[68:71]
ds_read_b128 a[228:231], v33 offset:8192
v_mfma_f32_16x16x32_bf16 v[72:75], a[192:195], a[16:19], v[72:75]
v_mfma_f32_16x16x32_bf16 v[72:75], a[196:199], a[20:23], v[72:75]
v_mfma_f32_16x16x32_bf16 v[76:79], a[192:195], a[24:27], v[76:79]
v_mfma_f32_16x16x32_bf16 v[76:79], a[196:199], a[28:31], v[76:79]
buffer_load_dword v45, v46, s[68:71], s72 offen
v_mfma_f32_16x16x32_bf16 v[80:83], a[192:195], a[32:35], v[80:83]
ds_read_b128 a[232:235], v32 offset:10240
v_mfma_f32_16x16x32_bf16 v[80:83], a[196:199], a[36:39], v[80:83]
s_add_u32 s72, s72, s73
v_mfma_f32_16x16x32_bf16 v[84:87], a[192:195], a[40:43], v[84:87]
v_mfma_f32_16x16x32_bf16 v[84:87], a[196:199], a[44:47], v[84:87]
v_mfma_f32_16x16x32_bf16 v[88:91], a[192:195], a[48:51], v[88:91]
v_mfma_f32_16x16x32_bf16 v[88:91], a[196:199], a[52:55], v[88:91]
ds_read_b128 a[236:239], v33 offset:10240
v_mfma_f32_16x16x32_bf16 v[92:95], a[192:195], a[56:59], v[92:95]
v_mfma_f32_16x16x32_bf16 v[92:95], a[196:199], a[60:63], v[92:95]
buffer_load_dword v45, v47, s[80:83], s86 offen
v_mfma_f32_16x16x32_bf16 v[96:99], a[200:203], a[0:3], v[96:99]
v_mfma_f32_16x16x32_bf16 v[96:99], a[204:207], a[4:7], v[96:99]
s_add_u32 s86, s86, s87
v_mfma_f32_16x16x32_bf16 v[100:103], a[200:203], a[8:11], v[100:103]
ds_read_b128 a[240:243], v32 offset:12288
v_mfma_f32_16x16x32_bf16 v[100:103], a[204:207], a[12:15], v[100:103]
v_mfma_f32_16x16x32_bf16 v[104:107], a[200:203], a[16:19], v[104:107]
v_mfma_f32_16x16x32_bf16 v[104:107], a[204:207], a[20:23], v[104:107]
v_mfma_f32_16x16x32_bf16 v[108:111], a[200:203], a[24:27], v[108:111]
v_mfma_f32_16x16x32_bf16 v[108:111], a[204:207], a[28:31], v[108:111]
ds_read_b128 a[244:247], v33 offset:12288
v_mfma_f32_16x16x32_bf16 v[112:115], a[200:203], a[32:35], v[112:115]
v_mfma_f32_16x16x32_bf16 v[112:115], a[204:207], a[36:39], v[112:115]
v_mfma_f32_16x16x32_bf16 v[116:119], a[200:203], a[40:43], v[116:119]
v_mfma_f32_16x16x32_bf16 v[116:119], a[204:207], a[44:47], v[116:119]
v_mfma_f32_16x16x32_bf16 v[120:123], a[200:203], a[48:51], v[120:123]
ds_read_b128 a[248:251], v32 offset:14336
v_mfma_f32_16x16x32_bf16 v[120:123], a[204:207], a[52:55], v[120:123]
v_mfma_f32_16x16x32_bf16 v[124:127], a[200:203], a[56:59], v[124:127]
v_mfma_f32_16x16x32_bf16 v[124:127], a[204:207], a[60:63], v[124:127]
v_mfma_f32_16x16x32_bf16 v[128:131], a[208:211], a[0:3], v[128:131]
v_mfma_f32_16x16x32_bf16 v[128:131], a[212:215], a[4:7], v[128:131]
ds_read_b128 a[252:255], v33 offset:14336
v_mfma_f32_16x16x32_bf16 v[132:135], a[208:211], a[8:11], v[132:135]
v_mfma_f32_16x16x32_bf16 v[132:135], a[212:215], a[12:15], v[132:135]
v_mfma_f32_16x16x32_bf16 v[136:139], a[208:211], a[16:19], v[136:139]
v_mfma_f32_16x16x32_bf16 v[136:139], a[212:215], a[20:23], v[136:139]
v_mfma_f32_16x16x32_bf16 v[140:143], a[208:211], a[24:27], v[140:143]
v_mfma_f32_16x16x32_bf16 v[140:143], a[212:215], a[28:31], v[140:143]
v_mfma_f32_16x16x32_bf16 v[144:147], a[208:211], a[32:35], v[144:147]
v_mfma_f32_16x16x32_bf16 v[144:147], a[212:215], a[36:39], v[144:147]
v_mfma_f32_16x16x32_bf16 v[148:151], a[208:211], a[40:43], v[148:151]
v_mfma_f32_16x16x32_bf16 v[148:151], a[212:215], a[44:47], v[148:151]
v_mfma_f32_16x16x32_bf16 v[152:155], a[208:211], a[48:51], v[152:155]
v_mfma_f32_16x16x32_bf16 v[152:155], a[212:215], a[52:55], v[152:155]
v_mfma_f32_16x16x32_bf16 v[156:159], a[208:211], a[56:59], v[156:159]
v_mfma_f32_16x16x32_bf16 v[156:159], a[212:215], a[60:63], v[156:159]
v_mfma_f32_16x16x32_bf16 v[160:163], a[216:219], a[0:3], v[160:163]
v_mfma_f32_16x16x32_bf16 v[160:163], a[220:223], a[4:7], v[160:163]
v_mfma_f32_16x16x32_bf16 v[164:167], a[216:219], a[8:11], v[164:167]
v_mfma_f32_16x16x32_bf16 v[164:167], a[220:223], a[12:15], v[164:167]
v_mfma_f32_16x16x32_bf16 v[168:171], a[216:219], a[16:19], v[168:171]
v_mfma_f32_16x16x32_bf16 v[168:171], a[220:223], a[20:23], v[168:171]
v_mfma_f32_16x16x32_bf16 v[172:175], a[216:219], a[24:27], v[172:175]
v_mfma_f32_16x16x32_bf16 v[172:175], a[220:223], a[28:31], v[172:175]
v_mfma_f32_16x16x32_bf16 v[176:179], a[216:219], a[32:35], v[176:179]
v_mfma_f32_16x16x32_bf16 v[176:179], a[220:223], a[36:39], v[176:179]
v_mfma_f32_16x16x32_bf16 v[180:183], a[216:219], a[40:43], v[180:183]
v_mfma_f32_16x16x32_bf16 v[180:183], a[220:223], a[44:47], v[180:183]
v_mfma_f32_16x16x32_bf16 v[184:187], a[216:219], a[48:51], v[184:187]
v_mfma_f32_16x16x32_bf16 v[184:187], a[220:223], a[52:55], v[184:187]
v_mfma_f32_16x16x32_bf16 v[188:191], a[216:219], a[56:59], v[188:191]
s_cmp_eq_u32 s21, s39
v_mfma_f32_16x16x32_bf16 v[188:191], a[220:223], a[60:63], v[188:191]
s_waitcnt vmcnt(2) lgkmcnt(0)
s_barrier
v_mfma_f32_16x16x32_bf16 v[192:195], a[224:227], a[0:3], v[192:195]
s_cbranch_scc1 mega_kernel_t1_hk0
mega_kernel_t1_hkr0:
v_mfma_f32_16x16x32_bf16 v[192:195], a[228:231], a[4:7], v[192:195]
s_add_u32 m0, s25, 0
ds_read_b128 a[192:195], v32 offset:32768
v_mfma_f32_16x16x32_bf16 v[196:199], a[224:227], a[8:11], v[196:199]
buffer_load_dwordx4 v24, s[8:11], s19 offen offset:0 lds
v_mfma_f32_16x16x32_bf16 v[196:199], a[228:231], a[12:15], v[196:199]
ds_read_b128 a[196:199], v33 offset:32768
v_mfma_f32_16x16x32_bf16 v[200:203], a[224:227], a[16:19], v[200:203]
ds_read_b64_tr_b16 a[64:65], v34 offset:32768
v_mfma_f32_16x16x32_bf16 v[200:203], a[228:231], a[20:23], v[200:203]
ds_read_b64_tr_b16 a[66:67], v34 offset:34816
v_mfma_f32_16x16x32_bf16 v[204:207], a[224:227], a[24:27], v[204:207]
buffer_load_dwordx4 v25, s[8:11], s19 offen offset:1024 lds
v_mfma_f32_16x16x32_bf16 v[204:207], a[228:231], a[28:31], v[204:207]
ds_read_b64_tr_b16 a[68:69], v34 offset:49152
v_mfma_f32_16x16x32_bf16 v[208:211], a[224:227], a[32:35], v[208:211]
ds_read_b64_tr_b16 a[70:71], v34 offset:51200
v_mfma_f32_16x16x32_bf16 v[208:211], a[228:231], a[36:39], v[208:211]
ds_read_b64_tr_b16 a[72:73], v35 offset:32768
v_mfma_f32_16x16x32_bf16 v[212:215], a[224:227], a[40:43], v[212:215]
buffer_load_dwordx4 v26, s[8:11], s19 offen offset:2048 lds
v_mfma_f32_16x16x32_bf16 v[212:215], a[228:231], a[44:47], v[212:215]
ds_read_b64_tr_b16 a[74:75], v35 offset:34816
v_mfma_f32_16x16x32_bf16 v[216:219], a[224:227], a[48:51], v[216:219]
ds_read_b64_tr_b16 a[76:77], v35 offset:49152
v_mfma_f32_16x16x32_bf16 v[216:219], a[228:231], a[52:55], v[216:219]
ds_read_b64_tr_b16 a[78:79], v35 offset:51200
v_mfma_f32_16x16x32_bf16 v[220:223], a[224:227], a[56:59], v[220:223]
buffer_load_dwordx4 v27, s[8:11], s19 offen offset:3072 lds
v_mfma_f32_16x16x32_bf16 v[220:223], a[228:231], a[60:63], v[220:223]
ds_read_b64_tr_b16 a[80:81], v36 offset:32768
v_mfma_f32_16x16x32_bf16 v[224:227], a[232:235], a[0:3], v[224:227]
ds_read_b64_tr_b16 a[82:83], v36 offset:34816
v_mfma_f32_16x16x32_bf16 v[224:227], a[236:239], a[4:7], v[224:227]
s_add_u32 m0, s25, 4096
ds_read_b64_tr_b16 a[84:85], v36 offset:49152
v_mfma_f32_16x16x32_bf16 v[228:231], a[232:235], a[8:11], v[228:231]
buffer_load_dwordx4 v28, s[8:11], s19 offen offset:0 lds
v_mfma_f32_16x16x32_bf16 v[228:231], a[236:239], a[12:15], v[228:231]
ds_read_b64_tr_b16 a[86:87], v36 offset:51200
v_mfma_f32_16x16x32_bf16 v[232:235], a[232:235], a[16:19], v[232:235]
ds_read_b64_tr_b16 a[88:89], v37 offset:32768
v_mfma_f32_16x16x32_bf16 v[232:235], a[236:239], a[20:23], v[232:235]
ds_read_b64_tr_b16 a[90:91], v37 offset:34816
v_mfma_f32_16x16x32_bf16 v[236:239], a[232:235], a[24:27], v[236:239]
buffer_load_dwordx4 v29, s[8:11], s19 offen offset:1024 lds
v_mfma_f32_16x16x32_bf16 v[236:239], a[236:239], a[28:31], v[236:239]
ds_read_b64_tr_b16 a[92:93], v37 offset:49152
v_mfma_f32_16x16x32_bf16 v[240:243], a[232:235], a[32:35], v[240:243]
ds_read_b64_tr_b16 a[94:95], v37 offset:51200
v_mfma_f32_16x16x32_bf16 v[240:243], a[236:239], a[36:39], v[240:243]
ds_read_b64_tr_b16 a[96:97], v38 offset:32768
v_mfma_f32_16x16x32_bf16 v[244:247], a[232:235], a[40:43], v[244:247]
buffer_load_dwordx4 v30, s[8:11], s19 offen offset:2048 lds
v_mfma_f32_16x16x32_bf16 v[244:247], a[236:239], a[44:47], v[244:247]
ds_read_b64_tr_b16 a[98:99], v38 offset:34816
v_mfma_f32_16x16x32_bf16 v[248:251], a[232:235], a[48:51], v[248:251]
ds_read_b64_tr_b16 a[100:101], v38 offset:49152
v_mfma_f32_16x16x32_bf16 v[248:251], a[236:239], a[52:55], v[248:251]
ds_read_b64_tr_b16 a[102:103], v38 offset:51200
v_mfma_f32_16x16x32_bf16 v[252:255], a[232:235], a[56:59], v[252:255]
buffer_load_dwordx4 v31, s[8:11], s19 offen offset:3072 lds
v_mfma_f32_16x16x32_bf16 v[252:255], a[236:239], a[60:63], v[252:255]
ds_read_b64_tr_b16 a[104:105], v39 offset:32768
v_mfma_f32_16x16x32_bf16 a[128:131], a[240:243], a[0:3], a[128:131]
ds_read_b64_tr_b16 a[106:107], v39 offset:34816
v_mfma_f32_16x16x32_bf16 a[128:131], a[244:247], a[4:7], a[128:131]
s_add_u32 m0, s24, 0
s_add_u32 s19, s19, s23
ds_read_b64_tr_b16 a[108:109], v39 offset:49152
v_mfma_f32_16x16x32_bf16 a[132:135], a[240:243], a[8:11], a[132:135]
buffer_load_dwordx4 v16, s[4:7], s18 offen offset:0 lds
v_mfma_f32_16x16x32_bf16 a[132:135], a[244:247], a[12:15], a[132:135]
ds_read_b64_tr_b16 a[110:111], v39 offset:51200
v_mfma_f32_16x16x32_bf16 a[136:139], a[240:243], a[16:19], a[136:139]
ds_read_b64_tr_b16 a[112:113], v40 offset:32768
v_mfma_f32_16x16x32_bf16 a[136:139], a[244:247], a[20:23], a[136:139]
ds_read_b64_tr_b16 a[114:115], v40 offset:34816
v_mfma_f32_16x16x32_bf16 a[140:143], a[240:243], a[24:27], a[140:143]
buffer_load_dwordx4 v17, s[4:7], s18 offen offset:1024 lds
v_mfma_f32_16x16x32_bf16 a[140:143], a[244:247], a[28:31], a[140:143]
ds_read_b64_tr_b16 a[116:117], v40 offset:49152
v_mfma_f32_16x16x32_bf16 a[144:147], a[240:243], a[32:35], a[144:147]
ds_read_b64_tr_b16 a[118:119], v40 offset:51200
v_mfma_f32_16x16x32_bf16 a[144:147], a[244:247], a[36:39], a[144:147]
ds_read_b64_tr_b16 a[120:121], v41 offset:32768
v_mfma_f32_16x16x32_bf16 a[148:151], a[240:243], a[40:43], a[148:151]
buffer_load_dwordx4 v18, s[4:7], s18 offen offset:2048 lds
v_mfma_f32_16x16x32_bf16 a[148:151], a[244:247], a[44:47], a[148:151]
ds_read_b64_tr_b16 a[122:123], v41 offset:34816
v_mfma_f32_16x16x32_bf16 a[152:155], a[240:243], a[48:51], a[152:155]
ds_read_b64_tr_b16 a[124:125], v41 offset:49152
v_mfma_f32_16x16x32_bf16 a[152:155], a[244:247], a[52:55], a[152:155]
ds_read_b64_tr_b16 a[126:127], v41 offset:51200
v_mfma_f32_16x16x32_bf16 a[156:159], a[240:243], a[56:59], a[156:159]
buffer_load_dwordx4 v19, s[4:7], s18 offen offset:3072 lds
v_mfma_f32_16x16x32_bf16 a[156:159], a[244:247], a[60:63], a[156:159]
ds_read_b128 a[200:203], v32 offset:34816
v_mfma_f32_16x16x32_bf16 a[160:163], a[248:251], a[0:3], a[160:163]
ds_read_b128 a[204:207], v33 offset:34816
v_mfma_f32_16x16x32_bf16 a[160:163], a[252:255], a[4:7], a[160:163]
s_add_u32 m0, s24, 4096
ds_read_b128 a[208:211], v32 offset:36864
v_mfma_f32_16x16x32_bf16 a[164:167], a[248:251], a[8:11], a[164:167]
buffer_load_dwordx4 v20, s[4:7], s18 offen offset:0 lds
v_mfma_f32_16x16x32_bf16 a[164:167], a[252:255], a[12:15], a[164:167]
ds_read_b128 a[212:215], v33 offset:36864
v_mfma_f32_16x16x32_bf16 a[168:171], a[248:251], a[16:19], a[168:171]
ds_read_b128 a[216:219], v32 offset:38912
v_mfma_f32_16x16x32_bf16 a[168:171], a[252:255], a[20:23], a[168:171]
ds_read_b128 a[220:223], v33 offset:38912
v_mfma_f32_16x16x32_bf16 a[172:175], a[248:251], a[24:27], a[172:175]
buffer_load_dwordx4 v21, s[4:7], s18 offen offset:1024 lds
v_mfma_f32_16x16x32_bf16 a[172:175], a[252:255], a[28:31], a[172:175]
v_mfma_f32_16x16x32_bf16 a[176:179], a[248:251], a[32:35], a[176:179]
v_mfma_f32_16x16x32_bf16 a[176:179], a[252:255], a[36:39], a[176:179]
v_mfma_f32_16x16x32_bf16 a[180:183], a[248:251], a[40:43], a[180:183]
buffer_load_dwordx4 v22, s[4:7], s18 offen offset:2048 lds
v_mfma_f32_16x16x32_bf16 a[180:183], a[252:255], a[44:47], a[180:183]
v_mfma_f32_16x16x32_bf16 a[184:187], a[248:251], a[48:51], a[184:187]
v_mfma_f32_16x16x32_bf16 a[184:187], a[252:255], a[52:55], a[184:187]
buffer_load_dwordx4 v23, s[4:7], s18 offen offset:3072 lds
v_mfma_f32_16x16x32_bf16 a[188:191], a[248:251], a[56:59], a[188:191]
s_add_u32 s18, s18, 128
s_cmp_eq_u32 s21, s38
v_mfma_f32_16x16x32_bf16 a[188:191], a[252:255], a[60:63], a[188:191]
s_cbranch_scc1 mega_kernel_t1_epi
s_add_u32 s21, s21, 1
s_waitcnt lgkmcnt(0)
v_mfma_f32_16x16x32_bf16 v[64:67], a[192:195], a[64:67], v[64:67]
ds_read_b128 a[224:227], v32 offset:40960
v_mfma_f32_16x16x32_bf16 v[64:67], a[196:199], a[68:71], v[64:67]
v_mfma_f32_16x16x32_bf16 v[68:71], a[192:195], a[72:75], v[68:71]
v_mfma_f32_16x16x32_bf16 v[68:71], a[196:199], a[76:79], v[68:71]
ds_read_b128 a[228:231], v33 offset:40960
v_mfma_f32_16x16x32_bf16 v[72:75], a[192:195], a[80:83], v[72:75]
v_mfma_f32_16x16x32_bf16 v[72:75], a[196:199], a[84:87], v[72:75]
v_mfma_f32_16x16x32_bf16 v[76:79], a[192:195], a[88:91], v[76:79]
v_mfma_f32_16x16x32_bf16 v[76:79], a[196:199], a[92:95], v[76:79]
buffer_load_dword v45, v46, s[68:71], s72 offen
v_mfma_f32_16x16x32_bf16 v[80:83], a[192:195], a[96:99], v[80:83]
ds_read_b128 a[232:235], v32 offset:43008
v_mfma_f32_16x16x32_bf16 v[80:83], a[196:199], a[100:103], v[80:83]
s_add_u32 s72, s72, s73
v_mfma_f32_16x16x32_bf16 v[84:87], a[192:195], a[104:107], v[84:87]
v_mfma_f32_16x16x32_bf16 v[84:87], a[196:199], a[108:111], v[84:87]
v_mfma_f32_16x16x32_bf16 v[88:91], a[192:195], a[112:115], v[88:91]
v_mfma_f32_16x16x32_bf16 v[88:91], a[196:199], a[116:119], v[88:91]
ds_read_b128 a[236:239], v33 offset:43008
v_mfma_f32_16x16x32_bf16 v[92:95], a[192:195], a[120:123], v[92:95]
v_mfma_f32_16x16x32_bf16 v[92:95], a[196:199], a[124:127], v[92:95]
buffer_load_dword v45, v47, s[80:83], s86 offen
v_mfma_f32_16x16x32_bf16 v[96:99], a[200:203], a[64:67], v[96:99]
v_mfma_f32_16x16x32_bf16 v[96:99], a[204:207], a[68:71], v[96:99]
s_add_u32 s86, s86, s87
v_mfma_f32_16x16x32_bf16 v[100:103], a[200:203], a[72:75], v[100:103]
ds_read_b128 a[240:243], v32 offset:45056
v_mfma_f32_16x16x32_bf16 v[100:103], a[204:207], a[76:79], v[100:103]
v_mfma_f32_16x16x32_bf16 v[104:107], a[200:203], a[80:83], v[104:107]
v_mfma_f32_16x16x32_bf16 v[104:107], a[204:207], a[84:87], v[104:107]
v_mfma_f32_16x16x32_bf16 v[108:111], a[200:203], a[88:91], v[108:111]
v_mfma_f32_16x16x32_bf16 v[108:111], a[204:207], a[92:95], v[108:111]
ds_read_b128 a[244:247], v33 offset:45056
v_mfma_f32_16x16x32_bf16 v[112:115], a[200:203], a[96:99], v[112:115]
v_mfma_f32_16x16x32_bf16 v[112:115], a[204:207], a[100:103], v[112:115]
v_mfma_f32_16x16x32_bf16 v[116:119], a[200:203], a[104:107], v[116:119]
v_mfma_f32_16x16x32_bf16 v[116:119], a[204:207], a[108:111], v[116:119]
v_mfma_f32_16x16x32_bf16 v[120:123], a[200:203], a[112:115], v[120:123]
ds_read_b128 a[248:251], v32 offset:47104
v_mfma_f32_16x16x32_bf16 v[120:123], a[204:207], a[116:119], v[120:123]
v_mfma_f32_16x16x32_bf16 v[124:127], a[200:203], a[120:123], v[124:127]
v_mfma_f32_16x16x32_bf16 v[124:127], a[204:207], a[124:127], v[124:127]
v_mfma_f32_16x16x32_bf16 v[128:131], a[208:211], a[64:67], v[128:131]
v_mfma_f32_16x16x32_bf16 v[128:131], a[212:215], a[68:71], v[128:131]
ds_read_b128 a[252:255], v33 offset:47104
v_mfma_f32_16x16x32_bf16 v[132:135], a[208:211], a[72:75], v[132:135]
v_mfma_f32_16x16x32_bf16 v[132:135], a[212:215], a[76:79], v[132:135]
v_mfma_f32_16x16x32_bf16 v[136:139], a[208:211], a[80:83], v[136:139]
v_mfma_f32_16x16x32_bf16 v[136:139], a[212:215], a[84:87], v[136:139]
v_mfma_f32_16x16x32_bf16 v[140:143], a[208:211], a[88:91], v[140:143]
v_mfma_f32_16x16x32_bf16 v[140:143], a[212:215], a[92:95], v[140:143]
v_mfma_f32_16x16x32_bf16 v[144:147], a[208:211], a[96:99], v[144:147]
v_mfma_f32_16x16x32_bf16 v[144:147], a[212:215], a[100:103], v[144:147]
v_mfma_f32_16x16x32_bf16 v[148:151], a[208:211], a[104:107], v[148:151]
v_mfma_f32_16x16x32_bf16 v[148:151], a[212:215], a[108:111], v[148:151]
v_mfma_f32_16x16x32_bf16 v[152:155], a[208:211], a[112:115], v[152:155]
v_mfma_f32_16x16x32_bf16 v[152:155], a[212:215], a[116:119], v[152:155]
v_mfma_f32_16x16x32_bf16 v[156:159], a[208:211], a[120:123], v[156:159]
v_mfma_f32_16x16x32_bf16 v[156:159], a[212:215], a[124:127], v[156:159]
v_mfma_f32_16x16x32_bf16 v[160:163], a[216:219], a[64:67], v[160:163]
v_mfma_f32_16x16x32_bf16 v[160:163], a[220:223], a[68:71], v[160:163]
v_mfma_f32_16x16x32_bf16 v[164:167], a[216:219], a[72:75], v[164:167]
v_mfma_f32_16x16x32_bf16 v[164:167], a[220:223], a[76:79], v[164:167]
v_mfma_f32_16x16x32_bf16 v[168:171], a[216:219], a[80:83], v[168:171]
v_mfma_f32_16x16x32_bf16 v[168:171], a[220:223], a[84:87], v[168:171]
v_mfma_f32_16x16x32_bf16 v[172:175], a[216:219], a[88:91], v[172:175]
v_mfma_f32_16x16x32_bf16 v[172:175], a[220:223], a[92:95], v[172:175]
v_mfma_f32_16x16x32_bf16 v[176:179], a[216:219], a[96:99], v[176:179]
v_mfma_f32_16x16x32_bf16 v[176:179], a[220:223], a[100:103], v[176:179]
v_mfma_f32_16x16x32_bf16 v[180:183], a[216:219], a[104:107], v[180:183]
v_mfma_f32_16x16x32_bf16 v[180:183], a[220:223], a[108:111], v[180:183]
v_mfma_f32_16x16x32_bf16 v[184:187], a[216:219], a[112:115], v[184:187]
v_mfma_f32_16x16x32_bf16 v[184:187], a[220:223], a[116:119], v[184:187]
v_mfma_f32_16x16x32_bf16 v[188:191], a[216:219], a[120:123], v[188:191]
s_cmp_eq_u32 s21, s39
v_mfma_f32_16x16x32_bf16 v[188:191], a[220:223], a[124:127], v[188:191]
s_waitcnt vmcnt(2) lgkmcnt(0)
s_barrier
v_mfma_f32_16x16x32_bf16 v[192:195], a[224:227], a[64:67], v[192:195]
s_cbranch_scc1 mega_kernel_t1_hk1
mega_kernel_t1_hkr1:
v_mfma_f32_16x16x32_bf16 v[192:195], a[228:231], a[68:71], v[192:195]
s_add_u32 m0, s25, 32768
ds_read_b128 a[192:195], v32 offset:0
v_mfma_f32_16x16x32_bf16 v[196:199], a[224:227], a[72:75], v[196:199]
buffer_load_dwordx4 v24, s[8:11], s19 offen offset:0 lds
v_mfma_f32_16x16x32_bf16 v[196:199], a[228:231], a[76:79], v[196:199]
ds_read_b128 a[196:199], v33 offset:0
v_mfma_f32_16x16x32_bf16 v[200:203], a[224:227], a[80:83], v[200:203]
ds_read_b64_tr_b16 a[0:1], v34 offset:0
v_mfma_f32_16x16x32_bf16 v[200:203], a[228:231], a[84:87], v[200:203]
ds_read_b64_tr_b16 a[2:3], v34 offset:2048
v_mfma_f32_16x16x32_bf16 v[204:207], a[224:227], a[88:91], v[204:207]
buffer_load_dwordx4 v25, s[8:11], s19 offen offset:1024 lds
v_mfma_f32_16x16x32_bf16 v[204:207], a[228:231], a[92:95], v[204:207]
ds_read_b64_tr_b16 a[4:5], v34 offset:16384
v_mfma_f32_16x16x32_bf16 v[208:211], a[224:227], a[96:99], v[208:211]
ds_read_b64_tr_b16 a[6:7], v34 offset:18432
v_mfma_f32_16x16x32_bf16 v[208:211], a[228:231], a[100:103], v[208:211]
ds_read_b64_tr_b16 a[8:9], v35 offset:0
v_mfma_f32_16x16x32_bf16 v[212:215], a[224:227], a[104:107], v[212:215]
buffer_load_dwordx4 v26, s[8:11], s19 offen offset:2048 lds
v_mfma_f32_16x16x32_bf16 v[212:215], a[228:231], a[108:111], v[212:215]
ds_read_b64_tr_b16 a[10:11], v35 offset:2048
v_mfma_f32_16x16x32_bf16 v[216:219], a[224:227], a[112:115], v[216:219]
ds_read_b64_tr_b16 a[12:13], v35 offset:16384
v_mfma_f32_16x16x32_bf16 v[216:219], a[228:231], a[116:119], v[216:219]
ds_read_b64_tr_b16 a[14:15], v35 offset:18432
v_mfma_f32_16x16x32_bf16 v[220:223], a[224:227], a[120:123], v[220:223]
buffer_load_dwordx4 v27, s[8:11], s19 offen offset:3072 lds
v_mfma_f32_16x16x32_bf16 v[220:223], a[228:231], a[124:127], v[220:223]
ds_read_b64_tr_b16 a[16:17], v36 offset:0
v_mfma_f32_16x16x32_bf16 v[224:227], a[232:235], a[64:67], v[224:227]
ds_read_b64_tr_b16 a[18:19], v36 offset:2048
v_mfma_f32_16x16x32_bf16 v[224:227], a[236:239], a[68:71], v[224:227]
s_add_u32 m0, s25, 36864
ds_read_b64_tr_b16 a[20:21], v36 offset:16384
v_mfma_f32_16x16x32_bf16 v[228:231], a[232:235], a[72:75], v[228:231]
buffer_load_dwordx4 v28, s[8:11], s19 offen offset:0 lds
v_mfma_f32_16x16x32_bf16 v[228:231], a[236:239], a[76:79], v[228:231]
ds_read_b64_tr_b16 a[22:23], v36 offset:18432
v_mfma_f32_16x16x32_bf16 v[232:235], a[232:235], a[80:83], v[232:235]
ds_read_b64_tr_b16 a[24:25], v37 offset:0
v_mfma_f32_16x16x32_bf16 v[232:235], a[236:239], a[84:87], v[232:235]
ds_read_b64_tr_b16 a[26:27], v37 offset:2048
v_mfma_f32_16x16x32_bf16 v[236:239], a[232:235], a[88:91], v[236:239]
buffer_load_dwordx4 v29, s[8:11], s19 offen offset:1024 lds
v_mfma_f32_16x16x32_bf16 v[236:239], a[236:239], a[92:95], v[236:239]
ds_read_b64_tr_b16 a[28:29], v37 offset:16384
v_mfma_f32_16x16x32_bf16 v[240:243], a[232:235], a[96:99], v[240:243]
ds_read_b64_tr_b16 a[30:31], v37 offset:18432
v_mfma_f32_16x16x32_bf16 v[240:243], a[236:239], a[100:103], v[240:243]
ds_read_b64_tr_b16 a[32:33], v38 offset:0
v_mfma_f32_16x16x32_bf16 v[244:247], a[232:235], a[104:107], v[244:247]
buffer_load_dwordx4 v30, s[8:11], s19 offen offset:2048 lds
v_mfma_f32_16x16x32_bf16 v[244:247], a[236:239], a[108:111], v[244:247]
ds_read_b64_tr_b16 a[34:35], v38 offset:2048
v_mfma_f32_16x16x32_bf16 v[248:251], a[232:235], a[112:115], v[248:251]
ds_read_b64_tr_b16 a[36:37], v38 offset:16384
v_mfma_f32_16x16x32_bf16 v[248:251], a[236:239], a[116:119], v[248:251]
ds_read_b64_tr_b16 a[38:39], v38 offset:18432
v_mfma_f32_16x16x32_bf16 v[252:255], a[232:235], a[120:123], v[252:255]
buffer_load_dwordx4 v31, s[8:11], s19 offen offset:3072 lds
v_mfma_f32_16x16x32_bf16 v[252:255], a[236:239], a[124:127], v[252:255]
ds_read_b64_tr_b16 a[40:41], v39 offset:0
v_mfma_f32_16x16x32_bf16 a[128:131], a[240:243], a[64:67], a[128:131]
ds_read_b64_tr_b16 a[42:43], v39 offset:2048
v_mfma_f32_16x16x32_bf16 a[128:131], a[244:247], a[68:71], a[128:131]
s_add_u32 m0, s24, 32768
s_add_u32 s19, s19, s23
ds_read_b64_tr_b16 a[44:45], v39 offset:16384
v_mfma_f32_16x16x32_bf16 a[132:135], a[240:243], a[72:75], a[132:135]
buffer_load_dwordx4 v16, s[4:7], s18 offen offset:0 lds
v_mfma_f32_16x16x32_bf16 a[132:135], a[244:247], a[76:79], a[132:135]
ds_read_b64_tr_b16 a[46:47], v39 offset:18432
v_mfma_f32_16x16x32_bf16 a[136:139], a[240:243], a[80:83], a[136:139]
ds_read_b64_tr_b16 a[48:49], v40 offset:0
v_mfma_f32_16x16x32_bf16 a[136:139], a[244:247], a[84:87], a[136:139]
ds_read_b64_tr_b16 a[50:51], v40 offset:2048
v_mfma_f32_16x16x32_bf16 a[140:143], a[240:243], a[88:91], a[140:143]
buffer_load_dwordx4 v17, s[4:7], s18 offen offset:1024 lds
v_mfma_f32_16x16x32_bf16 a[140:143], a[244:247], a[92:95], a[140:143]
ds_read_b64_tr_b16 a[52:53], v40 offset:16384
v_mfma_f32_16x16x32_bf16 a[144:147], a[240:243], a[96:99], a[144:147]
ds_read_b64_tr_b16 a[54:55], v40 offset:18432
v_mfma_f32_16x16x32_bf16 a[144:147], a[244:247], a[100:103], a[144:147]
ds_read_b64_tr_b16 a[56:57], v41 offset:0
v_mfma_f32_16x16x32_bf16 a[148:151], a[240:243], a[104:107], a[148:151]
buffer_load_dwordx4 v18, s[4:7], s18 offen offset:2048 lds
v_mfma_f32_16x16x32_bf16 a[148:151], a[244:247], a[108:111], a[148:151]
ds_read_b64_tr_b16 a[58:59], v41 offset:2048
v_mfma_f32_16x16x32_bf16 a[152:155], a[240:243], a[112:115], a[152:155]
ds_read_b64_tr_b16 a[60:61], v41 offset:16384
v_mfma_f32_16x16x32_bf16 a[152:155], a[244:247], a[116:119], a[152:155]
ds_read_b64_tr_b16 a[62:63], v41 offset:18432
v_mfma_f32_16x16x32_bf16 a[156:159], a[240:243], a[120:123], a[156:159]
buffer_load_dwordx4 v19, s[4:7], s18 offen offset:3072 lds
v_mfma_f32_16x16x32_bf16 a[156:159], a[244:247], a[124:127], a[156:159]
ds_read_b128 a[200:203], v32 offset:2048
v_mfma_f32_16x16x32_bf16 a[160:163], a[248:251], a[64:67], a[160:163]
ds_read_b128 a[204:207], v33 offset:2048
v_mfma_f32_16x16x32_bf16 a[160:163], a[252:255], a[68:71], a[160:163]
s_add_u32 m0, s24, 36864
ds_read_b128 a[208:211], v32 offset:4096
v_mfma_f32_16x16x32_bf16 a[164:167], a[248:251], a[72:75], a[164:167]
buffer_load_dwordx4 v20, s[4:7], s18 offen offset:0 lds
v_mfma_f32_16x16x32_bf16 a[164:167], a[252:255], a[76:79], a[164:167]
ds_read_b128 a[212:215], v33 offset:4096
v_mfma_f32_16x16x32_bf16 a[168:171], a[248:251], a[80:83], a[168:171]
ds_read_b128 a[216:219], v32 offset:6144
v_mfma_f32_16x16x32_bf16 a[168:171], a[252:255], a[84:87], a[168:171]
ds_read_b128 a[220:223], v33 offset:6144
v_mfma_f32_16x16x32_bf16 a[172:175], a[248:251], a[88:91], a[172:175]
buffer_load_dwordx4 v21, s[4:7], s18 offen offset:1024 lds
v_mfma_f32_16x16x32_bf16 a[172:175], a[252:255], a[92:95], a[172:175]
v_mfma_f32_16x16x32_bf16 a[176:179], a[248:251], a[96:99], a[176:179]
v_mfma_f32_16x16x32_bf16 a[176:179], a[252:255], a[100:103], a[176:179]
v_mfma_f32_16x16x32_bf16 a[180:183], a[248:251], a[104:107], a[180:183]
buffer_load_dwordx4 v22, s[4:7], s18 offen offset:2048 lds
v_mfma_f32_16x16x32_bf16 a[180:183], a[252:255], a[108:111], a[180:183]
v_mfma_f32_16x16x32_bf16 a[184:187], a[248:251], a[112:115], a[184:187]
v_mfma_f32_16x16x32_bf16 a[184:187], a[252:255], a[116:119], a[184:187]
buffer_load_dwordx4 v23, s[4:7], s18 offen offset:3072 lds
v_mfma_f32_16x16x32_bf16 a[188:191], a[248:251], a[120:123], a[188:191]
s_add_u32 s18, s18, 128
s_cmp_eq_u32 s21, s38
v_mfma_f32_16x16x32_bf16 a[188:191], a[252:255], a[124:127], a[188:191]
s_cbranch_scc1 mega_kernel_t1_epi
s_add_u32 s21, s21, 1
s_branch mega_kernel_t1_bz
mega_kernel_t1_hk0:
s_cmp_eq_u32 s21, 14
s_cbranch_scc0 mega_kernel_t1_h0_b
s_mov_b32 s86, 0
s_mov_b32 s70, 0
s_mov_b32 s39, 16
s_branch mega_kernel_t1_hkr0
mega_kernel_t1_h0_b:
s_cmp_eq_u32 s89, 0
s_cbranch_scc0 mega_kernel_t1_h0_far
s_mov_b32 s8, s44
s_mov_b32 s9, s45
s_mov_b32 s10, s48
s_mov_b32 s6, 0
s_mov_b32 s19, 0
s_branch mega_kernel_t1_hkr0
mega_kernel_t1_epi:
s_cmp_eq_u32 s89, 0
s_cbranch_scc0 mega_kernel_t1_epi2
s_waitcnt lgkmcnt(0)
s_load_dwordx2 s[68:69], s[0:1], 24
s_load_dwordx2 s[48:49], s[0:1], 64
s_load_dwordx2 s[50:51], s[0:1], 16
s_lshl_b32 s18, s20, 13
s_lshr_b32 s41, s55, 1
s_sub_u32 s41, 15, s41
s_mul_i32 s61, s41, 114688
s_mov_b32 s70, 172032
s_lshl_b32 s25, s20, 12
s_add_u32 s25, s25, 32768
s_mov_b32 s65, 57344
v_lshrrev_b32 v2, 3, v1
s_lshl_b32 s64, s20, 5
v_add_u32 v2, s64, v2
v_mul_u32_u24 v2, 896, v2
v_and_b32 v3, 7, v1
v_lshrrev_b32 v4, 4, v1
v_xor_b32 v3, v3, v4
v_lshlrev_b32 v3, 4, v3
v_xor_b32 v4, 64, v3
v_add_u32 v14, v2, v3
v_add_u32 v4, v2, v4
v_add_u32 v15, 6144, v4
v_add_u32 v59, 12288, v14
v_add_u32 v61, 18432, v4
s_waitcnt lgkmcnt(0)
s_add_u32 s68, s68, s61
s_addc_u32 s69, s69, 0
s_sub_u32 s68, s68, 57344
s_subb_u32 s69, s69, 0
s_add_u32 m0, s25, 98304
s_nop 0
buffer_load_dwordx4 v14, s[68:71], s65 offen offset:0 lds
buffer_load_dwordx4 v15, s[68:71], s65 offen offset:1024 lds
buffer_load_dwordx4 v59, s[68:71], s65 offen offset:2048 lds
buffer_load_dwordx4 v61, s[68:71], s65 offen offset:3072 lds
s_add_u32 s65, s65, 128
s_add_u32 m0, s25, 114688
s_nop 0
buffer_load_dwordx4 v14, s[68:71], s65 offen offset:0 lds
buffer_load_dwordx4 v15, s[68:71], s65 offen offset:1024 lds
buffer_load_dwordx4 v59, s[68:71], s65 offen offset:2048 lds
buffer_load_dwordx4 v61, s[68:71], s65 offen offset:3072 lds
s_add_u32 s65, s65, 128
s_mul_i32 s86, s87, 3
buffer_load_dword v45, v47, s[80:83], s86 offen
s_add_u32 s86, s86, s87
buffer_load_dword v45, v47, s[80:83], s86 offen
s_add_u32 s86, s86, s87
buffer_load_dword v45, v47, s[80:83], s86 offen
s_add_u32 s86, s86, s87
buffer_load_dword v45, v47, s[80:83], s86 offen
s_add_u32 s86, s86, s87
v_mov_b32 v10, 0
v_mov_b32 v11, 0
v_mov_b32 v12, 0
v_mov_b32 v13, 0
v_cvt_pk_bf16_f32 v192, v192, v193
v_cvt_pk_bf16_f32 v193, v194, v195
v_cvt_pk_bf16_f32 v194, v224, v225
v_cvt_pk_bf16_f32 v195, v226, v227
v_cvt_pk_bf16_f32 v196, v196, v197
v_cvt_pk_bf16_f32 v197, v198, v199
v_cvt_pk_bf16_f32 v198, v228, v229
v_cvt_pk_bf16_f32 v199, v230, v231
v_cvt_pk_bf16_f32 v200, v200, v201
v_cvt_pk_bf16_f32 v201, v202, v203
v_cvt_pk_bf16_f32 v202, v232, v233
v_cvt_pk_bf16_f32 v203, v234, v235
v_cvt_pk_bf16_f32 v204, v204, v205
v_cvt_pk_bf16_f32 v205, v206, v207
v_cvt_pk_bf16_f32 v206, v236, v237
v_cvt_pk_bf16_f32 v207, v238, v239
v_cvt_pk_bf16_f32 v208, v208, v209
v_cvt_pk_bf16_f32 v209, v210, v211
v_cvt_pk_bf16_f32 v210, v240, v241
v_cvt_pk_bf16_f32 v211, v242, v243
v_cvt_pk_bf16_f32 v212, v212, v213
v_cvt_pk_bf16_f32 v213, v214, v215
v_cvt_pk_bf16_f32 v214, v244, v245
v_cvt_pk_bf16_f32 v215, v246, v247
v_cvt_pk_bf16_f32 v216, v216, v217
v_cvt_pk_bf16_f32 v217, v218, v219
v_cvt_pk_bf16_f32 v218, v248, v249
v_cvt_pk_bf16_f32 v219, v250, v251
v_cvt_pk_bf16_f32 v220, v220, v221
v_cvt_pk_bf16_f32 v221, v222, v223
v_cvt_pk_bf16_f32 v222, v252, v253
v_cvt_pk_bf16_f32 v223, v254, v255
v_accvgpr_read_b32 v2, a128
v_accvgpr_read_b32 v3, a129
v_accvgpr_read_b32 v4, a130
v_accvgpr_read_b32 v5, a131
v_accvgpr_read_b32 v6, a160
v_accvgpr_read_b32 v7, a161
v_accvgpr_read_b32 v8, a162
v_accvgpr_read_b32 v9, a163
v_cvt_pk_bf16_f32 v224, v2, v3
v_cvt_pk_bf16_f32 v225, v4, v5
v_cvt_pk_bf16_f32 v226, v6, v7
v_cvt_pk_bf16_f32 v227, v8, v9
v_accvgpr_read_b32 v2, a132
v_accvgpr_read_b32 v3, a133
v_accvgpr_read_b32 v4, a134
v_accvgpr_read_b32 v5, a135
v_accvgpr_read_b32 v6, a164
v_accvgpr_read_b32 v7, a165
v_accvgpr_read_b32 v8, a166
v_accvgpr_read_b32 v9, a167
v_cvt_pk_bf16_f32 v228, v2, v3
v_cvt_pk_bf16_f32 v229, v4, v5
v_cvt_pk_bf16_f32 v230, v6, v7
v_cvt_pk_bf16_f32 v231, v8, v9
v_accvgpr_read_b32 v2, a136
v_accvgpr_read_b32 v3, a137
v_accvgpr_read_b32 v4, a138
v_accvgpr_read_b32 v5, a139
v_accvgpr_read_b32 v6, a168
v_accvgpr_read_b32 v7, a169
v_accvgpr_read_b32 v8, a170
v_accvgpr_read_b32 v9, a171
v_cvt_pk_bf16_f32 v232, v2, v3
v_cvt_pk_bf16_f32 v233, v4, v5
v_cvt_pk_bf16_f32 v234, v6, v7
v_cvt_pk_bf16_f32 v235, v8, v9
v_accvgpr_read_b32 v2, a140
v_accvgpr_read_b32 v3, a141
v_accvgpr_read_b32 v4, a142
v_accvgpr_read_b32 v5, a143
v_accvgpr_read_b32 v6, a172
v_accvgpr_read_b32 v7, a173
v_accvgpr_read_b32 v8, a174
v_accvgpr_read_b32 v9, a175
v_cvt_pk_bf16_f32 v236, v2, v3
v_cvt_pk_bf16_f32 v237, v4, v5
v_cvt_pk_bf16_f32 v238, v6, v7
v_cvt_pk_bf16_f32 v239, v8, v9
v_accvgpr_read_b32 v2, a144
v_accvgpr_read_b32 v3, a145
v_accvgpr_read_b32 v4, a146
v_accvgpr_read_b32 v5, a147
v_accvgpr_read_b32 v6, a176
v_accvgpr_read_b32 v7, a177
v_accvgpr_read_b32 v8, a178
v_accvgpr_read_b32 v9, a179
v_cvt_pk_bf16_f32 v240, v2, v3
v_cvt_pk_bf16_f32 v241, v4, v5
v_cvt_pk_bf16_f32 v242, v6, v7
v_cvt_pk_bf16_f32 v243, v8, v9
v_accvgpr_read_b32 v2, a148
v_accvgpr_read_b32 v3, a149
v_accvgpr_read_b32 v4, a150
v_accvgpr_read_b32 v5, a151
v_accvgpr_read_b32 v6, a180
v_accvgpr_read_b32 v7, a181
v_accvgpr_read_b32 v8, a182
v_accvgpr_read_b32 v9, a183
v_cvt_pk_bf16_f32 v244, v2, v3
v_cvt_pk_bf16_f32 v245, v4, v5
v_cvt_pk_bf16_f32 v246, v6, v7
v_cvt_pk_bf16_f32 v247, v8, v9
v_accvgpr_read_b32 v2, a152
v_accvgpr_read_b32 v3, a153
v_accvgpr_read_b32 v4, a154
v_accvgpr_read_b32 v5, a155
v_accvgpr_read_b32 v6, a184
v_accvgpr_read_b32 v7, a185
v_accvgpr_read_b32 v8, a186
v_accvgpr_read_b32 v9, a187
v_cvt_pk_bf16_f32 v248, v2, v3
v_cvt_pk_bf16_f32 v249, v4, v5
v_cvt_pk_bf16_f32 v250, v6, v7
v_cvt_pk_bf16_f32 v251, v8, v9
v_accvgpr_read_b32 v2, a156
v_accvgpr_read_b32 v3, a157
v_accvgpr_read_b32 v4, a158
v_accvgpr_read_b32 v5, a159
v_accvgpr_read_b32 v6, a188
v_accvgpr_read_b32 v7, a189
v_accvgpr_read_b32 v8, a190
v_accvgpr_read_b32 v9, a191
v_cvt_pk_bf16_f32 v252, v2, v3
v_cvt_pk_bf16_f32 v253, v4, v5
v_cvt_pk_bf16_f32 v254, v6, v7
v_cvt_pk_bf16_f32 v255, v8, v9
v_mfma_f32_32x32x16_bf16 a[128:143], v[10:13], v[10:13], 0
v_cvt_pk_bf16_f32 v191, v190, v191
v_cvt_pk_bf16_f32 v190, v188, v189
v_cvt_pk_bf16_f32 v189, v158, v159
v_cvt_pk_bf16_f32 v188, v156, v157
v_cvt_pk_bf16_f32 v187, v186, v187
v_cvt_pk_bf16_f32 v186, v184, v185
v_cvt_pk_bf16_f32 v185, v154, v155
v_cvt_pk_bf16_f32 v184, v152, v153
v_mfma_f32_32x32x16_bf16 a[144:159], v[10:13], v[10:13], 0
v_cvt_pk_bf16_f32 v183, v182, v183
v_cvt_pk_bf16_f32 v182, v180, v181
v_cvt_pk_bf16_f32 v181, v150, v151
v_cvt_pk_bf16_f32 v180, v148, v149
v_cvt_pk_bf16_f32 v179, v178, v179
v_cvt_pk_bf16_f32 v178, v176, v177
v_cvt_pk_bf16_f32 v177, v146, v147
v_cvt_pk_bf16_f32 v176, v144, v145
v_mfma_f32_32x32x16_bf16 a[160:175], v[10:13], v[10:13], 0
v_cvt_pk_bf16_f32 v175, v174, v175
v_cvt_pk_bf16_f32 v174, v172, v173
v_cvt_pk_bf16_f32 v173, v142, v143
v_cvt_pk_bf16_f32 v172, v140, v141
v_cvt_pk_bf16_f32 v171, v170, v171
v_cvt_pk_bf16_f32 v170, v168, v169
v_cvt_pk_bf16_f32 v169, v138, v139
v_cvt_pk_bf16_f32 v168, v136, v137
v_mfma_f32_32x32x16_bf16 a[176:191], v[10:13], v[10:13], 0
v_cvt_pk_bf16_f32 v167, v166, v167
v_cvt_pk_bf16_f32 v166, v164, v165
v_cvt_pk_bf16_f32 v165, v134, v135
v_cvt_pk_bf16_f32 v164, v132, v133
v_cvt_pk_bf16_f32 v163, v162, v163
v_cvt_pk_bf16_f32 v162, v160, v161
v_cvt_pk_bf16_f32 v161, v130, v131
v_cvt_pk_bf16_f32 v160, v128, v129
v_mfma_f32_32x32x16_bf16 a[192:207], v[10:13], v[10:13], 0
v_cvt_pk_bf16_f32 v128, v64, v65
v_cvt_pk_bf16_f32 v129, v66, v67
v_cvt_pk_bf16_f32 v130, v96, v97
v_cvt_pk_bf16_f32 v131, v98, v99
v_cvt_pk_bf16_f32 v132, v68, v69
v_cvt_pk_bf16_f32 v133, v70, v71
v_cvt_pk_bf16_f32 v134, v100, v101
v_cvt_pk_bf16_f32 v135, v102, v103
v_mfma_f32_32x32x16_bf16 a[208:223], v[10:13], v[10:13], 0
v_cvt_pk_bf16_f32 v136, v72, v73
v_cvt_pk_bf16_f32 v137, v74, v75
v_cvt_pk_bf16_f32 v138, v104, v105
v_cvt_pk_bf16_f32 v139, v106, v107
v_cvt_pk_bf16_f32 v140, v76, v77
v_cvt_pk_bf16_f32 v141, v78, v79
v_cvt_pk_bf16_f32 v142, v108, v109
v_cvt_pk_bf16_f32 v143, v110, v111
v_mfma_f32_32x32x16_bf16 a[224:239], v[10:13], v[10:13], 0
v_cvt_pk_bf16_f32 v144, v80, v81
v_cvt_pk_bf16_f32 v145, v82, v83
v_cvt_pk_bf16_f32 v146, v112, v113
v_cvt_pk_bf16_f32 v147, v114, v115
v_cvt_pk_bf16_f32 v148, v84, v85
v_cvt_pk_bf16_f32 v149, v86, v87
v_cvt_pk_bf16_f32 v150, v116, v117
v_cvt_pk_bf16_f32 v151, v118, v119
v_mfma_f32_32x32x16_bf16 a[240:255], v[10:13], v[10:13], 0
v_cvt_pk_bf16_f32 v152, v88, v89
v_cvt_pk_bf16_f32 v153, v90, v91
v_cvt_pk_bf16_f32 v154, v120, v121
v_cvt_pk_bf16_f32 v155, v122, v123
v_cvt_pk_bf16_f32 v156, v92, v93
v_cvt_pk_bf16_f32 v157, v94, v95
v_cvt_pk_bf16_f32 v158, v124, v125
v_cvt_pk_bf16_f32 v159, v126, v127
s_mov_b32 s43, 4096
s_mov_b32 s44, 8192
s_mov_b32 s73, s28
s_mov_b32 s74, s27
s_lshl_b32 s76, s27, 1
s_mov_b32 s27, s29
s_mov_b32 s72, 0
s_add_u32 s75, s74, s73
s_add_u32 s77, s76, s73
s_add_u32 s78, s76, s74
s_add_u32 s79, s76, s75
mega_kernel_qproj:
s_lshl_b32 s61, s67, 8
v_subrev_u32 v16, s61, v34
v_add_u32 v34, 0xffff0000, v16
v_subrev_u32 v17, s61, v35
v_add_u32 v35, 0xffff0000, v17
v_subrev_u32 v18, s61, v36
v_add_u32 v36, 0xffff0000, v18
v_subrev_u32 v19, s61, v37
v_add_u32 v37, 0xffff0000, v19
v_subrev_u32 v20, s61, v38
v_add_u32 v38, 0xffff0000, v20
v_subrev_u32 v21, s61, v39
v_add_u32 v39, 0xffff0000, v21
v_subrev_u32 v22, s61, v40
v_add_u32 v40, 0xffff0000, v22
v_subrev_u32 v23, s61, v41
v_add_u32 v41, 0xffff0000, v23
v_and_b32 v2, 15, v1
v_lshrrev_b32 v3, 1, v2
v_lshrrev_b32 v4, 4, v1
v_xor_b32 v3, v3, v4
v_lshlrev_b32 v3, 4, v3
v_lshl_add_u32 v3, v2, 7, v3
v_add_u32 v43, s25, v3
v_xor_b32 v44, 64, v43
v_add_u32 v32, 98304, v43
v_add_u32 v33, 98304, v44
s_mov_b32 s42, 0
s_cmp_ge_u32 s55, 24
s_cbranch_scc1 mega_kernel_early
mega_kernel_late:
s_lshl_b32 s21, s41, 1
s_add_u32 s6, s21, 2
s_lshl_b32 s6, s6, 15
s_lshl_b32 s61, s56, 20
s_add_u32 s4, s12, s61
s_addc_u32 s5, s13, 0
s_sub_u32 s4, s4, 16384
s_subb_u32 s5, s5, 0
s_add_u32 s6, s6, 16384
s_mov_b32 s16, 16384
s_mov_b32 s17, 0
v_lshlrev_b32 v2, 4, v1
v_add_u32 v56, s18, v2
v_add_u32 v57, 4096, v56
v_mov_b32 v48, v56
v_mov_b32 v49, v56
v_mov_b32 v50, v56
v_mov_b32 v51, v56
v_mov_b32 v52, v57
v_mov_b32 v53, v57
v_mov_b32 v54, v57
v_mov_b32 v55, v57
s_xor_b32 s28, s18, 16384
s_xor_b32 s29, s25, 8192
s_mov_b32 s33, 0
s_mov_b32 s34, 65536
s_mov_b32 s35, 0
s_mov_b32 s36, 98304
s_mov_b32 s37, 16384
s_mov_b32 s38, 0x15aa
s_cmp_ge_u32 s20, 2
s_cselect_b32 s38, 0x254, s38
s_cselect_b32 s40, 0x21, 0x1f
s_cselect_b32 s47, -1, 1
s_mul_i32 s45, s47, 262144
s_mul_i32 s46, s47, 57344
s_lshl_b32 s47, s47, 14
s_waitcnt vmcnt(8) lgkmcnt(0)
s_barrier
ds_read_b128 a[0:3], v32 offset:0
ds_read_b128 a[4:7], v32 offset:2048
s_add_u32 m0, s25, 0
s_nop 0
buffer_load_dwordx4 v14, s[68:71], s65 offen offset:0 lds
buffer_load_dwordx4 v15, s[68:71], s65 offen offset:1024 lds
buffer_load_dwordx4 v59, s[68:71], s65 offen offset:2048 lds
buffer_load_dwordx4 v61, s[68:71], s65 offen offset:3072 lds
s_add_u32 s65, s65, 128
ds_read_b64_tr_b16 a[64:65], v16 offset:0
ds_read_b64_tr_b16 a[66:67], v16 offset:2048
ds_read_b64_tr_b16 a[68:69], v17 offset:0
ds_read_b64_tr_b16 a[70:71], v17 offset:2048
ds_read_b64_tr_b16 a[72:73], v18 offset:0
ds_read_b64_tr_b16 a[74:75], v18 offset:2048
ds_read_b64_tr_b16 a[76:77], v19 offset:0
ds_read_b64_tr_b16 a[78:79], v19 offset:2048
ds_read_b64_tr_b16 a[80:81], v20 offset:0
ds_read_b64_tr_b16 a[82:83], v20 offset:2048
ds_read_b64_tr_b16 a[84:85], v21 offset:0
ds_read_b64_tr_b16 a[86:87], v21 offset:2048
ds_read_b64_tr_b16 a[88:89], v22 offset:0
ds_read_b64_tr_b16 a[90:91], v22 offset:2048
ds_read_b64_tr_b16 a[92:93], v23 offset:0
s_cmp_ge_u32 s20, 2
s_cbranch_scc1 mega_kernel_qP
mega_kernel_qD:
s_waitcnt lgkmcnt(7)
v_mfma_f32_16x16x32_bf16 a[128:131], a[64:67], a[0:3], a[128:131]
ds_read_b64_tr_b16 a[94:95], v23 offset:2048
ds_read_b128 a[8:11], v33 offset:0
v_mfma_f32_16x16x32_bf16 a[132:135], a[64:67], a[4:7], a[132:135]
ds_read_b64_tr_b16 a[96:97], v16 offset:256
ds_read_b128 a[12:15], v33 offset:2048
s_add_u32 m0, s25, s37
v_mfma_f32_16x16x32_bf16 a[136:139], a[68:71], a[0:3], a[136:139]
ds_read_b64_tr_b16 a[98:99], v16 offset:2304
buffer_load_dwordx4 v14, s[68:71], s65 offen offset:0 lds
v_mfma_f32_16x16x32_bf16 a[140:143], a[68:71], a[4:7], a[140:143]
s_lshl_b32 s24, s33, 2
ds_read_b64_tr_b16 a[100:101], v17 offset:256
v_mfma_f32_16x16x32_bf16 a[144:147], a[72:75], a[0:3], a[144:147]
ds_read_b64_tr_b16 a[102:103], v17 offset:2304
buffer_load_dwordx4 v15, s[68:71], s65 offen offset:1024 lds
v_mfma_f32_16x16x32_bf16 a[148:151], a[72:75], a[4:7], a[148:151]
s_lshr_b32 s32, 0x6406406, s24
ds_read_b64_tr_b16 a[104:105], v18 offset:256
v_mfma_f32_16x16x32_bf16 a[152:155], a[76:79], a[0:3], a[152:155]
ds_read_b64_tr_b16 a[106:107], v18 offset:2304
buffer_load_dwordx4 v59, s[68:71], s65 offen offset:2048 lds
v_mfma_f32_16x16x32_bf16 a[156:159], a[76:79], a[4:7], a[156:159]
ds_read_b64_tr_b16 a[108:109], v19 offset:256
s_waitcnt lgkmcnt(9)
v_mfma_f32_16x16x32_bf16 a[160:163], a[80:83], a[0:3], a[160:163]
s_lshr_b32 s39, 0x1076107, s24
ds_read_b64_tr_b16 a[110:111], v19 offset:2304
v_mfma_f32_16x16x32_bf16 a[164:167], a[80:83], a[4:7], a[164:167]
ds_read_b64_tr_b16 a[112:113], v20 offset:256
buffer_load_dwordx4 v61, s[68:71], s65 offen offset:3072 lds
v_mfma_f32_16x16x32_bf16 a[168:171], a[84:87], a[0:3], a[168:171]
ds_read_b64_tr_b16 a[114:115], v20 offset:2304
s_add_u32 s30, s65, s46
s_add_u32 m0, s29, s37
v_mfma_f32_16x16x32_bf16 a[172:175], a[84:87], a[4:7], a[172:175]
ds_read_b64_tr_b16 a[116:117], v21 offset:256
buffer_load_dwordx4 v14, s[68:71], s30 offen offset:0 lds
v_mfma_f32_16x16x32_bf16 a[176:179], a[88:91], a[0:3], a[176:179]
s_and_b32 s32, s32, 15
ds_read_b64_tr_b16 a[118:119], v21 offset:2304
v_mfma_f32_16x16x32_bf16 a[180:183], a[88:91], a[4:7], a[180:183]
ds_read_b64_tr_b16 a[120:121], v22 offset:256
buffer_load_dwordx4 v15, s[68:71], s30 offen offset:1024 lds
v_mfma_f32_16x16x32_bf16 a[184:187], a[92:95], a[0:3], a[184:187]
s_and_b32 s39, s39, 15
ds_read_b64_tr_b16 a[122:123], v22 offset:2304
v_mfma_f32_16x16x32_bf16 a[188:191], a[92:95], a[4:7], a[188:191]
ds_read_b64_tr_b16 a[124:125], v23 offset:256
s_waitcnt lgkmcnt(7)
v_mfma_f32_16x16x32_bf16 a[192:195], a[96:99], a[0:3], a[192:195]
s_lshl_b32 s39, s39, 14
ds_read_b64_tr_b16 a[126:127], v23 offset:2304
v_mfma_f32_16x16x32_bf16 a[196:199], a[96:99], a[4:7], a[196:199]
ds_read_b64_tr_b16 a[64:65], v16 offset:16384
buffer_load_dwordx4 v59, s[68:71], s30 offen offset:2048 lds
v_mfma_f32_16x16x32_bf16 a[200:203], a[100:103], a[0:3], a[200:203]
ds_read_b64_tr_b16 a[66:67], v16 offset:18432
v_add_u32 v32, s39, v43
v_mfma_f32_16x16x32_bf16 a[204:207], a[100:103], a[4:7], a[204:207]
ds_read_b64_tr_b16 a[68:69], v17 offset:16384
buffer_load_dwordx4 v61, s[68:71], s30 offen offset:3072 lds
v_mfma_f32_16x16x32_bf16 a[208:211], a[104:107], a[0:3], a[208:211]
ds_read_b64_tr_b16 a[70:71], v17 offset:18432
s_add_u32 m0, s18, s35
v_mfma_f32_16x16x32_bf16 a[212:215], a[104:107], a[4:7], a[212:215]
ds_read_b64_tr_b16 a[72:73], v18 offset:16384
buffer_load_dwordx4 v24, s[8:11], s19 offen offset:0 lds
v_mfma_f32_16x16x32_bf16 a[216:219], a[108:111], a[0:3], a[216:219]
ds_read_b64_tr_b16 a[74:75], v18 offset:18432
v_add_u32 v33, s39, v44
v_mfma_f32_16x16x32_bf16 a[220:223], a[108:111], a[4:7], a[220:223]
ds_read_b64_tr_b16 a[76:77], v19 offset:16384
s_waitcnt lgkmcnt(7)
v_mfma_f32_16x16x32_bf16 a[224:227], a[112:115], a[0:3], a[224:227]
ds_read_b64_tr_b16 a[78:79], v19 offset:18432
buffer_load_dwordx4 v25, s[8:11], s19 offen offset:1024 lds
v_mfma_f32_16x16x32_bf16 a[228:231], a[112:115], a[4:7], a[228:231]
s_lshl_b32 s32, s32, 14
ds_read_b64_tr_b16 a[80:81], v20 offset:16384
v_mfma_f32_16x16x32_bf16 a[232:235], a[116:119], a[0:3], a[232:235]
ds_read_b64_tr_b16 a[82:83], v20 offset:18432
buffer_load_dwordx4 v26, s[8:11], s19 offen offset:2048 lds
v_mfma_f32_16x16x32_bf16 a[236:239], a[116:119], a[4:7], a[236:239]
ds_read_b64_tr_b16 a[84:85], v21 offset:16384
v_mfma_f32_16x16x32_bf16 a[240:243], a[120:123], a[0:3], a[240:243]
ds_read_b64_tr_b16 a[86:87], v21 offset:18432
buffer_load_dwordx4 v27, s[8:11], s19 offen offset:3072 lds
v_mfma_f32_16x16x32_bf16 a[244:247], a[120:123], a[4:7], a[244:247]
ds_read_b64_tr_b16 a[88:89], v22 offset:16384
v_mfma_f32_16x16x32_bf16 a[248:251], a[124:127], a[0:3], a[248:251]
ds_read_b64_tr_b16 a[90:91], v22 offset:18432
v_mfma_f32_16x16x32_bf16 a[252:255], a[124:127], a[4:7], a[252:255]
ds_read_b64_tr_b16 a[92:93], v23 offset:16384
s_waitcnt lgkmcnt(7)
s_add_u32 m0, m0, 4096
v_mfma_f32_16x16x32_bf16 a[128:131], a[64:67], a[8:11], a[128:131]
ds_read_b64_tr_b16 a[94:95], v23 offset:18432
buffer_load_dwordx4 v28, s[8:11], s19 offen offset:0 lds
v_mfma_f32_16x16x32_bf16 a[132:135], a[64:67], a[12:15], a[132:135]
ds_read_b64_tr_b16 a[96:97], v16 offset:16640
v_mfma_f32_16x16x32_bf16 a[136:139], a[68:71], a[8:11], a[136:139]
ds_read_b64_tr_b16 a[98:99], v16 offset:18688
buffer_load_dwordx4 v29, s[8:11], s19 offen offset:1024 lds
v_mfma_f32_16x16x32_bf16 a[140:143], a[68:71], a[12:15], a[140:143]
ds_read_b64_tr_b16 a[100:101], v17 offset:16640
v_add_u32 v16, s32, v34
v_mfma_f32_16x16x32_bf16 a[144:147], a[72:75], a[8:11], a[144:147]
ds_read_b64_tr_b16 a[102:103], v17 offset:18688
buffer_load_dwordx4 v30, s[8:11], s19 offen offset:2048 lds
v_mfma_f32_16x16x32_bf16 a[148:151], a[72:75], a[12:15], a[148:151]
ds_read_b64_tr_b16 a[104:105], v18 offset:16640
v_add_u32 v17, s32, v35
v_mfma_f32_16x16x32_bf16 a[152:155], a[76:79], a[8:11], a[152:155]
ds_read_b64_tr_b16 a[106:107], v18 offset:18688
buffer_load_dwordx4 v31, s[8:11], s19 offen offset:3072 lds
v_mfma_f32_16x16x32_bf16 a[156:159], a[76:79], a[12:15], a[156:159]
ds_read_b64_tr_b16 a[108:109], v19 offset:16640
s_waitcnt lgkmcnt(7)
v_mfma_f32_16x16x32_bf16 a[160:163], a[80:83], a[8:11], a[160:163]
ds_read_b64_tr_b16 a[110:111], v19 offset:18688
s_add_u32 s30, s19, s45
s_add_u32 m0, s28, s35
v_mfma_f32_16x16x32_bf16 a[164:167], a[80:83], a[12:15], a[164:167]
ds_read_b64_tr_b16 a[112:113], v20 offset:16640
buffer_load_dwordx4 v24, s[8:11], s30 offen offset:0 lds
v_mfma_f32_16x16x32_bf16 a[168:171], a[84:87], a[8:11], a[168:171]
ds_read_b64_tr_b16 a[114:115], v20 offset:18688
v_add_u32 v18, s32, v36
v_mfma_f32_16x16x32_bf16 a[172:175], a[84:87], a[12:15], a[172:175]
ds_read_b64_tr_b16 a[116:117], v21 offset:16640
buffer_load_dwordx4 v25, s[8:11], s30 offen offset:1024 lds
v_mfma_f32_16x16x32_bf16 a[176:179], a[88:91], a[8:11], a[176:179]
ds_read_b64_tr_b16 a[118:119], v21 offset:18688
v_add_u32 v19, s32, v37
v_mfma_f32_16x16x32_bf16 a[180:183], a[88:91], a[12:15], a[180:183]
s_add_u32 s19, s19, s23
ds_read_b64_tr_b16 a[120:121], v22 offset:16640
v_mfma_f32_16x16x32_bf16 a[184:187], a[92:95], a[8:11], a[184:187]
ds_read_b64_tr_b16 a[122:123], v22 offset:18688
buffer_load_dwordx4 v26, s[8:11], s30 offen offset:2048 lds
v_mfma_f32_16x16x32_bf16 a[188:191], a[92:95], a[12:15], a[188:191]
ds_read_b64_tr_b16 a[124:125], v23 offset:16640
s_waitcnt lgkmcnt(7)
v_mfma_f32_16x16x32_bf16 a[192:195], a[96:99], a[8:11], a[192:195]
ds_read_b64_tr_b16 a[126:127], v23 offset:18688
v_add_u32 v20, s32, v38
v_mfma_f32_16x16x32_bf16 a[196:199], a[96:99], a[12:15], a[196:199]
buffer_load_dwordx4 v27, s[8:11], s30 offen offset:3072 lds
v_mfma_f32_16x16x32_bf16 a[200:203], a[100:103], a[8:11], a[200:203]
s_add_u32 s65, s65, 128
v_add_u32 v21, s32, v39
v_mfma_f32_16x16x32_bf16 a[204:207], a[100:103], a[12:15], a[204:207]
v_add_u32 v22, s32, v40
v_add_u32 v23, s32, v41
s_bitcmp0_b32 s40, s33
v_mfma_f32_16x16x32_bf16 a[208:211], a[104:107], a[8:11], a[208:211]
s_cbranch_scc1 mega_kernel_qDnw
s_waitcnt vmcnt(20)
mega_kernel_qDnw:
s_waitcnt vmcnt(36) lgkmcnt(0)
s_barrier
ds_read_b128 a[0:3], v32 offset:0
ds_read_b128 a[4:7], v32 offset:2048
v_mfma_f32_16x16x32_bf16 a[212:215], a[104:107], a[12:15], a[212:215]
ds_read_b64_tr_b16 a[64:65], v16 offset:0
ds_read_b64_tr_b16 a[66:67], v16 offset:2048
s_add_u32 m0, m0, 4096
v_mfma_f32_16x16x32_bf16 a[216:219], a[108:111], a[8:11], a[216:219]
ds_read_b64_tr_b16 a[68:69], v17 offset:0
buffer_load_dwordx4 v28, s[8:11], s30 offen offset:0 lds
v_mfma_f32_16x16x32_bf16 a[220:223], a[108:111], a[12:15], a[220:223]
ds_read_b64_tr_b16 a[70:71], v17 offset:2048
ds_read_b64_tr_b16 a[72:73], v18 offset:0
v_mfma_f32_16x16x32_bf16 a[224:227], a[112:115], a[8:11], a[224:227]
s_mov_b32 s35, s34
ds_read_b64_tr_b16 a[74:75], v18 offset:2048
v_mfma_f32_16x16x32_bf16 a[228:231], a[112:115], a[12:15], a[228:231]
ds_read_b64_tr_b16 a[76:77], v19 offset:0
buffer_load_dwordx4 v29, s[8:11], s30 offen offset:1024 lds
v_mfma_f32_16x16x32_bf16 a[232:235], a[116:119], a[8:11], a[232:235]
ds_read_b64_tr_b16 a[78:79], v19 offset:2048
ds_read_b64_tr_b16 a[80:81], v20 offset:0
v_mfma_f32_16x16x32_bf16 a[236:239], a[116:119], a[12:15], a[236:239]
ds_read_b64_tr_b16 a[82:83], v20 offset:2048
buffer_load_dwordx4 v30, s[8:11], s30 offen offset:2048 lds
v_mfma_f32_16x16x32_bf16 a[240:243], a[120:123], a[8:11], a[240:243]
s_mov_b32 s34, s32
ds_read_b64_tr_b16 a[84:85], v21 offset:0
v_mfma_f32_16x16x32_bf16 a[244:247], a[120:123], a[12:15], a[244:247]
ds_read_b64_tr_b16 a[86:87], v21 offset:2048
ds_read_b64_tr_b16 a[88:89], v22 offset:0
v_mfma_f32_16x16x32_bf16 a[248:251], a[124:127], a[8:11], a[248:251]
ds_read_b64_tr_b16 a[90:91], v22 offset:2048
buffer_load_dwordx4 v31, s[8:11], s30 offen offset:3072 lds
v_mfma_f32_16x16x32_bf16 a[252:255], a[124:127], a[12:15], a[252:255]
s_mov_b32 s37, s36
s_mov_b32 s36, s39
s_add_u32 s33, s33, 1
s_lshr_b32 s38, s38, 2
s_and_b32 s24, s38, 3
s_cmp_ge_u32 s33, 5
s_cselect_b32 s24, 3, s24
ds_read_b64_tr_b16 a[92:93], v23 offset:0
s_cmp_eq_u32 s24, 2
s_cbranch_scc1 mega_kernel_qD
s_branch mega_kernel_qN
mega_kernel_qP:
s_waitcnt lgkmcnt(7)
v_mfma_f32_16x16x32_bf16 a[128:131], a[64:67], a[0:3], a[128:131]
ds_read_b64_tr_b16 a[94:95], v23 offset:2048
ds_read_b128 a[8:11], v33 offset:0
v_mfma_f32_16x16x32_bf16 a[132:135], a[64:67], a[4:7], a[132:135]
ds_read_b64_tr_b16 a[96:97], v16 offset:256
ds_read_b128 a[12:15], v33 offset:2048
v_mfma_f32_16x16x32_bf16 a[136:139], a[68:71], a[0:3], a[136:139]
ds_read_b64_tr_b16 a[98:99], v16 offset:2304
v_mfma_f32_16x16x32_bf16 a[140:143], a[68:71], a[4:7], a[140:143]
s_lshl_b32 s24, s33, 2
ds_read_b64_tr_b16 a[100:101], v17 offset:256
v_mfma_f32_16x16x32_bf16 a[144:147], a[72:75], a[0:3], a[144:147]
s_lshr_b32 s32, 0x6406406, s24
ds_read_b64_tr_b16 a[102:103], v17 offset:2304
v_mfma_f32_16x16x32_bf16 a[148:151], a[72:75], a[4:7], a[148:151]
s_lshr_b32 s39, 0x1076107, s24
ds_read_b64_tr_b16 a[104:105], v18 offset:256
v_mfma_f32_16x16x32_bf16 a[152:155], a[76:79], a[0:3], a[152:155]
s_and_b32 s32, s32, 15
ds_read_b64_tr_b16 a[106:107], v18 offset:2304
v_mfma_f32_16x16x32_bf16 a[156:159], a[76:79], a[4:7], a[156:159]
ds_read_b64_tr_b16 a[108:109], v19 offset:256
s_waitcnt lgkmcnt(9)
v_mfma_f32_16x16x32_bf16 a[160:163], a[80:83], a[0:3], a[160:163]
ds_read_b64_tr_b16 a[110:111], v19 offset:2304
v_mfma_f32_16x16x32_bf16 a[164:167], a[80:83], a[4:7], a[164:167]
s_and_b32 s39, s39, 15
ds_read_b64_tr_b16 a[112:113], v20 offset:256
v_mfma_f32_16x16x32_bf16 a[168:171], a[84:87], a[0:3], a[168:171]
ds_read_b64_tr_b16 a[114:115], v20 offset:2304
v_mfma_f32_16x16x32_bf16 a[172:175], a[84:87], a[4:7], a[172:175]
ds_read_b64_tr_b16 a[116:117], v21 offset:256
v_mfma_f32_16x16x32_bf16 a[176:179], a[88:91], a[0:3], a[176:179]
s_lshl_b32 s39, s39, 14
ds_read_b64_tr_b16 a[118:119], v21 offset:2304
v_mfma_f32_16x16x32_bf16 a[180:183], a[88:91], a[4:7], a[180:183]
ds_read_b64_tr_b16 a[120:121], v22 offset:256
v_mfma_f32_16x16x32_bf16 a[184:187], a[92:95], a[0:3], a[184:187]
ds_read_b64_tr_b16 a[122:123], v22 offset:2304
v_mfma_f32_16x16x32_bf16 a[188:191], a[92:95], a[4:7], a[188:191]
ds_read_b64_tr_b16 a[124:125], v23 offset:256
s_waitcnt lgkmcnt(7)
v_mfma_f32_16x16x32_bf16 a[192:195], a[96:99], a[0:3], a[192:195]
ds_read_b64_tr_b16 a[126:127], v23 offset:2304
v_add_u32 v32, s39, v43
v_mfma_f32_16x16x32_bf16 a[196:199], a[96:99], a[4:7], a[196:199]
ds_read_b64_tr_b16 a[64:65], v16 offset:16384
v_mfma_f32_16x16x32_bf16 a[200:203], a[100:103], a[0:3], a[200:203]
ds_read_b64_tr_b16 a[66:67], v16 offset:18432
v_add_u32 v33, s39, v44
v_mfma_f32_16x16x32_bf16 a[204:207], a[100:103], a[4:7], a[204:207]
ds_read_b64_tr_b16 a[68:69], v17 offset:16384
v_mfma_f32_16x16x32_bf16 a[208:211], a[104:107], a[0:3], a[208:211]
ds_read_b64_tr_b16 a[70:71], v17 offset:18432
v_mfma_f32_16x16x32_bf16 a[212:215], a[104:107], a[4:7], a[212:215]
s_lshl_b32 s32, s32, 14
ds_read_b64_tr_b16 a[72:73], v18 offset:16384
v_mfma_f32_16x16x32_bf16 a[216:219], a[108:111], a[0:3], a[216:219]
ds_read_b64_tr_b16 a[74:75], v18 offset:18432
v_mfma_f32_16x16x32_bf16 a[220:223], a[108:111], a[4:7], a[220:223]
ds_read_b64_tr_b16 a[76:77], v19 offset:16384
s_waitcnt lgkmcnt(7)
v_mfma_f32_16x16x32_bf16 a[224:227], a[112:115], a[0:3], a[224:227]
ds_read_b64_tr_b16 a[78:79], v19 offset:18432
v_mfma_f32_16x16x32_bf16 a[228:231], a[112:115], a[4:7], a[228:231]
ds_read_b64_tr_b16 a[80:81], v20 offset:16384
v_mfma_f32_16x16x32_bf16 a[232:235], a[116:119], a[0:3], a[232:235]
ds_read_b64_tr_b16 a[82:83], v20 offset:18432
v_mfma_f32_16x16x32_bf16 a[236:239], a[116:119], a[4:7], a[236:239]
ds_read_b64_tr_b16 a[84:85], v21 offset:16384
v_mfma_f32_16x16x32_bf16 a[240:243], a[120:123], a[0:3], a[240:243]
ds_read_b64_tr_b16 a[86:87], v21 offset:18432
v_mfma_f32_16x16x32_bf16 a[244:247], a[120:123], a[4:7], a[244:247]
ds_read_b64_tr_b16 a[88:89], v22 offset:16384
v_mfma_f32_16x16x32_bf16 a[248:251], a[124:127], a[0:3], a[248:251]
ds_read_b64_tr_b16 a[90:91], v22 offset:18432
v_mfma_f32_16x16x32_bf16 a[252:255], a[124:127], a[4:7], a[252:255]
ds_read_b64_tr_b16 a[92:93], v23 offset:16384
s_waitcnt lgkmcnt(7)
v_mfma_f32_16x16x32_bf16 a[128:131], a[64:67], a[8:11], a[128:131]
ds_read_b64_tr_b16 a[94:95], v23 offset:18432
v_mfma_f32_16x16x32_bf16 a[132:135], a[64:67], a[12:15], a[132:135]
ds_read_b64_tr_b16 a[96:97], v16 offset:16640
v_mfma_f32_16x16x32_bf16 a[136:139], a[68:71], a[8:11], a[136:139]
ds_read_b64_tr_b16 a[98:99], v16 offset:18688
v_mfma_f32_16x16x32_bf16 a[140:143], a[68:71], a[12:15], a[140:143]
ds_read_b64_tr_b16 a[100:101], v17 offset:16640
v_add_u32 v16, s32, v34
v_mfma_f32_16x16x32_bf16 a[144:147], a[72:75], a[8:11], a[144:147]
ds_read_b64_tr_b16 a[102:103], v17 offset:18688
v_mfma_f32_16x16x32_bf16 a[148:151], a[72:75], a[12:15], a[148:151]
ds_read_b64_tr_b16 a[104:105], v18 offset:16640
v_add_u32 v17, s32, v35
v_mfma_f32_16x16x32_bf16 a[152:155], a[76:79], a[8:11], a[152:155]
ds_read_b64_tr_b16 a[106:107], v18 offset:18688
v_mfma_f32_16x16x32_bf16 a[156:159], a[76:79], a[12:15], a[156:159]
ds_read_b64_tr_b16 a[108:109], v19 offset:16640
s_waitcnt lgkmcnt(7)
v_mfma_f32_16x16x32_bf16 a[160:163], a[80:83], a[8:11], a[160:163]
ds_read_b64_tr_b16 a[110:111], v19 offset:18688
v_add_u32 v18, s32, v36
v_mfma_f32_16x16x32_bf16 a[164:167], a[80:83], a[12:15], a[164:167]
ds_read_b64_tr_b16 a[112:113], v20 offset:16640
v_add_u32 v19, s32, v37
v_mfma_f32_16x16x32_bf16 a[168:171], a[84:87], a[8:11], a[168:171]
s_add_u32 s19, s19, s23
ds_read_b64_tr_b16 a[114:115], v20 offset:18688
v_mfma_f32_16x16x32_bf16 a[172:175], a[84:87], a[12:15], a[172:175]
ds_read_b64_tr_b16 a[116:117], v21 offset:16640
v_add_u32 v20, s32, v38
v_mfma_f32_16x16x32_bf16 a[176:179], a[88:91], a[8:11], a[176:179]
s_add_u32 s65, s65, 128
ds_read_b64_tr_b16 a[118:119], v21 offset:18688
v_mfma_f32_16x16x32_bf16 a[180:183], a[88:91], a[12:15], a[180:183]
ds_read_b64_tr_b16 a[120:121], v22 offset:16640
v_add_u32 v21, s32, v39
v_mfma_f32_16x16x32_bf16 a[184:187], a[92:95], a[8:11], a[184:187]
s_mov_b32 s35, s34
ds_read_b64_tr_b16 a[122:123], v22 offset:18688
v_mfma_f32_16x16x32_bf16 a[188:191], a[92:95], a[12:15], a[188:191]
ds_read_b64_tr_b16 a[124:125], v23 offset:16640
s_waitcnt lgkmcnt(7)
v_mfma_f32_16x16x32_bf16 a[192:195], a[96:99], a[8:11], a[192:195]
ds_read_b64_tr_b16 a[126:127], v23 offset:18688
v_add_u32 v22, s32, v40
v_mfma_f32_16x16x32_bf16 a[196:199], a[96:99], a[12:15], a[196:199]
s_mov_b32 s34, s32
v_add_u32 v23, s32, v41
v_mfma_f32_16x16x32_bf16 a[200:203], a[100:103], a[8:11], a[200:203]
s_mov_b32 s37, s36
s_mov_b32 s36, s39
v_mfma_f32_16x16x32_bf16 a[204:207], a[100:103], a[12:15], a[204:207]
s_bitcmp0_b32 s40, s33
v_mfma_f32_16x16x32_bf16 a[208:211], a[104:107], a[8:11], a[208:211]
s_cbranch_scc1 mega_kernel_qPnw
s_waitcnt vmcnt(0)
mega_kernel_qPnw:
s_waitcnt vmcnt(36) lgkmcnt(0)
s_barrier
ds_read_b128 a[0:3], v32 offset:0
ds_read_b128 a[4:7], v32 offset:2048
v_mfma_f32_16x16x32_bf16 a[212:215], a[104:107], a[12:15], a[212:215]
ds_read_b64_tr_b16 a[64:65], v16 offset:0
ds_read_b64_tr_b16 a[66:67], v16 offset:2048
v_mfma_f32_16x16x32_bf16 a[216:219], a[108:111], a[8:11], a[216:219]
s_add_u32 s33, s33, 1
ds_read_b64_tr_b16 a[68:69], v17 offset:0
v_mfma_f32_16x16x32_bf16 a[220:223], a[108:111], a[12:15], a[220:223]
ds_read_b64_tr_b16 a[70:71], v17 offset:2048
ds_read_b64_tr_b16 a[72:73], v18 offset:0
v_mfma_f32_16x16x32_bf16 a[224:227], a[112:115], a[8:11], a[224:227]
s_lshr_b32 s38, s38, 2
ds_read_b64_tr_b16 a[74:75], v18 offset:2048
v_mfma_f32_16x16x32_bf16 a[228:231], a[112:115], a[12:15], a[228:231]
s_and_b32 s24, s38, 3
ds_read_b64_tr_b16 a[76:77], v19 offset:0
v_mfma_f32_16x16x32_bf16 a[232:235], a[116:119], a[8:11], a[232:235]
ds_read_b64_tr_b16 a[78:79], v19 offset:2048
ds_read_b64_tr_b16 a[80:81], v20 offset:0
v_mfma_f32_16x16x32_bf16 a[236:239], a[116:119], a[12:15], a[236:239]
ds_read_b64_tr_b16 a[82:83], v20 offset:2048
v_mfma_f32_16x16x32_bf16 a[240:243], a[120:123], a[8:11], a[240:243]
ds_read_b64_tr_b16 a[84:85], v21 offset:0
v_mfma_f32_16x16x32_bf16 a[244:247], a[120:123], a[12:15], a[244:247]
ds_read_b64_tr_b16 a[86:87], v21 offset:2048
ds_read_b64_tr_b16 a[88:89], v22 offset:0
v_mfma_f32_16x16x32_bf16 a[248:251], a[124:127], a[8:11], a[248:251]
ds_read_b64_tr_b16 a[90:91], v22 offset:2048
v_mfma_f32_16x16x32_bf16 a[252:255], a[124:127], a[12:15], a[252:255]
s_cmp_ge_u32 s33, 5
s_cselect_b32 s24, 3, s24
ds_read_b64_tr_b16 a[92:93], v23 offset:0
s_cmp_eq_u32 s24, 1
s_cbranch_scc0 mega_kernel_qN
mega_kernel_qS:
s_waitcnt lgkmcnt(7)
v_mfma_f32_16x16x32_bf16 a[128:131], a[64:67], a[0:3], a[128:131]
ds_read_b64_tr_b16 a[94:95], v23 offset:2048
ds_read_b128 a[8:11], v33 offset:0
v_mfma_f32_16x16x32_bf16 a[132:135], a[64:67], a[4:7], a[132:135]
ds_read_b64_tr_b16 a[96:97], v16 offset:256
ds_read_b128 a[12:15], v33 offset:2048
v_mfma_f32_16x16x32_bf16 a[136:139], a[68:71], a[0:3], a[136:139]
ds_read_b64_tr_b16 a[98:99], v16 offset:2304
s_cmp_lt_u32 s42, 128
s_cselect_b32 s31, s26, 0x7ff00000
s_set_gpr_idx_on s42, gpr_idx(SRC0)
v_mov_b64 v[64:65], v[128:129]
v_mov_b64 v[66:67], v[130:131]
v_mov_b64 v[68:69], v[132:133]
v_mov_b64 v[70:71], v[134:135]
s_set_gpr_idx_off
v_mfma_f32_16x16x32_bf16 a[140:143], a[68:71], a[4:7], a[140:143]
ds_read_b64_tr_b16 a[100:101], v17 offset:256
s_add_u32 s42, s42, 8
v_mfma_f32_16x16x32_bf16 a[144:147], a[72:75], a[0:3], a[144:147]
ds_read_b64_tr_b16 a[102:103], v17 offset:2304
buffer_store_dwordx4 v[64:67], v42, s[12:15], s31 offen offset:0 sc0 sc1
v_mfma_f32_16x16x32_bf16 a[148:151], a[72:75], a[4:7], a[148:151]
s_lshl_b32 s24, s33, 2
ds_read_b64_tr_b16 a[104:105], v18 offset:256
v_mfma_f32_16x16x32_bf16 a[152:155], a[76:79], a[0:3], a[152:155]
s_lshr_b32 s32, 0x6406406, s24
ds_read_b64_tr_b16 a[106:107], v18 offset:2304
v_mfma_f32_16x16x32_bf16 a[156:159], a[76:79], a[4:7], a[156:159]
ds_read_b64_tr_b16 a[108:109], v19 offset:256
buffer_store_dwordx4 v[68:71], v42, s[12:15], s31 offen offset:1024 sc0 sc1
s_waitcnt lgkmcnt(9)
v_mfma_f32_16x16x32_bf16 a[160:163], a[80:83], a[0:3], a[160:163]
s_lshr_b32 s39, 0x1076107, s24
ds_read_b64_tr_b16 a[110:111], v19 offset:2304
v_mfma_f32_16x16x32_bf16 a[164:167], a[80:83], a[4:7], a[164:167]
s_and_b32 s32, s32, 15
ds_read_b64_tr_b16 a[112:113], v20 offset:256
v_mfma_f32_16x16x32_bf16 a[168:171], a[84:87], a[0:3], a[168:171]
ds_read_b64_tr_b16 a[114:115], v20 offset:2304
s_set_gpr_idx_on s42, gpr_idx(SRC0)
v_mov_b64 v[72:73], v[128:129]
v_mov_b64 v[74:75], v[130:131]
v_mov_b64 v[76:77], v[132:133]
v_mov_b64 v[78:79], v[134:135]
s_set_gpr_idx_off
v_mfma_f32_16x16x32_bf16 a[172:175], a[84:87], a[4:7], a[172:175]
ds_read_b64_tr_b16 a[116:117], v21 offset:256
s_add_u32 s42, s42, 8
v_mfma_f32_16x16x32_bf16 a[176:179], a[88:91], a[0:3], a[176:179]
ds_read_b64_tr_b16 a[118:119], v21 offset:2304
buffer_store_dwordx4 v[72:75], v42, s[12:15], s31 offen offset:2048 sc0 sc1
v_mfma_f32_16x16x32_bf16 a[180:183], a[88:91], a[4:7], a[180:183]
s_and_b32 s39, s39, 15
ds_read_b64_tr_b16 a[120:121], v22 offset:256
v_mfma_f32_16x16x32_bf16 a[184:187], a[92:95], a[0:3], a[184:187]
s_lshl_b32 s39, s39, 14
ds_read_b64_tr_b16 a[122:123], v22 offset:2304
v_mfma_f32_16x16x32_bf16 a[188:191], a[92:95], a[4:7], a[188:191]
ds_read_b64_tr_b16 a[124:125], v23 offset:256
buffer_store_dwordx4 v[76:79], v42, s[12:15], s31 offen offset:3072 sc0 sc1
s_waitcnt lgkmcnt(7)
v_mfma_f32_16x16x32_bf16 a[192:195], a[96:99], a[0:3], a[192:195]
ds_read_b64_tr_b16 a[126:127], v23 offset:2304
s_add_u32 s26, s26, s43
v_mfma_f32_16x16x32_bf16 a[196:199], a[96:99], a[4:7], a[196:199]
s_xor_b32 s43, s43, s44
ds_read_b64_tr_b16 a[64:65], v16 offset:16384
v_mfma_f32_16x16x32_bf16 a[200:203], a[100:103], a[0:3], a[200:203]
ds_read_b64_tr_b16 a[66:67], v16 offset:18432
s_cmp_lt_u32 s42, 128
s_cselect_b32 s31, s26, 0x7ff00000
s_set_gpr_idx_on s42, gpr_idx(SRC0)
v_mov_b64 v[64:65], v[128:129]
v_mov_b64 v[66:67], v[130:131]
v_mov_b64 v[68:69], v[132:133]
v_mov_b64 v[70:71], v[134:135]
s_set_gpr_idx_off
v_mfma_f32_16x16x32_bf16 a[204:207], a[100:103], a[4:7], a[204:207]
ds_read_b64_tr_b16 a[68:69], v17 offset:16384
s_add_u32 s42, s42, 8
v_mfma_f32_16x16x32_bf16 a[208:211], a[104:107], a[0:3], a[208:211]
ds_read_b64_tr_b16 a[70:71], v17 offset:18432
buffer_store_dwordx4 v[64:67], v42, s[12:15], s31 offen offset:0 sc0 sc1
v_mfma_f32_16x16x32_bf16 a[212:215], a[104:107], a[4:7], a[212:215]
ds_read_b64_tr_b16 a[72:73], v18 offset:16384
v_add_u32 v32, s39, v43
v_mfma_f32_16x16x32_bf16 a[216:219], a[108:111], a[0:3], a[216:219]
ds_read_b64_tr_b16 a[74:75], v18 offset:18432
v_add_u32 v33, s39, v44
v_mfma_f32_16x16x32_bf16 a[220:223], a[108:111], a[4:7], a[220:223]
ds_read_b64_tr_b16 a[76:77], v19 offset:16384
buffer_store_dwordx4 v[68:71], v42, s[12:15], s31 offen offset:1024 sc0 sc1
s_waitcnt lgkmcnt(7)
v_mfma_f32_16x16x32_bf16 a[224:227], a[112:115], a[0:3], a[224:227]
s_lshl_b32 s32, s32, 14
ds_read_b64_tr_b16 a[78:79], v19 offset:18432
v_mfma_f32_16x16x32_bf16 a[228:231], a[112:115], a[4:7], a[228:231]
ds_read_b64_tr_b16 a[80:81], v20 offset:16384
v_mfma_f32_16x16x32_bf16 a[232:235], a[116:119], a[0:3], a[232:235]
ds_read_b64_tr_b16 a[82:83], v20 offset:18432
s_set_gpr_idx_on s42, gpr_idx(SRC0)
v_mov_b64 v[72:73], v[128:129]
v_mov_b64 v[74:75], v[130:131]
v_mov_b64 v[76:77], v[132:133]
v_mov_b64 v[78:79], v[134:135]
s_set_gpr_idx_off
v_mfma_f32_16x16x32_bf16 a[236:239], a[116:119], a[4:7], a[236:239]
ds_read_b64_tr_b16 a[84:85], v21 offset:16384
s_add_u32 s42, s42, 8
v_mfma_f32_16x16x32_bf16 a[240:243], a[120:123], a[0:3], a[240:243]
ds_read_b64_tr_b16 a[86:87], v21 offset:18432
buffer_store_dwordx4 v[72:75], v42, s[12:15], s31 offen offset:2048 sc0 sc1
v_mfma_f32_16x16x32_bf16 a[244:247], a[120:123], a[4:7], a[244:247]
ds_read_b64_tr_b16 a[88:89], v22 offset:16384
v_mfma_f32_16x16x32_bf16 a[248:251], a[124:127], a[0:3], a[248:251]
ds_read_b64_tr_b16 a[90:91], v22 offset:18432
v_mfma_f32_16x16x32_bf16 a[252:255], a[124:127], a[4:7], a[252:255]
ds_read_b64_tr_b16 a[92:93], v23 offset:16384
buffer_store_dwordx4 v[76:79], v42, s[12:15], s31 offen offset:3072 sc0 sc1
s_waitcnt lgkmcnt(7)
v_mfma_f32_16x16x32_bf16 a[128:131], a[64:67], a[8:11], a[128:131]
ds_read_b64_tr_b16 a[94:95], v23 offset:18432
s_add_u32 s26, s26, s43
v_mfma_f32_16x16x32_bf16 a[132:135], a[64:67], a[12:15], a[132:135]
s_xor_b32 s43, s43, s44
ds_read_b64_tr_b16 a[96:97], v16 offset:16640
v_mfma_f32_16x16x32_bf16 a[136:139], a[68:71], a[8:11], a[136:139]
ds_read_b64_tr_b16 a[98:99], v16 offset:18688
s_cmp_lt_u32 s42, 128
s_cselect_b32 s31, s26, 0x7ff00000
s_set_gpr_idx_on s42, gpr_idx(SRC0)
v_mov_b64 v[64:65], v[128:129]
v_mov_b64 v[66:67], v[130:131]
v_mov_b64 v[68:69], v[132:133]
v_mov_b64 v[70:71], v[134:135]
s_set_gpr_idx_off
v_mfma_f32_16x16x32_bf16 a[140:143], a[68:71], a[12:15], a[140:143]
ds_read_b64_tr_b16 a[100:101], v17 offset:16640
s_add_u32 s42, s42, 8
v_mfma_f32_16x16x32_bf16 a[144:147], a[72:75], a[8:11], a[144:147]
ds_read_b64_tr_b16 a[102:103], v17 offset:18688
buffer_store_dwordx4 v[64:67], v42, s[12:15], s31 offen offset:0 sc0 sc1
v_mfma_f32_16x16x32_bf16 a[148:151], a[72:75], a[12:15], a[148:151]
ds_read_b64_tr_b16 a[104:105], v18 offset:16640
v_add_u32 v16, s32, v34
v_mfma_f32_16x16x32_bf16 a[152:155], a[76:79], a[8:11], a[152:155]
ds_read_b64_tr_b16 a[106:107], v18 offset:18688
v_add_u32 v17, s32, v35
v_mfma_f32_16x16x32_bf16 a[156:159], a[76:79], a[12:15], a[156:159]
ds_read_b64_tr_b16 a[108:109], v19 offset:16640
buffer_store_dwordx4 v[68:71], v42, s[12:15], s31 offen offset:1024 sc0 sc1
s_waitcnt lgkmcnt(7)
v_mfma_f32_16x16x32_bf16 a[160:163], a[80:83], a[8:11], a[160:163]
ds_read_b64_tr_b16 a[110:111], v19 offset:18688
v_add_u32 v18, s32, v36
v_mfma_f32_16x16x32_bf16 a[164:167], a[80:83], a[12:15], a[164:167]
ds_read_b64_tr_b16 a[112:113], v20 offset:16640
v_add_u32 v19, s32, v37
v_mfma_f32_16x16x32_bf16 a[168:171], a[84:87], a[8:11], a[168:171]
ds_read_b64_tr_b16 a[114:115], v20 offset:18688
s_set_gpr_idx_on s42, gpr_idx(SRC0)
v_mov_b64 v[72:73], v[128:129]
v_mov_b64 v[74:75], v[130:131]
v_mov_b64 v[76:77], v[132:133]
v_mov_b64 v[78:79], v[134:135]
s_set_gpr_idx_off
v_mfma_f32_16x16x32_bf16 a[172:175], a[84:87], a[12:15], a[172:175]
ds_read_b64_tr_b16 a[116:117], v21 offset:16640
s_add_u32 s42, s42, 8
v_mfma_f32_16x16x32_bf16 a[176:179], a[88:91], a[8:11], a[176:179]
ds_read_b64_tr_b16 a[118:119], v21 offset:18688
buffer_store_dwordx4 v[72:75], v42, s[12:15], s31 offen offset:2048 sc0 sc1
v_mfma_f32_16x16x32_bf16 a[180:183], a[88:91], a[12:15], a[180:183]
s_add_u32 s19, s19, s23
ds_read_b64_tr_b16 a[120:121], v22 offset:16640
v_mfma_f32_16x16x32_bf16 a[184:187], a[92:95], a[8:11], a[184:187]
ds_read_b64_tr_b16 a[122:123], v22 offset:18688
v_add_u32 v20, s32, v38
v_mfma_f32_16x16x32_bf16 a[188:191], a[92:95], a[12:15], a[188:191]
ds_read_b64_tr_b16 a[124:125], v23 offset:16640
buffer_store_dwordx4 v[76:79], v42, s[12:15], s31 offen offset:3072 sc0 sc1
s_waitcnt lgkmcnt(7)
v_mfma_f32_16x16x32_bf16 a[192:195], a[96:99], a[8:11], a[192:195]
ds_read_b64_tr_b16 a[126:127], v23 offset:18688
s_add_u32 s26, s26, s43
v_mfma_f32_16x16x32_bf16 a[196:199], a[96:99], a[12:15], a[196:199]
s_xor_b32 s43, s43, s44
s_add_u32 s65, s65, 128
v_mfma_f32_16x16x32_bf16 a[200:203], a[100:103], a[8:11], a[200:203]
v_add_u32 v21, s32, v39
s_min_u32 s42, s42, 128
v_mfma_f32_16x16x32_bf16 a[204:207], a[100:103], a[12:15], a[204:207]
v_add_u32 v22, s32, v40
v_add_u32 v23, s32, v41
s_bitcmp0_b32 s40, s33
v_mfma_f32_16x16x32_bf16 a[208:211], a[104:107], a[8:11], a[208:211]
s_cbranch_scc1 mega_kernel_qSnw
s_waitcnt vmcnt(12)
mega_kernel_qSnw:
s_waitcnt vmcnt(36) lgkmcnt(0)
s_barrier
ds_read_b128 a[0:3], v32 offset:0
ds_read_b128 a[4:7], v32 offset:2048
v_mfma_f32_16x16x32_bf16 a[212:215], a[104:107], a[12:15], a[212:215]
ds_read_b64_tr_b16 a[64:65], v16 offset:0
ds_read_b64_tr_b16 a[66:67], v16 offset:2048
v_mfma_f32_16x16x32_bf16 a[216:219], a[108:111], a[8:11], a[216:219]
s_mov_b32 s35, s34
ds_read_b64_tr_b16 a[68:69], v17 offset:0
v_mfma_f32_16x16x32_bf16 a[220:223], a[108:111], a[12:15], a[220:223]
ds_read_b64_tr_b16 a[70:71], v17 offset:2048
ds_read_b64_tr_b16 a[72:73], v18 offset:0
v_mfma_f32_16x16x32_bf16 a[224:227], a[112:115], a[8:11], a[224:227]
s_mov_b32 s34, s32
ds_read_b64_tr_b16 a[74:75], v18 offset:2048
v_mfma_f32_16x16x32_bf16 a[228:231], a[112:115], a[12:15], a[228:231]
s_mov_b32 s37, s36
ds_read_b64_tr_b16 a[76:77], v19 offset:0
v_mfma_f32_16x16x32_bf16 a[232:235], a[116:119], a[8:11], a[232:235]
ds_read_b64_tr_b16 a[78:79], v19 offset:2048
ds_read_b64_tr_b16 a[80:81], v20 offset:0
v_mfma_f32_16x16x32_bf16 a[236:239], a[116:119], a[12:15], a[236:239]
s_mov_b32 s36, s39
ds_read_b64_tr_b16 a[82:83], v20 offset:2048
v_mfma_f32_16x16x32_bf16 a[240:243], a[120:123], a[8:11], a[240:243]
s_add_u32 s33, s33, 1
ds_read_b64_tr_b16 a[84:85], v21 offset:0
v_mfma_f32_16x16x32_bf16 a[244:247], a[120:123], a[12:15], a[244:247]
ds_read_b64_tr_b16 a[86:87], v21 offset:2048
ds_read_b64_tr_b16 a[88:89], v22 offset:0
v_mfma_f32_16x16x32_bf16 a[248:251], a[124:127], a[8:11], a[248:251]
s_lshr_b32 s38, s38, 2
ds_read_b64_tr_b16 a[90:91], v22 offset:2048
v_mfma_f32_16x16x32_bf16 a[252:255], a[124:127], a[12:15], a[252:255]
s_and_b32 s24, s38, 3
s_cmp_ge_u32 s33, 5
s_cselect_b32 s24, 3, s24
ds_read_b64_tr_b16 a[92:93], v23 offset:0
s_cmp_eq_u32 s24, 1
s_cbranch_scc1 mega_kernel_qS
mega_kernel_qN:
s_cmp_eq_u32 s24, 1
s_cbranch_scc1 mega_kernel_qS
s_cmp_eq_u32 s24, 2
s_cbranch_scc1 mega_kernel_qD
s_cmp_eq_u32 s33, 6
s_cbranch_scc1 mega_kernel_qG6
s_cmp_eq_u32 s33, 7
s_cbranch_scc1 mega_kernel_qX
s_add_u32 s8, s4, 16793600
s_addc_u32 s9, s5, 0
s_sub_u32 s10, s6, 16384
s_cmp_lt_u32 s20, 2
s_cbranch_scc1 mega_kernel_qS
s_lshl_b32 s61, s56, 2
v_mov_b32 v3, s61
global_load_dword v2, v3, s[52:53] sc1
s_branch mega_kernel_qP
mega_kernel_qG6:
s_cmp_lt_u32 s20, 2
s_cbranch_scc1 mega_kernel_qS
v_readfirstlane_b32 s61, v2
s_add_u32 s30, s16, s47
s_and_b32 s61, s61, 255
s_cmp_lt_u32 s61, 4
s_cbranch_scc1 mega_kernel_chk
mega_kernel_chkr:
s_add_u32 m0, s18, 98304
s_nop 0
buffer_load_dwordx4 v48, s[4:7], s16 offen offset:0 sc1 lds
buffer_load_dwordx4 v49, s[4:7], s16 offen offset:1024 sc1 lds
buffer_load_dwordx4 v50, s[4:7], s16 offen offset:2048 sc1 lds
buffer_load_dwordx4 v51, s[4:7], s16 offen offset:3072 sc1 lds
s_add_u32 m0, s18, 102400
s_nop 0
buffer_load_dwordx4 v52, s[4:7], s16 offen offset:0 sc1 lds
buffer_load_dwordx4 v53, s[4:7], s16 offen offset:1024 sc1 lds
buffer_load_dwordx4 v54, s[4:7], s16 offen offset:2048 sc1 lds
buffer_load_dwordx4 v55, s[4:7], s16 offen offset:3072 sc1 lds
s_add_u32 m0, s28, 98304
s_nop 0
buffer_load_dwordx4 v48, s[4:7], s30 offen offset:0 sc1 lds
buffer_load_dwordx4 v49, s[4:7], s30 offen offset:1024 sc1 lds
buffer_load_dwordx4 v50, s[4:7], s30 offen offset:2048 sc1 lds
buffer_load_dwordx4 v51, s[4:7], s30 offen offset:3072 sc1 lds
s_add_u32 m0, s28, 102400
s_nop 0
buffer_load_dwordx4 v52, s[4:7], s30 offen offset:0 sc1 lds
buffer_load_dwordx4 v53, s[4:7], s30 offen offset:1024 sc1 lds
buffer_load_dwordx4 v54, s[4:7], s30 offen offset:2048 sc1 lds
buffer_load_dwordx4 v55, s[4:7], s30 offen offset:3072 sc1 lds
s_branch mega_kernel_qP
mega_kernel_qX:
s_add_u32 s16, s16, 32768
s_mov_b32 s60, 0x3db8aa3b
s_mov_b32 s61, s60
v_lshlrev_b32 v16, 4, v1
v_add_u32 v17, 0x10000, v16
v_add_u32 v58, 14336, v16
v_lshrrev_b32 v2, 4, v1
v_lshlrev_b32 v2, 2, v2
v_and_b32 v3, 15, v1
v_sub_u32 v20, v2, v3
s_mov_b32 s22, 1106247680
s_lshl_b32 s24, s20, 5
s_mov_b32 s19, 1
s_mov_b32 s26, 32768
v_accvgpr_read_b32 v128, a128
v_accvgpr_read_b32 v129, a129
v_accvgpr_read_b32 v130, a130
v_accvgpr_read_b32 v131, a131
v_accvgpr_read_b32 v132, a136
v_accvgpr_read_b32 v133, a137
v_accvgpr_read_b32 v134, a138
v_accvgpr_read_b32 v135, a139
v_mul_f32 v128, s60, v128
v_mul_f32 v129, s60, v129
v_mul_f32 v130, s60, v130
v_mul_f32 v131, s60, v131
v_mul_f32 v132, s60, v132
v_mul_f32 v133, s60, v133
v_mul_f32 v134, s60, v134
v_mul_f32 v135, s60, v135
v_cvt_pk_bf16_f32 v192, v128, v129
v_cvt_pk_bf16_f32 v193, v130, v131
v_cvt_pk_bf16_f32 v194, v132, v133
v_cvt_pk_bf16_f32 v195, v134, v135
v_accvgpr_read_b32 v136, a132
v_accvgpr_read_b32 v137, a133
v_accvgpr_read_b32 v138, a134
v_accvgpr_read_b32 v139, a135
v_accvgpr_read_b32 v140, a140
v_accvgpr_read_b32 v141, a141
v_accvgpr_read_b32 v142, a142
v_accvgpr_read_b32 v143, a143
v_mul_f32 v136, s60, v136
v_mul_f32 v137, s60, v137
v_mul_f32 v138, s60, v138
v_mul_f32 v139, s60, v139
v_mul_f32 v140, s60, v140
v_mul_f32 v141, s60, v141
v_mul_f32 v142, s60, v142
v_mul_f32 v143, s60, v143
v_cvt_pk_bf16_f32 v224, v136, v137
v_cvt_pk_bf16_f32 v225, v138, v139
v_cvt_pk_bf16_f32 v226, v140, v141
v_cvt_pk_bf16_f32 v227, v142, v143
s_cmp_lt_u32 s20, 2
s_cbranch_scc1 mega_kernel_k0w
s_waitcnt vmcnt(0)
mega_kernel_k0w:
s_waitcnt vmcnt(36) lgkmcnt(0)
s_barrier
ds_read_b128 a[64:67], v17 offset:32768
ds_read_b128 a[68:71], v17 offset:40960
ds_read_b128 a[72:75], v17 offset:49152
ds_read_b128 a[76:79], v17 offset:57344
ds_read_b128 a[80:83], v17 offset:33792
ds_read_b128 a[84:87], v17 offset:41984
ds_read_b128 a[88:91], v17 offset:50176
ds_read_b128 a[92:95], v17 offset:58368
ds_read_b128 a[96:99], v17 offset:34816
v_mfma_f32_32x32x16_bf16 a[0:15], v[10:13], v[10:13], 0
v_mfma_f32_32x32x16_bf16 a[16:31], v[10:13], v[10:13], 0
v_mfma_f32_32x32x16_bf16 a[32:47], v[10:13], v[10:13], 0
v_mfma_f32_32x32x16_bf16 a[48:63], v[10:13], v[10:13], 0
s_waitcnt lgkmcnt(5)
s_add_u32 m0, s18, 65536
v_mfma_f32_16x16x32_bf16 v[64:67], a[64:67], v[192:195], 0
ds_read_b128 a[100:103], v17 offset:43008
v_accvgpr_read_b32 v128, a144
v_accvgpr_read_b32 v129, a145
v_accvgpr_read_b32 v130, a146
v_accvgpr_read_b32 v131, a147
v_accvgpr_read_b32 v132, a152
v_accvgpr_read_b32 v133, a153
v_accvgpr_read_b32 v134, a154
v_mfma_f32_16x16x32_bf16 v[68:71], a[64:67], v[224:227], 0
ds_read_b128 a[104:107], v17 offset:51200
v_accvgpr_read_b32 v135, a155
v_mul_f32 v128, s60, v128
v_mul_f32 v129, s60, v129
v_mul_f32 v130, s60, v130
v_mul_f32 v131, s60, v131
v_mul_f32 v132, s60, v132
v_mul_f32 v133, s60, v133
v_mfma_f32_16x16x32_bf16 v[72:75], a[68:71], v[192:195], 0
v_mul_f32 v134, s60, v134
v_mul_f32 v135, s60, v135
v_cvt_pk_bf16_f32 v196, v128, v129
v_cvt_pk_bf16_f32 v197, v130, v131
v_cvt_pk_bf16_f32 v198, v132, v133
v_cvt_pk_bf16_f32 v199, v134, v135
v_mfma_f32_16x16x32_bf16 v[76:79], a[68:71], v[224:227], 0
ds_read_b128 a[108:111], v17 offset:59392
v_accvgpr_read_b32 v136, a148
v_accvgpr_read_b32 v137, a149
v_accvgpr_read_b32 v138, a150
v_accvgpr_read_b32 v139, a151
v_accvgpr_read_b32 v140, a156
v_accvgpr_read_b32 v141, a157
v_accvgpr_read_b32 v142, a158
v_mfma_f32_16x16x32_bf16 v[80:83], a[72:75], v[192:195], 0
v_accvgpr_read_b32 v143, a159
v_mul_f32 v136, s60, v136
v_mul_f32 v137, s60, v137
v_mul_f32 v138, s60, v138
v_mul_f32 v139, s60, v139
v_mul_f32 v140, s60, v140
v_mul_f32 v141, s60, v141
v_mfma_f32_16x16x32_bf16 v[84:87], a[72:75], v[224:227], 0
ds_read_b128 a[112:115], v17 offset:35840
v_mul_f32 v142, s60, v142
v_mul_f32 v143, s60, v143
v_cvt_pk_bf16_f32 v228, v136, v137
v_cvt_pk_bf16_f32 v229, v138, v139
v_cvt_pk_bf16_f32 v230, v140, v141
v_cvt_pk_bf16_f32 v231, v142, v143
v_mfma_f32_16x16x32_bf16 v[88:91], a[76:79], v[192:195], 0
buffer_load_dwordx4 v48, s[4:7], s16 offen offset:0 sc1 lds
v_mfma_f32_16x16x32_bf16 v[92:95], a[76:79], v[224:227], 0
ds_read_b128 a[116:119], v17 offset:44032
s_waitcnt lgkmcnt(6)
v_mfma_f32_16x16x32_bf16 v[64:67], a[80:83], v[196:199], v[64:67]
v_accvgpr_read_b32 v128, a160
v_accvgpr_read_b32 v129, a161
v_accvgpr_read_b32 v130, a162
v_accvgpr_read_b32 v131, a163
v_accvgpr_read_b32 v132, a168
v_accvgpr_read_b32 v133, a169
v_accvgpr_read_b32 v134, a170
v_mfma_f32_16x16x32_bf16 v[68:71], a[80:83], v[228:231], v[68:71]
ds_read_b128 a[120:123], v17 offset:52224
v_accvgpr_read_b32 v135, a171
v_mul_f32 v128, s60, v128
v_mul_f32 v129, s60, v129
v_mul_f32 v130, s60, v130
v_mul_f32 v131, s60, v131
v_mul_f32 v132, s60, v132
v_mul_f32 v133, s60, v133
v_mfma_f32_16x16x32_bf16 v[72:75], a[84:87], v[196:199], v[72:75]
ds_read_b128 a[124:127], v17 offset:60416
v_mul_f32 v134, s60, v134
v_mul_f32 v135, s60, v135
v_cvt_pk_bf16_f32 v200, v128, v129
v_cvt_pk_bf16_f32 v201, v130, v131
v_cvt_pk_bf16_f32 v202, v132, v133
v_cvt_pk_bf16_f32 v203, v134, v135
v_mfma_f32_16x16x32_bf16 v[76:79], a[84:87], v[228:231], v[76:79]
v_accvgpr_read_b32 v136, a164
v_accvgpr_read_b32 v137, a165
v_accvgpr_read_b32 v138, a166
v_accvgpr_read_b32 v139, a167
v_accvgpr_read_b32 v140, a172
v_accvgpr_read_b32 v141, a173
v_accvgpr_read_b32 v142, a174
v_mfma_f32_16x16x32_bf16 v[80:83], a[88:91], v[196:199], v[80:83]
ds_read_b128 a[64:67], v17 offset:36864
v_accvgpr_read_b32 v143, a175
v_mul_f32 v136, s60, v136
v_mul_f32 v137, s60, v137
v_mul_f32 v138, s60, v138
v_mul_f32 v139, s60, v139
v_mul_f32 v140, s60, v140
v_mul_f32 v141, s60, v141
v_mfma_f32_16x16x32_bf16 v[84:87], a[88:91], v[228:231], v[84:87]
v_mul_f32 v142, s60, v142
v_mul_f32 v143, s60, v143
v_cvt_pk_bf16_f32 v232, v136, v137
v_cvt_pk_bf16_f32 v233, v138, v139
v_cvt_pk_bf16_f32 v234, v140, v141
v_cvt_pk_bf16_f32 v235, v142, v143
v_mfma_f32_16x16x32_bf16 v[88:91], a[92:95], v[196:199], v[88:91]
s_lshl_b32 s44, s56, 2
ds_read_b128 a[68:71], v17 offset:45056
v_mfma_f32_16x16x32_bf16 v[92:95], a[92:95], v[228:231], v[92:95]
v_mov_b32 v60, s44
s_waitcnt lgkmcnt(6)
v_mfma_f32_16x16x32_bf16 v[64:67], a[96:99], v[200:203], v[64:67]
ds_read_b128 a[72:75], v17 offset:53248
v_accvgpr_read_b32 v128, a176
v_accvgpr_read_b32 v129, a177
v_accvgpr_read_b32 v130, a178
v_accvgpr_read_b32 v131, a179
v_accvgpr_read_b32 v132, a184
v_accvgpr_read_b32 v133, a185
v_accvgpr_read_b32 v134, a186
v_mfma_f32_16x16x32_bf16 v[68:71], a[96:99], v[232:235], v[68:71]
v_accvgpr_read_b32 v135, a187
v_mul_f32 v128, s60, v128
v_mul_f32 v129, s60, v129
v_mul_f32 v130, s60, v130
v_mul_f32 v131, s60, v131
v_mul_f32 v132, s60, v132
v_mul_f32 v133, s60, v133
v_mfma_f32_16x16x32_bf16 v[72:75], a[100:103], v[200:203], v[72:75]
ds_read_b128 a[76:79], v17 offset:61440
v_mul_f32 v134, s60, v134
v_mul_f32 v135, s60, v135
v_cvt_pk_bf16_f32 v204, v128, v129
v_cvt_pk_bf16_f32 v205, v130, v131
v_cvt_pk_bf16_f32 v206, v132, v133
v_cvt_pk_bf16_f32 v207, v134, v135
v_mfma_f32_16x16x32_bf16 v[76:79], a[100:103], v[232:235], v[76:79]
v_accvgpr_read_b32 v136, a180
v_accvgpr_read_b32 v137, a181
v_accvgpr_read_b32 v138, a182
v_accvgpr_read_b32 v139, a183
v_accvgpr_read_b32 v140, a188
v_accvgpr_read_b32 v141, a189
v_accvgpr_read_b32 v142, a190
v_mfma_f32_16x16x32_bf16 v[80:83], a[104:107], v[200:203], v[80:83]
ds_read_b128 a[80:83], v17 offset:37888
v_accvgpr_read_b32 v143, a191
v_mul_f32 v136, s60, v136
v_mul_f32 v137, s60, v137
v_mul_f32 v138, s60, v138
v_mul_f32 v139, s60, v139
v_mul_f32 v140, s60, v140
v_mul_f32 v141, s60, v141
v_mfma_f32_16x16x32_bf16 v[84:87], a[104:107], v[232:235], v[84:87]
ds_read_b128 a[84:87], v17 offset:46080
v_mul_f32 v142, s60, v142
v_mul_f32 v143, s60, v143
v_cvt_pk_bf16_f32 v236, v136, v137
v_cvt_pk_bf16_f32 v237, v138, v139
v_cvt_pk_bf16_f32 v238, v140, v141
v_cvt_pk_bf16_f32 v239, v142, v143
v_mfma_f32_16x16x32_bf16 v[88:91], a[108:111], v[200:203], v[88:91]
buffer_load_dwordx4 v49, s[4:7], s16 offen offset:1024 sc1 lds
v_mfma_f32_16x16x32_bf16 v[92:95], a[108:111], v[232:235], v[92:95]
ds_read_b128 a[88:91], v17 offset:54272
s_waitcnt lgkmcnt(7)
v_mfma_f32_16x16x32_bf16 v[64:67], a[112:115], v[204:207], v[64:67]
v_accvgpr_read_b32 v128, a192
v_accvgpr_read_b32 v129, a193
v_accvgpr_read_b32 v130, a194
v_accvgpr_read_b32 v131, a195
v_accvgpr_read_b32 v132, a200
v_accvgpr_read_b32 v133, a201
v_accvgpr_read_b32 v134, a202
v_mfma_f32_16x16x32_bf16 v[68:71], a[112:115], v[236:239], v[68:71]
ds_read_b128 a[92:95], v17 offset:62464
v_accvgpr_read_b32 v135, a203
v_mul_f32 v128, s60, v128
v_mul_f32 v129, s60, v129
v_mul_f32 v130, s60, v130
v_mul_f32 v131, s60, v131
v_mul_f32 v132, s60, v132
v_mul_f32 v133, s60, v133
v_mfma_f32_16x16x32_bf16 v[72:75], a[116:119], v[204:207], v[72:75]
v_mul_f32 v134, s60, v134
v_mul_f32 v135, s60, v135
v_cvt_pk_bf16_f32 v208, v128, v129
v_cvt_pk_bf16_f32 v209, v130, v131
v_cvt_pk_bf16_f32 v210, v132, v133
v_cvt_pk_bf16_f32 v211, v134, v135
v_mfma_f32_16x16x32_bf16 v[76:79], a[116:119], v[236:239], v[76:79]
ds_read_b128 a[96:99], v17 offset:38912
v_accvgpr_read_b32 v136, a196
v_accvgpr_read_b32 v137, a197
v_accvgpr_read_b32 v138, a198
v_accvgpr_read_b32 v139, a199
v_accvgpr_read_b32 v140, a204
v_accvgpr_read_b32 v141, a205
v_accvgpr_read_b32 v142, a206
v_mfma_f32_16x16x32_bf16 v[80:83], a[120:123], v[204:207], v[80:83]
v_accvgpr_read_b32 v143, a207
v_mul_f32 v136, s60, v136
v_mul_f32 v137, s60, v137
v_mul_f32 v138, s60, v138
v_mul_f32 v139, s60, v139
v_mul_f32 v140, s60, v140
v_mul_f32 v141, s60, v141
v_mfma_f32_16x16x32_bf16 v[84:87], a[120:123], v[236:239], v[84:87]
ds_read_b128 a[100:103], v17 offset:47104
v_mul_f32 v142, s60, v142
v_mul_f32 v143, s60, v143
v_cvt_pk_bf16_f32 v240, v136, v137
v_cvt_pk_bf16_f32 v241, v138, v139
v_cvt_pk_bf16_f32 v242, v140, v141
v_cvt_pk_bf16_f32 v243, v142, v143
v_mfma_f32_16x16x32_bf16 v[88:91], a[124:127], v[204:207], v[88:91]
s_lshl_b32 s44, s41, 3
ds_read_b128 a[104:107], v17 offset:55296
v_mfma_f32_16x16x32_bf16 v[92:95], a[124:127], v[236:239], v[92:95]
s_lshl_b32 s45, s20, 1
s_waitcnt lgkmcnt(7)
v_mfma_f32_16x16x32_bf16 v[64:67], a[64:67], v[208:211], v[64:67]
ds_read_b128 a[108:111], v17 offset:63488
v_accvgpr_read_b32 v128, a208
v_accvgpr_read_b32 v129, a209
v_accvgpr_read_b32 v130, a210
v_accvgpr_read_b32 v131, a211
v_accvgpr_read_b32 v132, a216
v_accvgpr_read_b32 v133, a217
v_accvgpr_read_b32 v134, a218
v_mfma_f32_16x16x32_bf16 v[68:71], a[64:67], v[240:243], v[68:71]
v_accvgpr_read_b32 v135, a219
v_mul_f32 v128, s60, v128
v_mul_f32 v129, s60, v129
v_mul_f32 v130, s60, v130
v_mul_f32 v131, s60, v131
v_mul_f32 v132, s60, v132
v_mul_f32 v133, s60, v133
v_mfma_f32_16x16x32_bf16 v[72:75], a[68:71], v[208:211], v[72:75]
ds_read_b128 a[112:115], v17 offset:39936
v_mul_f32 v134, s60, v134
v_mul_f32 v135, s60, v135
v_cvt_pk_bf16_f32 v212, v128, v129
v_cvt_pk_bf16_f32 v213, v130, v131
v_cvt_pk_bf16_f32 v214, v132, v133
v_cvt_pk_bf16_f32 v215, v134, v135
v_mfma_f32_16x16x32_bf16 v[76:79], a[68:71], v[240:243], v[76:79]
buffer_load_dwordx4 v50, s[4:7], s16 offen offset:2048 sc1 lds
v_accvgpr_read_b32 v136, a212
v_accvgpr_read_b32 v137, a213
v_accvgpr_read_b32 v138, a214
v_accvgpr_read_b32 v139, a215
v_accvgpr_read_b32 v140, a220
v_accvgpr_read_b32 v141, a221
v_accvgpr_read_b32 v142, a222
v_mfma_f32_16x16x32_bf16 v[80:83], a[72:75], v[208:211], v[80:83]
ds_read_b128 a[116:119], v17 offset:48128
buffer_load_dwordx4 v51, s[4:7], s16 offen offset:3072 sc1 lds
s_add_u32 m0, s18, 69632
v_accvgpr_read_b32 v143, a223
v_mul_f32 v136, s60, v136
v_mul_f32 v137, s60, v137
v_mul_f32 v138, s60, v138
v_mul_f32 v139, s60, v139
v_mul_f32 v140, s60, v140
v_mul_f32 v141, s60, v141
v_mfma_f32_16x16x32_bf16 v[84:87], a[72:75], v[240:243], v[84:87]
buffer_load_dwordx4 v52, s[4:7], s16 offen offset:0 sc1 lds
v_mul_f32 v142, s60, v142
v_mul_f32 v143, s60, v143
v_cvt_pk_bf16_f32 v244, v136, v137
v_cvt_pk_bf16_f32 v245, v138, v139
v_cvt_pk_bf16_f32 v246, v140, v141
v_cvt_pk_bf16_f32 v247, v142, v143
v_mfma_f32_16x16x32_bf16 v[88:91], a[76:79], v[208:211], v[88:91]
ds_read_b128 a[120:123], v17 offset:56320
buffer_load_dwordx4 v53, s[4:7], s16 offen offset:1024 sc1 lds
v_mfma_f32_16x16x32_bf16 v[92:95], a[76:79], v[240:243], v[92:95]
buffer_load_dwordx4 v54, s[4:7], s16 offen offset:2048 sc1 lds
s_waitcnt lgkmcnt(7)
v_mfma_f32_16x16x32_bf16 v[64:67], a[80:83], v[212:215], v[64:67]
ds_read_b128 a[124:127], v17 offset:64512
buffer_load_dwordx4 v55, s[4:7], s16 offen offset:3072 sc1 lds
v_accvgpr_read_b32 v128, a224
v_accvgpr_read_b32 v129, a225
v_accvgpr_read_b32 v130, a226
v_accvgpr_read_b32 v131, a227
v_accvgpr_read_b32 v132, a232
v_accvgpr_read_b32 v133, a233
v_accvgpr_read_b32 v134, a234
v_mfma_f32_16x16x32_bf16 v[68:71], a[80:83], v[244:247], v[68:71]
v_accvgpr_read_b32 v135, a235
v_mul_f32 v128, s60, v128
v_mul_f32 v129, s60, v129
v_mul_f32 v130, s60, v130
v_mul_f32 v131, s60, v131
v_mul_f32 v132, s60, v132
v_mul_f32 v133, s60, v133
v_mfma_f32_16x16x32_bf16 v[72:75], a[84:87], v[212:215], v[72:75]
v_mul_f32 v134, s60, v134
v_mul_f32 v135, s60, v135
v_cvt_pk_bf16_f32 v216, v128, v129
v_cvt_pk_bf16_f32 v217, v130, v131
v_cvt_pk_bf16_f32 v218, v132, v133
v_cvt_pk_bf16_f32 v219, v134, v135
v_mfma_f32_16x16x32_bf16 v[76:79], a[84:87], v[244:247], v[76:79]
v_accvgpr_read_b32 v136, a228
v_accvgpr_read_b32 v137, a229
v_accvgpr_read_b32 v138, a230
v_accvgpr_read_b32 v139, a231
v_accvgpr_read_b32 v140, a236
v_accvgpr_read_b32 v141, a237
v_accvgpr_read_b32 v142, a238
v_mfma_f32_16x16x32_bf16 v[80:83], a[88:91], v[212:215], v[80:83]
v_accvgpr_read_b32 v143, a239
v_mul_f32 v136, s60, v136
v_mul_f32 v137, s60, v137
v_mul_f32 v138, s60, v138
v_mul_f32 v139, s60, v139
v_mul_f32 v140, s60, v140
v_mul_f32 v141, s60, v141
v_mfma_f32_16x16x32_bf16 v[84:87], a[88:91], v[244:247], v[84:87]
v_mul_f32 v142, s60, v142
v_mul_f32 v143, s60, v143
v_cvt_pk_bf16_f32 v248, v136, v137
v_cvt_pk_bf16_f32 v249, v138, v139
v_cvt_pk_bf16_f32 v250, v140, v141
v_cvt_pk_bf16_f32 v251, v142, v143
v_mfma_f32_16x16x32_bf16 v[88:91], a[92:95], v[212:215], v[88:91]
s_add_u32 s44, s44, s45
s_lshl_b32 s46, s56, 7
v_mfma_f32_16x16x32_bf16 v[92:95], a[92:95], v[244:247], v[92:95]
s_add_u32 s46, s46, s44
s_waitcnt lgkmcnt(0)
v_mfma_f32_16x16x32_bf16 v[64:67], a[96:99], v[216:219], v[64:67]
v_accvgpr_read_b32 v128, a240
v_accvgpr_read_b32 v129, a241
v_accvgpr_read_b32 v130, a242
v_accvgpr_read_b32 v131, a243
v_accvgpr_read_b32 v132, a248
v_accvgpr_read_b32 v133, a249
v_accvgpr_read_b32 v134, a250
v_mfma_f32_16x16x32_bf16 v[68:71], a[96:99], v[248:251], v[68:71]
v_accvgpr_read_b32 v135, a251
v_mul_f32 v128, s60, v128
v_mul_f32 v129, s60, v129
v_mul_f32 v130, s60, v130
v_mul_f32 v131, s60, v131
v_mul_f32 v132, s60, v132
v_mul_f32 v133, s60, v133
v_mfma_f32_16x16x32_bf16 v[72:75], a[100:103], v[216:219], v[72:75]
v_mul_f32 v134, s60, v134
v_mul_f32 v135, s60, v135
v_cvt_pk_bf16_f32 v220, v128, v129
v_cvt_pk_bf16_f32 v221, v130, v131
v_cvt_pk_bf16_f32 v222, v132, v133
v_cvt_pk_bf16_f32 v223, v134, v135
v_mfma_f32_16x16x32_bf16 v[76:79], a[100:103], v[248:251], v[76:79]
v_accvgpr_read_b32 v136, a244
v_accvgpr_read_b32 v137, a245
v_accvgpr_read_b32 v138, a246
v_accvgpr_read_b32 v139, a247
v_accvgpr_read_b32 v140, a252
v_accvgpr_read_b32 v141, a253
v_accvgpr_read_b32 v142, a254
v_mfma_f32_16x16x32_bf16 v[80:83], a[104:107], v[216:219], v[80:83]
v_accvgpr_read_b32 v143, a255
v_mul_f32 v136, s60, v136
v_mul_f32 v137, s60, v137
v_mul_f32 v138, s60, v138
v_mul_f32 v139, s60, v139
v_mul_f32 v140, s60, v140
v_mul_f32 v141, s60, v141
v_mfma_f32_16x16x32_bf16 v[84:87], a[104:107], v[248:251], v[84:87]
v_mul_f32 v142, s60, v142
v_mul_f32 v143, s60, v143
v_cvt_pk_bf16_f32 v252, v136, v137
v_cvt_pk_bf16_f32 v253, v138, v139
v_cvt_pk_bf16_f32 v254, v140, v141
v_cvt_pk_bf16_f32 v255, v142, v143
v_mfma_f32_16x16x32_bf16 v[88:91], a[108:111], v[216:219], v[88:91]
s_add_u32 m0, s18, 0
s_mul_i32 s46, s46, 14336
v_mfma_f32_16x16x32_bf16 v[92:95], a[108:111], v[248:251], v[92:95]
buffer_load_dwordx4 v56, s[8:11], s17 offen offset:0 sc1 lds
v_mfma_f32_16x16x32_bf16 v[64:67], a[112:115], v[220:223], v[64:67]
buffer_load_dwordx4 v56, s[8:11], s17 offen offset:1024 sc1 lds
v_mfma_f32_16x16x32_bf16 v[68:71], a[112:115], v[252:255], v[68:71]
buffer_load_dwordx4 v56, s[8:11], s17 offen offset:2048 sc1 lds
v_mfma_f32_16x16x32_bf16 v[72:75], a[116:119], v[220:223], v[72:75]
buffer_load_dwordx4 v56, s[8:11], s17 offen offset:3072 sc1 lds
s_add_u32 m0, s18, 4096
v_mfma_f32_16x16x32_bf16 v[76:79], a[116:119], v[252:255], v[76:79]
buffer_load_dwordx4 v57, s[8:11], s17 offen offset:0 sc1 lds
v_mfma_f32_16x16x32_bf16 v[80:83], a[120:123], v[220:223], v[80:83]
buffer_load_dwordx4 v57, s[8:11], s17 offen offset:1024 sc1 lds
v_mfma_f32_16x16x32_bf16 v[84:87], a[120:123], v[252:255], v[84:87]
buffer_load_dwordx4 v57, s[8:11], s17 offen offset:2048 sc1 lds
v_mfma_f32_16x16x32_bf16 v[88:91], a[124:127], v[220:223], v[88:91]
buffer_load_dwordx4 v57, s[8:11], s17 offen offset:3072 sc1 lds
v_mfma_f32_16x16x32_bf16 v[92:95], a[124:127], v[252:255], v[92:95]
s_add_u32 s16, s16, s26
s_add_u32 s17, s17, 32768
s_add_u32 s46, s46, 83886080
s_mul_i32 s47, s56, 229376
s_add_u32 s48, s48, s47
s_addc_u32 s49, s49, 0
v_lshrrev_b32 v2, 3, v1
s_lshl_b32 s47, s20, 6
v_add_u32 v2, s47, v2
v_mul_u32_u24 v2, 896, v2
v_lshrrev_b32 v3, 4, v1
v_lshlrev_b32 v4, 1, v3
v_and_b32 v5, 7, v1
v_xor_b32 v4, v4, v5
v_lshl_add_u32 v160, v4, 4, v2
v_bfe_u32 v4, v1, 2, 2
v_lshl_add_u32 v5, v3, 2, v4
v_lshrrev_b32 v6, 1, v5
v_and_b32 v6, 3, v6
v_lshlrev_b32 v5, 7, v5
v_lshl_add_u32 v5, v6, 5, v5
v_and_b32 v6, 3, v1
v_lshl_add_u32 v161, v6, 3, v5
v_xor_b32 v162, 32, v161
v_xor_b32 v163, 64, v161
v_xor_b32 v164, 96, v161
v_add_u32 v165, 0x10000, v161
v_add_u32 v166, 0x10000, v162
v_add_u32 v167, 0x10000, v163
v_add_u32 v168, 0x10000, v164
v_mfma_f32_32x32x16_bf16 a[64:79], v[10:13], v[10:13], 0
v_mfma_f32_32x32x16_bf16 a[80:95], v[10:13], v[10:13], 0
v_mfma_f32_32x32x16_bf16 a[96:111], v[10:13], v[10:13], 0
v_mfma_f32_32x32x16_bf16 a[112:127], v[10:13], v[10:13], 0
s_barrier
s_cmp_lg_u32 s21, 0
s_cbranch_scc1 mega_kernel_nomask0
s_mov_b32 s4, s48
s_mov_b32 s5, s49
s_mov_b32 s6, 229376
s_mov_b32 s16, 0
s_mov_b32 s26, 128
v_add_u32 v48, 0, v160
v_add_u32 v49, 6144, v160
v_add_u32 v50, 12288, v160
v_add_u32 v51, 18432, v160
v_add_u32 v52, 28672, v160
v_add_u32 v53, 34816, v160
v_add_u32 v54, 40960, v160
v_add_u32 v55, 47104, v160
s_nop 7
v_mov_b32 v3, 0xf149f2ca
s_add_i32 s25, s24, 0
v_cmp_ge_i32 s[28:29], s25, v20
s_add_i32 s25, s24, -1
v_cmp_ge_i32 s[30:31], s25, v20
s_add_i32 s25, s24, -2
v_cmp_ge_i32 s[32:33], s25, v20
s_add_i32 s25, s24, -3
v_cmp_ge_i32 s[34:35], s25, v20
v_cndmask_b32 v64, v3, v64, s[28:29]
v_cndmask_b32 v65, v3, v65, s[30:31]
v_cndmask_b32 v66, v3, v66, s[32:33]
v_cndmask_b32 v67, v3, v67, s[34:35]
s_add_i32 s25, s24, 16
v_cmp_ge_i32 s[28:29], s25, v20
s_add_i32 s25, s24, 15
v_cmp_ge_i32 s[30:31], s25, v20
s_add_i32 s25, s24, 14
v_cmp_ge_i32 s[32:33], s25, v20
s_add_i32 s25, s24, 13
v_cmp_ge_i32 s[34:35], s25, v20
v_cndmask_b32 v68, v3, v68, s[28:29]
v_cndmask_b32 v69, v3, v69, s[30:31]
v_cndmask_b32 v70, v3, v70, s[32:33]
v_cndmask_b32 v71, v3, v71, s[34:35]
s_add_i32 s25, s24, -16
v_cmp_ge_i32 s[28:29], s25, v20
s_add_i32 s25, s24, -17
v_cmp_ge_i32 s[30:31], s25, v20
s_add_i32 s25, s24, -18
v_cmp_ge_i32 s[32:33], s25, v20
s_add_i32 s25, s24, -19
v_cmp_ge_i32 s[34:35], s25, v20
v_cndmask_b32 v72, v3, v72, s[28:29]
v_cndmask_b32 v73, v3, v73, s[30:31]
v_cndmask_b32 v74, v3, v74, s[32:33]
v_cndmask_b32 v75, v3, v75, s[34:35]
s_add_i32 s25, s24, 0
v_cmp_ge_i32 s[28:29], s25, v20
s_add_i32 s25, s24, -1
v_cmp_ge_i32 s[30:31], s25, v20
s_add_i32 s25, s24, -2
v_cmp_ge_i32 s[32:33], s25, v20
s_add_i32 s25, s24, -3
v_cmp_ge_i32 s[34:35], s25, v20
v_cndmask_b32 v76, v3, v76, s[28:29]
v_cndmask_b32 v77, v3, v77, s[30:31]
v_cndmask_b32 v78, v3, v78, s[32:33]
v_cndmask_b32 v79, v3, v79, s[34:35]
s_add_i32 s25, s24, -32
v_cmp_ge_i32 s[28:29], s25, v20
s_add_i32 s25, s24, -33
v_cmp_ge_i32 s[30:31], s25, v20
s_add_i32 s25, s24, -34
v_cmp_ge_i32 s[32:33], s25, v20
s_add_i32 s25, s24, -35
v_cmp_ge_i32 s[34:35], s25, v20
v_cndmask_b32 v80, v3, v80, s[28:29]
v_cndmask_b32 v81, v3, v81, s[30:31]
v_cndmask_b32 v82, v3, v82, s[32:33]
v_cndmask_b32 v83, v3, v83, s[34:35]
s_add_i32 s25, s24, -16
v_cmp_ge_i32 s[28:29], s25, v20
s_add_i32 s25, s24, -17
v_cmp_ge_i32 s[30:31], s25, v20
s_add_i32 s25, s24, -18
v_cmp_ge_i32 s[32:33], s25, v20
s_add_i32 s25, s24, -19
v_cmp_ge_i32 s[34:35], s25, v20
v_cndmask_b32 v84, v3, v84, s[28:29]
v_cndmask_b32 v85, v3, v85, s[30:31]
v_cndmask_b32 v86, v3, v86, s[32:33]
v_cndmask_b32 v87, v3, v87, s[34:35]
s_add_i32 s25, s24, -48
v_cmp_ge_i32 s[28:29], s25, v20
s_add_i32 s25, s24, -49
v_cmp_ge_i32 s[30:31], s25, v20
s_add_i32 s25, s24, -50
v_cmp_ge_i32 s[32:33], s25, v20
s_add_i32 s25, s24, -51
v_cmp_ge_i32 s[34:35], s25, v20
v_cndmask_b32 v88, v3, v88, s[28:29]
v_cndmask_b32 v89, v3, v89, s[30:31]
v_cndmask_b32 v90, v3, v90, s[32:33]
v_cndmask_b32 v91, v3, v91, s[34:35]
s_add_i32 s25, s24, -32
v_cmp_ge_i32 s[28:29], s25, v20
s_add_i32 s25, s24, -33
v_cmp_ge_i32 s[30:31], s25, v20
s_add_i32 s25, s24, -34
v_cmp_ge_i32 s[32:33], s25, v20
s_add_i32 s25, s24, -35
v_cmp_ge_i32 s[34:35], s25, v20
v_cndmask_b32 v92, v3, v92, s[28:29]
v_cndmask_b32 v93, v3, v93, s[30:31]
v_cndmask_b32 v94, v3, v94, s[32:33]
v_cndmask_b32 v95, v3, v95, s[34:35]
s_sub_i32 s24, s24, 64
mega_kernel_nomask0:
s_add_u32 m0, s18, 98304
s_nop 0
buffer_load_dwordx4 v48, s[4:7], s16 offen offset:0 sc1 lds
buffer_load_dwordx4 v49, s[4:7], s16 offen offset:1024 sc1 lds
buffer_load_dwordx4 v50, s[4:7], s16 offen offset:2048 sc1 lds
buffer_load_dwordx4 v51, s[4:7], s16 offen offset:3072 sc1 lds
s_add_u32 m0, s18, 102400
s_nop 0
buffer_load_dwordx4 v52, s[4:7], s16 offen offset:0 sc1 lds
buffer_load_dwordx4 v53, s[4:7], s16 offen offset:1024 sc1 lds
buffer_load_dwordx4 v54, s[4:7], s16 offen offset:2048 sc1 lds
buffer_load_dwordx4 v55, s[4:7], s16 offen offset:3072 sc1 lds
s_add_u32 s16, s16, s26
s_nop 7
v_max3_f32 v21, v64, v65, v66
v_max3_f32 v22, v68, v69, v70
v_max3_f32 v21, v67, v72, v21
v_max3_f32 v22, v71, v76, v22
v_max3_f32 v21, v73, v74, v21
v_max3_f32 v22, v77, v78, v22
v_max3_f32 v21, v75, v80, v21
v_max3_f32 v22, v79, v84, v22
v_max3_f32 v21, v81, v82, v21
v_max3_f32 v22, v85, v86, v22
v_max3_f32 v21, v83, v88, v21
v_max3_f32 v22, v87, v92, v22
v_max3_f32 v21, v89, v90, v21
v_max3_f32 v22, v93, v94, v22
v_max_f32 v21, v91, v21
v_max_f32 v22, v95, v22
s_nop 7
v_mov_b32 v2, v21
s_nop 1
v_permlane16_swap_b32 v2, v21
s_nop 1
v_max_f32 v21, v21, v2
v_mov_b32 v2, v21
s_nop 1
v_permlane32_swap_b32 v2, v21
s_nop 1
v_max_f32 v21, v21, v2
v_sub_f32 v32, 0, v21
v_sub_f32 v33, 0, v21
v_sub_f32 v34, 0, v21
v_sub_f32 v35, 0, v21
v_sub_f32 v64, v64, v21
v_sub_f32 v65, v65, v21
v_sub_f32 v66, v66, v21
v_sub_f32 v67, v67, v21
v_sub_f32 v72, v72, v21
v_sub_f32 v73, v73, v21
v_sub_f32 v74, v74, v21
v_sub_f32 v75, v75, v21
v_sub_f32 v80, v80, v21
v_sub_f32 v81, v81, v21
v_sub_f32 v82, v82, v21
v_sub_f32 v83, v83, v21
v_sub_f32 v88, v88, v21
v_sub_f32 v89, v89, v21
v_sub_f32 v90, v90, v21
v_sub_f32 v91, v91, v21
v_mov_b32 v24, 0
v_mov_b32 v2, v22
s_nop 1
v_permlane16_swap_b32 v2, v22
s_nop 1
v_max_f32 v22, v22, v2
v_mov_b32 v2, v22
s_nop 1
v_permlane32_swap_b32 v2, v22
s_nop 1
v_max_f32 v22, v22, v2
v_sub_f32 v36, 0, v22
v_sub_f32 v37, 0, v22
v_sub_f32 v38, 0, v22
v_sub_f32 v39, 0, v22
v_sub_f32 v68, v68, v22
v_sub_f32 v69, v69, v22
v_sub_f32 v70, v70, v22
v_sub_f32 v71, v71, v22
v_sub_f32 v76, v76, v22
v_sub_f32 v77, v77, v22
v_sub_f32 v78, v78, v22
v_sub_f32 v79, v79, v22
v_sub_f32 v84, v84, v22
v_sub_f32 v85, v85, v22
v_sub_f32 v86, v86, v22
v_sub_f32 v87, v87, v22
v_sub_f32 v92, v92, v22
v_sub_f32 v93, v93, v22
v_sub_f32 v94, v94, v22
v_sub_f32 v95, v95, v22
v_mov_b32 v25, 0
v_exp_f32 v64, v64
s_nop 0
v_exp_f32 v65, v65
s_nop 0
v_add_f32 v24, v64, v24
v_cvt_pk_bf16_f32 v128, v64, v65
v_add_f32 v24, v65, v24
v_exp_f32 v66, v66
s_nop 0
v_exp_f32 v67, v67
s_nop 0
v_add_f32 v24, v66, v24
v_cvt_pk_bf16_f32 v129, v66, v67
v_add_f32 v24, v67, v24
v_exp_f32 v72, v72
s_nop 0
v_exp_f32 v73, v73
s_nop 0
v_add_f32 v24, v72, v24
v_cvt_pk_bf16_f32 v130, v72, v73
v_add_f32 v24, v73, v24
v_exp_f32 v74, v74
s_nop 0
v_exp_f32 v75, v75
s_nop 0
v_add_f32 v24, v74, v24
v_cvt_pk_bf16_f32 v131, v74, v75
v_add_f32 v24, v75, v24
v_exp_f32 v68, v68
s_nop 0
v_exp_f32 v69, v69
s_nop 0
v_add_f32 v25, v68, v25
v_cvt_pk_bf16_f32 v132, v68, v69
v_add_f32 v25, v69, v25
v_exp_f32 v70, v70
s_nop 0
v_exp_f32 v71, v71
s_nop 0
v_add_f32 v25, v70, v25
v_cvt_pk_bf16_f32 v133, v70, v71
v_add_f32 v25, v71, v25
v_exp_f32 v76, v76
s_nop 0
v_exp_f32 v77, v77
s_nop 0
v_add_f32 v25, v76, v25
v_cvt_pk_bf16_f32 v134, v76, v77
v_add_f32 v25, v77, v25
s_waitcnt vmcnt(16)
s_barrier
s_cmp_eq_u32 s20, 0
s_cbranch_scc0 mega_kernel_sig2r
s_cmp_ge_u32 s55, 24
s_cbranch_scc1 mega_kernel_sig2r
v_mov_b32 v3, s3
v_mov_b32 v2, 256
s_mov_b64 exec, 1
global_atomic_add v3, v2, s[52:53] sc1
s_mov_b64 exec, -1
mega_kernel_sig2r:
ds_read_b128 a[192:195], v17 offset:0
ds_read_b128 a[196:199], v17 offset:1024
ds_read_b128 a[200:203], v17 offset:2048
ds_read_b128 a[204:207], v17 offset:3072
ds_read_b128 a[208:211], v17 offset:4096
ds_read_b128 a[212:215], v17 offset:5120
ds_read_b128 a[216:219], v17 offset:6144
ds_read_b128 a[220:223], v17 offset:7168
s_cmp_eq_u32 s21, 0
s_cbranch_scc1 mega_kernel_m0
.p2align 6
mega_kernel_loop:
s_waitcnt lgkmcnt(4)
s_add_u32 m0, s18, 32768
v_mfma_f32_16x16x32_bf16 v[96:99], a[192:195], v[192:195], v[32:35]
ds_read_b128 a[224:227], v17 offset:8192
v_mfma_f32_16x16x32_bf16 v[96:99], a[196:199], v[196:199], v[96:99]
v_exp_f32 v78, v78
v_mfma_f32_16x16x32_bf16 v[96:99], a[200:203], v[200:203], v[96:99]
ds_read_b128 a[228:231], v17 offset:9216
v_add_f32 v25, v78, v25
v_mfma_f32_16x16x32_bf16 v[96:99], a[204:207], v[204:207], v[96:99]
ds_read_b128 a[232:235], v17 offset:10240
s_waitcnt lgkmcnt(3)
v_mfma_f32_16x16x32_bf16 v[96:99], a[208:211], v[208:211], v[96:99]
buffer_load_dwordx4 v56, s[8:11], s17 offen offset:0 sc1 lds
v_mfma_f32_16x16x32_bf16 v[96:99], a[212:215], v[212:215], v[96:99]
v_exp_f32 v79, v79
v_mfma_f32_16x16x32_bf16 v[96:99], a[216:219], v[216:219], v[96:99]
ds_read_b128 a[236:239], v17 offset:11264
v_add_f32 v25, v79, v25
v_mfma_f32_16x16x32_bf16 v[96:99], a[220:223], v[220:223], v[96:99]
ds_read_b128 a[240:243], v17 offset:12288
v_cvt_pk_bf16_f32 v135, v78, v79
v_mfma_f32_16x16x32_bf16 v[100:103], a[192:195], v[224:227], v[36:39]
v_exp_f32 v80, v80
v_mfma_f32_16x16x32_bf16 v[100:103], a[196:199], v[228:231], v[100:103]
buffer_load_dwordx4 v56, s[8:11], s17 offen offset:1024 sc1 lds
v_mfma_f32_16x16x32_bf16 v[100:103], a[200:203], v[232:235], v[100:103]
ds_read_b128 a[244:247], v17 offset:13312
v_add_f32 v24, v80, v24
v_mfma_f32_16x16x32_bf16 v[100:103], a[204:207], v[236:239], v[100:103]
v_exp_f32 v81, v81
v_mfma_f32_16x16x32_bf16 v[100:103], a[208:211], v[240:243], v[100:103]
ds_read_b128 a[248:251], v17 offset:14336
v_add_f32 v24, v81, v24
v_mfma_f32_16x16x32_bf16 v[100:103], a[212:215], v[244:247], v[100:103]
ds_read_b128 a[252:255], v17 offset:15360
v_cvt_pk_bf16_f32 v136, v80, v81
v_mfma_f32_16x16x32_bf16 v[100:103], a[216:219], v[248:251], v[100:103]
v_exp_f32 v82, v82
v_mfma_f32_16x16x32_bf16 v[100:103], a[220:223], v[252:255], v[100:103]
ds_read_b128 a[192:195], v17 offset:16384
s_waitcnt lgkmcnt(5)
v_mfma_f32_16x16x32_bf16 v[104:107], a[224:227], v[192:195], v[32:35]
buffer_load_dwordx4 v56, s[8:11], s17 offen offset:2048 sc1 lds
v_mfma_f32_16x16x32_bf16 v[104:107], a[228:231], v[196:199], v[104:107]
ds_read_b128 a[196:199], v17 offset:17408
v_add_f32 v24, v82, v24
v_mfma_f32_16x16x32_bf16 v[104:107], a[232:235], v[200:203], v[104:107]
v_exp_f32 v83, v83
v_mfma_f32_16x16x32_bf16 v[104:107], a[236:239], v[204:207], v[104:107]
ds_read_b128 a[200:203], v17 offset:18432
s_waitcnt lgkmcnt(3)
v_mfma_f32_16x16x32_bf16 v[104:107], a[240:243], v[208:211], v[104:107]
v_exp_f32 v88, v88
v_mfma_f32_16x16x32_bf16 v[104:107], a[244:247], v[212:215], v[104:107]
ds_read_b128 a[204:207], v17 offset:19456
v_add_f32 v24, v83, v24
v_mfma_f32_16x16x32_bf16 v[104:107], a[248:251], v[216:219], v[104:107]
buffer_load_dwordx4 v56, s[8:11], s17 offen offset:3072 sc1 lds
v_mfma_f32_16x16x32_bf16 v[104:107], a[252:255], v[220:223], v[104:107]
ds_read_b128 a[208:211], v17 offset:20480
v_cvt_pk_bf16_f32 v137, v82, v83
v_mfma_f32_16x16x32_bf16 v[108:111], a[224:227], v[224:227], v[36:39]
v_exp_f32 v89, v89
v_mfma_f32_16x16x32_bf16 v[108:111], a[228:231], v[228:231], v[108:111]
s_add_u32 m0, s18, 36864
ds_read_b128 a[212:215], v17 offset:21504
v_mfma_f32_16x16x32_bf16 v[108:111], a[232:235], v[232:235], v[108:111]
ds_read_b128 a[216:219], v17 offset:22528
v_add_f32 v24, v88, v24
v_mfma_f32_16x16x32_bf16 v[108:111], a[236:239], v[236:239], v[108:111]
v_exp_f32 v90, v90
v_mfma_f32_16x16x32_bf16 v[108:111], a[240:243], v[240:243], v[108:111]
buffer_load_dwordx4 v57, s[8:11], s17 offen offset:0 sc1 lds
v_mfma_f32_16x16x32_bf16 v[108:111], a[244:247], v[244:247], v[108:111]
ds_read_b128 a[220:223], v17 offset:23552
v_add_f32 v24, v89, v24
v_mfma_f32_16x16x32_bf16 v[108:111], a[248:251], v[248:251], v[108:111]
ds_read_b128 a[224:227], v17 offset:24576
v_cvt_pk_bf16_f32 v138, v88, v89
v_mfma_f32_16x16x32_bf16 v[108:111], a[252:255], v[252:255], v[108:111]
ds_read_b128 a[228:231], v17 offset:25600
s_waitcnt lgkmcnt(6)
v_mfma_f32_16x16x32_bf16 v[112:115], a[192:195], v[192:195], v[32:35]
v_exp_f32 v91, v91
v_mfma_f32_16x16x32_bf16 v[112:115], a[196:199], v[196:199], v[112:115]
ds_read_b128 a[232:235], v17 offset:26624
v_add_f32 v24, v90, v24
v_mfma_f32_16x16x32_bf16 v[112:115], a[200:203], v[200:203], v[112:115]
buffer_load_dwordx4 v57, s[8:11], s17 offen offset:1024 sc1 lds
v_mfma_f32_16x16x32_bf16 v[112:115], a[204:207], v[204:207], v[112:115]
ds_read_b128 a[236:239], v17 offset:27648
s_waitcnt lgkmcnt(4)
v_mfma_f32_16x16x32_bf16 v[112:115], a[208:211], v[208:211], v[112:115]
v_exp_f32 v84, v84
v_mfma_f32_16x16x32_bf16 v[112:115], a[212:215], v[212:215], v[112:115]
ds_read_b128 a[240:243], v17 offset:28672
v_add_f32 v24, v91, v24
v_mfma_f32_16x16x32_bf16 v[112:115], a[216:219], v[216:219], v[112:115]
v_exp_f32 v85, v85
v_mfma_f32_16x16x32_bf16 v[112:115], a[220:223], v[220:223], v[112:115]
ds_read_b128 a[244:247], v17 offset:29696
v_cvt_pk_bf16_f32 v139, v90, v91
v_mfma_f32_16x16x32_bf16 v[116:119], a[192:195], v[224:227], v[36:39]
buffer_load_dwordx4 v57, s[8:11], s17 offen offset:2048 sc1 lds
v_mfma_f32_16x16x32_bf16 v[116:119], a[196:199], v[228:231], v[116:119]
v_exp_f32 v86, v86
v_mfma_f32_16x16x32_bf16 v[116:119], a[200:203], v[232:235], v[116:119]
ds_read_b128 a[248:251], v17 offset:30720
v_max3_f32 v21, v96, v97, v98
v_mfma_f32_16x16x32_bf16 v[116:119], a[204:207], v[236:239], v[116:119]
ds_read_b128 a[252:255], v17 offset:31744
v_max3_f32 v22, v100, v101, v102
v_mfma_f32_16x16x32_bf16 v[116:119], a[208:211], v[240:243], v[116:119]
v_exp_f32 v87, v87
v_mfma_f32_16x16x32_bf16 v[116:119], a[212:215], v[244:247], v[116:119]
v_exp_f32 v92, v92
v_mfma_f32_16x16x32_bf16 v[116:119], a[216:219], v[248:251], v[116:119]
buffer_load_dwordx4 v57, s[8:11], s17 offen offset:3072 sc1 lds
v_mfma_f32_16x16x32_bf16 v[116:119], a[220:223], v[252:255], v[116:119]
s_waitcnt vmcnt(16) lgkmcnt(0)
s_barrier
v_mfma_f32_16x16x32_bf16 v[120:123], a[224:227], v[192:195], v[32:35]
v_exp_f32 v93, v93
v_mfma_f32_16x16x32_bf16 v[120:123], a[228:231], v[196:199], v[120:123]
ds_read_b128 a[192:195], v16 offset:0
v_add_f32 v25, v84, v25
v_mfma_f32_16x16x32_bf16 v[120:123], a[232:235], v[200:203], v[120:123]
ds_read_b128 a[196:199], v16 offset:16384
v_max3_f32 v21, v99, v104, v21
v_mfma_f32_16x16x32_bf16 v[120:123], a[236:239], v[204:207], v[120:123]
v_exp_f32 v94, v94
v_mfma_f32_16x16x32_bf16 v[120:123], a[240:243], v[208:211], v[120:123]
ds_read_b128 a[200:203], v16 offset:1024
v_add_f32 v25, v85, v25
v_mfma_f32_16x16x32_bf16 v[120:123], a[244:247], v[212:215], v[120:123]
v_exp_f32 v95, v95
v_mfma_f32_16x16x32_bf16 v[120:123], a[248:251], v[216:219], v[120:123]
ds_read_b128 a[204:207], v16 offset:17408
v_cvt_pk_bf16_f32 v140, v84, v85
v_mfma_f32_16x16x32_bf16 v[120:123], a[252:255], v[220:223], v[120:123]
ds_read_b128 a[208:211], v16 offset:2048
v_max3_f32 v22, v103, v108, v22
v_mfma_f32_16x16x32_bf16 v[124:127], a[224:227], v[224:227], v[36:39]
v_max3_f32 v21, v105, v106, v21
v_add_f32 v25, v86, v25
v_mfma_f32_16x16x32_bf16 v[124:127], a[228:231], v[228:231], v[124:127]
ds_read_b128 a[212:215], v16 offset:18432
v_max3_f32 v22, v109, v110, v22
v_mfma_f32_16x16x32_bf16 v[124:127], a[232:235], v[232:235], v[124:127]
v_add_f32 v25, v87, v25
v_cvt_pk_bf16_f32 v141, v86, v87
v_mfma_f32_16x16x32_bf16 v[124:127], a[236:239], v[236:239], v[124:127]
ds_read_b128 a[216:219], v16 offset:3072
v_max3_f32 v21, v107, v112, v21
v_mfma_f32_16x16x32_bf16 v[124:127], a[240:243], v[240:243], v[124:127]
s_add_u32 s17, s17, 32768
v_add_f32 v25, v92, v25
v_mfma_f32_16x16x32_bf16 v[124:127], a[244:247], v[244:247], v[124:127]
v_cvt_pk_bf16_f32 v142, v92, v93
v_cvt_pk_bf16_f32 v143, v94, v95
v_mfma_f32_16x16x32_bf16 v[124:127], a[248:251], v[248:251], v[124:127]
ds_read_b128 a[220:223], v16 offset:19456
v_max3_f32 v21, v113, v114, v21
v_mfma_f32_16x16x32_bf16 v[124:127], a[252:255], v[252:255], v[124:127]
v_add_f32 v25, v93, v25
s_waitcnt lgkmcnt(4)
v_mfma_f32_16x16x32_bf16 a[0:3], a[192:195], v[128:131], a[0:3]
ds_read_b128 a[224:227], v16 offset:4096
v_add_f32 v25, v94, v25
v_mfma_f32_16x16x32_bf16 a[0:3], a[196:199], v[136:139], a[0:3]
ds_read_b128 a[228:231], v16 offset:20480
v_max3_f32 v22, v111, v116, v22
v_mfma_f32_16x16x32_bf16 a[4:7], a[192:195], v[132:135], a[4:7]
v_max3_f32 v22, v117, v118, v22
v_add_f32 v25, v95, v25
v_mfma_f32_16x16x32_bf16 a[4:7], a[196:199], v[140:143], a[4:7]
s_add_u32 m0, s18, 65536
ds_read_b128 a[232:235], v16 offset:5120
v_mfma_f32_16x16x32_bf16 a[8:11], a[200:203], v[128:131], a[8:11]
buffer_load_dwordx4 v48, s[4:7], s16 offen offset:0 sc1 lds
v_mfma_f32_16x16x32_bf16 a[8:11], a[204:207], v[136:139], a[8:11]
ds_read_b128 a[236:239], v16 offset:21504
v_max3_f32 v21, v115, v120, v21
v_mfma_f32_16x16x32_bf16 a[12:15], a[200:203], v[132:135], a[12:15]
ds_read_b128 a[240:243], v16 offset:6144
v_max3_f32 v21, v121, v122, v21
v_mfma_f32_16x16x32_bf16 a[12:15], a[204:207], v[140:143], a[12:15]
v_max3_f32 v22, v119, v124, v22
v_max_f32 v21, v123, v21
s_waitcnt lgkmcnt(5)
v_mfma_f32_16x16x32_bf16 a[16:19], a[208:211], v[128:131], a[16:19]
ds_read_b128 a[244:247], v16 offset:22528
v_max3_f32 v22, v125, v126, v22
v_mfma_f32_16x16x32_bf16 a[16:19], a[212:215], v[136:139], a[16:19]
ds_read_b128 a[248:251], v16 offset:7168
v_max_f32 v22, v127, v22
v_mfma_f32_16x16x32_bf16 a[20:23], a[208:211], v[132:135], a[20:23]
ds_read_b128 a[252:255], v16 offset:23552
v_max_f32 v23, v21, v22
v_mfma_f32_16x16x32_bf16 a[20:23], a[212:215], v[140:143], a[20:23]
ds_read_b128 a[192:195], v16 offset:8192
v_cmp_lt_f32 vcc, s22, v23
v_mfma_f32_16x16x32_bf16 a[24:27], a[216:219], v[128:131], a[24:27]
s_cbranch_vccnz mega_kernel_i0_r1
v_mfma_f32_16x16x32_bf16 a[24:27], a[220:223], v[136:139], a[24:27]
buffer_load_dwordx4 v49, s[4:7], s16 offen offset:1024 sc1 lds
v_mfma_f32_16x16x32_bf16 a[28:31], a[216:219], v[132:135], a[28:31]
v_exp_f32 v96, v96
v_mfma_f32_16x16x32_bf16 a[28:31], a[220:223], v[140:143], a[28:31]
ds_read_b128 a[196:199], v16 offset:24576
s_waitcnt lgkmcnt(6)
v_mfma_f32_16x16x32_bf16 a[32:35], a[224:227], v[128:131], a[32:35]
buffer_load_dwordx4 v50, s[4:7], s16 offen offset:2048 sc1 lds
v_mfma_f32_16x16x32_bf16 a[32:35], a[228:231], v[136:139], a[32:35]
v_exp_f32 v97, v97
v_mfma_f32_16x16x32_bf16 a[36:39], a[224:227], v[132:135], a[36:39]
ds_read_b128 a[200:203], v16 offset:9216
v_add_f32 v24, v96, v24
v_mfma_f32_16x16x32_bf16 a[36:39], a[228:231], v[140:143], a[36:39]
ds_read_b128 a[204:207], v16 offset:25600
v_add_f32 v24, v97, v24
v_mfma_f32_16x16x32_bf16 a[40:43], a[232:235], v[128:131], a[40:43]
v_exp_f32 v98, v98
v_mfma_f32_16x16x32_bf16 a[40:43], a[236:239], v[136:139], a[40:43]
ds_read_b128 a[208:211], v16 offset:10240
v_cvt_pk_bf16_f32 v144, v96, v97
v_mfma_f32_16x16x32_bf16 a[44:47], a[232:235], v[132:135], a[44:47]
buffer_load_dwordx4 v51, s[4:7], s16 offen offset:3072 sc1 lds
v_mfma_f32_16x16x32_bf16 a[44:47], a[236:239], v[140:143], a[44:47]
ds_read_b128 a[212:215], v16 offset:26624
s_waitcnt lgkmcnt(6)
v_mfma_f32_16x16x32_bf16 a[48:51], a[240:243], v[128:131], a[48:51]
v_exp_f32 v99, v99
v_mfma_f32_16x16x32_bf16 a[48:51], a[244:247], v[136:139], a[48:51]
s_add_u32 m0, s18, 69632
ds_read_b128 a[216:219], v16 offset:11264
v_mfma_f32_16x16x32_bf16 a[52:55], a[240:243], v[132:135], a[52:55]
ds_read_b128 a[220:223], v16 offset:27648
v_add_f32 v24, v98, v24
v_mfma_f32_16x16x32_bf16 a[52:55], a[244:247], v[140:143], a[52:55]
buffer_load_dwordx4 v52, s[4:7], s16 offen offset:0 sc1 lds
v_mfma_f32_16x16x32_bf16 a[56:59], a[248:251], v[128:131], a[56:59]
v_exp_f32 v104, v104
v_mfma_f32_16x16x32_bf16 a[56:59], a[252:255], v[136:139], a[56:59]
ds_read_b128 a[224:227], v16 offset:12288
v_add_f32 v24, v99, v24
v_mfma_f32_16x16x32_bf16 a[60:63], a[248:251], v[132:135], a[60:63]
ds_read_b128 a[228:231], v16 offset:28672
v_cvt_pk_bf16_f32 v145, v98, v99
v_mfma_f32_16x16x32_bf16 a[60:63], a[252:255], v[140:143], a[60:63]
ds_read_b128 a[232:235], v16 offset:13312
s_waitcnt lgkmcnt(7)
v_mfma_f32_16x16x32_bf16 a[64:67], a[192:195], v[128:131], a[64:67]
v_exp_f32 v105, v105
v_mfma_f32_16x16x32_bf16 a[64:67], a[196:199], v[136:139], a[64:67]
buffer_load_dwordx4 v53, s[4:7], s16 offen offset:1024 sc1 lds
v_mfma_f32_16x16x32_bf16 a[68:71], a[192:195], v[132:135], a[68:71]
ds_read_b128 a[236:239], v16 offset:29696
v_add_f32 v24, v104, v24
v_mfma_f32_16x16x32_bf16 a[68:71], a[196:199], v[140:143], a[68:71]
v_exp_f32 v106, v106
v_mfma_f32_16x16x32_bf16 a[72:75], a[200:203], v[128:131], a[72:75]
ds_read_b128 a[240:243], v16 offset:14336
v_add_f32 v24, v105, v24
v_mfma_f32_16x16x32_bf16 a[72:75], a[204:207], v[136:139], a[72:75]
ds_read_b128 a[244:247], v16 offset:30720
v_cvt_pk_bf16_f32 v146, v104, v105
v_mfma_f32_16x16x32_bf16 a[76:79], a[200:203], v[132:135], a[76:79]
v_exp_f32 v107, v107
v_mfma_f32_16x16x32_bf16 a[76:79], a[204:207], v[140:143], a[76:79]
ds_read_b128 a[248:251], v16 offset:15360
s_waitcnt lgkmcnt(7)
v_mfma_f32_16x16x32_bf16 a[80:83], a[208:211], v[128:131], a[80:83]
buffer_load_dwordx4 v54, s[4:7], s16 offen offset:2048 sc1 lds
v_mfma_f32_16x16x32_bf16 a[80:83], a[212:215], v[136:139], a[80:83]
v_exp_f32 v100, v100
v_mfma_f32_16x16x32_bf16 a[84:87], a[208:211], v[132:135], a[84:87]
ds_read_b128 a[252:255], v16 offset:31744
v_add_f32 v24, v106, v24
v_mfma_f32_16x16x32_bf16 a[84:87], a[212:215], v[140:143], a[84:87]
v_exp_f32 v101, v101
v_mfma_f32_16x16x32_bf16 a[88:91], a[216:219], v[128:131], a[88:91]
buffer_load_dwordx4 v55, s[4:7], s16 offen offset:3072 sc1 lds
v_mfma_f32_16x16x32_bf16 a[88:91], a[220:223], v[136:139], a[88:91]
v_add_f32 v24, v107, v24
v_cvt_pk_bf16_f32 v147, v106, v107
v_mfma_f32_16x16x32_bf16 a[92:95], a[216:219], v[132:135], a[92:95]
v_exp_f32 v102, v102
v_mfma_f32_16x16x32_bf16 a[92:95], a[220:223], v[140:143], a[92:95]
s_waitcnt vmcnt(16) lgkmcnt(0)
s_barrier
v_mfma_f32_16x16x32_bf16 a[96:99], a[224:227], v[128:131], a[96:99]
ds_read_b128 a[192:195], v17 offset:32768
v_add_f32 v25, v100, v25
v_mfma_f32_16x16x32_bf16 a[96:99], a[228:231], v[136:139], a[96:99]
ds_read_b128 a[196:199], v17 offset:33792
v_add_f32 v25, v101, v25
v_mfma_f32_16x16x32_bf16 a[100:103], a[224:227], v[132:135], a[100:103]
v_exp_f32 v103, v103
v_mfma_f32_16x16x32_bf16 a[100:103], a[228:231], v[140:143], a[100:103]
ds_read_b128 a[200:203], v17 offset:34816
v_cvt_pk_bf16_f32 v148, v100, v101
v_mfma_f32_16x16x32_bf16 a[104:107], a[232:235], v[128:131], a[104:107]
s_add_u32 s16, s16, s26
v_add_f32 v25, v102, v25
v_mfma_f32_16x16x32_bf16 a[104:107], a[236:239], v[136:139], a[104:107]
s_add_u32 s19, s19, 1
ds_read_b128 a[204:207], v17 offset:35840
v_mfma_f32_16x16x32_bf16 a[108:111], a[232:235], v[132:135], a[108:111]
v_exp_f32 v108, v108
v_mfma_f32_16x16x32_bf16 a[108:111], a[236:239], v[140:143], a[108:111]
ds_read_b128 a[208:211], v17 offset:36864
v_add_f32 v25, v103, v25
v_mfma_f32_16x16x32_bf16 a[112:115], a[240:243], v[128:131], a[112:115]
v_exp_f32 v109, v109
v_mfma_f32_16x16x32_bf16 a[112:115], a[244:247], v[136:139], a[112:115]
ds_read_b128 a[212:215], v17 offset:37888
v_cvt_pk_bf16_f32 v149, v102, v103
v_mfma_f32_16x16x32_bf16 a[116:119], a[240:243], v[132:135], a[116:119]
v_add_f32 v25, v108, v25
v_cvt_pk_bf16_f32 v150, v108, v109
v_mfma_f32_16x16x32_bf16 a[116:119], a[244:247], v[140:143], a[116:119]
ds_read_b128 a[216:219], v17 offset:38912
v_add_f32 v25, v109, v25
v_mfma_f32_16x16x32_bf16 a[120:123], a[248:251], v[128:131], a[120:123]
ds_read_b128 a[220:223], v17 offset:39936
v_mfma_f32_16x16x32_bf16 a[120:123], a[252:255], v[136:139], a[120:123]
v_mfma_f32_16x16x32_bf16 a[124:127], a[248:251], v[132:135], a[124:127]
v_mfma_f32_16x16x32_bf16 a[124:127], a[252:255], v[140:143], a[124:127]
mega_kernel_i0_end:
s_cmp_eq_u32 s19, s21
s_cbranch_scc1 mega_kernel_m1
s_waitcnt lgkmcnt(4)
s_add_u32 m0, s18, 0
v_mfma_f32_16x16x32_bf16 v[64:67], a[192:195], v[192:195], v[32:35]
ds_read_b128 a[224:227], v17 offset:40960
v_mfma_f32_16x16x32_bf16 v[64:67], a[196:199], v[196:199], v[64:67]
v_exp_f32 v110, v110
v_mfma_f32_16x16x32_bf16 v[64:67], a[200:203], v[200:203], v[64:67]
ds_read_b128 a[228:231], v17 offset:41984
v_add_f32 v25, v110, v25
v_mfma_f32_16x16x32_bf16 v[64:67], a[204:207], v[204:207], v[64:67]
ds_read_b128 a[232:235], v17 offset:43008
s_waitcnt lgkmcnt(3)
v_mfma_f32_16x16x32_bf16 v[64:67], a[208:211], v[208:211], v[64:67]
buffer_load_dwordx4 v56, s[8:11], s17 offen offset:0 sc1 lds
v_mfma_f32_16x16x32_bf16 v[64:67], a[212:215], v[212:215], v[64:67]
v_exp_f32 v111, v111
v_mfma_f32_16x16x32_bf16 v[64:67], a[216:219], v[216:219], v[64:67]
ds_read_b128 a[236:239], v17 offset:44032
v_add_f32 v25, v111, v25
v_mfma_f32_16x16x32_bf16 v[64:67], a[220:223], v[220:223], v[64:67]
ds_read_b128 a[240:243], v17 offset:45056
v_cvt_pk_bf16_f32 v151, v110, v111
v_mfma_f32_16x16x32_bf16 v[68:71], a[192:195], v[224:227], v[36:39]
v_exp_f32 v112, v112
v_mfma_f32_16x16x32_bf16 v[68:71], a[196:199], v[228:231], v[68:71]
buffer_load_dwordx4 v56, s[8:11], s17 offen offset:1024 sc1 lds
v_mfma_f32_16x16x32_bf16 v[68:71], a[200:203], v[232:235], v[68:71]
ds_read_b128 a[244:247], v17 offset:46080
v_add_f32 v24, v112, v24
v_mfma_f32_16x16x32_bf16 v[68:71], a[204:207], v[236:239], v[68:71]
v_exp_f32 v113, v113
v_mfma_f32_16x16x32_bf16 v[68:71], a[208:211], v[240:243], v[68:71]
ds_read_b128 a[248:251], v17 offset:47104
v_add_f32 v24, v113, v24
v_mfma_f32_16x16x32_bf16 v[68:71], a[212:215], v[244:247], v[68:71]
ds_read_b128 a[252:255], v17 offset:48128
v_cvt_pk_bf16_f32 v152, v112, v113
v_mfma_f32_16x16x32_bf16 v[68:71], a[216:219], v[248:251], v[68:71]
v_exp_f32 v114, v114
v_mfma_f32_16x16x32_bf16 v[68:71], a[220:223], v[252:255], v[68:71]
ds_read_b128 a[192:195], v17 offset:49152
s_waitcnt lgkmcnt(5)
v_mfma_f32_16x16x32_bf16 v[72:75], a[224:227], v[192:195], v[32:35]
buffer_load_dwordx4 v56, s[8:11], s17 offen offset:2048 sc1 lds
v_mfma_f32_16x16x32_bf16 v[72:75], a[228:231], v[196:199], v[72:75]
ds_read_b128 a[196:199], v17 offset:50176
v_add_f32 v24, v114, v24
v_mfma_f32_16x16x32_bf16 v[72:75], a[232:235], v[200:203], v[72:75]
v_exp_f32 v115, v115
v_mfma_f32_16x16x32_bf16 v[72:75], a[236:239], v[204:207], v[72:75]
ds_read_b128 a[200:203], v17 offset:51200
s_waitcnt lgkmcnt(3)
v_mfma_f32_16x16x32_bf16 v[72:75], a[240:243], v[208:211], v[72:75]
v_exp_f32 v120, v120
v_mfma_f32_16x16x32_bf16 v[72:75], a[244:247], v[212:215], v[72:75]
ds_read_b128 a[204:207], v17 offset:52224
v_add_f32 v24, v115, v24
v_mfma_f32_16x16x32_bf16 v[72:75], a[248:251], v[216:219], v[72:75]
buffer_load_dwordx4 v56, s[8:11], s17 offen offset:3072 sc1 lds
v_mfma_f32_16x16x32_bf16 v[72:75], a[252:255], v[220:223], v[72:75]
ds_read_b128 a[208:211], v17 offset:53248
v_cvt_pk_bf16_f32 v153, v114, v115
v_mfma_f32_16x16x32_bf16 v[76:79], a[224:227], v[224:227], v[36:39]
v_exp_f32 v121, v121
v_mfma_f32_16x16x32_bf16 v[76:79], a[228:231], v[228:231], v[76:79]
s_add_u32 m0, s18, 4096
ds_read_b128 a[212:215], v17 offset:54272
v_mfma_f32_16x16x32_bf16 v[76:79], a[232:235], v[232:235], v[76:79]
ds_read_b128 a[216:219], v17 offset:55296
v_add_f32 v24, v120, v24
v_mfma_f32_16x16x32_bf16 v[76:79], a[236:239], v[236:239], v[76:79]
v_exp_f32 v122, v122
v_mfma_f32_16x16x32_bf16 v[76:79], a[240:243], v[240:243], v[76:79]
buffer_load_dwordx4 v57, s[8:11], s17 offen offset:0 sc1 lds
v_mfma_f32_16x16x32_bf16 v[76:79], a[244:247], v[244:247], v[76:79]
ds_read_b128 a[220:223], v17 offset:56320
v_add_f32 v24, v121, v24
v_mfma_f32_16x16x32_bf16 v[76:79], a[248:251], v[248:251], v[76:79]
ds_read_b128 a[224:227], v17 offset:57344
v_cvt_pk_bf16_f32 v154, v120, v121
v_mfma_f32_16x16x32_bf16 v[76:79], a[252:255], v[252:255], v[76:79]
ds_read_b128 a[228:231], v17 offset:58368
s_waitcnt lgkmcnt(6)
v_mfma_f32_16x16x32_bf16 v[80:83], a[192:195], v[192:195], v[32:35]
v_exp_f32 v123, v123
v_mfma_f32_16x16x32_bf16 v[80:83], a[196:199], v[196:199], v[80:83]
ds_read_b128 a[232:235], v17 offset:59392
v_add_f32 v24, v122, v24
v_mfma_f32_16x16x32_bf16 v[80:83], a[200:203], v[200:203], v[80:83]
buffer_load_dwordx4 v57, s[8:11], s17 offen offset:1024 sc1 lds
v_mfma_f32_16x16x32_bf16 v[80:83], a[204:207], v[204:207], v[80:83]
ds_read_b128 a[236:239], v17 offset:60416
s_waitcnt lgkmcnt(4)
v_mfma_f32_16x16x32_bf16 v[80:83], a[208:211], v[208:211], v[80:83]
v_exp_f32 v116, v116
v_mfma_f32_16x16x32_bf16 v[80:83], a[212:215], v[212:215], v[80:83]
ds_read_b128 a[240:243], v17 offset:61440
v_add_f32 v24, v123, v24
v_mfma_f32_16x16x32_bf16 v[80:83], a[216:219], v[216:219], v[80:83]
v_exp_f32 v117, v117
v_mfma_f32_16x16x32_bf16 v[80:83], a[220:223], v[220:223], v[80:83]
ds_read_b128 a[244:247], v17 offset:62464
v_cvt_pk_bf16_f32 v155, v122, v123
v_mfma_f32_16x16x32_bf16 v[84:87], a[192:195], v[224:227], v[36:39]
buffer_load_dwordx4 v57, s[8:11], s17 offen offset:2048 sc1 lds
v_mfma_f32_16x16x32_bf16 v[84:87], a[196:199], v[228:231], v[84:87]
v_exp_f32 v118, v118
v_mfma_f32_16x16x32_bf16 v[84:87], a[200:203], v[232:235], v[84:87]
ds_read_b128 a[248:251], v17 offset:63488
v_max3_f32 v21, v64, v65, v66
v_mfma_f32_16x16x32_bf16 v[84:87], a[204:207], v[236:239], v[84:87]
ds_read_b128 a[252:255], v17 offset:64512
v_max3_f32 v22, v68, v69, v70
v_mfma_f32_16x16x32_bf16 v[84:87], a[208:211], v[240:243], v[84:87]
v_exp_f32 v119, v119
v_mfma_f32_16x16x32_bf16 v[84:87], a[212:215], v[244:247], v[84:87]
v_exp_f32 v124, v124
v_mfma_f32_16x16x32_bf16 v[84:87], a[216:219], v[248:251], v[84:87]
buffer_load_dwordx4 v57, s[8:11], s17 offen offset:3072 sc1 lds
v_mfma_f32_16x16x32_bf16 v[84:87], a[220:223], v[252:255], v[84:87]
s_waitcnt vmcnt(16) lgkmcnt(0)
s_barrier
v_mfma_f32_16x16x32_bf16 v[88:91], a[224:227], v[192:195], v[32:35]
v_exp_f32 v125, v125
v_mfma_f32_16x16x32_bf16 v[88:91], a[228:231], v[196:199], v[88:91]
ds_read_b128 a[192:195], v16 offset:32768
v_add_f32 v25, v116, v25
v_mfma_f32_16x16x32_bf16 v[88:91], a[232:235], v[200:203], v[88:91]
ds_read_b128 a[196:199], v16 offset:49152
v_max3_f32 v21, v67, v72, v21
v_mfma_f32_16x16x32_bf16 v[88:91], a[236:239], v[204:207], v[88:91]
v_exp_f32 v126, v126
v_mfma_f32_16x16x32_bf16 v[88:91], a[240:243], v[208:211], v[88:91]
ds_read_b128 a[200:203], v16 offset:33792
v_add_f32 v25, v117, v25
v_mfma_f32_16x16x32_bf16 v[88:91], a[244:247], v[212:215], v[88:91]
v_exp_f32 v127, v127
v_mfma_f32_16x16x32_bf16 v[88:91], a[248:251], v[216:219], v[88:91]
ds_read_b128 a[204:207], v16 offset:50176
v_cvt_pk_bf16_f32 v156, v116, v117
v_mfma_f32_16x16x32_bf16 v[88:91], a[252:255], v[220:223], v[88:91]
ds_read_b128 a[208:211], v16 offset:34816
v_max3_f32 v22, v71, v76, v22
v_mfma_f32_16x16x32_bf16 v[92:95], a[224:227], v[224:227], v[36:39]
v_max3_f32 v21, v73, v74, v21
v_add_f32 v25, v118, v25
v_mfma_f32_16x16x32_bf16 v[92:95], a[228:231], v[228:231], v[92:95]
ds_read_b128 a[212:215], v16 offset:51200
v_max3_f32 v22, v77, v78, v22
v_mfma_f32_16x16x32_bf16 v[92:95], a[232:235], v[232:235], v[92:95]
v_add_f32 v25, v119, v25
v_cvt_pk_bf16_f32 v157, v118, v119
v_mfma_f32_16x16x32_bf16 v[92:95], a[236:239], v[236:239], v[92:95]
ds_read_b128 a[216:219], v16 offset:35840
v_max3_f32 v21, v75, v80, v21
v_mfma_f32_16x16x32_bf16 v[92:95], a[240:243], v[240:243], v[92:95]
s_add_u32 s17, s17, 32768
v_add_f32 v25, v124, v25
v_mfma_f32_16x16x32_bf16 v[92:95], a[244:247], v[244:247], v[92:95]
v_cvt_pk_bf16_f32 v158, v124, v125
v_cvt_pk_bf16_f32 v159, v126, v127
v_mfma_f32_16x16x32_bf16 v[92:95], a[248:251], v[248:251], v[92:95]
ds_read_b128 a[220:223], v16 offset:52224
v_max3_f32 v21, v81, v82, v21
v_mfma_f32_16x16x32_bf16 v[92:95], a[252:255], v[252:255], v[92:95]
v_add_f32 v25, v125, v25
s_waitcnt lgkmcnt(4)
v_mfma_f32_16x16x32_bf16 a[0:3], a[192:195], v[144:147], a[0:3]
ds_read_b128 a[224:227], v16 offset:36864
v_add_f32 v25, v126, v25
v_mfma_f32_16x16x32_bf16 a[0:3], a[196:199], v[152:155], a[0:3]
ds_read_b128 a[228:231], v16 offset:53248
v_max3_f32 v22, v79, v84, v22
v_mfma_f32_16x16x32_bf16 a[4:7], a[192:195], v[148:151], a[4:7]
v_max3_f32 v22, v85, v86, v22
v_add_f32 v25, v127, v25
v_mfma_f32_16x16x32_bf16 a[4:7], a[196:199], v[156:159], a[4:7]
s_add_u32 m0, s18, 98304
ds_read_b128 a[232:235], v16 offset:37888
v_mfma_f32_16x16x32_bf16 a[8:11], a[200:203], v[144:147], a[8:11]
buffer_load_dwordx4 v48, s[4:7], s16 offen offset:0 sc1 lds
v_mfma_f32_16x16x32_bf16 a[8:11], a[204:207], v[152:155], a[8:11]
ds_read_b128 a[236:239], v16 offset:54272
v_max3_f32 v21, v83, v88, v21
v_mfma_f32_16x16x32_bf16 a[12:15], a[200:203], v[148:151], a[12:15]
ds_read_b128 a[240:243], v16 offset:38912
v_max3_f32 v21, v89, v90, v21
v_mfma_f32_16x16x32_bf16 a[12:15], a[204:207], v[156:159], a[12:15]
v_max3_f32 v22, v87, v92, v22
v_max_f32 v21, v91, v21
s_waitcnt lgkmcnt(5)
v_mfma_f32_16x16x32_bf16 a[16:19], a[208:211], v[144:147], a[16:19]
ds_read_b128 a[244:247], v16 offset:55296
v_max3_f32 v22, v93, v94, v22
v_mfma_f32_16x16x32_bf16 a[16:19], a[212:215], v[152:155], a[16:19]
ds_read_b128 a[248:251], v16 offset:39936
v_max_f32 v22, v95, v22
v_mfma_f32_16x16x32_bf16 a[20:23], a[208:211], v[148:151], a[20:23]
ds_read_b128 a[252:255], v16 offset:56320
v_max_f32 v23, v21, v22
v_mfma_f32_16x16x32_bf16 a[20:23], a[212:215], v[156:159], a[20:23]
ds_read_b128 a[192:195], v16 offset:40960
v_cmp_lt_f32 vcc, s22, v23
v_mfma_f32_16x16x32_bf16 a[24:27], a[216:219], v[144:147], a[24:27]
s_cbranch_vccnz mega_kernel_i1_r1
v_mfma_f32_16x16x32_bf16 a[24:27], a[220:223], v[152:155], a[24:27]
buffer_load_dwordx4 v49, s[4:7], s16 offen offset:1024 sc1 lds
v_mfma_f32_16x16x32_bf16 a[28:31], a[216:219], v[148:151], a[28:31]
v_exp_f32 v64, v64
v_mfma_f32_16x16x32_bf16 a[28:31], a[220:223], v[156:159], a[28:31]
ds_read_b128 a[196:199], v16 offset:57344
s_waitcnt lgkmcnt(6)
v_mfma_f32_16x16x32_bf16 a[32:35], a[224:227], v[144:147], a[32:35]
buffer_load_dwordx4 v50, s[4:7], s16 offen offset:2048 sc1 lds
v_mfma_f32_16x16x32_bf16 a[32:35], a[228:231], v[152:155], a[32:35]
v_exp_f32 v65, v65
v_mfma_f32_16x16x32_bf16 a[36:39], a[224:227], v[148:151], a[36:39]
ds_read_b128 a[200:203], v16 offset:41984
v_add_f32 v24, v64, v24
v_mfma_f32_16x16x32_bf16 a[36:39], a[228:231], v[156:159], a[36:39]
ds_read_b128 a[204:207], v16 offset:58368
v_add_f32 v24, v65, v24
v_mfma_f32_16x16x32_bf16 a[40:43], a[232:235], v[144:147], a[40:43]
v_exp_f32 v66, v66
v_mfma_f32_16x16x32_bf16 a[40:43], a[236:239], v[152:155], a[40:43]
ds_read_b128 a[208:211], v16 offset:43008
v_cvt_pk_bf16_f32 v128, v64, v65
v_mfma_f32_16x16x32_bf16 a[44:47], a[232:235], v[148:151], a[44:47]
buffer_load_dwordx4 v51, s[4:7], s16 offen offset:3072 sc1 lds
v_mfma_f32_16x16x32_bf16 a[44:47], a[236:239], v[156:159], a[44:47]
ds_read_b128 a[212:215], v16 offset:59392
s_waitcnt lgkmcnt(6)
v_mfma_f32_16x16x32_bf16 a[48:51], a[240:243], v[144:147], a[48:51]
v_exp_f32 v67, v67
v_mfma_f32_16x16x32_bf16 a[48:51], a[244:247], v[152:155], a[48:51]
s_add_u32 m0, s18, 102400
ds_read_b128 a[216:219], v16 offset:44032
v_mfma_f32_16x16x32_bf16 a[52:55], a[240:243], v[148:151], a[52:55]
ds_read_b128 a[220:223], v16 offset:60416
v_add_f32 v24, v66, v24
v_mfma_f32_16x16x32_bf16 a[52:55], a[244:247], v[156:159], a[52:55]
buffer_load_dwordx4 v52, s[4:7], s16 offen offset:0 sc1 lds
v_mfma_f32_16x16x32_bf16 a[56:59], a[248:251], v[144:147], a[56:59]
v_exp_f32 v72, v72
v_mfma_f32_16x16x32_bf16 a[56:59], a[252:255], v[152:155], a[56:59]
ds_read_b128 a[224:227], v16 offset:45056
v_add_f32 v24, v67, v24
v_mfma_f32_16x16x32_bf16 a[60:63], a[248:251], v[148:151], a[60:63]
ds_read_b128 a[228:231], v16 offset:61440
v_cvt_pk_bf16_f32 v129, v66, v67
v_mfma_f32_16x16x32_bf16 a[60:63], a[252:255], v[156:159], a[60:63]
ds_read_b128 a[232:235], v16 offset:46080
s_waitcnt lgkmcnt(7)
v_mfma_f32_16x16x32_bf16 a[64:67], a[192:195], v[144:147], a[64:67]
v_exp_f32 v73, v73
v_mfma_f32_16x16x32_bf16 a[64:67], a[196:199], v[152:155], a[64:67]
buffer_load_dwordx4 v53, s[4:7], s16 offen offset:1024 sc1 lds
v_mfma_f32_16x16x32_bf16 a[68:71], a[192:195], v[148:151], a[68:71]
ds_read_b128 a[236:239], v16 offset:62464
v_add_f32 v24, v72, v24
v_mfma_f32_16x16x32_bf16 a[68:71], a[196:199], v[156:159], a[68:71]
v_exp_f32 v74, v74
v_mfma_f32_16x16x32_bf16 a[72:75], a[200:203], v[144:147], a[72:75]
ds_read_b128 a[240:243], v16 offset:47104
v_add_f32 v24, v73, v24
v_mfma_f32_16x16x32_bf16 a[72:75], a[204:207], v[152:155], a[72:75]
ds_read_b128 a[244:247], v16 offset:63488
v_cvt_pk_bf16_f32 v130, v72, v73
v_mfma_f32_16x16x32_bf16 a[76:79], a[200:203], v[148:151], a[76:79]
v_exp_f32 v75, v75
v_mfma_f32_16x16x32_bf16 a[76:79], a[204:207], v[156:159], a[76:79]
ds_read_b128 a[248:251], v16 offset:48128
s_waitcnt lgkmcnt(7)
v_mfma_f32_16x16x32_bf16 a[80:83], a[208:211], v[144:147], a[80:83]
buffer_load_dwordx4 v54, s[4:7], s16 offen offset:2048 sc1 lds
v_mfma_f32_16x16x32_bf16 a[80:83], a[212:215], v[152:155], a[80:83]
v_exp_f32 v68, v68
v_mfma_f32_16x16x32_bf16 a[84:87], a[208:211], v[148:151], a[84:87]
ds_read_b128 a[252:255], v16 offset:64512
v_add_f32 v24, v74, v24
v_mfma_f32_16x16x32_bf16 a[84:87], a[212:215], v[156:159], a[84:87]
v_exp_f32 v69, v69
v_mfma_f32_16x16x32_bf16 a[88:91], a[216:219], v[144:147], a[88:91]
buffer_load_dwordx4 v55, s[4:7], s16 offen offset:3072 sc1 lds
v_mfma_f32_16x16x32_bf16 a[88:91], a[220:223], v[152:155], a[88:91]
v_add_f32 v24, v75, v24
v_cvt_pk_bf16_f32 v131, v74, v75
v_mfma_f32_16x16x32_bf16 a[92:95], a[216:219], v[148:151], a[92:95]
v_exp_f32 v70, v70
v_mfma_f32_16x16x32_bf16 a[92:95], a[220:223], v[156:159], a[92:95]
s_waitcnt vmcnt(16) lgkmcnt(0)
s_barrier
v_mfma_f32_16x16x32_bf16 a[96:99], a[224:227], v[144:147], a[96:99]
ds_read_b128 a[192:195], v17 offset:0
v_add_f32 v25, v68, v25
v_mfma_f32_16x16x32_bf16 a[96:99], a[228:231], v[152:155], a[96:99]
ds_read_b128 a[196:199], v17 offset:1024
v_add_f32 v25, v69, v25
v_mfma_f32_16x16x32_bf16 a[100:103], a[224:227], v[148:151], a[100:103]
v_exp_f32 v71, v71
v_mfma_f32_16x16x32_bf16 a[100:103], a[228:231], v[156:159], a[100:103]
ds_read_b128 a[200:203], v17 offset:2048
v_cvt_pk_bf16_f32 v132, v68, v69
v_mfma_f32_16x16x32_bf16 a[104:107], a[232:235], v[144:147], a[104:107]
s_add_u32 s16, s16, s26
v_add_f32 v25, v70, v25
v_mfma_f32_16x16x32_bf16 a[104:107], a[236:239], v[152:155], a[104:107]
s_add_u32 s19, s19, 1
ds_read_b128 a[204:207], v17 offset:3072
v_mfma_f32_16x16x32_bf16 a[108:111], a[232:235], v[148:151], a[108:111]
v_exp_f32 v76, v76
v_mfma_f32_16x16x32_bf16 a[108:111], a[236:239], v[156:159], a[108:111]
ds_read_b128 a[208:211], v17 offset:4096
v_add_f32 v25, v71, v25
v_mfma_f32_16x16x32_bf16 a[112:115], a[240:243], v[144:147], a[112:115]
v_exp_f32 v77, v77
v_mfma_f32_16x16x32_bf16 a[112:115], a[244:247], v[152:155], a[112:115]
ds_read_b128 a[212:215], v17 offset:5120
v_cvt_pk_bf16_f32 v133, v70, v71
v_mfma_f32_16x16x32_bf16 a[116:119], a[240:243], v[148:151], a[116:119]
v_add_f32 v25, v76, v25
v_cvt_pk_bf16_f32 v134, v76, v77
v_mfma_f32_16x16x32_bf16 a[116:119], a[244:247], v[156:159], a[116:119]
ds_read_b128 a[216:219], v17 offset:6144
v_add_f32 v25, v77, v25
v_mfma_f32_16x16x32_bf16 a[120:123], a[248:251], v[144:147], a[120:123]
ds_read_b128 a[220:223], v17 offset:7168
v_mfma_f32_16x16x32_bf16 a[120:123], a[252:255], v[152:155], a[120:123]
v_mfma_f32_16x16x32_bf16 a[124:127], a[248:251], v[148:151], a[124:127]
v_mfma_f32_16x16x32_bf16 a[124:127], a[252:255], v[156:159], a[124:127]
mega_kernel_i1_end:
s_sub_u32 s61, s19, 3
s_cmp_gt_u32 s61, 2
s_cbranch_scc1 mega_kernel_loop
s_cmp_eq_u32 s20, 0
s_cbranch_scc0 mega_kernel_loop
s_cmp_eq_u32 s61, 2
s_cbranch_scc1 mega_kernel_l2chk
global_load_dword v59, v60, s[52:53] sc1
s_branch mega_kernel_loop
mega_kernel_l2chk:
s_mov_b32 s62, 200000
mega_kernel_l2spin:
v_readfirstlane_b32 s61, v59
s_and_b32 s61, s61, -1
s_cmp_ge_u32 s61, 3072
s_cbranch_scc1 mega_kernel_l2ok
s_sleep 4
global_load_dword v59, v60, s[52:53] sc1
s_waitcnt vmcnt(0)
s_sub_u32 s62, s62, 1
s_cmp_lg_u32 s62, 0
s_cbranch_scc1 mega_kernel_l2spin
mega_kernel_l2ok:
s_branch mega_kernel_loop
mega_kernel_m1:
s_waitcnt lgkmcnt(4)
s_add_u32 m0, s18, 0
v_mfma_f32_16x16x32_bf16 v[64:67], a[192:195], v[192:195], v[32:35]
ds_read_b128 a[224:227], v17 offset:40960
v_mfma_f32_16x16x32_bf16 v[64:67], a[196:199], v[196:199], v[64:67]
v_exp_f32 v110, v110
v_mfma_f32_16x16x32_bf16 v[64:67], a[200:203], v[200:203], v[64:67]
ds_read_b128 a[228:231], v17 offset:41984
v_add_f32 v25, v110, v25
v_mfma_f32_16x16x32_bf16 v[64:67], a[204:207], v[204:207], v[64:67]
ds_read_b128 a[232:235], v17 offset:43008
s_waitcnt lgkmcnt(3)
v_mfma_f32_16x16x32_bf16 v[64:67], a[208:211], v[208:211], v[64:67]
buffer_load_dwordx4 v56, s[8:11], s17 offen offset:0 sc1 lds
v_mfma_f32_16x16x32_bf16 v[64:67], a[212:215], v[212:215], v[64:67]
v_exp_f32 v111, v111
v_mfma_f32_16x16x32_bf16 v[64:67], a[216:219], v[216:219], v[64:67]
ds_read_b128 a[236:239], v17 offset:44032
v_add_f32 v25, v111, v25
v_mfma_f32_16x16x32_bf16 v[64:67], a[220:223], v[220:223], v[64:67]
ds_read_b128 a[240:243], v17 offset:45056
v_cvt_pk_bf16_f32 v151, v110, v111
v_mfma_f32_16x16x32_bf16 v[68:71], a[192:195], v[224:227], v[36:39]
v_exp_f32 v112, v112
v_mfma_f32_16x16x32_bf16 v[68:71], a[196:199], v[228:231], v[68:71]
buffer_load_dwordx4 v56, s[8:11], s17 offen offset:1024 sc1 lds
v_mfma_f32_16x16x32_bf16 v[68:71], a[200:203], v[232:235], v[68:71]
ds_read_b128 a[244:247], v17 offset:46080
v_add_f32 v24, v112, v24
v_mfma_f32_16x16x32_bf16 v[68:71], a[204:207], v[236:239], v[68:71]
v_exp_f32 v113, v113
v_mfma_f32_16x16x32_bf16 v[68:71], a[208:211], v[240:243], v[68:71]
ds_read_b128 a[248:251], v17 offset:47104
v_add_f32 v24, v113, v24
v_mfma_f32_16x16x32_bf16 v[68:71], a[212:215], v[244:247], v[68:71]
ds_read_b128 a[252:255], v17 offset:48128
v_cvt_pk_bf16_f32 v152, v112, v113
v_mfma_f32_16x16x32_bf16 v[68:71], a[216:219], v[248:251], v[68:71]
v_exp_f32 v114, v114
v_mfma_f32_16x16x32_bf16 v[68:71], a[220:223], v[252:255], v[68:71]
ds_read_b128 a[192:195], v17 offset:49152
s_waitcnt lgkmcnt(5)
v_mfma_f32_16x16x32_bf16 v[72:75], a[224:227], v[192:195], v[32:35]
buffer_load_dwordx4 v56, s[8:11], s17 offen offset:2048 sc1 lds
v_mfma_f32_16x16x32_bf16 v[72:75], a[228:231], v[196:199], v[72:75]
ds_read_b128 a[196:199], v17 offset:50176
v_add_f32 v24, v114, v24
v_mfma_f32_16x16x32_bf16 v[72:75], a[232:235], v[200:203], v[72:75]
v_exp_f32 v115, v115
v_mfma_f32_16x16x32_bf16 v[72:75], a[236:239], v[204:207], v[72:75]
ds_read_b128 a[200:203], v17 offset:51200
s_waitcnt lgkmcnt(3)
v_mfma_f32_16x16x32_bf16 v[72:75], a[240:243], v[208:211], v[72:75]
v_exp_f32 v120, v120
v_mfma_f32_16x16x32_bf16 v[72:75], a[244:247], v[212:215], v[72:75]
ds_read_b128 a[204:207], v17 offset:52224
v_add_f32 v24, v115, v24
v_mfma_f32_16x16x32_bf16 v[72:75], a[248:251], v[216:219], v[72:75]
buffer_load_dwordx4 v56, s[8:11], s17 offen offset:3072 sc1 lds
v_mfma_f32_16x16x32_bf16 v[72:75], a[252:255], v[220:223], v[72:75]
ds_read_b128 a[208:211], v17 offset:53248
v_cvt_pk_bf16_f32 v153, v114, v115
v_mfma_f32_16x16x32_bf16 v[76:79], a[224:227], v[224:227], v[36:39]
v_exp_f32 v121, v121
v_mfma_f32_16x16x32_bf16 v[76:79], a[228:231], v[228:231], v[76:79]
s_add_u32 m0, s18, 4096
ds_read_b128 a[212:215], v17 offset:54272
v_mfma_f32_16x16x32_bf16 v[76:79], a[232:235], v[232:235], v[76:79]
ds_read_b128 a[216:219], v17 offset:55296
v_add_f32 v24, v120, v24
v_mfma_f32_16x16x32_bf16 v[76:79], a[236:239], v[236:239], v[76:79]
v_exp_f32 v122, v122
v_mfma_f32_16x16x32_bf16 v[76:79], a[240:243], v[240:243], v[76:79]
buffer_load_dwordx4 v57, s[8:11], s17 offen offset:0 sc1 lds
v_mfma_f32_16x16x32_bf16 v[76:79], a[244:247], v[244:247], v[76:79]
ds_read_b128 a[220:223], v17 offset:56320
v_add_f32 v24, v121, v24
v_mfma_f32_16x16x32_bf16 v[76:79], a[248:251], v[248:251], v[76:79]
ds_read_b128 a[224:227], v17 offset:57344
v_cvt_pk_bf16_f32 v154, v120, v121
v_mfma_f32_16x16x32_bf16 v[76:79], a[252:255], v[252:255], v[76:79]
ds_read_b128 a[228:231], v17 offset:58368
s_waitcnt lgkmcnt(6)
s_cmp_eq_u32 s20, 0
s_cbranch_scc1 mega_kernel_k1
v_mfma_f32_16x16x32_bf16 v[80:83], a[192:195], v[192:195], v[32:35]
v_exp_f32 v123, v123
v_mfma_f32_16x16x32_bf16 v[80:83], a[196:199], v[196:199], v[80:83]
ds_read_b128 a[232:235], v17 offset:59392
v_add_f32 v24, v122, v24
v_mfma_f32_16x16x32_bf16 v[80:83], a[200:203], v[200:203], v[80:83]
buffer_load_dwordx4 v57, s[8:11], s17 offen offset:1024 sc1 lds
v_mfma_f32_16x16x32_bf16 v[80:83], a[204:207], v[204:207], v[80:83]
ds_read_b128 a[236:239], v17 offset:60416
s_waitcnt lgkmcnt(4)
v_mfma_f32_16x16x32_bf16 v[80:83], a[208:211], v[208:211], v[80:83]
v_exp_f32 v116, v116
v_mfma_f32_16x16x32_bf16 v[80:83], a[212:215], v[212:215], v[80:83]
ds_read_b128 a[240:243], v17 offset:61440
v_add_f32 v24, v123, v24
v_mfma_f32_16x16x32_bf16 v[80:83], a[216:219], v[216:219], v[80:83]
v_exp_f32 v117, v117
v_mfma_f32_16x16x32_bf16 v[80:83], a[220:223], v[220:223], v[80:83]
ds_read_b128 a[244:247], v17 offset:62464
v_cvt_pk_bf16_f32 v155, v122, v123
v_mfma_f32_16x16x32_bf16 v[84:87], a[192:195], v[224:227], v[36:39]
buffer_load_dwordx4 v57, s[8:11], s17 offen offset:2048 sc1 lds
v_mfma_f32_16x16x32_bf16 v[84:87], a[196:199], v[228:231], v[84:87]
v_exp_f32 v118, v118
v_mfma_f32_16x16x32_bf16 v[84:87], a[200:203], v[232:235], v[84:87]
ds_read_b128 a[248:251], v17 offset:63488
v_add_f32 v25, v116, v25
v_mfma_f32_16x16x32_bf16 v[84:87], a[204:207], v[236:239], v[84:87]
ds_read_b128 a[252:255], v17 offset:64512
v_add_f32 v25, v117, v25
v_mfma_f32_16x16x32_bf16 v[84:87], a[208:211], v[240:243], v[84:87]
v_exp_f32 v119, v119
v_mfma_f32_16x16x32_bf16 v[84:87], a[212:215], v[244:247], v[84:87]
v_exp_f32 v124, v124
v_mfma_f32_16x16x32_bf16 v[84:87], a[216:219], v[248:251], v[84:87]
buffer_load_dwordx4 v57, s[8:11], s17 offen offset:3072 sc1 lds
v_mfma_f32_16x16x32_bf16 v[84:87], a[220:223], v[252:255], v[84:87]
s_waitcnt vmcnt(16) lgkmcnt(0)
s_barrier
v_mfma_f32_16x16x32_bf16 v[88:91], a[224:227], v[192:195], v[32:35]
v_exp_f32 v125, v125
v_mfma_f32_16x16x32_bf16 v[88:91], a[228:231], v[196:199], v[88:91]
ds_read_b128 a[192:195], v16 offset:32768
v_cvt_pk_bf16_f32 v156, v116, v117
v_mfma_f32_16x16x32_bf16 v[88:91], a[232:235], v[200:203], v[88:91]
ds_read_b128 a[196:199], v16 offset:49152
v_add_f32 v25, v118, v25
v_mfma_f32_16x16x32_bf16 v[88:91], a[236:239], v[204:207], v[88:91]
v_exp_f32 v126, v126
v_mfma_f32_16x16x32_bf16 v[88:91], a[240:243], v[208:211], v[88:91]
ds_read_b128 a[200:203], v16 offset:33792
v_add_f32 v25, v119, v25
v_mfma_f32_16x16x32_bf16 v[88:91], a[244:247], v[212:215], v[88:91]
v_exp_f32 v127, v127
v_mfma_f32_16x16x32_bf16 v[88:91], a[248:251], v[216:219], v[88:91]
ds_read_b128 a[204:207], v16 offset:50176
v_cvt_pk_bf16_f32 v157, v118, v119
v_mfma_f32_16x16x32_bf16 v[88:91], a[252:255], v[220:223], v[88:91]
ds_read_b128 a[208:211], v16 offset:34816
v_add_f32 v25, v124, v25
v_mfma_f32_16x16x32_bf16 v[92:95], a[224:227], v[224:227], v[36:39]
s_add_u32 s17, s17, 32768
v_add_f32 v25, v125, v25
v_mfma_f32_16x16x32_bf16 v[92:95], a[228:231], v[228:231], v[92:95]
ds_read_b128 a[212:215], v16 offset:51200
v_cvt_pk_bf16_f32 v158, v124, v125
v_mfma_f32_16x16x32_bf16 v[92:95], a[232:235], v[232:235], v[92:95]
v_add_f32 v25, v126, v25
v_cvt_pk_bf16_f32 v159, v126, v127
v_mfma_f32_16x16x32_bf16 v[92:95], a[236:239], v[236:239], v[92:95]
ds_read_b128 a[216:219], v16 offset:35840
v_add_f32 v25, v127, v25
v_mfma_f32_16x16x32_bf16 v[92:95], a[240:243], v[240:243], v[92:95]
ds_read_b128 a[220:223], v16 offset:52224
v_mfma_f32_16x16x32_bf16 v[92:95], a[244:247], v[244:247], v[92:95]
v_mfma_f32_16x16x32_bf16 v[92:95], a[248:251], v[248:251], v[92:95]
v_mfma_f32_16x16x32_bf16 v[92:95], a[252:255], v[252:255], v[92:95]
mega_kernel_k1r:
s_mov_b32 s4, s48
s_mov_b32 s5, s49
s_mov_b32 s6, 229376
s_mov_b32 s16, 0
s_mov_b32 s26, 128
v_add_u32 v48, 0, v160
v_add_u32 v49, 6144, v160
v_add_u32 v50, 12288, v160
v_add_u32 v51, 18432, v160
v_add_u32 v52, 28672, v160
v_add_u32 v53, 34816, v160
v_add_u32 v54, 40960, v160
v_add_u32 v55, 47104, v160
s_nop 7
v_mov_b32 v3, 0xf149f2ca
s_add_i32 s25, s24, 0
v_cmp_ge_i32 s[28:29], s25, v20
s_add_i32 s25, s24, -1
v_cmp_ge_i32 s[30:31], s25, v20
s_add_i32 s25, s24, -2
v_cmp_ge_i32 s[32:33], s25, v20
s_add_i32 s25, s24, -3
v_cmp_ge_i32 s[34:35], s25, v20
v_cndmask_b32 v64, v3, v64, s[28:29]
v_cndmask_b32 v65, v3, v65, s[30:31]
v_cndmask_b32 v66, v3, v66, s[32:33]
v_cndmask_b32 v67, v3, v67, s[34:35]
s_add_i32 s25, s24, 16
v_cmp_ge_i32 s[28:29], s25, v20
s_add_i32 s25, s24, 15
v_cmp_ge_i32 s[30:31], s25, v20
s_add_i32 s25, s24, 14
v_cmp_ge_i32 s[32:33], s25, v20
s_add_i32 s25, s24, 13
v_cmp_ge_i32 s[34:35], s25, v20
v_cndmask_b32 v68, v3, v68, s[28:29]
v_cndmask_b32 v69, v3, v69, s[30:31]
v_cndmask_b32 v70, v3, v70, s[32:33]
v_cndmask_b32 v71, v3, v71, s[34:35]
s_add_i32 s25, s24, -16
v_cmp_ge_i32 s[28:29], s25, v20
s_add_i32 s25, s24, -17
v_cmp_ge_i32 s[30:31], s25, v20
s_add_i32 s25, s24, -18
v_cmp_ge_i32 s[32:33], s25, v20
s_add_i32 s25, s24, -19
v_cmp_ge_i32 s[34:35], s25, v20
v_cndmask_b32 v72, v3, v72, s[28:29]
v_cndmask_b32 v73, v3, v73, s[30:31]
v_cndmask_b32 v74, v3, v74, s[32:33]
v_cndmask_b32 v75, v3, v75, s[34:35]
s_add_i32 s25, s24, 0
v_cmp_ge_i32 s[28:29], s25, v20
s_add_i32 s25, s24, -1
v_cmp_ge_i32 s[30:31], s25, v20
s_add_i32 s25, s24, -2
v_cmp_ge_i32 s[32:33], s25, v20
s_add_i32 s25, s24, -3
v_cmp_ge_i32 s[34:35], s25, v20
v_cndmask_b32 v76, v3, v76, s[28:29]
v_cndmask_b32 v77, v3, v77, s[30:31]
v_cndmask_b32 v78, v3, v78, s[32:33]
v_cndmask_b32 v79, v3, v79, s[34:35]
s_add_i32 s25, s24, -32
v_cmp_ge_i32 s[28:29], s25, v20
s_add_i32 s25, s24, -33
v_cmp_ge_i32 s[30:31], s25, v20
s_add_i32 s25, s24, -34
v_cmp_ge_i32 s[32:33], s25, v20
s_add_i32 s25, s24, -35
v_cmp_ge_i32 s[34:35], s25, v20
v_cndmask_b32 v80, v3, v80, s[28:29]
v_cndmask_b32 v81, v3, v81, s[30:31]
v_cndmask_b32 v82, v3, v82, s[32:33]
v_cndmask_b32 v83, v3, v83, s[34:35]
s_add_i32 s25, s24, -16
v_cmp_ge_i32 s[28:29], s25, v20
s_add_i32 s25, s24, -17
v_cmp_ge_i32 s[30:31], s25, v20
s_add_i32 s25, s24, -18
v_cmp_ge_i32 s[32:33], s25, v20
s_add_i32 s25, s24, -19
v_cmp_ge_i32 s[34:35], s25, v20
v_cndmask_b32 v84, v3, v84, s[28:29]
v_cndmask_b32 v85, v3, v85, s[30:31]
v_cndmask_b32 v86, v3, v86, s[32:33]
v_cndmask_b32 v87, v3, v87, s[34:35]
s_add_i32 s25, s24, -48
v_cmp_ge_i32 s[28:29], s25, v20
s_add_i32 s25, s24, -49
v_cmp_ge_i32 s[30:31], s25, v20
s_add_i32 s25, s24, -50
v_cmp_ge_i32 s[32:33], s25, v20
s_add_i32 s25, s24, -51
v_cmp_ge_i32 s[34:35], s25, v20
v_cndmask_b32 v88, v3, v88, s[28:29]
v_cndmask_b32 v89, v3, v89, s[30:31]
v_cndmask_b32 v90, v3, v90, s[32:33]
v_cndmask_b32 v91, v3, v91, s[34:35]
s_add_i32 s25, s24, -32
v_cmp_ge_i32 s[28:29], s25, v20
s_add_i32 s25, s24, -33
v_cmp_ge_i32 s[30:31], s25, v20
s_add_i32 s25, s24, -34
v_cmp_ge_i32 s[32:33], s25, v20
s_add_i32 s25, s24, -35
v_cmp_ge_i32 s[34:35], s25, v20
v_cndmask_b32 v92, v3, v92, s[28:29]
v_cndmask_b32 v93, v3, v93, s[30:31]
v_cndmask_b32 v94, v3, v94, s[32:33]
v_cndmask_b32 v95, v3, v95, s[34:35]
s_sub_i32 s24, s24, 64
s_waitcnt lgkmcnt(4)
v_mfma_f32_16x16x32_bf16 a[0:3], a[192:195], v[144:147], a[0:3]
s_add_u32 m0, s18, 98304
ds_read_b128 a[224:227], v16 offset:36864
v_mfma_f32_16x16x32_bf16 a[0:3], a[196:199], v[152:155], a[0:3]
ds_read_b128 a[228:231], v16 offset:53248
v_max3_f32 v21, v64, v65, v66
v_mfma_f32_16x16x32_bf16 a[4:7], a[192:195], v[148:151], a[4:7]
buffer_load_dwordx4 v48, s[4:7], s16 offen offset:0 sc1 lds
v_mfma_f32_16x16x32_bf16 a[4:7], a[196:199], v[156:159], a[4:7]
ds_read_b128 a[232:235], v16 offset:37888
v_max3_f32 v22, v68, v69, v70
v_mfma_f32_16x16x32_bf16 a[8:11], a[200:203], v[144:147], a[8:11]
v_max3_f32 v21, v67, v72, v21
v_max3_f32 v22, v71, v76, v22
v_mfma_f32_16x16x32_bf16 a[8:11], a[204:207], v[152:155], a[8:11]
ds_read_b128 a[236:239], v16 offset:54272
v_max3_f32 v21, v73, v74, v21
v_mfma_f32_16x16x32_bf16 a[12:15], a[200:203], v[148:151], a[12:15]
ds_read_b128 a[240:243], v16 offset:38912
v_max3_f32 v22, v77, v78, v22
v_mfma_f32_16x16x32_bf16 a[12:15], a[204:207], v[156:159], a[12:15]
v_max3_f32 v21, v75, v80, v21
v_max3_f32 v22, v79, v84, v22
s_waitcnt lgkmcnt(5)
v_mfma_f32_16x16x32_bf16 a[16:19], a[208:211], v[144:147], a[16:19]
v_max3_f32 v21, v81, v82, v21
v_max3_f32 v22, v85, v86, v22
v_mfma_f32_16x16x32_bf16 a[16:19], a[212:215], v[152:155], a[16:19]
v_max3_f32 v21, v83, v88, v21
v_max3_f32 v22, v87, v92, v22
v_mfma_f32_16x16x32_bf16 a[20:23], a[208:211], v[148:151], a[20:23]
v_max3_f32 v21, v89, v90, v21
v_max3_f32 v22, v93, v94, v22
v_mfma_f32_16x16x32_bf16 a[20:23], a[212:215], v[156:159], a[20:23]
v_max_f32 v21, v91, v21
v_max_f32 v22, v95, v22
v_mfma_f32_16x16x32_bf16 a[24:27], a[216:219], v[144:147], a[24:27]
ds_read_b128 a[244:247], v16 offset:55296
v_max_f32 v23, v21, v22
v_mfma_f32_16x16x32_bf16 a[24:27], a[220:223], v[152:155], a[24:27]
ds_read_b128 a[248:251], v16 offset:39936
v_cmp_lt_f32 vcc, s22, v23
v_mfma_f32_16x16x32_bf16 a[28:31], a[216:219], v[148:151], a[28:31]
s_cbranch_vccnz mega_kernel_m1_r1
v_mfma_f32_16x16x32_bf16 a[28:31], a[220:223], v[156:159], a[28:31]
ds_read_b128 a[252:255], v16 offset:56320
s_waitcnt lgkmcnt(4)
v_mfma_f32_16x16x32_bf16 a[32:35], a[224:227], v[144:147], a[32:35]
buffer_load_dwordx4 v49, s[4:7], s16 offen offset:1024 sc1 lds
v_mfma_f32_16x16x32_bf16 a[32:35], a[228:231], v[152:155], a[32:35]
ds_read_b128 a[192:195], v16 offset:40960
v_mfma_f32_16x16x32_bf16 a[36:39], a[224:227], v[148:151], a[36:39]
v_exp_f32 v64, v64
v_mfma_f32_16x16x32_bf16 a[36:39], a[228:231], v[156:159], a[36:39]
buffer_load_dwordx4 v50, s[4:7], s16 offen offset:2048 sc1 lds
v_mfma_f32_16x16x32_bf16 a[40:43], a[232:235], v[144:147], a[40:43]
ds_read_b128 a[196:199], v16 offset:57344
v_add_f32 v24, v64, v24
v_mfma_f32_16x16x32_bf16 a[40:43], a[236:239], v[152:155], a[40:43]
v_exp_f32 v65, v65
v_mfma_f32_16x16x32_bf16 a[44:47], a[232:235], v[148:151], a[44:47]
ds_read_b128 a[200:203], v16 offset:41984
v_add_f32 v24, v65, v24
v_mfma_f32_16x16x32_bf16 a[44:47], a[236:239], v[156:159], a[44:47]
ds_read_b128 a[204:207], v16 offset:58368
s_waitcnt lgkmcnt(4)
v_mfma_f32_16x16x32_bf16 a[48:51], a[240:243], v[144:147], a[48:51]
v_exp_f32 v66, v66
v_mfma_f32_16x16x32_bf16 a[48:51], a[244:247], v[152:155], a[48:51]
ds_read_b128 a[208:211], v16 offset:43008
v_cvt_pk_bf16_f32 v128, v64, v65
v_mfma_f32_16x16x32_bf16 a[52:55], a[240:243], v[148:151], a[52:55]
buffer_load_dwordx4 v51, s[4:7], s16 offen offset:3072 sc1 lds
v_mfma_f32_16x16x32_bf16 a[52:55], a[244:247], v[156:159], a[52:55]
s_add_u32 m0, s18, 102400
ds_read_b128 a[212:215], v16 offset:59392
v_mfma_f32_16x16x32_bf16 a[56:59], a[248:251], v[144:147], a[56:59]
v_exp_f32 v67, v67
v_mfma_f32_16x16x32_bf16 a[56:59], a[252:255], v[152:155], a[56:59]
ds_read_b128 a[216:219], v16 offset:44032
v_add_f32 v24, v66, v24
v_mfma_f32_16x16x32_bf16 a[60:63], a[248:251], v[148:151], a[60:63]
ds_read_b128 a[220:223], v16 offset:60416
v_add_f32 v24, v67, v24
v_mfma_f32_16x16x32_bf16 a[60:63], a[252:255], v[156:159], a[60:63]
ds_read_b128 a[224:227], v16 offset:45056
s_waitcnt lgkmcnt(5)
v_mfma_f32_16x16x32_bf16 a[64:67], a[192:195], v[144:147], a[64:67]
buffer_load_dwordx4 v52, s[4:7], s16 offen offset:0 sc1 lds
v_mfma_f32_16x16x32_bf16 a[64:67], a[196:199], v[152:155], a[64:67]
v_exp_f32 v72, v72
v_mfma_f32_16x16x32_bf16 a[68:71], a[192:195], v[148:151], a[68:71]
ds_read_b128 a[228:231], v16 offset:61440
v_cvt_pk_bf16_f32 v129, v66, v67
v_mfma_f32_16x16x32_bf16 a[68:71], a[196:199], v[156:159], a[68:71]
v_exp_f32 v73, v73
v_mfma_f32_16x16x32_bf16 a[72:75], a[200:203], v[144:147], a[72:75]
ds_read_b128 a[232:235], v16 offset:46080
v_add_f32 v24, v72, v24
v_mfma_f32_16x16x32_bf16 a[72:75], a[204:207], v[152:155], a[72:75]
buffer_load_dwordx4 v53, s[4:7], s16 offen offset:1024 sc1 lds
v_mfma_f32_16x16x32_bf16 a[76:79], a[200:203], v[148:151], a[76:79]
ds_read_b128 a[236:239], v16 offset:62464
v_add_f32 v24, v73, v24
v_mfma_f32_16x16x32_bf16 a[76:79], a[204:207], v[156:159], a[76:79]
ds_read_b128 a[240:243], v16 offset:47104
s_waitcnt lgkmcnt(5)
v_mfma_f32_16x16x32_bf16 a[80:83], a[208:211], v[144:147], a[80:83]
v_exp_f32 v74, v74
v_mfma_f32_16x16x32_bf16 a[80:83], a[212:215], v[152:155], a[80:83]
ds_read_b128 a[244:247], v16 offset:63488
v_cvt_pk_bf16_f32 v130, v72, v73
v_mfma_f32_16x16x32_bf16 a[84:87], a[208:211], v[148:151], a[84:87]
ds_read_b128 a[248:251], v16 offset:48128
v_add_f32 v24, v74, v24
v_mfma_f32_16x16x32_bf16 a[84:87], a[212:215], v[156:159], a[84:87]
s_add_u32 s19, s19, 1
ds_read_b128 a[252:255], v16 offset:64512
v_mfma_f32_16x16x32_bf16 a[88:91], a[216:219], v[144:147], a[88:91]
v_exp_f32 v75, v75
v_mfma_f32_16x16x32_bf16 a[88:91], a[220:223], v[152:155], a[88:91]
buffer_load_dwordx4 v54, s[4:7], s16 offen offset:2048 sc1 lds
v_mfma_f32_16x16x32_bf16 a[92:95], a[216:219], v[148:151], a[92:95]
buffer_load_dwordx4 v55, s[4:7], s16 offen offset:3072 sc1 lds
v_mfma_f32_16x16x32_bf16 a[92:95], a[220:223], v[156:159], a[92:95]
s_waitcnt vmcnt(16) lgkmcnt(0)
s_barrier
v_mfma_f32_16x16x32_bf16 a[96:99], a[224:227], v[144:147], a[96:99]
v_exp_f32 v68, v68
v_mfma_f32_16x16x32_bf16 a[96:99], a[228:231], v[152:155], a[96:99]
v_exp_f32 v69, v69
v_mfma_f32_16x16x32_bf16 a[100:103], a[224:227], v[148:151], a[100:103]
v_exp_f32 v70, v70
v_mfma_f32_16x16x32_bf16 a[100:103], a[228:231], v[156:159], a[100:103]
ds_read_b128 a[192:195], v17 offset:0
v_add_f32 v24, v75, v24
v_mfma_f32_16x16x32_bf16 a[104:107], a[232:235], v[144:147], a[104:107]
ds_read_b128 a[196:199], v17 offset:1024
v_cvt_pk_bf16_f32 v131, v74, v75
v_mfma_f32_16x16x32_bf16 a[104:107], a[236:239], v[152:155], a[104:107]
v_exp_f32 v71, v71
v_mfma_f32_16x16x32_bf16 a[108:111], a[232:235], v[148:151], a[108:111]
ds_read_b128 a[200:203], v17 offset:2048
v_add_f32 v25, v68, v25
v_mfma_f32_16x16x32_bf16 a[108:111], a[236:239], v[156:159], a[108:111]
ds_read_b128 a[204:207], v17 offset:3072
v_add_f32 v25, v69, v25
v_mfma_f32_16x16x32_bf16 a[112:115], a[240:243], v[144:147], a[112:115]
v_exp_f32 v76, v76
v_mfma_f32_16x16x32_bf16 a[112:115], a[244:247], v[152:155], a[112:115]
ds_read_b128 a[208:211], v17 offset:4096
v_cvt_pk_bf16_f32 v132, v68, v69
v_mfma_f32_16x16x32_bf16 a[116:119], a[240:243], v[148:151], a[116:119]
v_exp_f32 v77, v77
v_mfma_f32_16x16x32_bf16 a[116:119], a[244:247], v[156:159], a[116:119]
s_add_u32 s16, s16, s26
ds_read_b128 a[212:215], v17 offset:5120
v_mfma_f32_16x16x32_bf16 a[120:123], a[248:251], v[144:147], a[120:123]
ds_read_b128 a[216:219], v17 offset:6144
v_add_f32 v25, v70, v25
v_mfma_f32_16x16x32_bf16 a[120:123], a[252:255], v[152:155], a[120:123]
ds_read_b128 a[220:223], v17 offset:7168
v_add_f32 v25, v71, v25
v_mfma_f32_16x16x32_bf16 a[124:127], a[248:251], v[148:151], a[124:127]
v_cvt_pk_bf16_f32 v133, v70, v71
v_add_f32 v25, v76, v25
v_mfma_f32_16x16x32_bf16 a[124:127], a[252:255], v[156:159], a[124:127]
v_add_f32 v25, v77, v25
v_cvt_pk_bf16_f32 v134, v76, v77
mega_kernel_m1_end:
mega_kernel_m0:
s_cmp_lt_u32 s20, 2
s_cbranch_scc1 mega_kernel_k0a
s_waitcnt lgkmcnt(4)
s_add_u32 m0, s18, 32768
v_mfma_f32_16x16x32_bf16 v[96:99], a[192:195], v[192:195], v[32:35]
ds_read_b128 a[224:227], v17 offset:8192
v_mfma_f32_16x16x32_bf16 v[96:99], a[196:199], v[196:199], v[96:99]
v_exp_f32 v78, v78
v_mfma_f32_16x16x32_bf16 v[96:99], a[200:203], v[200:203], v[96:99]
ds_read_b128 a[228:231], v17 offset:9216
v_add_f32 v25, v78, v25
v_mfma_f32_16x16x32_bf16 v[96:99], a[204:207], v[204:207], v[96:99]
ds_read_b128 a[232:235], v17 offset:10240
s_waitcnt lgkmcnt(3)
v_mfma_f32_16x16x32_bf16 v[96:99], a[208:211], v[208:211], v[96:99]
buffer_load_dwordx4 v56, s[8:11], s17 offen offset:0 sc1 lds
v_mfma_f32_16x16x32_bf16 v[96:99], a[212:215], v[212:215], v[96:99]
v_exp_f32 v79, v79
v_mfma_f32_16x16x32_bf16 v[96:99], a[216:219], v[216:219], v[96:99]
ds_read_b128 a[236:239], v17 offset:11264
v_add_f32 v25, v79, v25
v_mfma_f32_16x16x32_bf16 v[96:99], a[220:223], v[220:223], v[96:99]
ds_read_b128 a[240:243], v17 offset:12288
v_cvt_pk_bf16_f32 v135, v78, v79
v_mfma_f32_16x16x32_bf16 v[100:103], a[192:195], v[224:227], v[36:39]
v_exp_f32 v80, v80
v_mfma_f32_16x16x32_bf16 v[100:103], a[196:199], v[228:231], v[100:103]
buffer_load_dwordx4 v56, s[8:11], s17 offen offset:1024 sc1 lds
v_mfma_f32_16x16x32_bf16 v[100:103], a[200:203], v[232:235], v[100:103]
ds_read_b128 a[244:247], v17 offset:13312
v_add_f32 v24, v80, v24
v_mfma_f32_16x16x32_bf16 v[100:103], a[204:207], v[236:239], v[100:103]
v_exp_f32 v81, v81
v_mfma_f32_16x16x32_bf16 v[100:103], a[208:211], v[240:243], v[100:103]
ds_read_b128 a[248:251], v17 offset:14336
v_add_f32 v24, v81, v24
v_mfma_f32_16x16x32_bf16 v[100:103], a[212:215], v[244:247], v[100:103]
ds_read_b128 a[252:255], v17 offset:15360
v_cvt_pk_bf16_f32 v136, v80, v81
v_mfma_f32_16x16x32_bf16 v[100:103], a[216:219], v[248:251], v[100:103]
v_exp_f32 v82, v82
v_mfma_f32_16x16x32_bf16 v[100:103], a[220:223], v[252:255], v[100:103]
ds_read_b128 a[192:195], v17 offset:16384
s_waitcnt lgkmcnt(5)
v_mfma_f32_16x16x32_bf16 v[104:107], a[224:227], v[192:195], v[32:35]
buffer_load_dwordx4 v56, s[8:11], s17 offen offset:2048 sc1 lds
v_mfma_f32_16x16x32_bf16 v[104:107], a[228:231], v[196:199], v[104:107]
ds_read_b128 a[196:199], v17 offset:17408
v_add_f32 v24, v82, v24
v_mfma_f32_16x16x32_bf16 v[104:107], a[232:235], v[200:203], v[104:107]
v_exp_f32 v83, v83
v_mfma_f32_16x16x32_bf16 v[104:107], a[236:239], v[204:207], v[104:107]
ds_read_b128 a[200:203], v17 offset:18432
s_waitcnt lgkmcnt(3)
v_mfma_f32_16x16x32_bf16 v[104:107], a[240:243], v[208:211], v[104:107]
v_exp_f32 v88, v88
v_mfma_f32_16x16x32_bf16 v[104:107], a[244:247], v[212:215], v[104:107]
ds_read_b128 a[204:207], v17 offset:19456
v_add_f32 v24, v83, v24
v_mfma_f32_16x16x32_bf16 v[104:107], a[248:251], v[216:219], v[104:107]
buffer_load_dwordx4 v56, s[8:11], s17 offen offset:3072 sc1 lds
v_mfma_f32_16x16x32_bf16 v[104:107], a[252:255], v[220:223], v[104:107]
ds_read_b128 a[208:211], v17 offset:20480
v_cvt_pk_bf16_f32 v137, v82, v83
v_mfma_f32_16x16x32_bf16 v[108:111], a[224:227], v[224:227], v[36:39]
v_exp_f32 v89, v89
v_mfma_f32_16x16x32_bf16 v[108:111], a[228:231], v[228:231], v[108:111]
s_add_u32 m0, s18, 36864
ds_read_b128 a[212:215], v17 offset:21504
v_mfma_f32_16x16x32_bf16 v[108:111], a[232:235], v[232:235], v[108:111]
ds_read_b128 a[216:219], v17 offset:22528
v_add_f32 v24, v88, v24
v_mfma_f32_16x16x32_bf16 v[108:111], a[236:239], v[236:239], v[108:111]
v_exp_f32 v90, v90
v_mfma_f32_16x16x32_bf16 v[108:111], a[240:243], v[240:243], v[108:111]
buffer_load_dwordx4 v57, s[8:11], s17 offen offset:0 sc1 lds
v_mfma_f32_16x16x32_bf16 v[108:111], a[244:247], v[244:247], v[108:111]
ds_read_b128 a[220:223], v17 offset:23552
v_add_f32 v24, v89, v24
v_mfma_f32_16x16x32_bf16 v[108:111], a[248:251], v[248:251], v[108:111]
ds_read_b128 a[224:227], v17 offset:24576
v_cvt_pk_bf16_f32 v138, v88, v89
v_mfma_f32_16x16x32_bf16 v[108:111], a[252:255], v[252:255], v[108:111]
ds_read_b128 a[228:231], v17 offset:25600
s_waitcnt lgkmcnt(6)
s_cmp_eq_u32 s20, 2
s_cbranch_scc1 mega_kernel_k0b
v_mfma_f32_16x16x32_bf16 v[112:115], a[192:195], v[192:195], v[32:35]
v_exp_f32 v91, v91
v_mfma_f32_16x16x32_bf16 v[112:115], a[196:199], v[196:199], v[112:115]
ds_read_b128 a[232:235], v17 offset:26624
v_add_f32 v24, v90, v24
v_mfma_f32_16x16x32_bf16 v[112:115], a[200:203], v[200:203], v[112:115]
buffer_load_dwordx4 v57, s[8:11], s17 offen offset:1024 sc1 lds
v_mfma_f32_16x16x32_bf16 v[112:115], a[204:207], v[204:207], v[112:115]
ds_read_b128 a[236:239], v17 offset:27648
s_waitcnt lgkmcnt(4)
v_mfma_f32_16x16x32_bf16 v[112:115], a[208:211], v[208:211], v[112:115]
v_exp_f32 v84, v84
v_mfma_f32_16x16x32_bf16 v[112:115], a[212:215], v[212:215], v[112:115]
ds_read_b128 a[240:243], v17 offset:28672
v_add_f32 v24, v91, v24
v_mfma_f32_16x16x32_bf16 v[112:115], a[216:219], v[216:219], v[112:115]
v_exp_f32 v85, v85
v_mfma_f32_16x16x32_bf16 v[112:115], a[220:223], v[220:223], v[112:115]
ds_read_b128 a[244:247], v17 offset:29696
v_cvt_pk_bf16_f32 v139, v90, v91
v_mfma_f32_16x16x32_bf16 v[116:119], a[192:195], v[224:227], v[36:39]
buffer_load_dwordx4 v57, s[8:11], s17 offen offset:2048 sc1 lds
v_mfma_f32_16x16x32_bf16 v[116:119], a[196:199], v[228:231], v[116:119]
v_exp_f32 v86, v86
v_mfma_f32_16x16x32_bf16 v[116:119], a[200:203], v[232:235], v[116:119]
ds_read_b128 a[248:251], v17 offset:30720
v_add_f32 v25, v84, v25
v_mfma_f32_16x16x32_bf16 v[116:119], a[204:207], v[236:239], v[116:119]
ds_read_b128 a[252:255], v17 offset:31744
v_add_f32 v25, v85, v25
v_mfma_f32_16x16x32_bf16 v[116:119], a[208:211], v[240:243], v[116:119]
v_exp_f32 v87, v87
v_mfma_f32_16x16x32_bf16 v[116:119], a[212:215], v[244:247], v[116:119]
v_exp_f32 v92, v92
v_mfma_f32_16x16x32_bf16 v[116:119], a[216:219], v[248:251], v[116:119]
buffer_load_dwordx4 v57, s[8:11], s17 offen offset:3072 sc1 lds
v_mfma_f32_16x16x32_bf16 v[116:119], a[220:223], v[252:255], v[116:119]
s_waitcnt vmcnt(16) lgkmcnt(0)
s_barrier
v_mfma_f32_16x16x32_bf16 v[120:123], a[224:227], v[192:195], v[32:35]
v_exp_f32 v93, v93
v_mfma_f32_16x16x32_bf16 v[120:123], a[228:231], v[196:199], v[120:123]
ds_read_b128 a[192:195], v16 offset:0
v_cvt_pk_bf16_f32 v140, v84, v85
v_mfma_f32_16x16x32_bf16 v[120:123], a[232:235], v[200:203], v[120:123]
ds_read_b128 a[196:199], v16 offset:16384
v_add_f32 v25, v86, v25
v_mfma_f32_16x16x32_bf16 v[120:123], a[236:239], v[204:207], v[120:123]
v_exp_f32 v94, v94
v_mfma_f32_16x16x32_bf16 v[120:123], a[240:243], v[208:211], v[120:123]
ds_read_b128 a[200:203], v16 offset:1024
v_add_f32 v25, v87, v25
v_mfma_f32_16x16x32_bf16 v[120:123], a[244:247], v[212:215], v[120:123]
v_exp_f32 v95, v95
v_mfma_f32_16x16x32_bf16 v[120:123], a[248:251], v[216:219], v[120:123]
ds_read_b128 a[204:207], v16 offset:17408
v_cvt_pk_bf16_f32 v141, v86, v87
v_mfma_f32_16x16x32_bf16 v[120:123], a[252:255], v[220:223], v[120:123]
ds_read_b128 a[208:211], v16 offset:2048
v_add_f32 v25, v92, v25
v_mfma_f32_16x16x32_bf16 v[124:127], a[224:227], v[224:227], v[36:39]
s_add_u32 s17, s17, 32768
v_add_f32 v25, v93, v25
v_mfma_f32_16x16x32_bf16 v[124:127], a[228:231], v[228:231], v[124:127]
ds_read_b128 a[212:215], v16 offset:18432
v_cvt_pk_bf16_f32 v142, v92, v93
v_mfma_f32_16x16x32_bf16 v[124:127], a[232:235], v[232:235], v[124:127]
v_add_f32 v25, v94, v25
v_cvt_pk_bf16_f32 v143, v94, v95
v_mfma_f32_16x16x32_bf16 v[124:127], a[236:239], v[236:239], v[124:127]
ds_read_b128 a[216:219], v16 offset:3072
v_add_f32 v25, v95, v25
v_mfma_f32_16x16x32_bf16 v[124:127], a[240:243], v[240:243], v[124:127]
ds_read_b128 a[220:223], v16 offset:19456
v_mfma_f32_16x16x32_bf16 v[124:127], a[244:247], v[244:247], v[124:127]
v_mfma_f32_16x16x32_bf16 v[124:127], a[248:251], v[248:251], v[124:127]
v_mfma_f32_16x16x32_bf16 v[124:127], a[252:255], v[252:255], v[124:127]
mega_kernel_k0r:
s_nop 7
v_mov_b32 v3, 0xf149f2ca
s_add_i32 s25, s24, 0
v_cmp_ge_i32 s[28:29], s25, v20
s_add_i32 s25, s24, -1
v_cmp_ge_i32 s[30:31], s25, v20
s_add_i32 s25, s24, -2
v_cmp_ge_i32 s[32:33], s25, v20
s_add_i32 s25, s24, -3
v_cmp_ge_i32 s[34:35], s25, v20
v_cndmask_b32 v96, v3, v96, s[28:29]
v_cndmask_b32 v97, v3, v97, s[30:31]
v_cndmask_b32 v98, v3, v98, s[32:33]
v_cndmask_b32 v99, v3, v99, s[34:35]
s_add_i32 s25, s24, 16
v_cmp_ge_i32 s[28:29], s25, v20
s_add_i32 s25, s24, 15
v_cmp_ge_i32 s[30:31], s25, v20
s_add_i32 s25, s24, 14
v_cmp_ge_i32 s[32:33], s25, v20
s_add_i32 s25, s24, 13
v_cmp_ge_i32 s[34:35], s25, v20
v_cndmask_b32 v100, v3, v100, s[28:29]
v_cndmask_b32 v101, v3, v101, s[30:31]
v_cndmask_b32 v102, v3, v102, s[32:33]
v_cndmask_b32 v103, v3, v103, s[34:35]
s_add_i32 s25, s24, -16
v_cmp_ge_i32 s[28:29], s25, v20
s_add_i32 s25, s24, -17
v_cmp_ge_i32 s[30:31], s25, v20
s_add_i32 s25, s24, -18
v_cmp_ge_i32 s[32:33], s25, v20
s_add_i32 s25, s24, -19
v_cmp_ge_i32 s[34:35], s25, v20
v_cndmask_b32 v104, v3, v104, s[28:29]
v_cndmask_b32 v105, v3, v105, s[30:31]
v_cndmask_b32 v106, v3, v106, s[32:33]
v_cndmask_b32 v107, v3, v107, s[34:35]
s_add_i32 s25, s24, 0
v_cmp_ge_i32 s[28:29], s25, v20
s_add_i32 s25, s24, -1
v_cmp_ge_i32 s[30:31], s25, v20
s_add_i32 s25, s24, -2
v_cmp_ge_i32 s[32:33], s25, v20
s_add_i32 s25, s24, -3
v_cmp_ge_i32 s[34:35], s25, v20
v_cndmask_b32 v108, v3, v108, s[28:29]
v_cndmask_b32 v109, v3, v109, s[30:31]
v_cndmask_b32 v110, v3, v110, s[32:33]
v_cndmask_b32 v111, v3, v111, s[34:35]
s_add_i32 s25, s24, -32
v_cmp_ge_i32 s[28:29], s25, v20
s_add_i32 s25, s24, -33
v_cmp_ge_i32 s[30:31], s25, v20
s_add_i32 s25, s24, -34
v_cmp_ge_i32 s[32:33], s25, v20
s_add_i32 s25, s24, -35
v_cmp_ge_i32 s[34:35], s25, v20
v_cndmask_b32 v112, v3, v112, s[28:29]
v_cndmask_b32 v113, v3, v113, s[30:31]
v_cndmask_b32 v114, v3, v114, s[32:33]
v_cndmask_b32 v115, v3, v115, s[34:35]
s_add_i32 s25, s24, -16
v_cmp_ge_i32 s[28:29], s25, v20
s_add_i32 s25, s24, -17
v_cmp_ge_i32 s[30:31], s25, v20
s_add_i32 s25, s24, -18
v_cmp_ge_i32 s[32:33], s25, v20
s_add_i32 s25, s24, -19
v_cmp_ge_i32 s[34:35], s25, v20
v_cndmask_b32 v116, v3, v116, s[28:29]
v_cndmask_b32 v117, v3, v117, s[30:31]
v_cndmask_b32 v118, v3, v118, s[32:33]
v_cndmask_b32 v119, v3, v119, s[34:35]
s_add_i32 s25, s24, -48
v_cmp_ge_i32 s[28:29], s25, v20
s_add_i32 s25, s24, -49
v_cmp_ge_i32 s[30:31], s25, v20
s_add_i32 s25, s24, -50
v_cmp_ge_i32 s[32:33], s25, v20
s_add_i32 s25, s24, -51
v_cmp_ge_i32 s[34:35], s25, v20
v_cndmask_b32 v120, v3, v120, s[28:29]
v_cndmask_b32 v121, v3, v121, s[30:31]
v_cndmask_b32 v122, v3, v122, s[32:33]
v_cndmask_b32 v123, v3, v123, s[34:35]
s_add_i32 s25, s24, -32
v_cmp_ge_i32 s[28:29], s25, v20
s_add_i32 s25, s24, -33
v_cmp_ge_i32 s[30:31], s25, v20
s_add_i32 s25, s24, -34
v_cmp_ge_i32 s[32:33], s25, v20
s_add_i32 s25, s24, -35
v_cmp_ge_i32 s[34:35], s25, v20
v_cndmask_b32 v124, v3, v124, s[28:29]
v_cndmask_b32 v125, v3, v125, s[30:31]
v_cndmask_b32 v126, v3, v126, s[32:33]
v_cndmask_b32 v127, v3, v127, s[34:35]
s_sub_i32 s24, s24, 64
s_waitcnt lgkmcnt(4)
v_mfma_f32_16x16x32_bf16 a[0:3], a[192:195], v[128:131], a[0:3]
s_add_u32 m0, s18, 65536
ds_read_b128 a[224:227], v16 offset:4096
v_mfma_f32_16x16x32_bf16 a[0:3], a[196:199], v[136:139], a[0:3]
ds_read_b128 a[228:231], v16 offset:20480
v_max3_f32 v21, v96, v97, v98
v_mfma_f32_16x16x32_bf16 a[4:7], a[192:195], v[132:135], a[4:7]
buffer_load_dwordx4 v48, s[4:7], s16 offen offset:0 sc1 lds
v_mfma_f32_16x16x32_bf16 a[4:7], a[196:199], v[140:143], a[4:7]
ds_read_b128 a[232:235], v16 offset:5120
v_max3_f32 v22, v100, v101, v102
v_mfma_f32_16x16x32_bf16 a[8:11], a[200:203], v[128:131], a[8:11]
v_max3_f32 v21, v99, v104, v21
v_max3_f32 v22, v103, v108, v22
v_mfma_f32_16x16x32_bf16 a[8:11], a[204:207], v[136:139], a[8:11]
ds_read_b128 a[236:239], v16 offset:21504
v_max3_f32 v21, v105, v106, v21
v_mfma_f32_16x16x32_bf16 a[12:15], a[200:203], v[132:135], a[12:15]
ds_read_b128 a[240:243], v16 offset:6144
v_max3_f32 v22, v109, v110, v22
v_mfma_f32_16x16x32_bf16 a[12:15], a[204:207], v[140:143], a[12:15]
v_max3_f32 v21, v107, v112, v21
v_max3_f32 v22, v111, v116, v22
s_waitcnt lgkmcnt(5)
v_mfma_f32_16x16x32_bf16 a[16:19], a[208:211], v[128:131], a[16:19]
v_max3_f32 v21, v113, v114, v21
v_max3_f32 v22, v117, v118, v22
v_mfma_f32_16x16x32_bf16 a[16:19], a[212:215], v[136:139], a[16:19]
v_max3_f32 v21, v115, v120, v21
v_max3_f32 v22, v119, v124, v22
v_mfma_f32_16x16x32_bf16 a[20:23], a[208:211], v[132:135], a[20:23]
v_max3_f32 v21, v121, v122, v21
v_max3_f32 v22, v125, v126, v22
v_mfma_f32_16x16x32_bf16 a[20:23], a[212:215], v[140:143], a[20:23]
v_max_f32 v21, v123, v21
v_max_f32 v22, v127, v22
v_mfma_f32_16x16x32_bf16 a[24:27], a[216:219], v[128:131], a[24:27]
ds_read_b128 a[244:247], v16 offset:22528
v_max_f32 v23, v21, v22
v_mfma_f32_16x16x32_bf16 a[24:27], a[220:223], v[136:139], a[24:27]
ds_read_b128 a[248:251], v16 offset:7168
v_cmp_lt_f32 vcc, s22, v23
v_mfma_f32_16x16x32_bf16 a[28:31], a[216:219], v[132:135], a[28:31]
s_cbranch_vccnz mega_kernel_m0_r1
v_mfma_f32_16x16x32_bf16 a[28:31], a[220:223], v[140:143], a[28:31]
ds_read_b128 a[252:255], v16 offset:23552
s_waitcnt lgkmcnt(4)
v_mfma_f32_16x16x32_bf16 a[32:35], a[224:227], v[128:131], a[32:35]
buffer_load_dwordx4 v49, s[4:7], s16 offen offset:1024 sc1 lds
v_mfma_f32_16x16x32_bf16 a[32:35], a[228:231], v[136:139], a[32:35]
ds_read_b128 a[192:195], v16 offset:8192
v_mfma_f32_16x16x32_bf16 a[36:39], a[224:227], v[132:135], a[36:39]
v_exp_f32 v96, v96
v_mfma_f32_16x16x32_bf16 a[36:39], a[228:231], v[140:143], a[36:39]
buffer_load_dwordx4 v50, s[4:7], s16 offen offset:2048 sc1 lds
v_mfma_f32_16x16x32_bf16 a[40:43], a[232:235], v[128:131], a[40:43]
ds_read_b128 a[196:199], v16 offset:24576
v_add_f32 v24, v96, v24
v_mfma_f32_16x16x32_bf16 a[40:43], a[236:239], v[136:139], a[40:43]
v_exp_f32 v97, v97
v_mfma_f32_16x16x32_bf16 a[44:47], a[232:235], v[132:135], a[44:47]
ds_read_b128 a[200:203], v16 offset:9216
v_add_f32 v24, v97, v24
v_mfma_f32_16x16x32_bf16 a[44:47], a[236:239], v[140:143], a[44:47]
ds_read_b128 a[204:207], v16 offset:25600
s_waitcnt lgkmcnt(4)
v_mfma_f32_16x16x32_bf16 a[48:51], a[240:243], v[128:131], a[48:51]
v_exp_f32 v98, v98
v_mfma_f32_16x16x32_bf16 a[48:51], a[244:247], v[136:139], a[48:51]
ds_read_b128 a[208:211], v16 offset:10240
v_cvt_pk_bf16_f32 v144, v96, v97
v_mfma_f32_16x16x32_bf16 a[52:55], a[240:243], v[132:135], a[52:55]
buffer_load_dwordx4 v51, s[4:7], s16 offen offset:3072 sc1 lds
v_mfma_f32_16x16x32_bf16 a[52:55], a[244:247], v[140:143], a[52:55]
s_add_u32 m0, s18, 69632
ds_read_b128 a[212:215], v16 offset:26624
v_mfma_f32_16x16x32_bf16 a[56:59], a[248:251], v[128:131], a[56:59]
v_exp_f32 v99, v99
v_mfma_f32_16x16x32_bf16 a[56:59], a[252:255], v[136:139], a[56:59]
ds_read_b128 a[216:219], v16 offset:11264
v_add_f32 v24, v98, v24
v_mfma_f32_16x16x32_bf16 a[60:63], a[248:251], v[132:135], a[60:63]
ds_read_b128 a[220:223], v16 offset:27648
v_add_f32 v24, v99, v24
v_mfma_f32_16x16x32_bf16 a[60:63], a[252:255], v[140:143], a[60:63]
ds_read_b128 a[224:227], v16 offset:12288
s_waitcnt lgkmcnt(5)
v_mfma_f32_16x16x32_bf16 a[64:67], a[192:195], v[128:131], a[64:67]
buffer_load_dwordx4 v52, s[4:7], s16 offen offset:0 sc1 lds
v_mfma_f32_16x16x32_bf16 a[64:67], a[196:199], v[136:139], a[64:67]
v_exp_f32 v104, v104
v_mfma_f32_16x16x32_bf16 a[68:71], a[192:195], v[132:135], a[68:71]
ds_read_b128 a[228:231], v16 offset:28672
v_cvt_pk_bf16_f32 v145, v98, v99
v_mfma_f32_16x16x32_bf16 a[68:71], a[196:199], v[140:143], a[68:71]
v_exp_f32 v105, v105
v_mfma_f32_16x16x32_bf16 a[72:75], a[200:203], v[128:131], a[72:75]
ds_read_b128 a[232:235], v16 offset:13312
v_add_f32 v24, v104, v24
v_mfma_f32_16x16x32_bf16 a[72:75], a[204:207], v[136:139], a[72:75]
buffer_load_dwordx4 v53, s[4:7], s16 offen offset:1024 sc1 lds
v_mfma_f32_16x16x32_bf16 a[76:79], a[200:203], v[132:135], a[76:79]
ds_read_b128 a[236:239], v16 offset:29696
v_add_f32 v24, v105, v24
v_mfma_f32_16x16x32_bf16 a[76:79], a[204:207], v[140:143], a[76:79]
ds_read_b128 a[240:243], v16 offset:14336
s_waitcnt lgkmcnt(5)
v_mfma_f32_16x16x32_bf16 a[80:83], a[208:211], v[128:131], a[80:83]
v_exp_f32 v106, v106
v_mfma_f32_16x16x32_bf16 a[80:83], a[212:215], v[136:139], a[80:83]
ds_read_b128 a[244:247], v16 offset:30720
v_cvt_pk_bf16_f32 v146, v104, v105
v_mfma_f32_16x16x32_bf16 a[84:87], a[208:211], v[132:135], a[84:87]
ds_read_b128 a[248:251], v16 offset:15360
v_add_f32 v24, v106, v24
v_mfma_f32_16x16x32_bf16 a[84:87], a[212:215], v[140:143], a[84:87]
s_add_u32 s19, s19, 1
ds_read_b128 a[252:255], v16 offset:31744
v_mfma_f32_16x16x32_bf16 a[88:91], a[216:219], v[128:131], a[88:91]
v_exp_f32 v107, v107
v_mfma_f32_16x16x32_bf16 a[88:91], a[220:223], v[136:139], a[88:91]
buffer_load_dwordx4 v54, s[4:7], s16 offen offset:2048 sc1 lds
v_mfma_f32_16x16x32_bf16 a[92:95], a[216:219], v[132:135], a[92:95]
buffer_load_dwordx4 v55, s[4:7], s16 offen offset:3072 sc1 lds
v_mfma_f32_16x16x32_bf16 a[92:95], a[220:223], v[140:143], a[92:95]
s_waitcnt vmcnt(16) lgkmcnt(0)
s_barrier
v_mfma_f32_16x16x32_bf16 a[96:99], a[224:227], v[128:131], a[96:99]
v_exp_f32 v100, v100
v_mfma_f32_16x16x32_bf16 a[96:99], a[228:231], v[136:139], a[96:99]
v_exp_f32 v101, v101
v_mfma_f32_16x16x32_bf16 a[100:103], a[224:227], v[132:135], a[100:103]
v_exp_f32 v102, v102
v_mfma_f32_16x16x32_bf16 a[100:103], a[228:231], v[140:143], a[100:103]
ds_read_b128 a[192:195], v17 offset:32768
v_add_f32 v24, v107, v24
v_mfma_f32_16x16x32_bf16 a[104:107], a[232:235], v[128:131], a[104:107]
ds_read_b128 a[196:199], v17 offset:33792
v_cvt_pk_bf16_f32 v147, v106, v107
v_mfma_f32_16x16x32_bf16 a[104:107], a[236:239], v[136:139], a[104:107]
v_exp_f32 v103, v103
v_mfma_f32_16x16x32_bf16 a[108:111], a[232:235], v[132:135], a[108:111]
ds_read_b128 a[200:203], v17 offset:34816
v_add_f32 v25, v100, v25
v_mfma_f32_16x16x32_bf16 a[108:111], a[236:239], v[140:143], a[108:111]
ds_read_b128 a[204:207], v17 offset:35840
v_add_f32 v25, v101, v25
v_mfma_f32_16x16x32_bf16 a[112:115], a[240:243], v[128:131], a[112:115]
v_exp_f32 v108, v108
v_mfma_f32_16x16x32_bf16 a[112:115], a[244:247], v[136:139], a[112:115]
ds_read_b128 a[208:211], v17 offset:36864
v_cvt_pk_bf16_f32 v148, v100, v101
v_mfma_f32_16x16x32_bf16 a[116:119], a[240:243], v[132:135], a[116:119]
v_exp_f32 v109, v109
v_mfma_f32_16x16x32_bf16 a[116:119], a[244:247], v[140:143], a[116:119]
s_add_u32 s16, s16, s26
ds_read_b128 a[212:215], v17 offset:37888
v_mfma_f32_16x16x32_bf16 a[120:123], a[248:251], v[128:131], a[120:123]
ds_read_b128 a[216:219], v17 offset:38912
v_add_f32 v25, v102, v25
v_mfma_f32_16x16x32_bf16 a[120:123], a[252:255], v[136:139], a[120:123]
ds_read_b128 a[220:223], v17 offset:39936
v_add_f32 v25, v103, v25
v_mfma_f32_16x16x32_bf16 a[124:127], a[248:251], v[132:135], a[124:127]
v_cvt_pk_bf16_f32 v149, v102, v103
v_add_f32 v25, v108, v25
v_mfma_f32_16x16x32_bf16 a[124:127], a[252:255], v[140:143], a[124:127]
v_add_f32 v25, v109, v25
v_cvt_pk_bf16_f32 v150, v108, v109
mega_kernel_m0_end:
s_waitcnt vmcnt(8) lgkmcnt(0)
s_barrier
ds_read_b128 a[192:195], v16 offset:32768
ds_read_b128 a[196:199], v16 offset:49152
ds_read_b128 a[200:203], v16 offset:33792
ds_read_b128 a[204:207], v16 offset:50176
ds_read_b128 a[208:211], v16 offset:34816
ds_read_b128 a[212:215], v16 offset:51200
ds_read_b128 a[216:219], v16 offset:35840
ds_read_b128 a[220:223], v16 offset:52224
v_exp_f32 v110, v110
v_exp_f32 v111, v111
v_exp_f32 v112, v112
v_exp_f32 v113, v113
v_add_f32 v25, v110, v25
v_cvt_pk_bf16_f32 v151, v110, v111
v_add_f32 v25, v111, v25
v_exp_f32 v114, v114
v_exp_f32 v115, v115
v_add_f32 v24, v112, v24
v_cvt_pk_bf16_f32 v152, v112, v113
v_add_f32 v24, v113, v24
v_exp_f32 v120, v120
v_exp_f32 v121, v121
v_add_f32 v24, v114, v24
v_cvt_pk_bf16_f32 v153, v114, v115
v_add_f32 v24, v115, v24
v_exp_f32 v122, v122
v_exp_f32 v123, v123
v_add_f32 v24, v120, v24
v_cvt_pk_bf16_f32 v154, v120, v121
v_add_f32 v24, v121, v24
v_exp_f32 v116, v116
v_exp_f32 v117, v117
v_add_f32 v24, v122, v24
v_cvt_pk_bf16_f32 v155, v122, v123
v_add_f32 v24, v123, v24
v_exp_f32 v118, v118
v_exp_f32 v119, v119
v_add_f32 v25, v116, v25
v_cvt_pk_bf16_f32 v156, v116, v117
v_add_f32 v25, v117, v25
v_exp_f32 v124, v124
v_exp_f32 v125, v125
v_add_f32 v25, v118, v25
v_cvt_pk_bf16_f32 v157, v118, v119
v_add_f32 v25, v119, v25
v_exp_f32 v126, v126
v_exp_f32 v127, v127
v_add_f32 v25, v124, v25
v_cvt_pk_bf16_f32 v158, v124, v125
v_add_f32 v25, v125, v25
s_nop 0
v_add_f32 v25, v126, v25
v_cvt_pk_bf16_f32 v159, v126, v127
v_add_f32 v25, v127, v25
s_nop 1
s_cmp_lt_u32 s20, 2
s_cbranch_scc1 mega_kernel_kt
s_waitcnt lgkmcnt(4)
v_mfma_f32_16x16x32_bf16 a[0:3], a[192:195], v[144:147], a[0:3]
s_add_u32 m0, s18, 0
ds_read_b128 a[224:227], v16 offset:36864
v_mfma_f32_16x16x32_bf16 a[0:3], a[196:199], v[152:155], a[0:3]
ds_read_b128 a[228:231], v16 offset:53248
v_mov_b32 v2, v24
v_mfma_f32_16x16x32_bf16 a[4:7], a[192:195], v[148:151], a[4:7]
ds_read_b128 a[232:235], v16 offset:37888
v_mov_b32 v3, v25
v_mfma_f32_16x16x32_bf16 a[4:7], a[196:199], v[156:159], a[4:7]
ds_read_b128 a[236:239], v16 offset:54272
v_permlane16_swap_b32 v2, v24
v_mfma_f32_16x16x32_bf16 a[8:11], a[200:203], v[144:147], a[8:11]
ds_read_b128 a[240:243], v16 offset:38912
v_permlane16_swap_b32 v3, v25
v_mfma_f32_16x16x32_bf16 a[8:11], a[204:207], v[152:155], a[8:11]
ds_read_b128 a[244:247], v16 offset:55296
v_add_f32 v24, v24, v2
v_mfma_f32_16x16x32_bf16 a[12:15], a[200:203], v[148:151], a[12:15]
v_mov_b32 v2, v24
v_add_f32 v25, v25, v3
v_mfma_f32_16x16x32_bf16 a[12:15], a[204:207], v[156:159], a[12:15]
v_mov_b32 v3, v25
s_waitcnt lgkmcnt(6)
v_mfma_f32_16x16x32_bf16 a[16:19], a[208:211], v[144:147], a[16:19]
ds_read_b128 a[248:251], v16 offset:39936
v_permlane32_swap_b32 v2, v24
v_mfma_f32_16x16x32_bf16 a[16:19], a[212:215], v[152:155], a[16:19]
ds_read_b128 a[252:255], v16 offset:56320
v_permlane32_swap_b32 v3, v25
v_mfma_f32_16x16x32_bf16 a[20:23], a[208:211], v[148:151], a[20:23]
ds_read_b128 a[192:195], v16 offset:40960
v_add_f32 v24, v24, v2
v_mfma_f32_16x16x32_bf16 a[20:23], a[212:215], v[156:159], a[20:23]
v_rcp_f32 v20, v24
v_add_f32 v25, v25, v3
v_mfma_f32_16x16x32_bf16 a[24:27], a[216:219], v[144:147], a[24:27]
v_rcp_f32 v22, v25
v_mfma_f32_16x16x32_bf16 a[24:27], a[220:223], v[152:155], a[24:27]
buffer_load_dwordx4 v48, s[4:7], s16 offen offset:0 sc1 lds
v_mfma_f32_16x16x32_bf16 a[28:31], a[216:219], v[148:151], a[28:31]
buffer_load_dwordx4 v49, s[4:7], s16 offen offset:1024 sc1 lds
v_mfma_f32_16x16x32_bf16 a[28:31], a[220:223], v[156:159], a[28:31]
ds_read_b128 a[196:199], v16 offset:57344
s_waitcnt lgkmcnt(6)
v_mfma_f32_16x16x32_bf16 a[32:35], a[224:227], v[144:147], a[32:35]
v_accvgpr_read_b32 v4, a0
v_accvgpr_read_b32 v5, a1
v_accvgpr_read_b32 v6, a2
v_mfma_f32_16x16x32_bf16 a[32:35], a[228:231], v[152:155], a[32:35]
v_accvgpr_read_b32 v7, a3
v_accvgpr_read_b32 v8, a8
v_mfma_f32_16x16x32_bf16 a[36:39], a[224:227], v[148:151], a[36:39]
v_accvgpr_read_b32 v9, a9
v_accvgpr_read_b32 v10, a10
v_accvgpr_read_b32 v11, a11
v_mfma_f32_16x16x32_bf16 a[36:39], a[228:231], v[156:159], a[36:39]
v_mul_f32 v4, v4, v20
v_mul_f32 v5, v5, v20
v_mfma_f32_16x16x32_bf16 a[40:43], a[232:235], v[144:147], a[40:43]
v_mul_f32 v6, v6, v20
v_mul_f32 v7, v7, v20
v_mul_f32 v8, v8, v20
v_mfma_f32_16x16x32_bf16 a[40:43], a[236:239], v[152:155], a[40:43]
v_mul_f32 v9, v9, v20
v_mul_f32 v10, v10, v20
v_mfma_f32_16x16x32_bf16 a[44:47], a[232:235], v[148:151], a[44:47]
v_mul_f32 v11, v11, v20
v_cvt_pk_bf16_f32 v64, v4, v5
v_cvt_pk_bf16_f32 v65, v6, v7
v_mfma_f32_16x16x32_bf16 a[44:47], a[236:239], v[156:159], a[44:47]
v_cvt_pk_bf16_f32 v66, v8, v9
v_cvt_pk_bf16_f32 v67, v10, v11
s_waitcnt lgkmcnt(2)
v_mfma_f32_16x16x32_bf16 a[48:51], a[240:243], v[144:147], a[48:51]
v_accvgpr_read_b32 v4, a4
v_accvgpr_read_b32 v5, a5
v_accvgpr_read_b32 v6, a6
v_mfma_f32_16x16x32_bf16 a[48:51], a[244:247], v[152:155], a[48:51]
v_accvgpr_read_b32 v7, a7
v_accvgpr_read_b32 v8, a12
v_mfma_f32_16x16x32_bf16 a[52:55], a[240:243], v[148:151], a[52:55]
v_accvgpr_read_b32 v9, a13
v_accvgpr_read_b32 v10, a14
v_accvgpr_read_b32 v11, a15
v_mfma_f32_16x16x32_bf16 a[52:55], a[244:247], v[156:159], a[52:55]
ds_read_b128 a[200:203], v16 offset:41984
v_mul_f32 v4, v4, v22
v_mul_f32 v5, v5, v22
v_mfma_f32_16x16x32_bf16 a[56:59], a[248:251], v[144:147], a[56:59]
ds_read_b128 a[204:207], v16 offset:58368
v_mul_f32 v6, v6, v22
v_mul_f32 v7, v7, v22
v_mul_f32 v8, v8, v22
v_mfma_f32_16x16x32_bf16 a[56:59], a[252:255], v[152:155], a[56:59]
v_mul_f32 v9, v9, v22
v_mul_f32 v10, v10, v22
v_mfma_f32_16x16x32_bf16 a[60:63], a[248:251], v[148:151], a[60:63]
v_mul_f32 v11, v11, v22
v_cvt_pk_bf16_f32 v96, v4, v5
v_cvt_pk_bf16_f32 v97, v6, v7
v_mfma_f32_16x16x32_bf16 a[60:63], a[252:255], v[156:159], a[60:63]
v_cvt_pk_bf16_f32 v98, v8, v9
v_cvt_pk_bf16_f32 v99, v10, v11
s_waitcnt lgkmcnt(0)
v_mfma_f32_16x16x32_bf16 a[64:67], a[192:195], v[144:147], a[64:67]
buffer_load_dwordx4 v50, s[4:7], s16 offen offset:2048 sc1 lds
v_mfma_f32_16x16x32_bf16 a[64:67], a[196:199], v[152:155], a[64:67]
v_accvgpr_read_b32 v4, a16
v_accvgpr_read_b32 v5, a17
v_accvgpr_read_b32 v6, a18
v_mfma_f32_16x16x32_bf16 a[68:71], a[192:195], v[148:151], a[68:71]
v_accvgpr_read_b32 v7, a19
v_accvgpr_read_b32 v8, a24
v_mfma_f32_16x16x32_bf16 a[68:71], a[196:199], v[156:159], a[68:71]
ds_read_b128 a[208:211], v16 offset:43008
v_accvgpr_read_b32 v9, a25
v_accvgpr_read_b32 v10, a26
v_accvgpr_read_b32 v11, a27
v_mfma_f32_16x16x32_bf16 a[72:75], a[200:203], v[144:147], a[72:75]
ds_read_b128 a[212:215], v16 offset:59392
v_mul_f32 v4, v4, v20
v_mul_f32 v5, v5, v20
v_mfma_f32_16x16x32_bf16 a[72:75], a[204:207], v[152:155], a[72:75]
ds_read_b128 a[216:219], v16 offset:44032
v_mul_f32 v6, v6, v20
v_mul_f32 v7, v7, v20
v_mul_f32 v8, v8, v20
v_mfma_f32_16x16x32_bf16 a[76:79], a[200:203], v[148:151], a[76:79]
ds_read_b128 a[220:223], v16 offset:60416
v_mul_f32 v9, v9, v20
v_mul_f32 v10, v10, v20
v_mfma_f32_16x16x32_bf16 a[76:79], a[204:207], v[156:159], a[76:79]
ds_read_b128 a[224:227], v16 offset:45056
v_mul_f32 v11, v11, v20
v_cvt_pk_bf16_f32 v68, v4, v5
v_cvt_pk_bf16_f32 v69, v6, v7
s_waitcnt lgkmcnt(1)
v_mfma_f32_16x16x32_bf16 a[80:83], a[208:211], v[144:147], a[80:83]
ds_read_b128 a[228:231], v16 offset:61440
v_cvt_pk_bf16_f32 v70, v8, v9
v_cvt_pk_bf16_f32 v71, v10, v11
v_mfma_f32_16x16x32_bf16 a[80:83], a[212:215], v[152:155], a[80:83]
ds_read_b128 a[232:235], v16 offset:46080
v_accvgpr_read_b32 v4, a20
v_accvgpr_read_b32 v5, a21
v_accvgpr_read_b32 v6, a22
v_mfma_f32_16x16x32_bf16 a[84:87], a[208:211], v[148:151], a[84:87]
ds_read_b128 a[236:239], v16 offset:62464
v_accvgpr_read_b32 v7, a23
v_accvgpr_read_b32 v8, a28
v_mfma_f32_16x16x32_bf16 a[84:87], a[212:215], v[156:159], a[84:87]
ds_read_b128 a[240:243], v16 offset:47104
v_accvgpr_read_b32 v9, a29
v_accvgpr_read_b32 v10, a30
v_accvgpr_read_b32 v11, a31
v_mfma_f32_16x16x32_bf16 a[88:91], a[216:219], v[144:147], a[88:91]
ds_read_b128 a[244:247], v16 offset:63488
v_mul_f32 v4, v4, v22
v_mul_f32 v5, v5, v22
v_mfma_f32_16x16x32_bf16 a[88:91], a[220:223], v[152:155], a[88:91]
ds_read_b128 a[248:251], v16 offset:48128
v_mul_f32 v6, v6, v22
v_mul_f32 v7, v7, v22
v_mul_f32 v8, v8, v22
v_mfma_f32_16x16x32_bf16 a[92:95], a[216:219], v[148:151], a[92:95]
ds_read_b128 a[252:255], v16 offset:64512
v_mul_f32 v9, v9, v22
v_mul_f32 v10, v10, v22
v_mfma_f32_16x16x32_bf16 a[92:95], a[220:223], v[156:159], a[92:95]
s_waitcnt lgkmcnt(0)
s_barrier
v_mul_f32 v11, v11, v22
v_cvt_pk_bf16_f32 v100, v4, v5
v_cvt_pk_bf16_f32 v101, v6, v7
v_mfma_f32_16x16x32_bf16 a[96:99], a[224:227], v[144:147], a[96:99]
ds_read_b64_tr_b16 a[192:193], v165 offset:32768
v_cvt_pk_bf16_f32 v102, v8, v9
v_cvt_pk_bf16_f32 v103, v10, v11
v_mfma_f32_16x16x32_bf16 a[96:99], a[228:231], v[152:155], a[96:99]
ds_read_b64_tr_b16 a[194:195], v165 offset:34816
v_accvgpr_read_b32 v4, a32
v_mfma_f32_16x16x32_bf16 a[100:103], a[224:227], v[148:151], a[100:103]
ds_read_b64_tr_b16 a[196:197], v166 offset:32768
v_accvgpr_read_b32 v5, a33
v_accvgpr_read_b32 v6, a34
v_mfma_f32_16x16x32_bf16 a[100:103], a[228:231], v[156:159], a[100:103]
ds_read_b64_tr_b16 a[198:199], v166 offset:34816
v_accvgpr_read_b32 v7, a35
v_accvgpr_read_b32 v8, a40
v_mfma_f32_16x16x32_bf16 a[104:107], a[232:235], v[144:147], a[104:107]
ds_read_b64_tr_b16 a[200:201], v167 offset:32768
v_accvgpr_read_b32 v9, a41
v_accvgpr_read_b32 v10, a42
v_accvgpr_read_b32 v11, a43
v_mfma_f32_16x16x32_bf16 a[104:107], a[236:239], v[152:155], a[104:107]
ds_read_b64_tr_b16 a[202:203], v167 offset:34816
v_mul_f32 v4, v4, v20
v_mul_f32 v5, v5, v20
v_mfma_f32_16x16x32_bf16 a[108:111], a[232:235], v[148:151], a[108:111]
ds_read_b64_tr_b16 a[204:205], v168 offset:32768
v_mul_f32 v6, v6, v20
v_mul_f32 v7, v7, v20
v_mul_f32 v8, v8, v20
v_mfma_f32_16x16x32_bf16 a[108:111], a[236:239], v[156:159], a[108:111]
ds_read_b64_tr_b16 a[206:207], v168 offset:34816
v_mul_f32 v9, v9, v20
v_mul_f32 v10, v10, v20
v_mfma_f32_16x16x32_bf16 a[112:115], a[240:243], v[144:147], a[112:115]
buffer_load_dwordx4 v51, s[4:7], s16 offen offset:3072 sc1 lds
ds_read_b64_tr_b16 a[208:209], v165 offset:36864
s_add_u32 m0, s18, 4096
v_mul_f32 v11, v11, v20
v_cvt_pk_bf16_f32 v72, v4, v5
v_cvt_pk_bf16_f32 v73, v6, v7
v_mfma_f32_16x16x32_bf16 a[112:115], a[244:247], v[152:155], a[112:115]
buffer_load_dwordx4 v52, s[4:7], s16 offen offset:0 sc1 lds
ds_read_b64_tr_b16 a[210:211], v165 offset:38912
v_cvt_pk_bf16_f32 v74, v8, v9
v_cvt_pk_bf16_f32 v75, v10, v11
v_mfma_f32_16x16x32_bf16 a[116:119], a[240:243], v[148:151], a[116:119]
buffer_load_dwordx4 v53, s[4:7], s16 offen offset:1024 sc1 lds
ds_read_b64_tr_b16 a[212:213], v166 offset:36864
v_accvgpr_read_b32 v4, a36
v_accvgpr_read_b32 v5, a37
v_accvgpr_read_b32 v6, a38
v_mfma_f32_16x16x32_bf16 a[116:119], a[244:247], v[156:159], a[116:119]
buffer_load_dwordx4 v54, s[4:7], s16 offen offset:2048 sc1 lds
ds_read_b64_tr_b16 a[214:215], v166 offset:38912
v_accvgpr_read_b32 v7, a39
v_accvgpr_read_b32 v8, a44
v_mfma_f32_16x16x32_bf16 a[120:123], a[248:251], v[144:147], a[120:123]
buffer_load_dwordx4 v55, s[4:7], s16 offen offset:3072 sc1 lds
ds_read_b64_tr_b16 a[216:217], v167 offset:36864
v_accvgpr_read_b32 v9, a45
v_accvgpr_read_b32 v10, a46
v_accvgpr_read_b32 v11, a47
v_mfma_f32_16x16x32_bf16 a[120:123], a[252:255], v[152:155], a[120:123]
ds_read_b64_tr_b16 a[218:219], v167 offset:38912
v_mul_f32 v4, v4, v22
v_mul_f32 v5, v5, v22
v_mfma_f32_16x16x32_bf16 a[124:127], a[248:251], v[148:151], a[124:127]
ds_read_b64_tr_b16 a[220:221], v168 offset:36864
v_mul_f32 v6, v6, v22
v_mul_f32 v7, v7, v22
v_mul_f32 v8, v8, v22
v_mul_f32 v9, v9, v22
v_mul_f32 v10, v10, v22
v_mul_f32 v11, v11, v22
v_cvt_pk_bf16_f32 v104, v4, v5
v_cvt_pk_bf16_f32 v105, v6, v7
v_cvt_pk_bf16_f32 v106, v8, v9
v_cvt_pk_bf16_f32 v107, v10, v11
v_mfma_f32_16x16x32_bf16 a[124:127], a[252:255], v[156:159], a[124:127]
s_add_u32 s16, s16, s26
mega_kernel_ktr:
s_nop 1
s_waitcnt lgkmcnt(7)
v_mfma_f32_16x16x32_bf16 v[192:195], a[192:195], v[64:67], 0
ds_read_b64_tr_b16 a[222:223], v168 offset:38912
v_accvgpr_read_b32 v4, a48
v_accvgpr_read_b32 v5, a49
v_accvgpr_read_b32 v6, a50
v_accvgpr_read_b32 v7, a51
v_mfma_f32_16x16x32_bf16 v[196:199], a[192:195], v[96:99], 0
s_add_u32 m0, s18, 32768
ds_read_b64_tr_b16 a[224:225], v165 offset:40960
v_accvgpr_read_b32 v8, a56
v_accvgpr_read_b32 v9, a57
v_accvgpr_read_b32 v10, a58
v_accvgpr_read_b32 v11, a59
v_mfma_f32_16x16x32_bf16 v[200:203], a[196:199], v[64:67], 0
ds_read_b64_tr_b16 a[226:227], v165 offset:43008
buffer_load_dwordx4 v48, s[4:7], s16 offen offset:0 sc1 lds
v_mul_f32 v4, v4, v20
v_mul_f32 v5, v5, v20
v_mul_f32 v6, v6, v20
v_mul_f32 v7, v7, v20
v_mfma_f32_16x16x32_bf16 v[204:207], a[196:199], v[96:99], 0
ds_read_b64_tr_b16 a[228:229], v166 offset:40960
v_mul_f32 v8, v8, v20
v_mul_f32 v9, v9, v20
v_mul_f32 v10, v10, v20
v_mfma_f32_16x16x32_bf16 v[208:211], a[200:203], v[64:67], 0
ds_read_b64_tr_b16 a[230:231], v166 offset:43008
v_mul_f32 v11, v11, v20
v_cvt_pk_bf16_f32 v76, v4, v5
v_cvt_pk_bf16_f32 v77, v6, v7
v_cvt_pk_bf16_f32 v78, v8, v9
v_mfma_f32_16x16x32_bf16 v[212:215], a[200:203], v[96:99], 0
ds_read_b64_tr_b16 a[232:233], v167 offset:40960
v_cvt_pk_bf16_f32 v79, v10, v11
v_accvgpr_read_b32 v4, a52
v_accvgpr_read_b32 v5, a53
v_accvgpr_read_b32 v6, a54
v_mfma_f32_16x16x32_bf16 v[216:219], a[204:207], v[64:67], 0
ds_read_b64_tr_b16 a[234:235], v167 offset:43008
v_accvgpr_read_b32 v7, a55
v_accvgpr_read_b32 v8, a60
v_accvgpr_read_b32 v9, a61
v_mfma_f32_16x16x32_bf16 v[220:223], a[204:207], v[96:99], 0
ds_read_b64_tr_b16 a[236:237], v168 offset:40960
v_accvgpr_read_b32 v10, a62
v_accvgpr_read_b32 v11, a63
v_mul_f32 v4, v4, v22
v_mul_f32 v5, v5, v22
s_waitcnt lgkmcnt(7)
v_mfma_f32_16x16x32_bf16 v[192:195], a[208:211], v[68:71], v[192:195]
ds_read_b64_tr_b16 a[238:239], v168 offset:43008
buffer_load_dwordx4 v49, s[4:7], s16 offen offset:1024 sc1 lds
v_mul_f32 v6, v6, v22
v_mul_f32 v7, v7, v22
v_mul_f32 v8, v8, v22
v_mul_f32 v9, v9, v22
v_mfma_f32_16x16x32_bf16 v[196:199], a[208:211], v[100:103], v[196:199]
ds_read_b64_tr_b16 a[240:241], v165 offset:45056
v_mul_f32 v10, v10, v22
v_mul_f32 v11, v11, v22
v_cvt_pk_bf16_f32 v108, v4, v5
v_cvt_pk_bf16_f32 v109, v6, v7
v_mfma_f32_16x16x32_bf16 v[200:203], a[212:215], v[68:71], v[200:203]
ds_read_b64_tr_b16 a[242:243], v165 offset:47104
v_cvt_pk_bf16_f32 v110, v8, v9
v_cvt_pk_bf16_f32 v111, v10, v11
v_accvgpr_read_b32 v4, a64
v_mfma_f32_16x16x32_bf16 v[204:207], a[212:215], v[100:103], v[204:207]
ds_read_b64_tr_b16 a[244:245], v166 offset:45056
v_accvgpr_read_b32 v5, a65
v_accvgpr_read_b32 v6, a66
v_accvgpr_read_b32 v7, a67
v_accvgpr_read_b32 v8, a72
v_mfma_f32_16x16x32_bf16 v[208:211], a[216:219], v[68:71], v[208:211]
ds_read_b64_tr_b16 a[246:247], v166 offset:47104
v_accvgpr_read_b32 v9, a73
v_accvgpr_read_b32 v10, a74
v_accvgpr_read_b32 v11, a75
v_mul_f32 v4, v4, v20
v_mfma_f32_16x16x32_bf16 v[212:215], a[216:219], v[100:103], v[212:215]
ds_read_b64_tr_b16 a[248:249], v167 offset:45056
v_mul_f32 v5, v5, v20
v_mul_f32 v6, v6, v20
v_mul_f32 v7, v7, v20
v_mfma_f32_16x16x32_bf16 v[216:219], a[220:223], v[68:71], v[216:219]
ds_read_b64_tr_b16 a[250:251], v167 offset:47104
buffer_load_dwordx4 v50, s[4:7], s16 offen offset:2048 sc1 lds
v_mul_f32 v8, v8, v20
v_mul_f32 v9, v9, v20
v_mul_f32 v10, v10, v20
v_mul_f32 v11, v11, v20
v_mfma_f32_16x16x32_bf16 v[220:223], a[220:223], v[100:103], v[220:223]
ds_read_b64_tr_b16 a[252:253], v168 offset:45056
v_cvt_pk_bf16_f32 v80, v4, v5
v_cvt_pk_bf16_f32 v81, v6, v7
v_cvt_pk_bf16_f32 v82, v8, v9
v_cvt_pk_bf16_f32 v83, v10, v11
s_waitcnt lgkmcnt(7)
v_mfma_f32_16x16x32_bf16 v[192:195], a[224:227], v[72:75], v[192:195]
ds_read_b64_tr_b16 a[254:255], v168 offset:47104
v_accvgpr_read_b32 v4, a68
v_accvgpr_read_b32 v5, a69
v_accvgpr_read_b32 v6, a70
v_mfma_f32_16x16x32_bf16 v[196:199], a[224:227], v[104:107], v[196:199]
ds_read_b64_tr_b16 a[192:193], v165 offset:49152
v_accvgpr_read_b32 v7, a71
v_accvgpr_read_b32 v8, a76
v_accvgpr_read_b32 v9, a77
v_accvgpr_read_b32 v10, a78
v_mfma_f32_16x16x32_bf16 v[200:203], a[228:231], v[72:75], v[200:203]
ds_read_b64_tr_b16 a[194:195], v165 offset:51200
v_accvgpr_read_b32 v11, a79
v_mul_f32 v4, v4, v22
v_mul_f32 v5, v5, v22
v_mul_f32 v6, v6, v22
v_mfma_f32_16x16x32_bf16 v[204:207], a[228:231], v[104:107], v[204:207]
ds_read_b64_tr_b16 a[196:197], v166 offset:49152
v_mul_f32 v7, v7, v22
v_mul_f32 v8, v8, v22
v_mul_f32 v9, v9, v22
v_mul_f32 v10, v10, v22
v_mfma_f32_16x16x32_bf16 v[208:211], a[232:235], v[72:75], v[208:211]
ds_read_b64_tr_b16 a[198:199], v166 offset:51200
buffer_load_dwordx4 v51, s[4:7], s16 offen offset:3072 sc1 lds
v_mul_f32 v11, v11, v22
v_cvt_pk_bf16_f32 v112, v4, v5
v_cvt_pk_bf16_f32 v113, v6, v7
v_mfma_f32_16x16x32_bf16 v[212:215], a[232:235], v[104:107], v[212:215]
ds_read_b64_tr_b16 a[200:201], v167 offset:49152
v_cvt_pk_bf16_f32 v114, v8, v9
v_cvt_pk_bf16_f32 v115, v10, v11
v_accvgpr_read_b32 v4, a80
v_accvgpr_read_b32 v5, a81
v_mfma_f32_16x16x32_bf16 v[216:219], a[236:239], v[72:75], v[216:219]
ds_read_b64_tr_b16 a[202:203], v167 offset:51200
v_accvgpr_read_b32 v6, a82
v_accvgpr_read_b32 v7, a83
v_accvgpr_read_b32 v8, a88
v_accvgpr_read_b32 v9, a89
v_mfma_f32_16x16x32_bf16 v[220:223], a[236:239], v[104:107], v[220:223]
ds_read_b64_tr_b16 a[204:205], v168 offset:49152
v_accvgpr_read_b32 v10, a90
v_accvgpr_read_b32 v11, a91
v_mul_f32 v4, v4, v20
s_waitcnt lgkmcnt(7)
v_mfma_f32_16x16x32_bf16 v[192:195], a[240:243], v[76:79], v[192:195]
ds_read_b64_tr_b16 a[206:207], v168 offset:51200
v_mul_f32 v5, v5, v20
v_mul_f32 v6, v6, v20
v_mul_f32 v7, v7, v20
v_mul_f32 v8, v8, v20
v_mfma_f32_16x16x32_bf16 v[196:199], a[240:243], v[108:111], v[196:199]
s_add_u32 m0, s18, 36864
ds_read_b64_tr_b16 a[208:209], v165 offset:53248
v_mul_f32 v9, v9, v20
v_mul_f32 v10, v10, v20
v_mul_f32 v11, v11, v20
v_cvt_pk_bf16_f32 v84, v4, v5
v_mfma_f32_16x16x32_bf16 v[200:203], a[244:247], v[76:79], v[200:203]
ds_read_b64_tr_b16 a[210:211], v165 offset:55296
buffer_load_dwordx4 v52, s[4:7], s16 offen offset:0 sc1 lds
v_cvt_pk_bf16_f32 v85, v6, v7
v_cvt_pk_bf16_f32 v86, v8, v9
v_cvt_pk_bf16_f32 v87, v10, v11
v_mfma_f32_16x16x32_bf16 v[204:207], a[244:247], v[108:111], v[204:207]
ds_read_b64_tr_b16 a[212:213], v166 offset:53248
v_accvgpr_read_b32 v4, a84
v_accvgpr_read_b32 v5, a85
v_accvgpr_read_b32 v6, a86
v_accvgpr_read_b32 v7, a87
v_mfma_f32_16x16x32_bf16 v[208:211], a[248:251], v[76:79], v[208:211]
ds_read_b64_tr_b16 a[214:215], v166 offset:55296
v_accvgpr_read_b32 v8, a92
v_accvgpr_read_b32 v9, a93
v_accvgpr_read_b32 v10, a94
v_accvgpr_read_b32 v11, a95
v_mfma_f32_16x16x32_bf16 v[212:215], a[248:251], v[108:111], v[212:215]
ds_read_b64_tr_b16 a[216:217], v167 offset:53248
v_mul_f32 v4, v4, v22
v_mul_f32 v5, v5, v22
v_mul_f32 v6, v6, v22
v_mul_f32 v7, v7, v22
v_mfma_f32_16x16x32_bf16 v[216:219], a[252:255], v[76:79], v[216:219]
ds_read_b64_tr_b16 a[218:219], v167 offset:55296
v_mul_f32 v8, v8, v22
v_mul_f32 v9, v9, v22
v_mul_f32 v10, v10, v22
v_mfma_f32_16x16x32_bf16 v[220:223], a[252:255], v[108:111], v[220:223]
ds_read_b64_tr_b16 a[220:221], v168 offset:53248
v_mul_f32 v11, v11, v22
v_cvt_pk_bf16_f32 v116, v4, v5
v_cvt_pk_bf16_f32 v117, v6, v7
v_cvt_pk_bf16_f32 v118, v8, v9
s_waitcnt lgkmcnt(7)
v_mfma_f32_16x16x32_bf16 v[192:195], a[192:195], v[80:83], v[192:195]
ds_read_b64_tr_b16 a[222:223], v168 offset:55296
buffer_load_dwordx4 v53, s[4:7], s16 offen offset:1024 sc1 lds
v_cvt_pk_bf16_f32 v119, v10, v11
v_accvgpr_read_b32 v4, a96
v_accvgpr_read_b32 v5, a97
v_accvgpr_read_b32 v6, a98
v_mfma_f32_16x16x32_bf16 v[196:199], a[192:195], v[112:115], v[196:199]
ds_read_b64_tr_b16 a[224:225], v165 offset:57344
v_accvgpr_read_b32 v7, a99
v_accvgpr_read_b32 v8, a104
v_accvgpr_read_b32 v9, a105
v_mfma_f32_16x16x32_bf16 v[200:203], a[196:199], v[80:83], v[200:203]
ds_read_b64_tr_b16 a[226:227], v165 offset:59392
v_accvgpr_read_b32 v10, a106
v_accvgpr_read_b32 v11, a107
v_mul_f32 v4, v4, v20
v_mul_f32 v5, v5, v20
v_mfma_f32_16x16x32_bf16 v[204:207], a[196:199], v[112:115], v[204:207]
ds_read_b64_tr_b16 a[228:229], v166 offset:57344
v_mul_f32 v6, v6, v20
v_mul_f32 v7, v7, v20
v_mul_f32 v8, v8, v20
v_mul_f32 v9, v9, v20
v_mfma_f32_16x16x32_bf16 v[208:211], a[200:203], v[80:83], v[208:211]
ds_read_b64_tr_b16 a[230:231], v166 offset:59392
v_mul_f32 v10, v10, v20
v_mul_f32 v11, v11, v20
v_cvt_pk_bf16_f32 v88, v4, v5
v_cvt_pk_bf16_f32 v89, v6, v7
v_mfma_f32_16x16x32_bf16 v[212:215], a[200:203], v[112:115], v[212:215]
ds_read_b64_tr_b16 a[232:233], v167 offset:57344
v_cvt_pk_bf16_f32 v90, v8, v9
v_cvt_pk_bf16_f32 v91, v10, v11
v_accvgpr_read_b32 v4, a100
v_mfma_f32_16x16x32_bf16 v[216:219], a[204:207], v[80:83], v[216:219]
ds_read_b64_tr_b16 a[234:235], v167 offset:59392
buffer_load_dwordx4 v54, s[4:7], s16 offen offset:2048 sc1 lds
v_accvgpr_read_b32 v5, a101
v_accvgpr_read_b32 v6, a102
v_accvgpr_read_b32 v7, a103
v_accvgpr_read_b32 v8, a108
v_mfma_f32_16x16x32_bf16 v[220:223], a[204:207], v[112:115], v[220:223]
ds_read_b64_tr_b16 a[236:237], v168 offset:57344
v_accvgpr_read_b32 v9, a109
v_accvgpr_read_b32 v10, a110
v_accvgpr_read_b32 v11, a111
v_mul_f32 v4, v4, v22
s_waitcnt lgkmcnt(7)
v_mfma_f32_16x16x32_bf16 v[192:195], a[208:211], v[84:87], v[192:195]
ds_read_b64_tr_b16 a[238:239], v168 offset:59392
v_mul_f32 v5, v5, v22
v_mul_f32 v6, v6, v22
v_mul_f32 v7, v7, v22
v_mfma_f32_16x16x32_bf16 v[196:199], a[208:211], v[116:119], v[196:199]
ds_read_b64_tr_b16 a[240:241], v165 offset:61440
v_mul_f32 v8, v8, v22
v_mul_f32 v9, v9, v22
v_mul_f32 v10, v10, v22
v_mul_f32 v11, v11, v22
v_mfma_f32_16x16x32_bf16 v[200:203], a[212:215], v[84:87], v[200:203]
ds_read_b64_tr_b16 a[242:243], v165 offset:63488
v_cvt_pk_bf16_f32 v120, v4, v5
v_cvt_pk_bf16_f32 v121, v6, v7
v_cvt_pk_bf16_f32 v122, v8, v9
v_cvt_pk_bf16_f32 v123, v10, v11
v_mfma_f32_16x16x32_bf16 v[204:207], a[212:215], v[116:119], v[204:207]
ds_read_b64_tr_b16 a[244:245], v166 offset:61440
v_accvgpr_read_b32 v4, a112
v_accvgpr_read_b32 v5, a113
v_accvgpr_read_b32 v6, a114
v_mfma_f32_16x16x32_bf16 v[208:211], a[216:219], v[84:87], v[208:211]
ds_read_b64_tr_b16 a[246:247], v166 offset:63488
buffer_load_dwordx4 v55, s[4:7], s16 offen offset:3072 sc1 lds
v_accvgpr_read_b32 v7, a115
v_accvgpr_read_b32 v8, a120
v_accvgpr_read_b32 v9, a121
v_accvgpr_read_b32 v10, a122
v_mfma_f32_16x16x32_bf16 v[212:215], a[216:219], v[116:119], v[212:215]
ds_read_b64_tr_b16 a[248:249], v167 offset:61440
v_accvgpr_read_b32 v11, a123
v_mul_f32 v4, v4, v20
v_mul_f32 v5, v5, v20
v_mul_f32 v6, v6, v20
v_mfma_f32_16x16x32_bf16 v[216:219], a[220:223], v[84:87], v[216:219]
s_add_u32 s16, s16, s26
ds_read_b64_tr_b16 a[250:251], v167 offset:63488
v_mul_f32 v7, v7, v20
v_mul_f32 v8, v8, v20
v_mul_f32 v9, v9, v20
v_mul_f32 v10, v10, v20
v_mfma_f32_16x16x32_bf16 v[220:223], a[220:223], v[116:119], v[220:223]
ds_read_b64_tr_b16 a[252:253], v168 offset:61440
v_mul_f32 v11, v11, v20
v_cvt_pk_bf16_f32 v92, v4, v5
v_cvt_pk_bf16_f32 v93, v6, v7
s_waitcnt lgkmcnt(7)
v_mfma_f32_16x16x32_bf16 v[192:195], a[224:227], v[88:91], v[192:195]
ds_read_b64_tr_b16 a[254:255], v168 offset:63488
v_cvt_pk_bf16_f32 v94, v8, v9
v_cvt_pk_bf16_f32 v95, v10, v11
v_accvgpr_read_b32 v4, a116
v_accvgpr_read_b32 v5, a117
v_mfma_f32_16x16x32_bf16 v[196:199], a[224:227], v[120:123], v[196:199]
v_accvgpr_read_b32 v6, a118
v_accvgpr_read_b32 v7, a119
v_accvgpr_read_b32 v8, a124
v_accvgpr_read_b32 v9, a125
v_mfma_f32_16x16x32_bf16 v[200:203], a[228:231], v[88:91], v[200:203]
v_accvgpr_read_b32 v10, a126
v_accvgpr_read_b32 v11, a127
v_mul_f32 v4, v4, v22
v_mfma_f32_16x16x32_bf16 v[204:207], a[228:231], v[120:123], v[204:207]
v_mul_f32 v5, v5, v22
v_mul_f32 v6, v6, v22
v_mul_f32 v7, v7, v22
v_mul_f32 v8, v8, v22
v_mfma_f32_16x16x32_bf16 v[208:211], a[232:235], v[88:91], v[208:211]
s_waitcnt vmcnt(16) lgkmcnt(0)
s_barrier
v_mul_f32 v9, v9, v22
v_mul_f32 v10, v10, v22
v_mul_f32 v11, v11, v22
v_cvt_pk_bf16_f32 v124, v4, v5
v_mfma_f32_16x16x32_bf16 v[212:215], a[232:235], v[120:123], v[212:215]
ds_read_b64_tr_b16 a[192:193], v165 offset:0
ds_read_b64_tr_b16 a[194:195], v165 offset:2048
v_cvt_pk_bf16_f32 v125, v6, v7
v_cvt_pk_bf16_f32 v126, v8, v9
v_cvt_pk_bf16_f32 v127, v10, v11
v_mfma_f32_16x16x32_bf16 v[216:219], a[236:239], v[88:91], v[216:219]
ds_read_b64_tr_b16 a[196:197], v165 offset:4096
v_mfma_f32_16x16x32_bf16 v[220:223], a[236:239], v[120:123], v[220:223]
ds_read_b64_tr_b16 a[198:199], v165 offset:6144
ds_read_b64_tr_b16 a[200:201], v165 offset:8192
v_mfma_f32_16x16x32_bf16 v[192:195], a[240:243], v[92:95], v[192:195]
ds_read_b64_tr_b16 a[202:203], v165 offset:10240
v_mfma_f32_16x16x32_bf16 v[196:199], a[240:243], v[124:127], v[196:199]
ds_read_b64_tr_b16 a[204:205], v165 offset:12288
v_mfma_f32_16x16x32_bf16 v[200:203], a[244:247], v[92:95], v[200:203]
ds_read_b64_tr_b16 a[206:207], v165 offset:14336
ds_read_b64_tr_b16 a[208:209], v165 offset:16384
v_mfma_f32_16x16x32_bf16 v[204:207], a[244:247], v[124:127], v[204:207]
ds_read_b64_tr_b16 a[210:211], v165 offset:18432
v_mfma_f32_16x16x32_bf16 v[208:211], a[248:251], v[92:95], v[208:211]
ds_read_b64_tr_b16 a[212:213], v165 offset:20480
v_mfma_f32_16x16x32_bf16 v[212:215], a[248:251], v[124:127], v[212:215]
ds_read_b64_tr_b16 a[214:215], v165 offset:22528
ds_read_b64_tr_b16 a[216:217], v165 offset:24576
v_mfma_f32_16x16x32_bf16 v[216:219], a[252:255], v[92:95], v[216:219]
ds_read_b64_tr_b16 a[218:219], v165 offset:26624
v_mfma_f32_16x16x32_bf16 v[220:223], a[252:255], v[124:127], v[220:223]
ds_read_b64_tr_b16 a[220:221], v165 offset:28672
s_waitcnt lgkmcnt(7)
v_mfma_f32_16x16x32_bf16 v[224:227], a[192:195], v[64:67], 0
ds_read_b64_tr_b16 a[222:223], v165 offset:30720
v_mfma_f32_16x16x32_bf16 v[224:227], a[196:199], v[68:71], v[224:227]
s_add_u32 m0, s18, 98304
ds_read_b64_tr_b16 a[224:225], v166 offset:0
v_mfma_f32_16x16x32_bf16 v[224:227], a[200:203], v[72:75], v[224:227]
ds_read_b64_tr_b16 a[226:227], v166 offset:2048
buffer_load_dwordx4 v48, s[4:7], s16 offen offset:0 sc1 lds
v_mfma_f32_16x16x32_bf16 v[224:227], a[204:207], v[76:79], v[224:227]
ds_read_b64_tr_b16 a[228:229], v166 offset:4096
v_mfma_f32_16x16x32_bf16 v[228:231], a[192:195], v[96:99], 0
ds_read_b64_tr_b16 a[230:231], v166 offset:6144
v_mfma_f32_16x16x32_bf16 v[228:231], a[196:199], v[100:103], v[228:231]
ds_read_b64_tr_b16 a[232:233], v166 offset:8192
v_cvt_pk_bf16_f32 v4, v192, v193
v_mfma_f32_16x16x32_bf16 v[228:231], a[200:203], v[104:107], v[228:231]
ds_read_b64_tr_b16 a[234:235], v166 offset:10240
v_cvt_pk_bf16_f32 v5, v194, v195
v_mfma_f32_16x16x32_bf16 v[228:231], a[204:207], v[108:111], v[228:231]
ds_read_b64_tr_b16 a[236:237], v166 offset:12288
s_waitcnt lgkmcnt(7)
v_mfma_f32_16x16x32_bf16 v[224:227], a[208:211], v[80:83], v[224:227]
ds_read_b64_tr_b16 a[238:239], v166 offset:14336
buffer_load_dwordx4 v49, s[4:7], s16 offen offset:1024 sc1 lds
v_mfma_f32_16x16x32_bf16 v[224:227], a[212:215], v[84:87], v[224:227]
ds_read_b64_tr_b16 a[240:241], v166 offset:16384
v_cvt_pk_bf16_f32 v6, v200, v201
v_mfma_f32_16x16x32_bf16 v[224:227], a[216:219], v[88:91], v[224:227]
ds_read_b64_tr_b16 a[242:243], v166 offset:18432
v_cvt_pk_bf16_f32 v7, v202, v203
v_mfma_f32_16x16x32_bf16 v[224:227], a[220:223], v[92:95], v[224:227]
ds_read_b64_tr_b16 a[244:245], v166 offset:20480
v_mfma_f32_16x16x32_bf16 v[228:231], a[208:211], v[112:115], v[228:231]
ds_read_b64_tr_b16 a[246:247], v166 offset:22528
v_mfma_f32_16x16x32_bf16 v[228:231], a[212:215], v[116:119], v[228:231]
ds_read_b64_tr_b16 a[248:249], v166 offset:24576
v_mfma_f32_16x16x32_bf16 v[228:231], a[216:219], v[120:123], v[228:231]
ds_read_b64_tr_b16 a[250:251], v166 offset:26624
buffer_load_dwordx4 v50, s[4:7], s16 offen offset:2048 sc1 lds
v_mfma_f32_16x16x32_bf16 v[228:231], a[220:223], v[124:127], v[228:231]
ds_read_b64_tr_b16 a[252:253], v166 offset:28672
s_waitcnt lgkmcnt(7)
v_mfma_f32_16x16x32_bf16 v[232:235], a[224:227], v[64:67], 0
ds_read_b64_tr_b16 a[254:255], v166 offset:30720
buffer_store_dwordx4 v[4:7], v16, s[12:15], s46 offen offset:0 sc0 sc1
v_mfma_f32_16x16x32_bf16 v[232:235], a[228:231], v[68:71], v[232:235]
ds_read_b64_tr_b16 a[192:193], v167 offset:0
v_cvt_pk_bf16_f32 v8, v208, v209
v_mfma_f32_16x16x32_bf16 v[232:235], a[232:235], v[72:75], v[232:235]
ds_read_b64_tr_b16 a[194:195], v167 offset:2048
v_cvt_pk_bf16_f32 v9, v210, v211
v_mfma_f32_16x16x32_bf16 v[232:235], a[236:239], v[76:79], v[232:235]
ds_read_b64_tr_b16 a[196:197], v167 offset:4096
v_cvt_pk_bf16_f32 v10, v216, v217
v_mfma_f32_16x16x32_bf16 v[236:239], a[224:227], v[96:99], 0
ds_read_b64_tr_b16 a[198:199], v167 offset:6144
buffer_load_dwordx4 v51, s[4:7], s16 offen offset:3072 sc1 lds
v_mfma_f32_16x16x32_bf16 v[236:239], a[228:231], v[100:103], v[236:239]
ds_read_b64_tr_b16 a[200:201], v167 offset:8192
v_cvt_pk_bf16_f32 v11, v218, v219
v_mfma_f32_16x16x32_bf16 v[236:239], a[232:235], v[104:107], v[236:239]
ds_read_b64_tr_b16 a[202:203], v167 offset:10240
v_mfma_f32_16x16x32_bf16 v[236:239], a[236:239], v[108:111], v[236:239]
ds_read_b64_tr_b16 a[204:205], v167 offset:12288
s_waitcnt lgkmcnt(7)
v_mfma_f32_16x16x32_bf16 v[232:235], a[240:243], v[80:83], v[232:235]
ds_read_b64_tr_b16 a[206:207], v167 offset:14336
v_mfma_f32_16x16x32_bf16 v[232:235], a[244:247], v[84:87], v[232:235]
s_add_u32 m0, s18, 102400
ds_read_b64_tr_b16 a[208:209], v167 offset:16384
v_mfma_f32_16x16x32_bf16 v[232:235], a[248:251], v[88:91], v[232:235]
ds_read_b64_tr_b16 a[210:211], v167 offset:18432
buffer_load_dwordx4 v52, s[4:7], s16 offen offset:0 sc1 lds
v_mfma_f32_16x16x32_bf16 v[232:235], a[252:255], v[92:95], v[232:235]
ds_read_b64_tr_b16 a[212:213], v167 offset:20480
v_mfma_f32_16x16x32_bf16 v[236:239], a[240:243], v[112:115], v[236:239]
ds_read_b64_tr_b16 a[214:215], v167 offset:22528
v_mfma_f32_16x16x32_bf16 v[236:239], a[244:247], v[116:119], v[236:239]
ds_read_b64_tr_b16 a[216:217], v167 offset:24576
buffer_store_dwordx4 v[8:11], v16, s[12:15], s46 offen offset:1024 sc0 sc1
v_mfma_f32_16x16x32_bf16 v[236:239], a[248:251], v[120:123], v[236:239]
ds_read_b64_tr_b16 a[218:219], v167 offset:26624
v_cvt_pk_bf16_f32 v12, v196, v197
v_mfma_f32_16x16x32_bf16 v[236:239], a[252:255], v[124:127], v[236:239]
ds_read_b64_tr_b16 a[220:221], v167 offset:28672
s_waitcnt lgkmcnt(7)
v_mfma_f32_16x16x32_bf16 v[240:243], a[192:195], v[64:67], 0
ds_read_b64_tr_b16 a[222:223], v167 offset:30720
buffer_load_dwordx4 v53, s[4:7], s16 offen offset:1024 sc1 lds
v_mfma_f32_16x16x32_bf16 v[240:243], a[196:199], v[68:71], v[240:243]
ds_read_b64_tr_b16 a[224:225], v168 offset:0
v_cvt_pk_bf16_f32 v13, v198, v199
v_mfma_f32_16x16x32_bf16 v[240:243], a[200:203], v[72:75], v[240:243]
ds_read_b64_tr_b16 a[226:227], v168 offset:2048
v_cvt_pk_bf16_f32 v14, v204, v205
v_mfma_f32_16x16x32_bf16 v[240:243], a[204:207], v[76:79], v[240:243]
ds_read_b64_tr_b16 a[228:229], v168 offset:4096
v_cvt_pk_bf16_f32 v15, v206, v207
v_mfma_f32_16x16x32_bf16 v[244:247], a[192:195], v[96:99], 0
ds_read_b64_tr_b16 a[230:231], v168 offset:6144
v_mfma_f32_16x16x32_bf16 v[244:247], a[196:199], v[100:103], v[244:247]
ds_read_b64_tr_b16 a[232:233], v168 offset:8192
v_mfma_f32_16x16x32_bf16 v[244:247], a[200:203], v[104:107], v[244:247]
ds_read_b64_tr_b16 a[234:235], v168 offset:10240
buffer_load_dwordx4 v54, s[4:7], s16 offen offset:2048 sc1 lds
v_mfma_f32_16x16x32_bf16 v[244:247], a[204:207], v[108:111], v[244:247]
ds_read_b64_tr_b16 a[236:237], v168 offset:12288
s_waitcnt lgkmcnt(7)
v_mfma_f32_16x16x32_bf16 v[240:243], a[208:211], v[80:83], v[240:243]
ds_read_b64_tr_b16 a[238:239], v168 offset:14336
v_mfma_f32_16x16x32_bf16 v[240:243], a[212:215], v[84:87], v[240:243]
ds_read_b64_tr_b16 a[240:241], v168 offset:16384
v_mfma_f32_16x16x32_bf16 v[240:243], a[216:219], v[88:91], v[240:243]
ds_read_b64_tr_b16 a[242:243], v168 offset:18432
v_mfma_f32_16x16x32_bf16 v[240:243], a[220:223], v[92:95], v[240:243]
ds_read_b64_tr_b16 a[244:245], v168 offset:20480
buffer_store_dwordx4 v[12:15], v58, s[12:15], s46 offen offset:0 sc0 sc1
v_mfma_f32_16x16x32_bf16 v[244:247], a[208:211], v[112:115], v[244:247]
ds_read_b64_tr_b16 a[246:247], v168 offset:22528
buffer_load_dwordx4 v55, s[4:7], s16 offen offset:3072 sc1 lds
v_mfma_f32_16x16x32_bf16 v[244:247], a[212:215], v[116:119], v[244:247]
ds_read_b64_tr_b16 a[248:249], v168 offset:24576
v_cvt_pk_bf16_f32 v28, v212, v213
v_mfma_f32_16x16x32_bf16 v[244:247], a[216:219], v[120:123], v[244:247]
s_add_u32 s16, s16, s26
ds_read_b64_tr_b16 a[250:251], v168 offset:26624
v_mov_b32 v60, 64
v_mfma_f32_16x16x32_bf16 v[244:247], a[220:223], v[124:127], v[244:247]
ds_read_b64_tr_b16 a[252:253], v168 offset:28672
s_waitcnt lgkmcnt(7)
v_mfma_f32_16x16x32_bf16 v[248:251], a[224:227], v[64:67], 0
ds_read_b64_tr_b16 a[254:255], v168 offset:30720
v_cvt_pk_bf16_f32 v29, v214, v215
v_mfma_f32_16x16x32_bf16 v[248:251], a[228:231], v[68:71], v[248:251]
global_load_dword v59, v60, s[52:53] sc1
v_mfma_f32_16x16x32_bf16 v[248:251], a[232:235], v[72:75], v[248:251]
v_cvt_pk_bf16_f32 v30, v220, v221
v_cvt_pk_bf16_f32 v31, v222, v223
v_mfma_f32_16x16x32_bf16 v[248:251], a[236:239], v[76:79], v[248:251]
buffer_store_dwordx4 v[28:31], v58, s[12:15], s46 offen offset:1024 sc0 sc1
v_mfma_f32_16x16x32_bf16 v[252:255], a[224:227], v[96:99], 0
s_waitcnt vmcnt(21) lgkmcnt(0)
s_barrier
v_mfma_f32_16x16x32_bf16 v[252:255], a[228:231], v[100:103], v[252:255]
ds_read_b64_tr_b16 a[192:193], v161 offset:0
ds_read_b64_tr_b16 a[194:195], v161 offset:2048
v_mfma_f32_16x16x32_bf16 v[252:255], a[232:235], v[104:107], v[252:255]
s_add_u32 s46, s46, 2048
ds_read_b64_tr_b16 a[196:197], v161 offset:4096
v_mfma_f32_16x16x32_bf16 v[252:255], a[236:239], v[108:111], v[252:255]
ds_read_b64_tr_b16 a[198:199], v161 offset:6144
ds_read_b64_tr_b16 a[200:201], v161 offset:8192
v_mfma_f32_16x16x32_bf16 v[248:251], a[240:243], v[80:83], v[248:251]
ds_read_b64_tr_b16 a[202:203], v161 offset:10240
v_mfma_f32_16x16x32_bf16 v[248:251], a[244:247], v[84:87], v[248:251]
ds_read_b64_tr_b16 a[204:205], v161 offset:12288
v_mfma_f32_16x16x32_bf16 v[248:251], a[248:251], v[88:91], v[248:251]
ds_read_b64_tr_b16 a[206:207], v161 offset:14336
ds_read_b64_tr_b16 a[208:209], v161 offset:16384
v_mfma_f32_16x16x32_bf16 v[248:251], a[252:255], v[92:95], v[248:251]
ds_read_b64_tr_b16 a[210:211], v161 offset:18432
v_mfma_f32_16x16x32_bf16 v[252:255], a[240:243], v[112:115], v[252:255]
ds_read_b64_tr_b16 a[212:213], v161 offset:20480
v_mfma_f32_16x16x32_bf16 v[252:255], a[244:247], v[116:119], v[252:255]
ds_read_b64_tr_b16 a[214:215], v161 offset:22528
ds_read_b64_tr_b16 a[216:217], v161 offset:24576
v_mfma_f32_16x16x32_bf16 v[252:255], a[248:251], v[120:123], v[252:255]
ds_read_b64_tr_b16 a[218:219], v161 offset:26624
v_mfma_f32_16x16x32_bf16 v[252:255], a[252:255], v[124:127], v[252:255]
ds_read_b64_tr_b16 a[220:221], v161 offset:28672
s_waitcnt lgkmcnt(7)
v_mfma_f32_16x16x32_bf16 v[192:195], a[192:195], v[64:67], 0
ds_read_b64_tr_b16 a[222:223], v161 offset:30720
v_mfma_f32_16x16x32_bf16 v[192:195], a[196:199], v[68:71], v[192:195]
s_add_u32 m0, s18, 65536
ds_read_b64_tr_b16 a[224:225], v162 offset:0
v_mfma_f32_16x16x32_bf16 v[192:195], a[200:203], v[72:75], v[192:195]
ds_read_b64_tr_b16 a[226:227], v162 offset:2048
buffer_load_dwordx4 v48, s[4:7], s16 offen offset:0 sc1 lds
v_mfma_f32_16x16x32_bf16 v[192:195], a[204:207], v[76:79], v[192:195]
ds_read_b64_tr_b16 a[228:229], v162 offset:4096
v_mfma_f32_16x16x32_bf16 v[196:199], a[192:195], v[96:99], 0
ds_read_b64_tr_b16 a[230:231], v162 offset:6144
v_mfma_f32_16x16x32_bf16 v[196:199], a[196:199], v[100:103], v[196:199]
ds_read_b64_tr_b16 a[232:233], v162 offset:8192
v_cvt_pk_bf16_f32 v4, v224, v225
v_mfma_f32_16x16x32_bf16 v[196:199], a[200:203], v[104:107], v[196:199]
ds_read_b64_tr_b16 a[234:235], v162 offset:10240
v_cvt_pk_bf16_f32 v5, v226, v227
v_mfma_f32_16x16x32_bf16 v[196:199], a[204:207], v[108:111], v[196:199]
ds_read_b64_tr_b16 a[236:237], v162 offset:12288
s_waitcnt lgkmcnt(7)
v_mfma_f32_16x16x32_bf16 v[192:195], a[208:211], v[80:83], v[192:195]
ds_read_b64_tr_b16 a[238:239], v162 offset:14336
buffer_load_dwordx4 v49, s[4:7], s16 offen offset:1024 sc1 lds
v_mfma_f32_16x16x32_bf16 v[192:195], a[212:215], v[84:87], v[192:195]
ds_read_b64_tr_b16 a[240:241], v162 offset:16384
v_cvt_pk_bf16_f32 v6, v232, v233
v_mfma_f32_16x16x32_bf16 v[192:195], a[216:219], v[88:91], v[192:195]
ds_read_b64_tr_b16 a[242:243], v162 offset:18432
v_cvt_pk_bf16_f32 v7, v234, v235
v_mfma_f32_16x16x32_bf16 v[192:195], a[220:223], v[92:95], v[192:195]
ds_read_b64_tr_b16 a[244:245], v162 offset:20480
v_mfma_f32_16x16x32_bf16 v[196:199], a[208:211], v[112:115], v[196:199]
ds_read_b64_tr_b16 a[246:247], v162 offset:22528
v_mfma_f32_16x16x32_bf16 v[196:199], a[212:215], v[116:119], v[196:199]
ds_read_b64_tr_b16 a[248:249], v162 offset:24576
v_mfma_f32_16x16x32_bf16 v[196:199], a[216:219], v[120:123], v[196:199]
ds_read_b64_tr_b16 a[250:251], v162 offset:26624
buffer_load_dwordx4 v50, s[4:7], s16 offen offset:2048 sc1 lds
v_mfma_f32_16x16x32_bf16 v[196:199], a[220:223], v[124:127], v[196:199]
ds_read_b64_tr_b16 a[252:253], v162 offset:28672
s_waitcnt lgkmcnt(7)
v_mfma_f32_16x16x32_bf16 v[200:203], a[224:227], v[64:67], 0
ds_read_b64_tr_b16 a[254:255], v162 offset:30720
buffer_store_dwordx4 v[4:7], v16, s[12:15], s46 offen offset:0 sc0 sc1
v_mfma_f32_16x16x32_bf16 v[200:203], a[228:231], v[68:71], v[200:203]
ds_read_b64_tr_b16 a[192:193], v163 offset:0
v_cvt_pk_bf16_f32 v8, v240, v241
v_mfma_f32_16x16x32_bf16 v[200:203], a[232:235], v[72:75], v[200:203]
ds_read_b64_tr_b16 a[194:195], v163 offset:2048
v_cvt_pk_bf16_f32 v9, v242, v243
v_mfma_f32_16x16x32_bf16 v[200:203], a[236:239], v[76:79], v[200:203]
ds_read_b64_tr_b16 a[196:197], v163 offset:4096
v_cvt_pk_bf16_f32 v10, v248, v249
v_mfma_f32_16x16x32_bf16 v[204:207], a[224:227], v[96:99], 0
ds_read_b64_tr_b16 a[198:199], v163 offset:6144
buffer_load_dwordx4 v51, s[4:7], s16 offen offset:3072 sc1 lds
v_mfma_f32_16x16x32_bf16 v[204:207], a[228:231], v[100:103], v[204:207]
ds_read_b64_tr_b16 a[200:201], v163 offset:8192
v_cvt_pk_bf16_f32 v11, v250, v251
v_mfma_f32_16x16x32_bf16 v[204:207], a[232:235], v[104:107], v[204:207]
ds_read_b64_tr_b16 a[202:203], v163 offset:10240
v_mfma_f32_16x16x32_bf16 v[204:207], a[236:239], v[108:111], v[204:207]
ds_read_b64_tr_b16 a[204:205], v163 offset:12288
s_waitcnt lgkmcnt(7)
v_mfma_f32_16x16x32_bf16 v[200:203], a[240:243], v[80:83], v[200:203]
ds_read_b64_tr_b16 a[206:207], v163 offset:14336
v_mfma_f32_16x16x32_bf16 v[200:203], a[244:247], v[84:87], v[200:203]
s_add_u32 m0, s18, 69632
ds_read_b64_tr_b16 a[208:209], v163 offset:16384
v_mfma_f32_16x16x32_bf16 v[200:203], a[248:251], v[88:91], v[200:203]
ds_read_b64_tr_b16 a[210:211], v163 offset:18432
buffer_load_dwordx4 v52, s[4:7], s16 offen offset:0 sc1 lds
v_mfma_f32_16x16x32_bf16 v[200:203], a[252:255], v[92:95], v[200:203]
ds_read_b64_tr_b16 a[212:213], v163 offset:20480
v_mfma_f32_16x16x32_bf16 v[204:207], a[240:243], v[112:115], v[204:207]
ds_read_b64_tr_b16 a[214:215], v163 offset:22528
v_mfma_f32_16x16x32_bf16 v[204:207], a[244:247], v[116:119], v[204:207]
ds_read_b64_tr_b16 a[216:217], v163 offset:24576
buffer_store_dwordx4 v[8:11], v16, s[12:15], s46 offen offset:1024 sc0 sc1
v_mfma_f32_16x16x32_bf16 v[204:207], a[248:251], v[120:123], v[204:207]
ds_read_b64_tr_b16 a[218:219], v163 offset:26624
v_cvt_pk_bf16_f32 v12, v228, v229
v_mfma_f32_16x16x32_bf16 v[204:207], a[252:255], v[124:127], v[204:207]
ds_read_b64_tr_b16 a[220:221], v163 offset:28672
s_waitcnt lgkmcnt(7)
v_mfma_f32_16x16x32_bf16 v[208:211], a[192:195], v[64:67], 0
ds_read_b64_tr_b16 a[222:223], v163 offset:30720
buffer_load_dwordx4 v53, s[4:7], s16 offen offset:1024 sc1 lds
v_mfma_f32_16x16x32_bf16 v[208:211], a[196:199], v[68:71], v[208:211]
ds_read_b64_tr_b16 a[224:225], v164 offset:0
v_cvt_pk_bf16_f32 v13, v230, v231
v_mfma_f32_16x16x32_bf16 v[208:211], a[200:203], v[72:75], v[208:211]
ds_read_b64_tr_b16 a[226:227], v164 offset:2048
v_cvt_pk_bf16_f32 v14, v236, v237
v_mfma_f32_16x16x32_bf16 v[208:211], a[204:207], v[76:79], v[208:211]
ds_read_b64_tr_b16 a[228:229], v164 offset:4096
v_cvt_pk_bf16_f32 v15, v238, v239
v_mfma_f32_16x16x32_bf16 v[212:215], a[192:195], v[96:99], 0
ds_read_b64_tr_b16 a[230:231], v164 offset:6144
v_mfma_f32_16x16x32_bf16 v[212:215], a[196:199], v[100:103], v[212:215]
ds_read_b64_tr_b16 a[232:233], v164 offset:8192
v_mfma_f32_16x16x32_bf16 v[212:215], a[200:203], v[104:107], v[212:215]
ds_read_b64_tr_b16 a[234:235], v164 offset:10240
buffer_load_dwordx4 v54, s[4:7], s16 offen offset:2048 sc1 lds
v_mfma_f32_16x16x32_bf16 v[212:215], a[204:207], v[108:111], v[212:215]
ds_read_b64_tr_b16 a[236:237], v164 offset:12288
s_waitcnt lgkmcnt(7)
v_mfma_f32_16x16x32_bf16 v[208:211], a[208:211], v[80:83], v[208:211]
ds_read_b64_tr_b16 a[238:239], v164 offset:14336
v_mfma_f32_16x16x32_bf16 v[208:211], a[212:215], v[84:87], v[208:211]
ds_read_b64_tr_b16 a[240:241], v164 offset:16384
v_mfma_f32_16x16x32_bf16 v[208:211], a[216:219], v[88:91], v[208:211]
ds_read_b64_tr_b16 a[242:243], v164 offset:18432
v_mfma_f32_16x16x32_bf16 v[208:211], a[220:223], v[92:95], v[208:211]
ds_read_b64_tr_b16 a[244:245], v164 offset:20480
buffer_store_dwordx4 v[12:15], v58, s[12:15], s46 offen offset:0 sc0 sc1
v_mfma_f32_16x16x32_bf16 v[212:215], a[208:211], v[112:115], v[212:215]
ds_read_b64_tr_b16 a[246:247], v164 offset:22528
buffer_load_dwordx4 v55, s[4:7], s16 offen offset:3072 sc1 lds
v_mfma_f32_16x16x32_bf16 v[212:215], a[212:215], v[116:119], v[212:215]
ds_read_b64_tr_b16 a[248:249], v164 offset:24576
v_cvt_pk_bf16_f32 v28, v244, v245
v_mfma_f32_16x16x32_bf16 v[212:215], a[216:219], v[120:123], v[212:215]
s_add_u32 s16, s16, s26
ds_read_b64_tr_b16 a[250:251], v164 offset:26624
v_mfma_f32_16x16x32_bf16 v[212:215], a[220:223], v[124:127], v[212:215]
ds_read_b64_tr_b16 a[252:253], v164 offset:28672
s_waitcnt lgkmcnt(7)
v_mfma_f32_16x16x32_bf16 v[216:219], a[224:227], v[64:67], 0
ds_read_b64_tr_b16 a[254:255], v164 offset:30720
v_cvt_pk_bf16_f32 v29, v246, v247
v_mfma_f32_16x16x32_bf16 v[216:219], a[228:231], v[68:71], v[216:219]
v_cvt_pk_bf16_f32 v30, v252, v253
v_cvt_pk_bf16_f32 v31, v254, v255
v_mfma_f32_16x16x32_bf16 v[216:219], a[232:235], v[72:75], v[216:219]
buffer_store_dwordx4 v[28:31], v58, s[12:15], s46 offen offset:1024 sc0 sc1
v_mfma_f32_16x16x32_bf16 v[216:219], a[236:239], v[76:79], v[216:219]
s_add_u32 s46, s46, 2048
v_mfma_f32_16x16x32_bf16 v[220:223], a[224:227], v[96:99], 0
s_waitcnt vmcnt(13) lgkmcnt(0)
v_readfirstlane_b32 s61, v59
s_cmp_lt_u32 s61, 48
s_cbranch_scc1 mega_kernel_achk
mega_kernel_achkr:
s_barrier
v_mfma_f32_16x16x32_bf16 v[220:223], a[228:231], v[100:103], v[220:223]
ds_read_b64_tr_b16 a[192:193], v161 offset:32768
ds_read_b64_tr_b16 a[194:195], v161 offset:34816
v_mfma_f32_16x16x32_bf16 v[220:223], a[232:235], v[104:107], v[220:223]
ds_read_b64_tr_b16 a[196:197], v161 offset:36864
v_mfma_f32_16x16x32_bf16 v[220:223], a[236:239], v[108:111], v[220:223]
ds_read_b64_tr_b16 a[198:199], v161 offset:38912
ds_read_b64_tr_b16 a[200:201], v161 offset:40960
v_mfma_f32_16x16x32_bf16 v[216:219], a[240:243], v[80:83], v[216:219]
ds_read_b64_tr_b16 a[202:203], v161 offset:43008
v_mfma_f32_16x16x32_bf16 v[216:219], a[244:247], v[84:87], v[216:219]
ds_read_b64_tr_b16 a[204:205], v161 offset:45056
v_mfma_f32_16x16x32_bf16 v[216:219], a[248:251], v[88:91], v[216:219]
ds_read_b64_tr_b16 a[206:207], v161 offset:47104
ds_read_b64_tr_b16 a[208:209], v161 offset:49152
v_mfma_f32_16x16x32_bf16 v[216:219], a[252:255], v[92:95], v[216:219]
ds_read_b64_tr_b16 a[210:211], v161 offset:51200
v_mfma_f32_16x16x32_bf16 v[220:223], a[240:243], v[112:115], v[220:223]
ds_read_b64_tr_b16 a[212:213], v161 offset:53248
v_mfma_f32_16x16x32_bf16 v[220:223], a[244:247], v[116:119], v[220:223]
ds_read_b64_tr_b16 a[214:215], v161 offset:55296
ds_read_b64_tr_b16 a[216:217], v161 offset:57344
v_mfma_f32_16x16x32_bf16 v[220:223], a[248:251], v[120:123], v[220:223]
ds_read_b64_tr_b16 a[218:219], v161 offset:59392
v_mfma_f32_16x16x32_bf16 v[220:223], a[252:255], v[124:127], v[220:223]
ds_read_b64_tr_b16 a[220:221], v161 offset:61440
s_waitcnt lgkmcnt(7)
v_mfma_f32_16x16x32_bf16 v[224:227], a[192:195], v[64:67], 0
s_lshr_b32 s57, s55, 1
ds_read_b64_tr_b16 a[222:223], v161 offset:63488
v_mfma_f32_16x16x32_bf16 v[224:227], a[196:199], v[68:71], v[224:227]
s_add_u32 m0, s18, 0
ds_read_b64_tr_b16 a[224:225], v162 offset:32768
v_mfma_f32_16x16x32_bf16 v[224:227], a[200:203], v[72:75], v[224:227]
ds_read_b64_tr_b16 a[226:227], v162 offset:34816
buffer_load_dwordx4 v48, s[4:7], s16 offen offset:0 sc1 lds
v_mfma_f32_16x16x32_bf16 v[224:227], a[204:207], v[76:79], v[224:227]
s_lshl_b32 s58, s57, 1
ds_read_b64_tr_b16 a[228:229], v162 offset:36864
v_mfma_f32_16x16x32_bf16 v[228:231], a[192:195], v[96:99], 0
s_lshr_b32 s59, 0xa6a55400, s58
ds_read_b64_tr_b16 a[230:231], v162 offset:38912
v_mfma_f32_16x16x32_bf16 v[228:231], a[196:199], v[100:103], v[228:231]
ds_read_b64_tr_b16 a[232:233], v162 offset:40960
v_cvt_pk_bf16_f32 v4, v192, v193
v_mfma_f32_16x16x32_bf16 v[228:231], a[200:203], v[104:107], v[228:231]
ds_read_b64_tr_b16 a[234:235], v162 offset:43008
v_cvt_pk_bf16_f32 v5, v194, v195
v_mfma_f32_16x16x32_bf16 v[228:231], a[204:207], v[108:111], v[228:231]
ds_read_b64_tr_b16 a[236:237], v162 offset:45056
s_waitcnt lgkmcnt(7)
v_mfma_f32_16x16x32_bf16 v[224:227], a[208:211], v[80:83], v[224:227]
ds_read_b64_tr_b16 a[238:239], v162 offset:47104
buffer_load_dwordx4 v49, s[4:7], s16 offen offset:1024 sc1 lds
v_mfma_f32_16x16x32_bf16 v[224:227], a[212:215], v[84:87], v[224:227]
s_and_b32 s59, s59, 3
ds_read_b64_tr_b16 a[240:241], v162 offset:49152
v_mfma_f32_16x16x32_bf16 v[224:227], a[216:219], v[88:91], v[224:227]
s_mov_b32 s60, 0x21000000
ds_read_b64_tr_b16 a[242:243], v162 offset:51200
v_mfma_f32_16x16x32_bf16 v[224:227], a[220:223], v[92:95], v[224:227]
ds_read_b64_tr_b16 a[244:245], v162 offset:53248
v_cvt_pk_bf16_f32 v6, v200, v201
v_mfma_f32_16x16x32_bf16 v[228:231], a[208:211], v[112:115], v[228:231]
s_mov_b32 s61, 0xecb97543
ds_read_b64_tr_b16 a[246:247], v162 offset:55296
v_mfma_f32_16x16x32_bf16 v[228:231], a[212:215], v[116:119], v[228:231]
s_lshl_b32 s58, s57, 2
ds_read_b64_tr_b16 a[248:249], v162 offset:57344
v_mfma_f32_16x16x32_bf16 v[228:231], a[216:219], v[120:123], v[228:231]
ds_read_b64_tr_b16 a[250:251], v162 offset:59392
buffer_load_dwordx4 v50, s[4:7], s16 offen offset:2048 sc1 lds
v_mfma_f32_16x16x32_bf16 v[228:231], a[220:223], v[124:127], v[228:231]
ds_read_b64_tr_b16 a[252:253], v162 offset:61440
s_waitcnt lgkmcnt(7)
v_mfma_f32_16x16x32_bf16 v[232:235], a[224:227], v[64:67], 0
ds_read_b64_tr_b16 a[254:255], v162 offset:63488
v_cvt_pk_bf16_f32 v7, v202, v203
v_mfma_f32_16x16x32_bf16 v[232:235], a[228:231], v[68:71], v[232:235]
ds_read_b64_tr_b16 a[192:193], v163 offset:32768
buffer_store_dwordx4 v[4:7], v16, s[12:15], s46 offen offset:0 sc0 sc1
v_mfma_f32_16x16x32_bf16 v[232:235], a[232:235], v[72:75], v[232:235]
s_lshr_b64 s[60:61], s[60:61], s58
ds_read_b64_tr_b16 a[194:195], v163 offset:34816
v_mfma_f32_16x16x32_bf16 v[232:235], a[236:239], v[76:79], v[232:235]
s_and_b32 s41, s60, 15
ds_read_b64_tr_b16 a[196:197], v163 offset:36864
v_mfma_f32_16x16x32_bf16 v[236:239], a[224:227], v[96:99], 0
ds_read_b64_tr_b16 a[198:199], v163 offset:38912
buffer_load_dwordx4 v51, s[4:7], s16 offen offset:3072 sc1 lds
v_mfma_f32_16x16x32_bf16 v[236:239], a[228:231], v[100:103], v[236:239]
s_lshl_b32 s76, s21, 6
ds_read_b64_tr_b16 a[200:201], v163 offset:40960
v_mfma_f32_16x16x32_bf16 v[236:239], a[232:235], v[104:107], v[236:239]
ds_read_b64_tr_b16 a[202:203], v163 offset:43008
v_cvt_pk_bf16_f32 v8, v208, v209
v_mfma_f32_16x16x32_bf16 v[236:239], a[236:239], v[108:111], v[236:239]
ds_read_b64_tr_b16 a[204:205], v163 offset:45056
s_waitcnt lgkmcnt(7)
v_mfma_f32_16x16x32_bf16 v[232:235], a[240:243], v[80:83], v[232:235]
s_add_u32 s76, s76, 117440512
ds_read_b64_tr_b16 a[206:207], v163 offset:47104
v_mfma_f32_16x16x32_bf16 v[232:235], a[244:247], v[84:87], v[232:235]
s_add_u32 m0, s18, 4096
ds_read_b64_tr_b16 a[208:209], v163 offset:49152
v_mfma_f32_16x16x32_bf16 v[232:235], a[248:251], v[88:91], v[232:235]
ds_read_b64_tr_b16 a[210:211], v163 offset:51200
buffer_load_dwordx4 v52, s[4:7], s16 offen offset:0 sc1 lds
v_mfma_f32_16x16x32_bf16 v[232:235], a[252:255], v[92:95], v[232:235]
s_lshl_b32 s77, s41, 7
ds_read_b64_tr_b16 a[212:213], v163 offset:53248
v_mfma_f32_16x16x32_bf16 v[236:239], a[240:243], v[112:115], v[236:239]
ds_read_b64_tr_b16 a[214:215], v163 offset:55296
v_cvt_pk_bf16_f32 v9, v210, v211
v_mfma_f32_16x16x32_bf16 v[236:239], a[244:247], v[116:119], v[236:239]
s_add_u32 s77, s77, 117442560
ds_read_b64_tr_b16 a[216:217], v163 offset:57344
v_mfma_f32_16x16x32_bf16 v[236:239], a[248:251], v[120:123], v[236:239]
s_lshr_b32 s42, s20, 1
ds_read_b64_tr_b16 a[218:219], v163 offset:59392
v_mfma_f32_16x16x32_bf16 v[236:239], a[252:255], v[124:127], v[236:239]
ds_read_b64_tr_b16 a[220:221], v163 offset:61440
s_waitcnt lgkmcnt(7)
v_mfma_f32_16x16x32_bf16 v[240:243], a[192:195], v[64:67], 0
ds_read_b64_tr_b16 a[222:223], v163 offset:63488
buffer_load_dwordx4 v53, s[4:7], s16 offen offset:1024 sc1 lds
v_mfma_f32_16x16x32_bf16 v[240:243], a[196:199], v[68:71], v[240:243]
ds_read_b64_tr_b16 a[224:225], v164 offset:32768
v_cvt_pk_bf16_f32 v10, v216, v217
v_mfma_f32_16x16x32_bf16 v[240:243], a[200:203], v[72:75], v[240:243]
s_and_b32 s43, s20, 1
ds_read_b64_tr_b16 a[226:227], v164 offset:34816
v_mfma_f32_16x16x32_bf16 v[240:243], a[204:207], v[76:79], v[240:243]
s_mov_b32 s66, 65536
ds_read_b64_tr_b16 a[228:229], v164 offset:36864
v_mfma_f32_16x16x32_bf16 v[244:247], a[192:195], v[96:99], 0
ds_read_b64_tr_b16 a[230:231], v164 offset:38912
v_cvt_pk_bf16_f32 v11, v218, v219
v_mfma_f32_16x16x32_bf16 v[244:247], a[196:199], v[100:103], v[244:247]
ds_read_b64_tr_b16 a[232:233], v164 offset:40960
buffer_store_dwordx4 v[8:11], v16, s[12:15], s46 offen offset:1024 sc0 sc1
v_mfma_f32_16x16x32_bf16 v[244:247], a[200:203], v[104:107], v[244:247]
ds_read_b64_tr_b16 a[234:235], v164 offset:43008
buffer_load_dwordx4 v54, s[4:7], s16 offen offset:2048 sc1 lds
v_mfma_f32_16x16x32_bf16 v[244:247], a[204:207], v[108:111], v[244:247]
ds_read_b64_tr_b16 a[236:237], v164 offset:45056
s_waitcnt lgkmcnt(7)
v_mfma_f32_16x16x32_bf16 v[240:243], a[208:211], v[80:83], v[240:243]
s_mov_b32 s70, 65536
ds_read_b64_tr_b16 a[238:239], v164 offset:47104
v_mfma_f32_16x16x32_bf16 v[240:243], a[212:215], v[84:87], v[240:243]
s_mov_b32 s67, 0x20000
ds_read_b64_tr_b16 a[240:241], v164 offset:49152
v_mfma_f32_16x16x32_bf16 v[240:243], a[216:219], v[88:91], v[240:243]
s_mov_b32 s71, 0x20000
ds_read_b64_tr_b16 a[242:243], v164 offset:51200
v_mfma_f32_16x16x32_bf16 v[240:243], a[220:223], v[92:95], v[240:243]
ds_read_b64_tr_b16 a[244:245], v164 offset:53248
v_cvt_pk_bf16_f32 v12, v196, v197
v_mfma_f32_16x16x32_bf16 v[244:247], a[208:211], v[112:115], v[244:247]
ds_read_b64_tr_b16 a[246:247], v164 offset:55296
buffer_load_dwordx4 v55, s[4:7], s16 offen offset:3072 sc1 lds
v_mfma_f32_16x16x32_bf16 v[244:247], a[212:215], v[116:119], v[244:247]
s_lshl_b32 s44, s42, 16
ds_read_b64_tr_b16 a[248:249], v164 offset:57344
v_mfma_f32_16x16x32_bf16 v[244:247], a[216:219], v[120:123], v[244:247]
s_add_u32 s16, s16, s26
ds_read_b64_tr_b16 a[250:251], v164 offset:59392
v_mfma_f32_16x16x32_bf16 v[244:247], a[220:223], v[124:127], v[244:247]
ds_read_b64_tr_b16 a[252:253], v164 offset:61440
s_waitcnt lgkmcnt(7)
v_mfma_f32_16x16x32_bf16 v[248:251], a[224:227], v[64:67], 0
s_lshl_b32 s45, s56, 17
ds_read_b64_tr_b16 a[254:255], v164 offset:63488
v_mfma_f32_16x16x32_bf16 v[248:251], a[228:231], v[68:71], v[248:251]
s_add_u32 s47, s45, s44
v_cvt_pk_bf16_f32 v13, v198, v199
v_mfma_f32_16x16x32_bf16 v[248:251], a[232:235], v[72:75], v[248:251]
s_add_u32 s47, s47, 69206016
v_cvt_pk_bf16_f32 v14, v204, v205
v_mfma_f32_16x16x32_bf16 v[248:251], a[236:239], v[76:79], v[248:251]
s_add_u32 s64, s12, s47
s_addc_u32 s65, s13, 0
v_mfma_f32_16x16x32_bf16 v[252:255], a[224:227], v[96:99], 0
s_waitcnt lgkmcnt(0)
s_barrier
v_mfma_f32_16x16x32_bf16 v[252:255], a[228:231], v[100:103], v[252:255]
ds_read_b64_tr_b16 a[192:193], v165 offset:32768
ds_read_b64_tr_b16 a[194:195], v165 offset:34816
v_mfma_f32_16x16x32_bf16 v[252:255], a[232:235], v[104:107], v[252:255]
ds_read_b64_tr_b16 a[196:197], v165 offset:36864
v_cvt_pk_bf16_f32 v15, v206, v207
v_mfma_f32_16x16x32_bf16 v[252:255], a[236:239], v[108:111], v[252:255]
ds_read_b64_tr_b16 a[198:199], v165 offset:38912
ds_read_b64_tr_b16 a[200:201], v165 offset:40960
buffer_store_dwordx4 v[12:15], v58, s[12:15], s46 offen offset:0 sc0 sc1
v_mfma_f32_16x16x32_bf16 v[248:251], a[240:243], v[80:83], v[248:251]
ds_read_b64_tr_b16 a[202:203], v165 offset:43008
v_cvt_pk_bf16_f32 v28, v212, v213
v_mfma_f32_16x16x32_bf16 v[248:251], a[244:247], v[84:87], v[248:251]
ds_read_b64_tr_b16 a[204:205], v165 offset:45056
v_cvt_pk_bf16_f32 v29, v214, v215
v_mfma_f32_16x16x32_bf16 v[248:251], a[248:251], v[88:91], v[248:251]
ds_read_b64_tr_b16 a[206:207], v165 offset:47104
ds_read_b64_tr_b16 a[208:209], v165 offset:49152
v_mfma_f32_16x16x32_bf16 v[248:251], a[252:255], v[92:95], v[248:251]
ds_read_b64_tr_b16 a[210:211], v165 offset:51200
v_cvt_pk_bf16_f32 v30, v220, v221
v_mfma_f32_16x16x32_bf16 v[252:255], a[240:243], v[112:115], v[252:255]
ds_read_b64_tr_b16 a[212:213], v165 offset:53248
v_cvt_pk_bf16_f32 v31, v222, v223
v_mfma_f32_16x16x32_bf16 v[252:255], a[244:247], v[116:119], v[252:255]
ds_read_b64_tr_b16 a[214:215], v165 offset:55296
ds_read_b64_tr_b16 a[216:217], v165 offset:57344
buffer_store_dwordx4 v[28:31], v58, s[12:15], s46 offen offset:1024 sc0 sc1
v_mfma_f32_16x16x32_bf16 v[252:255], a[248:251], v[120:123], v[252:255]
s_add_u32 s46, s46, 2048
ds_read_b64_tr_b16 a[218:219], v165 offset:59392
v_mfma_f32_16x16x32_bf16 v[252:255], a[252:255], v[124:127], v[252:255]
s_add_u32 s68, s64, 2097152
s_addc_u32 s69, s65, 0
s_lshl_b32 s48, s41, 2
s_lshl_b32 s49, s43, 1
s_add_u32 s48, s48, s49
s_lshl_b32 s75, s48, 11
s_add_u32 s75, s75, s45
s_add_u32 s75, s75, 67108864
s_add_u32 s48, s48, s42
s_lshl_b32 s74, s48, 15
s_lshl_b32 s49, s56, 10
s_add_u32 s74, s74, s49
s_add_u32 s74, s74, 73400320
s_mov_b32 s72, 0
s_mov_b32 s73, 0
s_cmp_eq_u32 s59, 0
s_cselect_b32 s66, 0, s66
s_cselect_b32 s70, 0, s70
ds_read_b64_tr_b16 a[220:221], v165 offset:61440
s_waitcnt lgkmcnt(7)
v_mfma_f32_16x16x32_bf16 v[192:195], a[192:195], v[64:67], 0
ds_read_b64_tr_b16 a[222:223], v165 offset:63488
v_mfma_f32_16x16x32_bf16 v[192:195], a[196:199], v[68:71], v[192:195]
ds_read_b64_tr_b16 a[224:225], v166 offset:32768
buffer_load_dwordx4 a[0:3], v16, s[64:67], s72 offen offset:0 sc1
v_mfma_f32_16x16x32_bf16 v[192:195], a[200:203], v[72:75], v[192:195]
ds_read_b64_tr_b16 a[226:227], v166 offset:34816
v_mfma_f32_16x16x32_bf16 v[192:195], a[204:207], v[76:79], v[192:195]
ds_read_b64_tr_b16 a[228:229], v166 offset:36864
buffer_load_dwordx4 a[4:7], v16, s[64:67], s72 offen offset:1024 sc1
v_mfma_f32_16x16x32_bf16 v[196:199], a[192:195], v[96:99], 0
ds_read_b64_tr_b16 a[230:231], v166 offset:38912
v_mfma_f32_16x16x32_bf16 v[196:199], a[196:199], v[100:103], v[196:199]
ds_read_b64_tr_b16 a[232:233], v166 offset:40960
v_cvt_pk_bf16_f32 v4, v224, v225
v_mfma_f32_16x16x32_bf16 v[196:199], a[200:203], v[104:107], v[196:199]
ds_read_b64_tr_b16 a[234:235], v166 offset:43008
buffer_load_dwordx4 a[8:11], v16, s[64:67], s72 offen offset:2048 sc1
v_mfma_f32_16x16x32_bf16 v[196:199], a[204:207], v[108:111], v[196:199]
ds_read_b64_tr_b16 a[236:237], v166 offset:45056
s_waitcnt lgkmcnt(7)
v_mfma_f32_16x16x32_bf16 v[192:195], a[208:211], v[80:83], v[192:195]
ds_read_b64_tr_b16 a[238:239], v166 offset:47104
buffer_load_dwordx4 a[12:15], v16, s[64:67], s72 offen offset:3072 sc1
v_mfma_f32_16x16x32_bf16 v[192:195], a[212:215], v[84:87], v[192:195]
ds_read_b64_tr_b16 a[240:241], v166 offset:49152
v_cvt_pk_bf16_f32 v5, v226, v227
v_mfma_f32_16x16x32_bf16 v[192:195], a[216:219], v[88:91], v[192:195]
ds_read_b64_tr_b16 a[242:243], v166 offset:51200
v_cvt_pk_bf16_f32 v6, v232, v233
v_mfma_f32_16x16x32_bf16 v[192:195], a[220:223], v[92:95], v[192:195]
s_add_u32 s72, s72, 4096
ds_read_b64_tr_b16 a[244:245], v166 offset:53248
v_mfma_f32_16x16x32_bf16 v[196:199], a[208:211], v[112:115], v[196:199]
ds_read_b64_tr_b16 a[246:247], v166 offset:55296
v_cvt_pk_bf16_f32 v7, v234, v235
v_mfma_f32_16x16x32_bf16 v[196:199], a[212:215], v[116:119], v[196:199]
ds_read_b64_tr_b16 a[248:249], v166 offset:57344
buffer_load_dwordx4 a[16:19], v16, s[64:67], s72 offen offset:0 sc1
v_mfma_f32_16x16x32_bf16 v[196:199], a[216:219], v[120:123], v[196:199]
ds_read_b64_tr_b16 a[250:251], v166 offset:59392
v_mfma_f32_16x16x32_bf16 v[196:199], a[220:223], v[124:127], v[196:199]
ds_read_b64_tr_b16 a[252:253], v166 offset:61440
s_waitcnt lgkmcnt(7)
v_mfma_f32_16x16x32_bf16 v[200:203], a[224:227], v[64:67], 0
ds_read_b64_tr_b16 a[254:255], v166 offset:63488
buffer_load_dwordx4 a[20:23], v16, s[64:67], s72 offen offset:1024 sc1
buffer_store_dwordx4 v[4:7], v16, s[12:15], s46 offen offset:0 sc0 sc1
v_mfma_f32_16x16x32_bf16 v[200:203], a[228:231], v[68:71], v[200:203]
ds_read_b64_tr_b16 a[192:193], v167 offset:32768
v_cvt_pk_bf16_f32 v8, v240, v241
v_mfma_f32_16x16x32_bf16 v[200:203], a[232:235], v[72:75], v[200:203]
ds_read_b64_tr_b16 a[194:195], v167 offset:34816
buffer_load_dwordx4 a[24:27], v16, s[64:67], s72 offen offset:2048 sc1
v_mfma_f32_16x16x32_bf16 v[200:203], a[236:239], v[76:79], v[200:203]
ds_read_b64_tr_b16 a[196:197], v167 offset:36864
v_cvt_pk_bf16_f32 v9, v242, v243
v_mfma_f32_16x16x32_bf16 v[204:207], a[224:227], v[96:99], 0
ds_read_b64_tr_b16 a[198:199], v167 offset:38912
v_cvt_pk_bf16_f32 v10, v248, v249
v_mfma_f32_16x16x32_bf16 v[204:207], a[228:231], v[100:103], v[204:207]
ds_read_b64_tr_b16 a[200:201], v167 offset:40960
buffer_load_dwordx4 a[28:31], v16, s[64:67], s72 offen offset:3072 sc1
v_mfma_f32_16x16x32_bf16 v[204:207], a[232:235], v[104:107], v[204:207]
ds_read_b64_tr_b16 a[202:203], v167 offset:43008
v_cvt_pk_bf16_f32 v11, v250, v251
v_mfma_f32_16x16x32_bf16 v[204:207], a[236:239], v[108:111], v[204:207]
s_add_u32 s72, s72, 4096
ds_read_b64_tr_b16 a[204:205], v167 offset:45056
s_waitcnt lgkmcnt(7)
v_mfma_f32_16x16x32_bf16 v[200:203], a[240:243], v[80:83], v[200:203]
ds_read_b64_tr_b16 a[206:207], v167 offset:47104
v_mfma_f32_16x16x32_bf16 v[200:203], a[244:247], v[84:87], v[200:203]
ds_read_b64_tr_b16 a[208:209], v167 offset:49152
v_mfma_f32_16x16x32_bf16 v[200:203], a[248:251], v[88:91], v[200:203]
ds_read_b64_tr_b16 a[210:211], v167 offset:51200
buffer_load_dwordx4 a[64:67], v16, s[68:71], s73 offen offset:0 sc1
v_mfma_f32_16x16x32_bf16 v[200:203], a[252:255], v[92:95], v[200:203]
ds_read_b64_tr_b16 a[212:213], v167 offset:53248
v_mfma_f32_16x16x32_bf16 v[204:207], a[240:243], v[112:115], v[204:207]
ds_read_b64_tr_b16 a[214:215], v167 offset:55296
buffer_load_dwordx4 a[68:71], v16, s[68:71], s73 offen offset:1024 sc1
v_mfma_f32_16x16x32_bf16 v[204:207], a[244:247], v[116:119], v[204:207]
ds_read_b64_tr_b16 a[216:217], v167 offset:57344
buffer_store_dwordx4 v[8:11], v16, s[12:15], s46 offen offset:1024 sc0 sc1
v_mfma_f32_16x16x32_bf16 v[204:207], a[248:251], v[120:123], v[204:207]
ds_read_b64_tr_b16 a[218:219], v167 offset:59392
v_cvt_pk_bf16_f32 v12, v228, v229
v_mfma_f32_16x16x32_bf16 v[204:207], a[252:255], v[124:127], v[204:207]
ds_read_b64_tr_b16 a[220:221], v167 offset:61440
buffer_load_dwordx4 a[72:75], v16, s[68:71], s73 offen offset:2048 sc1
s_waitcnt lgkmcnt(7)
v_mfma_f32_16x16x32_bf16 v[208:211], a[192:195], v[64:67], 0
ds_read_b64_tr_b16 a[222:223], v167 offset:63488
v_cvt_pk_bf16_f32 v13, v230, v231
v_mfma_f32_16x16x32_bf16 v[208:211], a[196:199], v[68:71], v[208:211]
ds_read_b64_tr_b16 a[224:225], v168 offset:32768
buffer_load_dwordx4 a[76:79], v16, s[68:71], s73 offen offset:3072 sc1
v_mfma_f32_16x16x32_bf16 v[208:211], a[200:203], v[72:75], v[208:211]
ds_read_b64_tr_b16 a[226:227], v168 offset:34816
v_cvt_pk_bf16_f32 v14, v236, v237
v_mfma_f32_16x16x32_bf16 v[208:211], a[204:207], v[76:79], v[208:211]
ds_read_b64_tr_b16 a[228:229], v168 offset:36864
v_cvt_pk_bf16_f32 v15, v238, v239
v_mfma_f32_16x16x32_bf16 v[212:215], a[192:195], v[96:99], 0
s_add_u32 s73, s73, 4096
ds_read_b64_tr_b16 a[230:231], v168 offset:38912
v_mfma_f32_16x16x32_bf16 v[212:215], a[196:199], v[100:103], v[212:215]
ds_read_b64_tr_b16 a[232:233], v168 offset:40960
v_mfma_f32_16x16x32_bf16 v[212:215], a[200:203], v[104:107], v[212:215]
ds_read_b64_tr_b16 a[234:235], v168 offset:43008
buffer_load_dwordx4 a[32:35], v16, s[64:67], s72 offen offset:0 sc1
v_mfma_f32_16x16x32_bf16 v[212:215], a[204:207], v[108:111], v[212:215]
ds_read_b64_tr_b16 a[236:237], v168 offset:45056
s_waitcnt lgkmcnt(7)
v_mfma_f32_16x16x32_bf16 v[208:211], a[208:211], v[80:83], v[208:211]
ds_read_b64_tr_b16 a[238:239], v168 offset:47104
v_mfma_f32_16x16x32_bf16 v[208:211], a[212:215], v[84:87], v[208:211]
ds_read_b64_tr_b16 a[240:241], v168 offset:49152
buffer_load_dwordx4 a[36:39], v16, s[64:67], s72 offen offset:1024 sc1
v_mfma_f32_16x16x32_bf16 v[208:211], a[216:219], v[88:91], v[208:211]
ds_read_b64_tr_b16 a[242:243], v168 offset:51200
v_mfma_f32_16x16x32_bf16 v[208:211], a[220:223], v[92:95], v[208:211]
ds_read_b64_tr_b16 a[244:245], v168 offset:53248
buffer_load_dwordx4 a[40:43], v16, s[64:67], s72 offen offset:2048 sc1
buffer_store_dwordx4 v[12:15], v58, s[12:15], s46 offen offset:0 sc0 sc1
v_mfma_f32_16x16x32_bf16 v[212:215], a[208:211], v[112:115], v[212:215]
ds_read_b64_tr_b16 a[246:247], v168 offset:55296
v_cvt_pk_bf16_f32 v28, v244, v245
v_mfma_f32_16x16x32_bf16 v[212:215], a[212:215], v[116:119], v[212:215]
ds_read_b64_tr_b16 a[248:249], v168 offset:57344
v_cvt_pk_bf16_f32 v29, v246, v247
v_mfma_f32_16x16x32_bf16 v[212:215], a[216:219], v[120:123], v[212:215]
ds_read_b64_tr_b16 a[250:251], v168 offset:59392
buffer_load_dwordx4 a[44:47], v16, s[64:67], s72 offen offset:3072 sc1
v_mfma_f32_16x16x32_bf16 v[212:215], a[220:223], v[124:127], v[212:215]
ds_read_b64_tr_b16 a[252:253], v168 offset:61440
s_waitcnt lgkmcnt(7)
v_mfma_f32_16x16x32_bf16 v[216:219], a[224:227], v[64:67], 0
s_add_u32 s72, s72, 4096
ds_read_b64_tr_b16 a[254:255], v168 offset:63488
v_mfma_f32_16x16x32_bf16 v[216:219], a[228:231], v[68:71], v[216:219]
v_cvt_pk_bf16_f32 v30, v252, v253
v_cvt_pk_bf16_f32 v31, v254, v255
v_mfma_f32_16x16x32_bf16 v[216:219], a[232:235], v[72:75], v[216:219]
buffer_store_dwordx4 v[28:31], v58, s[12:15], s46 offen offset:1024 sc0 sc1
v_mfma_f32_16x16x32_bf16 v[216:219], a[236:239], v[76:79], v[216:219]
s_add_u32 s46, s46, 2048
v_mfma_f32_16x16x32_bf16 v[220:223], a[224:227], v[96:99], 0
s_waitcnt vmcnt(33) lgkmcnt(0)
s_barrier
v_mfma_f32_16x16x32_bf16 v[220:223], a[228:231], v[100:103], v[220:223]
ds_read_b64_tr_b16 a[192:193], v165 offset:0
ds_read_b64_tr_b16 a[194:195], v165 offset:2048
v_mfma_f32_16x16x32_bf16 v[220:223], a[232:235], v[104:107], v[220:223]
ds_read_b64_tr_b16 a[196:197], v165 offset:4096
v_mfma_f32_16x16x32_bf16 v[220:223], a[236:239], v[108:111], v[220:223]
ds_read_b64_tr_b16 a[198:199], v165 offset:6144
ds_read_b64_tr_b16 a[200:201], v165 offset:8192
v_mfma_f32_16x16x32_bf16 v[216:219], a[240:243], v[80:83], v[216:219]
ds_read_b64_tr_b16 a[202:203], v165 offset:10240
v_mfma_f32_16x16x32_bf16 v[216:219], a[244:247], v[84:87], v[216:219]
ds_read_b64_tr_b16 a[204:205], v165 offset:12288
v_mfma_f32_16x16x32_bf16 v[216:219], a[248:251], v[88:91], v[216:219]
ds_read_b64_tr_b16 a[206:207], v165 offset:14336
ds_read_b64_tr_b16 a[208:209], v165 offset:16384
v_mfma_f32_16x16x32_bf16 v[216:219], a[252:255], v[92:95], v[216:219]
ds_read_b64_tr_b16 a[210:211], v165 offset:18432
v_mfma_f32_16x16x32_bf16 v[220:223], a[240:243], v[112:115], v[220:223]
ds_read_b64_tr_b16 a[212:213], v165 offset:20480
v_mfma_f32_16x16x32_bf16 v[220:223], a[244:247], v[116:119], v[220:223]
ds_read_b64_tr_b16 a[214:215], v165 offset:22528
ds_read_b64_tr_b16 a[216:217], v165 offset:24576
v_mfma_f32_16x16x32_bf16 v[220:223], a[248:251], v[120:123], v[220:223]
ds_read_b64_tr_b16 a[218:219], v165 offset:26624
v_mfma_f32_16x16x32_bf16 v[220:223], a[252:255], v[124:127], v[220:223]
ds_read_b64_tr_b16 a[220:221], v165 offset:28672
s_waitcnt lgkmcnt(7)
v_mfma_f32_16x16x32_bf16 v[224:227], a[192:195], v[64:67], 0
ds_read_b64_tr_b16 a[222:223], v165 offset:30720
v_mfma_f32_16x16x32_bf16 v[224:227], a[196:199], v[68:71], v[224:227]
ds_read_b64_tr_b16 a[224:225], v166 offset:0
buffer_load_dwordx4 a[80:83], v16, s[68:71], s73 offen offset:0 sc1
v_mfma_f32_16x16x32_bf16 v[224:227], a[200:203], v[72:75], v[224:227]
ds_read_b64_tr_b16 a[226:227], v166 offset:2048
v_mfma_f32_16x16x32_bf16 v[224:227], a[204:207], v[76:79], v[224:227]
ds_read_b64_tr_b16 a[228:229], v166 offset:4096
buffer_load_dwordx4 a[84:87], v16, s[68:71], s73 offen offset:1024 sc1
v_mfma_f32_16x16x32_bf16 v[228:231], a[192:195], v[96:99], 0
ds_read_b64_tr_b16 a[230:231], v166 offset:6144
v_mfma_f32_16x16x32_bf16 v[228:231], a[196:199], v[100:103], v[228:231]
ds_read_b64_tr_b16 a[232:233], v166 offset:8192
v_cvt_pk_bf16_f32 v4, v192, v193
v_mfma_f32_16x16x32_bf16 v[228:231], a[200:203], v[104:107], v[228:231]
ds_read_b64_tr_b16 a[234:235], v166 offset:10240
buffer_load_dwordx4 a[88:91], v16, s[68:71], s73 offen offset:2048 sc1
v_mfma_f32_16x16x32_bf16 v[228:231], a[204:207], v[108:111], v[228:231]
ds_read_b64_tr_b16 a[236:237], v166 offset:12288
s_waitcnt lgkmcnt(7)
v_mfma_f32_16x16x32_bf16 v[224:227], a[208:211], v[80:83], v[224:227]
ds_read_b64_tr_b16 a[238:239], v166 offset:14336
buffer_load_dwordx4 a[92:95], v16, s[68:71], s73 offen offset:3072 sc1
v_mfma_f32_16x16x32_bf16 v[224:227], a[212:215], v[84:87], v[224:227]
ds_read_b64_tr_b16 a[240:241], v166 offset:16384
v_cvt_pk_bf16_f32 v5, v194, v195
v_mfma_f32_16x16x32_bf16 v[224:227], a[216:219], v[88:91], v[224:227]
ds_read_b64_tr_b16 a[242:243], v166 offset:18432
v_cvt_pk_bf16_f32 v6, v200, v201
v_mfma_f32_16x16x32_bf16 v[224:227], a[220:223], v[92:95], v[224:227]
s_add_u32 s73, s73, 4096
ds_read_b64_tr_b16 a[244:245], v166 offset:20480
v_mfma_f32_16x16x32_bf16 v[228:231], a[208:211], v[112:115], v[228:231]
ds_read_b64_tr_b16 a[246:247], v166 offset:22528
v_cvt_pk_bf16_f32 v7, v202, v203
v_mfma_f32_16x16x32_bf16 v[228:231], a[212:215], v[116:119], v[228:231]
ds_read_b64_tr_b16 a[248:249], v166 offset:24576
buffer_load_dwordx4 a[48:51], v16, s[64:67], s72 offen offset:0 sc1
v_mfma_f32_16x16x32_bf16 v[228:231], a[216:219], v[120:123], v[228:231]
ds_read_b64_tr_b16 a[250:251], v166 offset:26624
v_mfma_f32_16x16x32_bf16 v[228:231], a[220:223], v[124:127], v[228:231]
ds_read_b64_tr_b16 a[252:253], v166 offset:28672
s_waitcnt lgkmcnt(7)
v_mfma_f32_16x16x32_bf16 v[232:235], a[224:227], v[64:67], 0
ds_read_b64_tr_b16 a[254:255], v166 offset:30720
buffer_load_dwordx4 a[52:55], v16, s[64:67], s72 offen offset:1024 sc1
buffer_store_dwordx4 v[4:7], v16, s[12:15], s46 offen offset:0 sc0 sc1
v_mfma_f32_16x16x32_bf16 v[232:235], a[228:231], v[68:71], v[232:235]
ds_read_b64_tr_b16 a[192:193], v167 offset:0
v_cvt_pk_bf16_f32 v8, v208, v209
v_mfma_f32_16x16x32_bf16 v[232:235], a[232:235], v[72:75], v[232:235]
ds_read_b64_tr_b16 a[194:195], v167 offset:2048
buffer_load_dwordx4 a[56:59], v16, s[64:67], s72 offen offset:2048 sc1
v_mfma_f32_16x16x32_bf16 v[232:235], a[236:239], v[76:79], v[232:235]
ds_read_b64_tr_b16 a[196:197], v167 offset:4096
v_cvt_pk_bf16_f32 v9, v210, v211
v_mfma_f32_16x16x32_bf16 v[236:239], a[224:227], v[96:99], 0
ds_read_b64_tr_b16 a[198:199], v167 offset:6144
v_cvt_pk_bf16_f32 v10, v216, v217
v_mfma_f32_16x16x32_bf16 v[236:239], a[228:231], v[100:103], v[236:239]
ds_read_b64_tr_b16 a[200:201], v167 offset:8192
buffer_load_dwordx4 a[60:63], v16, s[64:67], s72 offen offset:3072 sc1
v_mfma_f32_16x16x32_bf16 v[236:239], a[232:235], v[104:107], v[236:239]
ds_read_b64_tr_b16 a[202:203], v167 offset:10240
v_cvt_pk_bf16_f32 v11, v218, v219
v_mfma_f32_16x16x32_bf16 v[236:239], a[236:239], v[108:111], v[236:239]
s_add_u32 s72, s72, 4096
ds_read_b64_tr_b16 a[204:205], v167 offset:12288
s_waitcnt lgkmcnt(7)
v_mfma_f32_16x16x32_bf16 v[232:235], a[240:243], v[80:83], v[232:235]
ds_read_b64_tr_b16 a[206:207], v167 offset:14336
v_mfma_f32_16x16x32_bf16 v[232:235], a[244:247], v[84:87], v[232:235]
ds_read_b64_tr_b16 a[208:209], v167 offset:16384
v_mfma_f32_16x16x32_bf16 v[232:235], a[248:251], v[88:91], v[232:235]
ds_read_b64_tr_b16 a[210:211], v167 offset:18432
buffer_load_dwordx4 a[96:99], v16, s[68:71], s73 offen offset:0 sc1
v_mfma_f32_16x16x32_bf16 v[232:235], a[252:255], v[92:95], v[232:235]
ds_read_b64_tr_b16 a[212:213], v167 offset:20480
v_mfma_f32_16x16x32_bf16 v[236:239], a[240:243], v[112:115], v[236:239]
ds_read_b64_tr_b16 a[214:215], v167 offset:22528
buffer_load_dwordx4 a[100:103], v16, s[68:71], s73 offen offset:1024 sc1
v_mfma_f32_16x16x32_bf16 v[236:239], a[244:247], v[116:119], v[236:239]
ds_read_b64_tr_b16 a[216:217], v167 offset:24576
buffer_store_dwordx4 v[8:11], v16, s[12:15], s46 offen offset:1024 sc0 sc1
v_mfma_f32_16x16x32_bf16 v[236:239], a[248:251], v[120:123], v[236:239]
ds_read_b64_tr_b16 a[218:219], v167 offset:26624
v_cvt_pk_bf16_f32 v12, v196, v197
v_mfma_f32_16x16x32_bf16 v[236:239], a[252:255], v[124:127], v[236:239]
ds_read_b64_tr_b16 a[220:221], v167 offset:28672
buffer_load_dwordx4 a[104:107], v16, s[68:71], s73 offen offset:2048 sc1
s_waitcnt lgkmcnt(7)
v_mfma_f32_16x16x32_bf16 v[240:243], a[192:195], v[64:67], 0
ds_read_b64_tr_b16 a[222:223], v167 offset:30720
v_cvt_pk_bf16_f32 v13, v198, v199
v_mfma_f32_16x16x32_bf16 v[240:243], a[196:199], v[68:71], v[240:243]
ds_read_b64_tr_b16 a[224:225], v168 offset:0
buffer_load_dwordx4 a[108:111], v16, s[68:71], s73 offen offset:3072 sc1
v_mfma_f32_16x16x32_bf16 v[240:243], a[200:203], v[72:75], v[240:243]
ds_read_b64_tr_b16 a[226:227], v168 offset:2048
v_cvt_pk_bf16_f32 v14, v204, v205
v_mfma_f32_16x16x32_bf16 v[240:243], a[204:207], v[76:79], v[240:243]
ds_read_b64_tr_b16 a[228:229], v168 offset:4096
v_cvt_pk_bf16_f32 v15, v206, v207
v_mfma_f32_16x16x32_bf16 v[244:247], a[192:195], v[96:99], 0
s_add_u32 s73, s73, 4096
ds_read_b64_tr_b16 a[230:231], v168 offset:6144
v_mfma_f32_16x16x32_bf16 v[244:247], a[196:199], v[100:103], v[244:247]
ds_read_b64_tr_b16 a[232:233], v168 offset:8192
v_mfma_f32_16x16x32_bf16 v[244:247], a[200:203], v[104:107], v[244:247]
ds_read_b64_tr_b16 a[234:235], v168 offset:10240
buffer_load_dwordx4 a[128:131], v16, s[12:15], s75 offen offset:0 sc1
v_mfma_f32_16x16x32_bf16 v[244:247], a[204:207], v[108:111], v[244:247]
ds_read_b64_tr_b16 a[236:237], v168 offset:12288
s_waitcnt lgkmcnt(7)
v_mfma_f32_16x16x32_bf16 v[240:243], a[208:211], v[80:83], v[240:243]
ds_read_b64_tr_b16 a[238:239], v168 offset:14336
v_mfma_f32_16x16x32_bf16 v[240:243], a[212:215], v[84:87], v[240:243]
ds_read_b64_tr_b16 a[240:241], v168 offset:16384
buffer_load_dwordx4 a[132:135], v16, s[12:15], s75 offen offset:1024 sc1
v_mfma_f32_16x16x32_bf16 v[240:243], a[216:219], v[88:91], v[240:243]
ds_read_b64_tr_b16 a[242:243], v168 offset:18432
v_mfma_f32_16x16x32_bf16 v[240:243], a[220:223], v[92:95], v[240:243]
ds_read_b64_tr_b16 a[244:245], v168 offset:20480
buffer_load_dwordx4 a[136:139], v16, s[12:15], s75 offen offset:2048 sc1
buffer_store_dwordx4 v[12:15], v58, s[12:15], s46 offen offset:0 sc0 sc1
v_mfma_f32_16x16x32_bf16 v[244:247], a[208:211], v[112:115], v[244:247]
ds_read_b64_tr_b16 a[246:247], v168 offset:22528
v_cvt_pk_bf16_f32 v28, v212, v213
v_mfma_f32_16x16x32_bf16 v[244:247], a[212:215], v[116:119], v[244:247]
ds_read_b64_tr_b16 a[248:249], v168 offset:24576
v_cvt_pk_bf16_f32 v29, v214, v215
v_mfma_f32_16x16x32_bf16 v[244:247], a[216:219], v[120:123], v[244:247]
ds_read_b64_tr_b16 a[250:251], v168 offset:26624
buffer_load_dwordx4 a[140:143], v16, s[12:15], s75 offen offset:3072 sc1
v_mfma_f32_16x16x32_bf16 v[244:247], a[220:223], v[124:127], v[244:247]
ds_read_b64_tr_b16 a[252:253], v168 offset:28672
s_waitcnt lgkmcnt(7)
v_mfma_f32_16x16x32_bf16 v[248:251], a[224:227], v[64:67], 0
ds_read_b64_tr_b16 a[254:255], v168 offset:30720
v_cvt_pk_bf16_f32 v30, v220, v221
v_mfma_f32_16x16x32_bf16 v[248:251], a[228:231], v[68:71], v[248:251]
v_cvt_pk_bf16_f32 v31, v222, v223
v_mfma_f32_16x16x32_bf16 v[248:251], a[232:235], v[72:75], v[248:251]
buffer_store_dwordx4 v[28:31], v58, s[12:15], s46 offen offset:1024 sc0 sc1
v_mfma_f32_16x16x32_bf16 v[248:251], a[236:239], v[76:79], v[248:251]
s_add_u32 s46, s46, 2048
v_mfma_f32_16x16x32_bf16 v[252:255], a[224:227], v[96:99], 0
s_waitcnt vmcnt(42) lgkmcnt(0)
s_barrier
v_mfma_f32_16x16x32_bf16 v[252:255], a[228:231], v[100:103], v[252:255]
ds_read_b64_tr_b16 a[192:193], v161 offset:0
ds_read_b64_tr_b16 a[194:195], v161 offset:2048
v_mfma_f32_16x16x32_bf16 v[252:255], a[232:235], v[104:107], v[252:255]
ds_read_b64_tr_b16 a[196:197], v161 offset:4096
v_mfma_f32_16x16x32_bf16 v[252:255], a[236:239], v[108:111], v[252:255]
ds_read_b64_tr_b16 a[198:199], v161 offset:6144
ds_read_b64_tr_b16 a[200:201], v161 offset:8192
v_mfma_f32_16x16x32_bf16 v[248:251], a[240:243], v[80:83], v[248:251]
ds_read_b64_tr_b16 a[202:203], v161 offset:10240
v_mfma_f32_16x16x32_bf16 v[248:251], a[244:247], v[84:87], v[248:251]
ds_read_b64_tr_b16 a[204:205], v161 offset:12288
v_mfma_f32_16x16x32_bf16 v[248:251], a[248:251], v[88:91], v[248:251]
ds_read_b64_tr_b16 a[206:207], v161 offset:14336
ds_read_b64_tr_b16 a[208:209], v161 offset:16384
v_mfma_f32_16x16x32_bf16 v[248:251], a[252:255], v[92:95], v[248:251]
ds_read_b64_tr_b16 a[210:211], v161 offset:18432
v_mfma_f32_16x16x32_bf16 v[252:255], a[240:243], v[112:115], v[252:255]
ds_read_b64_tr_b16 a[212:213], v161 offset:20480
v_mfma_f32_16x16x32_bf16 v[252:255], a[244:247], v[116:119], v[252:255]
ds_read_b64_tr_b16 a[214:215], v161 offset:22528
ds_read_b64_tr_b16 a[216:217], v161 offset:24576
v_mfma_f32_16x16x32_bf16 v[252:255], a[248:251], v[120:123], v[252:255]
ds_read_b64_tr_b16 a[218:219], v161 offset:26624
v_mfma_f32_16x16x32_bf16 v[252:255], a[252:255], v[124:127], v[252:255]
ds_read_b64_tr_b16 a[220:221], v161 offset:28672
s_waitcnt lgkmcnt(7)
v_mfma_f32_16x16x32_bf16 v[192:195], a[192:195], v[64:67], 0
ds_read_b64_tr_b16 a[222:223], v161 offset:30720
v_mfma_f32_16x16x32_bf16 v[192:195], a[196:199], v[68:71], v[192:195]
ds_read_b64_tr_b16 a[224:225], v162 offset:0
v_mfma_f32_16x16x32_bf16 v[192:195], a[200:203], v[72:75], v[192:195]
ds_read_b64_tr_b16 a[226:227], v162 offset:2048
v_mfma_f32_16x16x32_bf16 v[192:195], a[204:207], v[76:79], v[192:195]
ds_read_b64_tr_b16 a[228:229], v162 offset:4096
v_mfma_f32_16x16x32_bf16 v[196:199], a[192:195], v[96:99], 0
ds_read_b64_tr_b16 a[230:231], v162 offset:6144
v_mfma_f32_16x16x32_bf16 v[196:199], a[196:199], v[100:103], v[196:199]
ds_read_b64_tr_b16 a[232:233], v162 offset:8192
v_cvt_pk_bf16_f32 v4, v224, v225
v_mfma_f32_16x16x32_bf16 v[196:199], a[200:203], v[104:107], v[196:199]
ds_read_b64_tr_b16 a[234:235], v162 offset:10240
v_cvt_pk_bf16_f32 v5, v226, v227
v_mfma_f32_16x16x32_bf16 v[196:199], a[204:207], v[108:111], v[196:199]
ds_read_b64_tr_b16 a[236:237], v162 offset:12288
s_waitcnt lgkmcnt(7)
v_mfma_f32_16x16x32_bf16 v[192:195], a[208:211], v[80:83], v[192:195]
ds_read_b64_tr_b16 a[238:239], v162 offset:14336
v_cvt_pk_bf16_f32 v6, v232, v233
v_mfma_f32_16x16x32_bf16 v[192:195], a[212:215], v[84:87], v[192:195]
ds_read_b64_tr_b16 a[240:241], v162 offset:16384
v_cvt_pk_bf16_f32 v7, v234, v235
v_mfma_f32_16x16x32_bf16 v[192:195], a[216:219], v[88:91], v[192:195]
ds_read_b64_tr_b16 a[242:243], v162 offset:18432
v_mfma_f32_16x16x32_bf16 v[192:195], a[220:223], v[92:95], v[192:195]
ds_read_b64_tr_b16 a[244:245], v162 offset:20480
v_mfma_f32_16x16x32_bf16 v[196:199], a[208:211], v[112:115], v[196:199]
ds_read_b64_tr_b16 a[246:247], v162 offset:22528
v_mfma_f32_16x16x32_bf16 v[196:199], a[212:215], v[116:119], v[196:199]
ds_read_b64_tr_b16 a[248:249], v162 offset:24576
v_mfma_f32_16x16x32_bf16 v[196:199], a[216:219], v[120:123], v[196:199]
ds_read_b64_tr_b16 a[250:251], v162 offset:26624
v_mfma_f32_16x16x32_bf16 v[196:199], a[220:223], v[124:127], v[196:199]
ds_read_b64_tr_b16 a[252:253], v162 offset:28672
s_waitcnt lgkmcnt(7)
v_mfma_f32_16x16x32_bf16 v[200:203], a[224:227], v[64:67], 0
ds_read_b64_tr_b16 a[254:255], v162 offset:30720
buffer_store_dwordx4 v[4:7], v16, s[12:15], s46 offen offset:0 sc0 sc1
v_mfma_f32_16x16x32_bf16 v[200:203], a[228:231], v[68:71], v[200:203]
ds_read_b64_tr_b16 a[192:193], v163 offset:0
v_cvt_pk_bf16_f32 v8, v240, v241
v_mfma_f32_16x16x32_bf16 v[200:203], a[232:235], v[72:75], v[200:203]
ds_read_b64_tr_b16 a[194:195], v163 offset:2048
v_cvt_pk_bf16_f32 v9, v242, v243
v_mfma_f32_16x16x32_bf16 v[200:203], a[236:239], v[76:79], v[200:203]
ds_read_b64_tr_b16 a[196:197], v163 offset:4096
v_cvt_pk_bf16_f32 v10, v248, v249
v_mfma_f32_16x16x32_bf16 v[204:207], a[224:227], v[96:99], 0
ds_read_b64_tr_b16 a[198:199], v163 offset:6144
v_cvt_pk_bf16_f32 v11, v250, v251
v_mfma_f32_16x16x32_bf16 v[204:207], a[228:231], v[100:103], v[204:207]
ds_read_b64_tr_b16 a[200:201], v163 offset:8192
v_mfma_f32_16x16x32_bf16 v[204:207], a[232:235], v[104:107], v[204:207]
ds_read_b64_tr_b16 a[202:203], v163 offset:10240
v_mfma_f32_16x16x32_bf16 v[204:207], a[236:239], v[108:111], v[204:207]
ds_read_b64_tr_b16 a[204:205], v163 offset:12288
s_waitcnt lgkmcnt(7)
v_mfma_f32_16x16x32_bf16 v[200:203], a[240:243], v[80:83], v[200:203]
ds_read_b64_tr_b16 a[206:207], v163 offset:14336
v_mfma_f32_16x16x32_bf16 v[200:203], a[244:247], v[84:87], v[200:203]
ds_read_b64_tr_b16 a[208:209], v163 offset:16384
v_mfma_f32_16x16x32_bf16 v[200:203], a[248:251], v[88:91], v[200:203]
ds_read_b64_tr_b16 a[210:211], v163 offset:18432
v_mfma_f32_16x16x32_bf16 v[200:203], a[252:255], v[92:95], v[200:203]
ds_read_b64_tr_b16 a[212:213], v163 offset:20480
v_mfma_f32_16x16x32_bf16 v[204:207], a[240:243], v[112:115], v[204:207]
ds_read_b64_tr_b16 a[214:215], v163 offset:22528
v_mfma_f32_16x16x32_bf16 v[204:207], a[244:247], v[116:119], v[204:207]
ds_read_b64_tr_b16 a[216:217], v163 offset:24576
buffer_store_dwordx4 v[8:11], v16, s[12:15], s46 offen offset:1024 sc0 sc1
v_mfma_f32_16x16x32_bf16 v[204:207], a[248:251], v[120:123], v[204:207]
ds_read_b64_tr_b16 a[218:219], v163 offset:26624
v_cvt_pk_bf16_f32 v12, v228, v229
v_mfma_f32_16x16x32_bf16 v[204:207], a[252:255], v[124:127], v[204:207]
ds_read_b64_tr_b16 a[220:221], v163 offset:28672
s_waitcnt lgkmcnt(7)
v_mfma_f32_16x16x32_bf16 v[208:211], a[192:195], v[64:67], 0
ds_read_b64_tr_b16 a[222:223], v163 offset:30720
v_cvt_pk_bf16_f32 v13, v230, v231
v_mfma_f32_16x16x32_bf16 v[208:211], a[196:199], v[68:71], v[208:211]
ds_read_b64_tr_b16 a[224:225], v164 offset:0
v_cvt_pk_bf16_f32 v14, v236, v237
v_mfma_f32_16x16x32_bf16 v[208:211], a[200:203], v[72:75], v[208:211]
ds_read_b64_tr_b16 a[226:227], v164 offset:2048
v_cvt_pk_bf16_f32 v15, v238, v239
v_mfma_f32_16x16x32_bf16 v[208:211], a[204:207], v[76:79], v[208:211]
ds_read_b64_tr_b16 a[228:229], v164 offset:4096
v_mfma_f32_16x16x32_bf16 v[212:215], a[192:195], v[96:99], 0
ds_read_b64_tr_b16 a[230:231], v164 offset:6144
v_mfma_f32_16x16x32_bf16 v[212:215], a[196:199], v[100:103], v[212:215]
ds_read_b64_tr_b16 a[232:233], v164 offset:8192
v_mfma_f32_16x16x32_bf16 v[212:215], a[200:203], v[104:107], v[212:215]
ds_read_b64_tr_b16 a[234:235], v164 offset:10240
v_mfma_f32_16x16x32_bf16 v[212:215], a[204:207], v[108:111], v[212:215]
ds_read_b64_tr_b16 a[236:237], v164 offset:12288
s_waitcnt lgkmcnt(7)
v_mfma_f32_16x16x32_bf16 v[208:211], a[208:211], v[80:83], v[208:211]
ds_read_b64_tr_b16 a[238:239], v164 offset:14336
v_mfma_f32_16x16x32_bf16 v[208:211], a[212:215], v[84:87], v[208:211]
ds_read_b64_tr_b16 a[240:241], v164 offset:16384
v_mfma_f32_16x16x32_bf16 v[208:211], a[216:219], v[88:91], v[208:211]
ds_read_b64_tr_b16 a[242:243], v164 offset:18432
v_mfma_f32_16x16x32_bf16 v[208:211], a[220:223], v[92:95], v[208:211]
ds_read_b64_tr_b16 a[244:245], v164 offset:20480
buffer_store_dwordx4 v[12:15], v58, s[12:15], s46 offen offset:0 sc0 sc1
v_mfma_f32_16x16x32_bf16 v[212:215], a[208:211], v[112:115], v[212:215]
ds_read_b64_tr_b16 a[246:247], v164 offset:22528
v_cvt_pk_bf16_f32 v28, v244, v245
v_mfma_f32_16x16x32_bf16 v[212:215], a[212:215], v[116:119], v[212:215]
ds_read_b64_tr_b16 a[248:249], v164 offset:24576
v_cvt_pk_bf16_f32 v29, v246, v247
v_mfma_f32_16x16x32_bf16 v[212:215], a[216:219], v[120:123], v[212:215]
ds_read_b64_tr_b16 a[250:251], v164 offset:26624
v_cvt_pk_bf16_f32 v30, v252, v253
v_mfma_f32_16x16x32_bf16 v[212:215], a[220:223], v[124:127], v[212:215]
ds_read_b64_tr_b16 a[252:253], v164 offset:28672
s_waitcnt lgkmcnt(7)
v_mfma_f32_16x16x32_bf16 v[216:219], a[224:227], v[64:67], 0
ds_read_b64_tr_b16 a[254:255], v164 offset:30720
v_cvt_pk_bf16_f32 v31, v254, v255
v_mfma_f32_16x16x32_bf16 v[216:219], a[228:231], v[68:71], v[216:219]
v_mfma_f32_16x16x32_bf16 v[216:219], a[232:235], v[72:75], v[216:219]
buffer_store_dwordx4 v[28:31], v58, s[12:15], s46 offen offset:1024 sc0 sc1
v_mfma_f32_16x16x32_bf16 v[216:219], a[236:239], v[76:79], v[216:219]
s_add_u32 s46, s46, 2048
v_mfma_f32_16x16x32_bf16 v[220:223], a[224:227], v[96:99], 0
v_mfma_f32_16x16x32_bf16 v[220:223], a[228:231], v[100:103], v[220:223]
v_mfma_f32_16x16x32_bf16 v[220:223], a[232:235], v[104:107], v[220:223]
v_mfma_f32_16x16x32_bf16 v[220:223], a[236:239], v[108:111], v[220:223]
s_waitcnt lgkmcnt(0)
v_mfma_f32_16x16x32_bf16 v[216:219], a[240:243], v[80:83], v[216:219]
v_mfma_f32_16x16x32_bf16 v[216:219], a[244:247], v[84:87], v[216:219]
v_mfma_f32_16x16x32_bf16 v[216:219], a[248:251], v[88:91], v[216:219]
v_mfma_f32_16x16x32_bf16 v[216:219], a[252:255], v[92:95], v[216:219]
v_mfma_f32_16x16x32_bf16 v[220:223], a[240:243], v[112:115], v[220:223]
v_mfma_f32_16x16x32_bf16 v[220:223], a[244:247], v[116:119], v[220:223]
v_mfma_f32_16x16x32_bf16 v[220:223], a[248:251], v[120:123], v[220:223]
v_mfma_f32_16x16x32_bf16 v[220:223], a[252:255], v[124:127], v[220:223]
s_nop 7
v_cvt_pk_bf16_f32 v4, v192, v193
v_cvt_pk_bf16_f32 v5, v194, v195
v_cvt_pk_bf16_f32 v6, v200, v201
v_cvt_pk_bf16_f32 v7, v202, v203
buffer_store_dwordx4 v[4:7], v16, s[12:15], s46 offen offset:0 sc0 sc1
v_cvt_pk_bf16_f32 v8, v208, v209
v_cvt_pk_bf16_f32 v9, v210, v211
v_cvt_pk_bf16_f32 v10, v216, v217
v_cvt_pk_bf16_f32 v11, v218, v219
buffer_store_dwordx4 v[8:11], v16, s[12:15], s46 offen offset:1024 sc0 sc1
v_cvt_pk_bf16_f32 v12, v196, v197
v_cvt_pk_bf16_f32 v13, v198, v199
v_cvt_pk_bf16_f32 v14, v204, v205
v_cvt_pk_bf16_f32 v15, v206, v207
buffer_store_dwordx4 v[12:15], v58, s[12:15], s46 offen offset:0 sc0 sc1
v_cvt_pk_bf16_f32 v28, v212, v213
v_cvt_pk_bf16_f32 v29, v214, v215
v_cvt_pk_bf16_f32 v30, v220, v221
v_cvt_pk_bf16_f32 v31, v222, v223
buffer_store_dwordx4 v[28:31], v58, s[12:15], s46 offen offset:1024 sc0 sc1
s_add_u32 s46, s46, 2048
s_cmp_eq_u32 s59, 0
s_cbranch_scc1 mega_kernel_end
s_waitcnt vmcnt(9) lgkmcnt(0)
s_mov_b32 s22, 1109393408
s_mov_b32 s62, 65536
mega_kernel_anext:
v_mov_b32 v224, 0
v_mov_b32 v225, 0
v_mov_b32 v226, 0
v_mov_b32 v227, 0
v_mov_b32 v228, 0
v_mov_b32 v229, 0
v_mov_b32 v230, 0
v_mov_b32 v231, 0
v_mov_b32 v232, 0
v_mov_b32 v233, 0
v_mov_b32 v234, 0
v_mov_b32 v235, 0
v_mov_b32 v236, 0
v_mov_b32 v237, 0
v_mov_b32 v238, 0
v_mov_b32 v239, 0
v_mov_b32 v240, 0
v_mov_b32 v241, 0
v_mov_b32 v242, 0
v_mov_b32 v243, 0
v_mov_b32 v244, 0
v_mov_b32 v245, 0
v_mov_b32 v246, 0
v_mov_b32 v247, 0
v_mov_b32 v248, 0
v_mov_b32 v249, 0
v_mov_b32 v250, 0
v_mov_b32 v251, 0
v_mov_b32 v252, 0
v_mov_b32 v253, 0
v_mov_b32 v254, 0
v_mov_b32 v255, 0
s_add_u32 s75, s75, 8192
v_mfma_f32_32x32x16_bf16 v[64:79], a[0:3], a[128:131], 0
v_mfma_f32_32x32x16_bf16 v[80:95], a[0:3], a[136:139], 0
v_mfma_f32_32x32x16_bf16 v[64:79], a[4:7], a[132:135], v[64:79]
v_mfma_f32_32x32x16_bf16 v[80:95], a[4:7], a[140:143], v[80:95]
s_nop 0
v_mfma_f32_32x32x16_bf16 v[96:111], a[8:11], a[128:131], 0
v_mfma_f32_32x32x16_bf16 v[112:127], a[8:11], a[136:139], 0
v_mfma_f32_32x32x16_bf16 v[96:111], a[12:15], a[132:135], v[96:111]
v_mfma_f32_32x32x16_bf16 v[112:127], a[12:15], a[140:143], v[112:127]
buffer_load_dwordx4 a[0:3], v16, s[64:67], s72 offen offset:0 sc1
buffer_load_dwordx4 a[4:7], v16, s[64:67], s72 offen offset:1024 sc1
buffer_load_dwordx4 a[8:11], v16, s[64:67], s72 offen offset:2048 sc1
buffer_load_dwordx4 a[12:15], v16, s[64:67], s72 offen offset:3072 sc1
s_add_u32 s72, s72, 4096
buffer_load_dwordx4 a[112:115], v16, s[68:71], s73 offen offset:0 sc1
buffer_load_dwordx4 a[116:119], v16, s[68:71], s73 offen offset:1024 sc1
buffer_load_dwordx4 a[120:123], v16, s[68:71], s73 offen offset:2048 sc1
buffer_load_dwordx4 a[124:127], v16, s[68:71], s73 offen offset:3072 sc1
s_add_u32 s73, s73, 4096
s_nop 7
v_max3_f32 v21, v64, v65, v66
v_max3_f32 v22, v80, v81, v82
v_max3_f32 v24, v96, v97, v98
v_max3_f32 v25, v112, v113, v114
v_max3_f32 v21, v67, v68, v21
v_max3_f32 v22, v83, v84, v22
v_max3_f32 v24, v99, v100, v24
v_max3_f32 v25, v115, v116, v25
v_max3_f32 v21, v69, v70, v21
v_max3_f32 v22, v85, v86, v22
v_max3_f32 v24, v101, v102, v24
v_max3_f32 v25, v117, v118, v25
v_max3_f32 v21, v71, v72, v21
v_max3_f32 v22, v87, v88, v22
v_max3_f32 v24, v103, v104, v24
v_max3_f32 v25, v119, v120, v25
v_max3_f32 v21, v73, v74, v21
v_max3_f32 v22, v89, v90, v22
v_max3_f32 v24, v105, v106, v24
v_max3_f32 v25, v121, v122, v25
v_max3_f32 v21, v75, v76, v21
v_max3_f32 v22, v91, v92, v22
v_max3_f32 v24, v107, v108, v24
v_max3_f32 v25, v123, v124, v25
v_max3_f32 v21, v77, v78, v21
v_max3_f32 v22, v93, v94, v22
v_max3_f32 v24, v109, v110, v24
v_max3_f32 v25, v125, v126, v25
v_max3_f32 v24, v79, v111, v24
v_max3_f32 v25, v95, v127, v25
v_max_f32 v21, v21, v24
v_max_f32 v22, v22, v25
v_mov_b32 v2, v21
s_nop 1
v_permlane32_swap_b32 v2, v21
s_nop 1
v_max_f32 v21, v21, v2
v_sub_f32 v32, 0, v21
v_sub_f32 v33, 0, v21
v_sub_f32 v34, 0, v21
v_sub_f32 v35, 0, v21
v_sub_f32 v36, 0, v21
v_sub_f32 v37, 0, v21
v_sub_f32 v38, 0, v21
v_sub_f32 v39, 0, v21
v_sub_f32 v40, 0, v21
v_sub_f32 v41, 0, v21
v_sub_f32 v42, 0, v21
v_sub_f32 v43, 0, v21
v_sub_f32 v44, 0, v21
v_sub_f32 v45, 0, v21
v_sub_f32 v46, 0, v21
v_sub_f32 v47, 0, v21
v_sub_f32 v64, v64, v21
v_sub_f32 v65, v65, v21
v_sub_f32 v66, v66, v21
v_sub_f32 v67, v67, v21
v_sub_f32 v68, v68, v21
v_sub_f32 v69, v69, v21
v_sub_f32 v70, v70, v21
v_sub_f32 v71, v71, v21
v_sub_f32 v72, v72, v21
v_sub_f32 v73, v73, v21
v_sub_f32 v74, v74, v21
v_sub_f32 v75, v75, v21
v_sub_f32 v76, v76, v21
v_sub_f32 v77, v77, v21
v_sub_f32 v78, v78, v21
v_sub_f32 v79, v79, v21
v_sub_f32 v96, v96, v21
v_sub_f32 v97, v97, v21
v_sub_f32 v98, v98, v21
v_sub_f32 v99, v99, v21
v_sub_f32 v100, v100, v21
v_sub_f32 v101, v101, v21
v_sub_f32 v102, v102, v21
v_sub_f32 v103, v103, v21
v_sub_f32 v104, v104, v21
v_sub_f32 v105, v105, v21
v_sub_f32 v106, v106, v21
v_sub_f32 v107, v107, v21
v_sub_f32 v108, v108, v21
v_sub_f32 v109, v109, v21
v_sub_f32 v110, v110, v21
v_sub_f32 v111, v111, v21
v_mov_b32 v2, v22
s_nop 1
v_permlane32_swap_b32 v2, v22
s_nop 1
v_max_f32 v22, v22, v2
v_sub_f32 v48, 0, v22
v_sub_f32 v49, 0, v22
v_sub_f32 v50, 0, v22
v_sub_f32 v51, 0, v22
v_sub_f32 v52, 0, v22
v_sub_f32 v53, 0, v22
v_sub_f32 v54, 0, v22
v_sub_f32 v55, 0, v22
v_sub_f32 v56, 0, v22
v_sub_f32 v57, 0, v22
v_sub_f32 v58, 0, v22
v_sub_f32 v59, 0, v22
v_sub_f32 v60, 0, v22
v_sub_f32 v61, 0, v22
v_sub_f32 v62, 0, v22
v_sub_f32 v63, 0, v22
v_sub_f32 v80, v80, v22
v_sub_f32 v81, v81, v22
v_sub_f32 v82, v82, v22
v_sub_f32 v83, v83, v22
v_sub_f32 v84, v84, v22
v_sub_f32 v85, v85, v22
v_sub_f32 v86, v86, v22
v_sub_f32 v87, v87, v22
v_sub_f32 v88, v88, v22
v_sub_f32 v89, v89, v22
v_sub_f32 v90, v90, v22
v_sub_f32 v91, v91, v22
v_sub_f32 v92, v92, v22
v_sub_f32 v93, v93, v22
v_sub_f32 v94, v94, v22
v_sub_f32 v95, v95, v22
v_sub_f32 v112, v112, v22
v_sub_f32 v113, v113, v22
v_sub_f32 v114, v114, v22
v_sub_f32 v115, v115, v22
v_sub_f32 v116, v116, v22
v_sub_f32 v117, v117, v22
v_sub_f32 v118, v118, v22
v_sub_f32 v119, v119, v22
v_sub_f32 v120, v120, v22
v_sub_f32 v121, v121, v22
v_sub_f32 v122, v122, v22
v_sub_f32 v123, v123, v22
v_sub_f32 v124, v124, v22
v_sub_f32 v125, v125, v22
v_sub_f32 v126, v126, v22
v_sub_f32 v127, v127, v22
s_nop 1
s_mov_b32 s19, 0
.p2align 6
mega_kernelA_loop:
v_exp_f32 v64, v64
v_exp_f32 v65, v65
s_waitcnt vmcnt(28)
v_mfma_f32_32x32x16_bf16 v[128:143], a[16:19], a[128:131], v[32:47]
v_exp_f32 v66, v66
v_exp_f32 v67, v67
v_exp_f32 v68, v68
v_exp_f32 v69, v69
v_cvt_pk_bf16_f32 v192, v64, v65
v_mfma_f32_32x32x16_bf16 v[144:159], a[16:19], a[136:139], v[48:63]
v_exp_f32 v70, v70
v_exp_f32 v71, v71
v_cvt_pk_bf16_f32 v193, v66, v67
v_exp_f32 v72, v72
v_exp_f32 v73, v73
v_mfma_f32_32x32x16_bf16 v[128:143], a[20:23], a[132:135], v[128:143]
v_cvt_pk_bf16_f32 v194, v68, v69
v_exp_f32 v74, v74
v_exp_f32 v75, v75
v_cvt_pk_bf16_f32 v195, v70, v71
v_exp_f32 v76, v76
v_mfma_f32_32x32x16_bf16 v[144:159], a[20:23], a[140:143], v[144:159]
v_exp_f32 v77, v77
v_cvt_pk_bf16_f32 v196, v72, v73
v_exp_f32 v78, v78
v_exp_f32 v79, v79
v_cvt_pk_bf16_f32 v197, v74, v75
v_mfma_f32_32x32x16_bf16 v[160:175], a[24:27], a[128:131], v[32:47]
v_exp_f32 v80, v80
v_exp_f32 v81, v81
v_cvt_pk_bf16_f32 v198, v76, v77
v_exp_f32 v82, v82
v_exp_f32 v83, v83
v_mfma_f32_32x32x16_bf16 v[176:191], a[24:27], a[136:139], v[48:63]
v_cvt_pk_bf16_f32 v199, v78, v79
v_exp_f32 v84, v84
v_exp_f32 v85, v85
v_cvt_pk_bf16_f32 v200, v80, v81
v_exp_f32 v86, v86
v_mfma_f32_32x32x16_bf16 v[160:175], a[28:31], a[132:135], v[160:175]
v_exp_f32 v87, v87
v_cvt_pk_bf16_f32 v201, v82, v83
v_exp_f32 v88, v88
v_exp_f32 v89, v89
v_cvt_pk_bf16_f32 v202, v84, v85
v_mfma_f32_32x32x16_bf16 v[176:191], a[28:31], a[140:143], v[176:191]
v_exp_f32 v90, v90
v_exp_f32 v91, v91
v_cvt_pk_bf16_f32 v203, v86, v87
v_exp_f32 v92, v92
v_exp_f32 v93, v93
v_cvt_pk_bf16_f32 v204, v88, v89
s_waitcnt vmcnt(24)
v_mfma_f32_32x32x16_bf16 v[224:239], a[64:67], v[192:195], v[224:239]
buffer_load_dwordx4 a[16:19], v16, s[64:67], s72 offen offset:0 sc1
v_exp_f32 v94, v94
v_exp_f32 v95, v95
v_cvt_pk_bf16_f32 v205, v90, v91
v_exp_f32 v96, v96
v_exp_f32 v97, v97
v_cvt_pk_bf16_f32 v206, v92, v93
v_mfma_f32_32x32x16_bf16 v[224:239], a[68:71], v[196:199], v[224:239]
buffer_load_dwordx4 a[20:23], v16, s[64:67], s72 offen offset:1024 sc1
v_exp_f32 v98, v98
v_exp_f32 v99, v99
v_cvt_pk_bf16_f32 v207, v94, v95
v_exp_f32 v100, v100
v_exp_f32 v101, v101
v_cvt_pk_bf16_f32 v208, v96, v97
v_mfma_f32_32x32x16_bf16 v[240:255], a[64:67], v[200:203], v[240:255]
buffer_load_dwordx4 a[24:27], v16, s[64:67], s72 offen offset:2048 sc1
v_exp_f32 v102, v102
v_exp_f32 v103, v103
v_cvt_pk_bf16_f32 v209, v98, v99
v_exp_f32 v104, v104
v_exp_f32 v105, v105
v_cvt_pk_bf16_f32 v210, v100, v101
v_mfma_f32_32x32x16_bf16 v[240:255], a[68:71], v[204:207], v[240:255]
buffer_load_dwordx4 a[28:31], v16, s[64:67], s72 offen offset:3072 sc1
s_add_u32 s72, s72, 4096
v_exp_f32 v106, v106
v_exp_f32 v107, v107
v_cvt_pk_bf16_f32 v211, v102, v103
v_exp_f32 v108, v108
v_exp_f32 v109, v109
v_cvt_pk_bf16_f32 v212, v104, v105
v_exp_f32 v110, v110
v_exp_f32 v111, v111
v_cvt_pk_bf16_f32 v213, v106, v107
v_exp_f32 v112, v112
v_exp_f32 v113, v113
v_cvt_pk_bf16_f32 v214, v108, v109
v_exp_f32 v114, v114
v_exp_f32 v115, v115
v_cvt_pk_bf16_f32 v215, v110, v111
v_exp_f32 v116, v116
v_exp_f32 v117, v117
v_mfma_f32_32x32x16_bf16 v[224:239], a[72:75], v[208:211], v[224:239]
buffer_load_dwordx4 a[64:67], v16, s[68:71], s73 offen offset:0 sc1
v_cvt_pk_bf16_f32 v216, v112, v113
v_exp_f32 v118, v118
v_exp_f32 v119, v119
v_cvt_pk_bf16_f32 v217, v114, v115
v_exp_f32 v120, v120
v_exp_f32 v121, v121
v_mfma_f32_32x32x16_bf16 v[224:239], a[76:79], v[212:215], v[224:239]
buffer_load_dwordx4 a[68:71], v16, s[68:71], s73 offen offset:1024 sc1
v_cvt_pk_bf16_f32 v218, v116, v117
v_exp_f32 v122, v122
v_exp_f32 v123, v123
v_cvt_pk_bf16_f32 v219, v118, v119
v_exp_f32 v124, v124
v_exp_f32 v125, v125
v_cvt_pk_bf16_f32 v220, v120, v121
v_exp_f32 v126, v126
v_exp_f32 v127, v127
v_cvt_pk_bf16_f32 v221, v122, v123
v_max3_f32 v21, v128, v129, v130
v_max3_f32 v22, v144, v145, v146
v_cvt_pk_bf16_f32 v222, v124, v125
v_max3_f32 v24, v160, v161, v162
v_max3_f32 v25, v176, v177, v178
v_cvt_pk_bf16_f32 v223, v126, v127
v_max3_f32 v21, v131, v132, v21
v_max3_f32 v22, v147, v148, v22
v_max3_f32 v24, v163, v164, v24
v_max3_f32 v25, v179, v180, v25
v_max3_f32 v21, v133, v134, v21
v_max3_f32 v22, v149, v150, v22
v_max3_f32 v24, v165, v166, v24
v_max3_f32 v25, v181, v182, v25
v_max3_f32 v21, v135, v136, v21
v_max3_f32 v22, v151, v152, v22
v_max3_f32 v24, v167, v168, v24
v_max3_f32 v25, v183, v184, v25
v_max3_f32 v21, v137, v138, v21
v_max3_f32 v22, v153, v154, v22
v_max3_f32 v24, v169, v170, v24
v_max3_f32 v25, v185, v186, v25
v_max3_f32 v21, v139, v140, v21
v_max3_f32 v22, v155, v156, v22
v_max3_f32 v24, v171, v172, v24
v_max3_f32 v25, v187, v188, v25
v_max3_f32 v21, v141, v142, v21
v_max3_f32 v22, v157, v158, v22
v_max3_f32 v24, v173, v174, v24
v_mfma_f32_32x32x16_bf16 v[240:255], a[72:75], v[216:219], v[240:255]
v_max3_f32 v25, v189, v190, v25
v_max3_f32 v24, v143, v175, v24
v_max3_f32 v25, v159, v191, v25
v_max_f32 v21, v21, v24
v_max_f32 v22, v22, v25
v_max_f32 v23, v21, v22
v_cmp_lt_f32 vcc, s22, v23
v_mfma_f32_32x32x16_bf16 v[240:255], a[76:79], v[220:223], v[240:255]
buffer_load_dwordx4 a[72:75], v16, s[68:71], s73 offen offset:2048 sc1
buffer_load_dwordx4 a[76:79], v16, s[68:71], s73 offen offset:3072 sc1
s_add_u32 s73, s73, 4096
s_cbranch_vccnz mega_kernelA_u0_rs
mega_kernelA_u0_rsret:
v_exp_f32 v128, v128
v_exp_f32 v129, v129
s_waitcnt vmcnt(28)
v_mfma_f32_32x32x16_bf16 v[64:79], a[32:35], a[128:131], v[32:47]
v_exp_f32 v130, v130
v_exp_f32 v131, v131
v_exp_f32 v132, v132
v_exp_f32 v133, v133
v_cvt_pk_bf16_f32 v192, v128, v129
v_mfma_f32_32x32x16_bf16 v[80:95], a[32:35], a[136:139], v[48:63]
v_exp_f32 v134, v134
v_exp_f32 v135, v135
v_cvt_pk_bf16_f32 v193, v130, v131
v_exp_f32 v136, v136
v_exp_f32 v137, v137
v_mfma_f32_32x32x16_bf16 v[64:79], a[36:39], a[132:135], v[64:79]
v_cvt_pk_bf16_f32 v194, v132, v133
v_exp_f32 v138, v138
v_exp_f32 v139, v139
v_cvt_pk_bf16_f32 v195, v134, v135
v_exp_f32 v140, v140
v_mfma_f32_32x32x16_bf16 v[80:95], a[36:39], a[140:143], v[80:95]
v_exp_f32 v141, v141
v_cvt_pk_bf16_f32 v196, v136, v137
v_exp_f32 v142, v142
v_exp_f32 v143, v143
v_cvt_pk_bf16_f32 v197, v138, v139
v_mfma_f32_32x32x16_bf16 v[96:111], a[40:43], a[128:131], v[32:47]
v_exp_f32 v144, v144
v_exp_f32 v145, v145
v_cvt_pk_bf16_f32 v198, v140, v141
v_exp_f32 v146, v146
v_exp_f32 v147, v147
v_mfma_f32_32x32x16_bf16 v[112:127], a[40:43], a[136:139], v[48:63]
v_cvt_pk_bf16_f32 v199, v142, v143
v_exp_f32 v148, v148
v_exp_f32 v149, v149
v_cvt_pk_bf16_f32 v200, v144, v145
v_exp_f32 v150, v150
v_mfma_f32_32x32x16_bf16 v[96:111], a[44:47], a[132:135], v[96:111]
v_exp_f32 v151, v151
v_cvt_pk_bf16_f32 v201, v146, v147
v_exp_f32 v152, v152
v_exp_f32 v153, v153
v_cvt_pk_bf16_f32 v202, v148, v149
v_mfma_f32_32x32x16_bf16 v[112:127], a[44:47], a[140:143], v[112:127]
v_exp_f32 v154, v154
v_exp_f32 v155, v155
v_cvt_pk_bf16_f32 v203, v150, v151
v_exp_f32 v156, v156
v_exp_f32 v157, v157
v_cvt_pk_bf16_f32 v204, v152, v153
s_waitcnt vmcnt(24)
v_mfma_f32_32x32x16_bf16 v[224:239], a[80:83], v[192:195], v[224:239]
buffer_load_dwordx4 a[32:35], v16, s[64:67], s72 offen offset:0 sc1
v_exp_f32 v158, v158
v_exp_f32 v159, v159
v_cvt_pk_bf16_f32 v205, v154, v155
v_exp_f32 v160, v160
v_exp_f32 v161, v161
v_cvt_pk_bf16_f32 v206, v156, v157
v_mfma_f32_32x32x16_bf16 v[224:239], a[84:87], v[196:199], v[224:239]
buffer_load_dwordx4 a[36:39], v16, s[64:67], s72 offen offset:1024 sc1
v_exp_f32 v162, v162
v_exp_f32 v163, v163
v_cvt_pk_bf16_f32 v207, v158, v159
v_exp_f32 v164, v164
v_exp_f32 v165, v165
v_cvt_pk_bf16_f32 v208, v160, v161
v_mfma_f32_32x32x16_bf16 v[240:255], a[80:83], v[200:203], v[240:255]
buffer_load_dwordx4 a[40:43], v16, s[64:67], s72 offen offset:2048 sc1
v_exp_f32 v166, v166
v_exp_f32 v167, v167
v_cvt_pk_bf16_f32 v209, v162, v163
v_exp_f32 v168, v168
v_exp_f32 v169, v169
v_cvt_pk_bf16_f32 v210, v164, v165
v_mfma_f32_32x32x16_bf16 v[240:255], a[84:87], v[204:207], v[240:255]
buffer_load_dwordx4 a[44:47], v16, s[64:67], s72 offen offset:3072 sc1
s_add_u32 s72, s72, 4096
v_exp_f32 v170, v170
v_exp_f32 v171, v171
v_cvt_pk_bf16_f32 v211, v166, v167
v_exp_f32 v172, v172
v_exp_f32 v173, v173
v_cvt_pk_bf16_f32 v212, v168, v169
v_exp_f32 v174, v174
v_exp_f32 v175, v175
v_cvt_pk_bf16_f32 v213, v170, v171
v_exp_f32 v176, v176
v_exp_f32 v177, v177
v_cvt_pk_bf16_f32 v214, v172, v173
v_exp_f32 v178, v178
v_exp_f32 v179, v179
v_cvt_pk_bf16_f32 v215, v174, v175
v_exp_f32 v180, v180
v_exp_f32 v181, v181
v_mfma_f32_32x32x16_bf16 v[224:239], a[88:91], v[208:211], v[224:239]
buffer_load_dwordx4 a[80:83], v16, s[68:71], s73 offen offset:0 sc1
v_cvt_pk_bf16_f32 v216, v176, v177
v_exp_f32 v182, v182
v_exp_f32 v183, v183
v_cvt_pk_bf16_f32 v217, v178, v179
v_exp_f32 v184, v184
v_exp_f32 v185, v185
v_mfma_f32_32x32x16_bf16 v[224:239], a[92:95], v[212:215], v[224:239]
buffer_load_dwordx4 a[84:87], v16, s[68:71], s73 offen offset:1024 sc1
v_cvt_pk_bf16_f32 v218, v180, v181
v_exp_f32 v186, v186
v_exp_f32 v187, v187
v_cvt_pk_bf16_f32 v219, v182, v183
v_exp_f32 v188, v188
v_exp_f32 v189, v189
v_cvt_pk_bf16_f32 v220, v184, v185
v_exp_f32 v190, v190
v_exp_f32 v191, v191
v_cvt_pk_bf16_f32 v221, v186, v187
v_max3_f32 v21, v64, v65, v66
v_max3_f32 v22, v80, v81, v82
v_cvt_pk_bf16_f32 v222, v188, v189
v_max3_f32 v24, v96, v97, v98
v_max3_f32 v25, v112, v113, v114
v_cvt_pk_bf16_f32 v223, v190, v191
v_max3_f32 v21, v67, v68, v21
v_max3_f32 v22, v83, v84, v22
v_max3_f32 v24, v99, v100, v24
v_max3_f32 v25, v115, v116, v25
v_max3_f32 v21, v69, v70, v21
v_max3_f32 v22, v85, v86, v22
v_max3_f32 v24, v101, v102, v24
v_max3_f32 v25, v117, v118, v25
v_max3_f32 v21, v71, v72, v21
v_max3_f32 v22, v87, v88, v22
v_max3_f32 v24, v103, v104, v24
v_max3_f32 v25, v119, v120, v25
v_max3_f32 v21, v73, v74, v21
v_max3_f32 v22, v89, v90, v22
v_max3_f32 v24, v105, v106, v24
v_max3_f32 v25, v121, v122, v25
v_max3_f32 v21, v75, v76, v21
v_max3_f32 v22, v91, v92, v22
v_max3_f32 v24, v107, v108, v24
v_max3_f32 v25, v123, v124, v25
v_max3_f32 v21, v77, v78, v21
v_max3_f32 v22, v93, v94, v22
v_max3_f32 v24, v109, v110, v24
v_mfma_f32_32x32x16_bf16 v[240:255], a[88:91], v[216:219], v[240:255]
v_max3_f32 v25, v125, v126, v25
v_max3_f32 v24, v79, v111, v24
v_max3_f32 v25, v95, v127, v25
v_max_f32 v21, v21, v24
v_max_f32 v22, v22, v25
v_max_f32 v23, v21, v22
v_cmp_lt_f32 vcc, s22, v23
v_mfma_f32_32x32x16_bf16 v[240:255], a[92:95], v[220:223], v[240:255]
buffer_load_dwordx4 a[88:91], v16, s[68:71], s73 offen offset:2048 sc1
buffer_load_dwordx4 a[92:95], v16, s[68:71], s73 offen offset:3072 sc1
s_add_u32 s73, s73, 4096
s_cbranch_vccnz mega_kernelA_u1_rs
mega_kernelA_u1_rsret:
v_exp_f32 v64, v64
v_exp_f32 v65, v65
s_waitcnt vmcnt(28)
v_mfma_f32_32x32x16_bf16 v[128:143], a[48:51], a[128:131], v[32:47]
v_exp_f32 v66, v66
v_exp_f32 v67, v67
v_exp_f32 v68, v68
v_exp_f32 v69, v69
v_cvt_pk_bf16_f32 v192, v64, v65
v_mfma_f32_32x32x16_bf16 v[144:159], a[48:51], a[136:139], v[48:63]
v_exp_f32 v70, v70
v_exp_f32 v71, v71
v_cvt_pk_bf16_f32 v193, v66, v67
v_exp_f32 v72, v72
v_exp_f32 v73, v73
v_mfma_f32_32x32x16_bf16 v[128:143], a[52:55], a[132:135], v[128:143]
v_cvt_pk_bf16_f32 v194, v68, v69
v_exp_f32 v74, v74
v_exp_f32 v75, v75
v_cvt_pk_bf16_f32 v195, v70, v71
v_exp_f32 v76, v76
v_mfma_f32_32x32x16_bf16 v[144:159], a[52:55], a[140:143], v[144:159]
v_exp_f32 v77, v77
v_cvt_pk_bf16_f32 v196, v72, v73
v_exp_f32 v78, v78
v_exp_f32 v79, v79
v_cvt_pk_bf16_f32 v197, v74, v75
v_mfma_f32_32x32x16_bf16 v[160:175], a[56:59], a[128:131], v[32:47]
v_exp_f32 v80, v80
v_exp_f32 v81, v81
v_cvt_pk_bf16_f32 v198, v76, v77
v_exp_f32 v82, v82
v_exp_f32 v83, v83
v_mfma_f32_32x32x16_bf16 v[176:191], a[56:59], a[136:139], v[48:63]
v_cvt_pk_bf16_f32 v199, v78, v79
v_exp_f32 v84, v84
v_exp_f32 v85, v85
v_cvt_pk_bf16_f32 v200, v80, v81
v_exp_f32 v86, v86
v_mfma_f32_32x32x16_bf16 v[160:175], a[60:63], a[132:135], v[160:175]
v_exp_f32 v87, v87
v_cvt_pk_bf16_f32 v201, v82, v83
v_exp_f32 v88, v88
v_exp_f32 v89, v89
v_cvt_pk_bf16_f32 v202, v84, v85
v_mfma_f32_32x32x16_bf16 v[176:191], a[60:63], a[140:143], v[176:191]
v_exp_f32 v90, v90
v_exp_f32 v91, v91
v_cvt_pk_bf16_f32 v203, v86, v87
v_exp_f32 v92, v92
v_exp_f32 v93, v93
v_cvt_pk_bf16_f32 v204, v88, v89
s_waitcnt vmcnt(24)
v_mfma_f32_32x32x16_bf16 v[224:239], a[96:99], v[192:195], v[224:239]
buffer_load_dwordx4 a[48:51], v16, s[64:67], s72 offen offset:0 sc1
v_exp_f32 v94, v94
v_exp_f32 v95, v95
v_cvt_pk_bf16_f32 v205, v90, v91
v_exp_f32 v96, v96
v_exp_f32 v97, v97
v_cvt_pk_bf16_f32 v206, v92, v93
v_mfma_f32_32x32x16_bf16 v[224:239], a[100:103], v[196:199], v[224:239]
buffer_load_dwordx4 a[52:55], v16, s[64:67], s72 offen offset:1024 sc1
v_exp_f32 v98, v98
v_exp_f32 v99, v99
v_cvt_pk_bf16_f32 v207, v94, v95
v_exp_f32 v100, v100
v_exp_f32 v101, v101
v_cvt_pk_bf16_f32 v208, v96, v97
v_mfma_f32_32x32x16_bf16 v[240:255], a[96:99], v[200:203], v[240:255]
buffer_load_dwordx4 a[56:59], v16, s[64:67], s72 offen offset:2048 sc1
v_exp_f32 v102, v102
v_exp_f32 v103, v103
v_cvt_pk_bf16_f32 v209, v98, v99
v_exp_f32 v104, v104
v_exp_f32 v105, v105
v_cvt_pk_bf16_f32 v210, v100, v101
v_mfma_f32_32x32x16_bf16 v[240:255], a[100:103], v[204:207], v[240:255]
buffer_load_dwordx4 a[60:63], v16, s[64:67], s72 offen offset:3072 sc1
s_add_u32 s72, s72, 4096
v_exp_f32 v106, v106
v_exp_f32 v107, v107
v_cvt_pk_bf16_f32 v211, v102, v103
v_exp_f32 v108, v108
v_exp_f32 v109, v109
v_cvt_pk_bf16_f32 v212, v104, v105
v_exp_f32 v110, v110
v_exp_f32 v111, v111
v_cvt_pk_bf16_f32 v213, v106, v107
v_exp_f32 v112, v112
v_exp_f32 v113, v113
v_cvt_pk_bf16_f32 v214, v108, v109
v_exp_f32 v114, v114
v_exp_f32 v115, v115
v_cvt_pk_bf16_f32 v215, v110, v111
v_exp_f32 v116, v116
v_exp_f32 v117, v117
v_mfma_f32_32x32x16_bf16 v[224:239], a[104:107], v[208:211], v[224:239]
buffer_load_dwordx4 a[96:99], v16, s[68:71], s73 offen offset:0 sc1
v_cvt_pk_bf16_f32 v216, v112, v113
v_exp_f32 v118, v118
v_exp_f32 v119, v119
v_cvt_pk_bf16_f32 v217, v114, v115
v_exp_f32 v120, v120
v_exp_f32 v121, v121
v_mfma_f32_32x32x16_bf16 v[224:239], a[108:111], v[212:215], v[224:239]
buffer_load_dwordx4 a[100:103], v16, s[68:71], s73 offen offset:1024 sc1
v_cvt_pk_bf16_f32 v218, v116, v117
v_exp_f32 v122, v122
v_exp_f32 v123, v123
v_cvt_pk_bf16_f32 v219, v118, v119
v_exp_f32 v124, v124
v_exp_f32 v125, v125
v_cvt_pk_bf16_f32 v220, v120, v121
v_exp_f32 v126, v126
v_exp_f32 v127, v127
v_cvt_pk_bf16_f32 v221, v122, v123
v_max3_f32 v21, v128, v129, v130
v_max3_f32 v22, v144, v145, v146
v_cvt_pk_bf16_f32 v222, v124, v125
v_max3_f32 v24, v160, v161, v162
v_max3_f32 v25, v176, v177, v178
v_cvt_pk_bf16_f32 v223, v126, v127
v_max3_f32 v21, v131, v132, v21
v_max3_f32 v22, v147, v148, v22
v_max3_f32 v24, v163, v164, v24
v_max3_f32 v25, v179, v180, v25
v_max3_f32 v21, v133, v134, v21
v_max3_f32 v22, v149, v150, v22
v_max3_f32 v24, v165, v166, v24
v_max3_f32 v25, v181, v182, v25
v_max3_f32 v21, v135, v136, v21
v_max3_f32 v22, v151, v152, v22
v_max3_f32 v24, v167, v168, v24
v_max3_f32 v25, v183, v184, v25
v_max3_f32 v21, v137, v138, v21
v_max3_f32 v22, v153, v154, v22
v_max3_f32 v24, v169, v170, v24
v_max3_f32 v25, v185, v186, v25
v_max3_f32 v21, v139, v140, v21
v_max3_f32 v22, v155, v156, v22
v_max3_f32 v24, v171, v172, v24
v_max3_f32 v25, v187, v188, v25
v_max3_f32 v21, v141, v142, v21
v_max3_f32 v22, v157, v158, v22
v_max3_f32 v24, v173, v174, v24
v_mfma_f32_32x32x16_bf16 v[240:255], a[104:107], v[216:219], v[240:255]
v_max3_f32 v25, v189, v190, v25
v_max3_f32 v24, v143, v175, v24
v_max3_f32 v25, v159, v191, v25
v_max_f32 v21, v21, v24
v_max_f32 v22, v22, v25
v_max_f32 v23, v21, v22
v_cmp_lt_f32 vcc, s22, v23
v_mfma_f32_32x32x16_bf16 v[240:255], a[108:111], v[220:223], v[240:255]
buffer_load_dwordx4 a[104:107], v16, s[68:71], s73 offen offset:2048 sc1
buffer_load_dwordx4 a[108:111], v16, s[68:71], s73 offen offset:3072 sc1
s_add_u32 s73, s73, 4096
s_cbranch_vccnz mega_kernelA_u2_rs
mega_kernelA_u2_rsret:
s_cmp_eq_u32 s19, 1
s_cbranch_scc1 mega_kernel_psig
mega_kernel_psigr:
s_and_b32 s72, s72, 0xffff
s_cmp_eq_u32 s19, 3
s_cbranch_scc1 mega_kernelA_tail
v_exp_f32 v128, v128
v_exp_f32 v129, v129
s_waitcnt vmcnt(28)
v_mfma_f32_32x32x16_bf16 v[64:79], a[0:3], a[128:131], v[32:47]
v_exp_f32 v130, v130
v_exp_f32 v131, v131
v_exp_f32 v132, v132
v_exp_f32 v133, v133
v_cvt_pk_bf16_f32 v192, v128, v129
v_mfma_f32_32x32x16_bf16 v[80:95], a[0:3], a[136:139], v[48:63]
v_exp_f32 v134, v134
v_exp_f32 v135, v135
v_cvt_pk_bf16_f32 v193, v130, v131
v_exp_f32 v136, v136
v_exp_f32 v137, v137
v_mfma_f32_32x32x16_bf16 v[64:79], a[4:7], a[132:135], v[64:79]
v_cvt_pk_bf16_f32 v194, v132, v133
v_exp_f32 v138, v138
v_exp_f32 v139, v139
v_cvt_pk_bf16_f32 v195, v134, v135
v_exp_f32 v140, v140
v_mfma_f32_32x32x16_bf16 v[80:95], a[4:7], a[140:143], v[80:95]
v_exp_f32 v141, v141
v_cvt_pk_bf16_f32 v196, v136, v137
v_exp_f32 v142, v142
v_exp_f32 v143, v143
v_cvt_pk_bf16_f32 v197, v138, v139
v_mfma_f32_32x32x16_bf16 v[96:111], a[8:11], a[128:131], v[32:47]
v_exp_f32 v144, v144
v_exp_f32 v145, v145
v_cvt_pk_bf16_f32 v198, v140, v141
v_exp_f32 v146, v146
v_exp_f32 v147, v147
v_mfma_f32_32x32x16_bf16 v[112:127], a[8:11], a[136:139], v[48:63]
v_cvt_pk_bf16_f32 v199, v142, v143
v_exp_f32 v148, v148
v_exp_f32 v149, v149
v_cvt_pk_bf16_f32 v200, v144, v145
v_exp_f32 v150, v150
v_mfma_f32_32x32x16_bf16 v[96:111], a[12:15], a[132:135], v[96:111]
v_exp_f32 v151, v151
v_cvt_pk_bf16_f32 v201, v146, v147
v_exp_f32 v152, v152
v_exp_f32 v153, v153
v_cvt_pk_bf16_f32 v202, v148, v149
v_mfma_f32_32x32x16_bf16 v[112:127], a[12:15], a[140:143], v[112:127]
v_exp_f32 v154, v154
v_exp_f32 v155, v155
v_cvt_pk_bf16_f32 v203, v150, v151
v_exp_f32 v156, v156
v_exp_f32 v157, v157
v_cvt_pk_bf16_f32 v204, v152, v153
s_waitcnt vmcnt(24)
v_mfma_f32_32x32x16_bf16 v[224:239], a[112:115], v[192:195], v[224:239]
buffer_load_dwordx4 a[0:3], v16, s[64:67], s72 offen offset:0 sc1
v_exp_f32 v158, v158
v_exp_f32 v159, v159
v_cvt_pk_bf16_f32 v205, v154, v155
v_exp_f32 v160, v160
v_exp_f32 v161, v161
v_cvt_pk_bf16_f32 v206, v156, v157
v_mfma_f32_32x32x16_bf16 v[224:239], a[116:119], v[196:199], v[224:239]
buffer_load_dwordx4 a[4:7], v16, s[64:67], s72 offen offset:1024 sc1
v_exp_f32 v162, v162
v_exp_f32 v163, v163
v_cvt_pk_bf16_f32 v207, v158, v159
v_exp_f32 v164, v164
v_exp_f32 v165, v165
v_cvt_pk_bf16_f32 v208, v160, v161
v_mfma_f32_32x32x16_bf16 v[240:255], a[112:115], v[200:203], v[240:255]
buffer_load_dwordx4 a[8:11], v16, s[64:67], s72 offen offset:2048 sc1
v_exp_f32 v166, v166
v_exp_f32 v167, v167
v_cvt_pk_bf16_f32 v209, v162, v163
v_exp_f32 v168, v168
v_exp_f32 v169, v169
v_cvt_pk_bf16_f32 v210, v164, v165
v_mfma_f32_32x32x16_bf16 v[240:255], a[116:119], v[204:207], v[240:255]
buffer_load_dwordx4 a[12:15], v16, s[64:67], s72 offen offset:3072 sc1
s_add_u32 s72, s72, 4096
v_exp_f32 v170, v170
v_exp_f32 v171, v171
v_cvt_pk_bf16_f32 v211, v166, v167
v_exp_f32 v172, v172
v_exp_f32 v173, v173
v_cvt_pk_bf16_f32 v212, v168, v169
v_exp_f32 v174, v174
v_exp_f32 v175, v175
v_cvt_pk_bf16_f32 v213, v170, v171
v_exp_f32 v176, v176
v_exp_f32 v177, v177
v_cvt_pk_bf16_f32 v214, v172, v173
v_exp_f32 v178, v178
v_exp_f32 v179, v179
v_cvt_pk_bf16_f32 v215, v174, v175
v_exp_f32 v180, v180
v_exp_f32 v181, v181
v_mfma_f32_32x32x16_bf16 v[224:239], a[120:123], v[208:211], v[224:239]
buffer_load_dwordx4 a[112:115], v16, s[68:71], s73 offen offset:0 sc1
v_cvt_pk_bf16_f32 v216, v176, v177
v_exp_f32 v182, v182
v_exp_f32 v183, v183
v_cvt_pk_bf16_f32 v217, v178, v179
v_exp_f32 v184, v184
v_exp_f32 v185, v185
v_mfma_f32_32x32x16_bf16 v[224:239], a[124:127], v[212:215], v[224:239]
buffer_load_dwordx4 a[116:119], v16, s[68:71], s73 offen offset:1024 sc1
v_cvt_pk_bf16_f32 v218, v180, v181
v_exp_f32 v186, v186
v_exp_f32 v187, v187
v_cvt_pk_bf16_f32 v219, v182, v183
v_exp_f32 v188, v188
v_exp_f32 v189, v189
v_cvt_pk_bf16_f32 v220, v184, v185
v_exp_f32 v190, v190
v_exp_f32 v191, v191
v_cvt_pk_bf16_f32 v221, v186, v187
v_max3_f32 v21, v64, v65, v66
v_max3_f32 v22, v80, v81, v82
v_cvt_pk_bf16_f32 v222, v188, v189
v_max3_f32 v24, v96, v97, v98
v_max3_f32 v25, v112, v113, v114
v_cvt_pk_bf16_f32 v223, v190, v191
v_max3_f32 v21, v67, v68, v21
v_max3_f32 v22, v83, v84, v22
v_max3_f32 v24, v99, v100, v24
v_max3_f32 v25, v115, v116, v25
v_max3_f32 v21, v69, v70, v21
v_max3_f32 v22, v85, v86, v22
v_max3_f32 v24, v101, v102, v24
v_max3_f32 v25, v117, v118, v25
v_max3_f32 v21, v71, v72, v21
v_max3_f32 v22, v87, v88, v22
v_max3_f32 v24, v103, v104, v24
v_max3_f32 v25, v119, v120, v25
v_max3_f32 v21, v73, v74, v21
v_max3_f32 v22, v89, v90, v22
v_max3_f32 v24, v105, v106, v24
v_max3_f32 v25, v121, v122, v25
v_max3_f32 v21, v75, v76, v21
v_max3_f32 v22, v91, v92, v22
v_max3_f32 v24, v107, v108, v24
v_max3_f32 v25, v123, v124, v25
v_max3_f32 v21, v77, v78, v21
v_max3_f32 v22, v93, v94, v22
v_max3_f32 v24, v109, v110, v24
v_mfma_f32_32x32x16_bf16 v[240:255], a[120:123], v[216:219], v[240:255]
v_max3_f32 v25, v125, v126, v25
v_max3_f32 v24, v79, v111, v24
v_max3_f32 v25, v95, v127, v25
v_max_f32 v21, v21, v24
v_max_f32 v22, v22, v25
v_max_f32 v23, v21, v22
v_cmp_lt_f32 vcc, s22, v23
v_mfma_f32_32x32x16_bf16 v[240:255], a[124:127], v[220:223], v[240:255]
buffer_load_dwordx4 a[120:123], v16, s[68:71], s73 offen offset:2048 sc1
buffer_load_dwordx4 a[124:127], v16, s[68:71], s73 offen offset:3072 sc1
s_add_u32 s73, s73, 4096
s_cbranch_vccnz mega_kernelA_u3_rs
mega_kernelA_u3_rsret:
s_and_b32 s73, s73, 0xffff
s_add_u32 s19, s19, 1
s_branch mega_kernelA_loop
mega_kernelA_tail:
v_exp_f32 v128, v128
v_exp_f32 v129, v129
v_exp_f32 v130, v130
v_exp_f32 v131, v131
v_exp_f32 v132, v132
v_exp_f32 v133, v133
v_cvt_pk_bf16_f32 v192, v128, v129
v_exp_f32 v134, v134
v_exp_f32 v135, v135
v_cvt_pk_bf16_f32 v193, v130, v131
v_exp_f32 v136, v136
v_exp_f32 v137, v137
v_cvt_pk_bf16_f32 v194, v132, v133
v_exp_f32 v138, v138
v_exp_f32 v139, v139
v_cvt_pk_bf16_f32 v195, v134, v135
v_exp_f32 v140, v140
v_exp_f32 v141, v141
v_cvt_pk_bf16_f32 v196, v136, v137
v_exp_f32 v142, v142
v_exp_f32 v143, v143
v_cvt_pk_bf16_f32 v197, v138, v139
v_exp_f32 v144, v144
v_exp_f32 v145, v145
v_cvt_pk_bf16_f32 v198, v140, v141
v_exp_f32 v146, v146
v_exp_f32 v147, v147
v_cvt_pk_bf16_f32 v199, v142, v143
v_exp_f32 v148, v148
v_exp_f32 v149, v149
v_cvt_pk_bf16_f32 v200, v144, v145
v_exp_f32 v150, v150
v_exp_f32 v151, v151
v_cvt_pk_bf16_f32 v201, v146, v147
v_exp_f32 v152, v152
v_exp_f32 v153, v153
v_cvt_pk_bf16_f32 v202, v148, v149
v_exp_f32 v154, v154
v_exp_f32 v155, v155
v_cvt_pk_bf16_f32 v203, v150, v151
v_exp_f32 v156, v156
v_exp_f32 v157, v157
v_cvt_pk_bf16_f32 v204, v152, v153
s_waitcnt vmcnt(24)
v_mfma_f32_32x32x16_bf16 v[224:239], a[112:115], v[192:195], v[224:239]
buffer_load_dwordx4 a[128:131], v16, s[12:15], s75 offen offset:0 sc1
v_exp_f32 v158, v158
v_exp_f32 v159, v159
v_cvt_pk_bf16_f32 v205, v154, v155
v_exp_f32 v160, v160
v_exp_f32 v161, v161
v_cvt_pk_bf16_f32 v206, v156, v157
v_mfma_f32_32x32x16_bf16 v[224:239], a[116:119], v[196:199], v[224:239]
buffer_load_dwordx4 a[132:135], v16, s[12:15], s75 offen offset:1024 sc1
v_exp_f32 v162, v162
v_exp_f32 v163, v163
v_cvt_pk_bf16_f32 v207, v158, v159
v_exp_f32 v164, v164
v_exp_f32 v165, v165
v_cvt_pk_bf16_f32 v208, v160, v161
v_mfma_f32_32x32x16_bf16 v[240:255], a[112:115], v[200:203], v[240:255]
buffer_load_dwordx4 a[136:139], v16, s[12:15], s75 offen offset:2048 sc1
v_exp_f32 v166, v166
v_exp_f32 v167, v167
v_cvt_pk_bf16_f32 v209, v162, v163
v_exp_f32 v168, v168
v_exp_f32 v169, v169
v_cvt_pk_bf16_f32 v210, v164, v165
v_mfma_f32_32x32x16_bf16 v[240:255], a[116:119], v[204:207], v[240:255]
buffer_load_dwordx4 a[140:143], v16, s[12:15], s75 offen offset:3072 sc1
v_exp_f32 v170, v170
v_exp_f32 v171, v171
v_cvt_pk_bf16_f32 v211, v166, v167
v_exp_f32 v172, v172
v_exp_f32 v173, v173
v_cvt_pk_bf16_f32 v212, v168, v169
v_exp_f32 v174, v174
v_exp_f32 v175, v175
v_cvt_pk_bf16_f32 v213, v170, v171
v_exp_f32 v176, v176
v_exp_f32 v177, v177
v_cvt_pk_bf16_f32 v214, v172, v173
v_exp_f32 v178, v178
v_exp_f32 v179, v179
v_cvt_pk_bf16_f32 v215, v174, v175
v_exp_f32 v180, v180
v_exp_f32 v181, v181
v_mfma_f32_32x32x16_bf16 v[224:239], a[120:123], v[208:211], v[224:239]
v_cvt_pk_bf16_f32 v216, v176, v177
v_exp_f32 v182, v182
v_exp_f32 v183, v183
v_cvt_pk_bf16_f32 v217, v178, v179
v_exp_f32 v184, v184
v_exp_f32 v185, v185
v_mfma_f32_32x32x16_bf16 v[224:239], a[124:127], v[212:215], v[224:239]
v_cvt_pk_bf16_f32 v218, v180, v181
v_exp_f32 v186, v186
v_exp_f32 v187, v187
v_cvt_pk_bf16_f32 v219, v182, v183
v_exp_f32 v188, v188
v_exp_f32 v189, v189
v_cvt_pk_bf16_f32 v220, v184, v185
v_exp_f32 v190, v190
v_exp_f32 v191, v191
v_cvt_pk_bf16_f32 v221, v186, v187
s_nop 0
v_cvt_pk_bf16_f32 v222, v188, v189
v_cvt_pk_bf16_f32 v223, v190, v191
s_nop 1
v_mfma_f32_32x32x16_bf16 v[240:255], a[120:123], v[216:219], v[240:255]
v_mfma_f32_32x32x16_bf16 v[240:255], a[124:127], v[220:223], v[240:255]
s_xor_b32 s50, s20, 2
s_mul_i32 s50, s50, 5120
s_add_u32 s50, s50, s62
v_add_u32 v19, s50, v16
s_mul_i32 s51, s20, 5120
s_add_u32 s51, s51, s62
v_add_u32 v18, s51, v16
v_bfe_u32 v7, v1, 4, 1
v_lshlrev_b32 v7, 14, v7
v_lshrrev_b32 v8, 5, v1
v_lshl_add_u32 v7, v8, 8, v7
v_and_b32 v8, 15, v1
v_lshl_add_u32 v7, v8, 4, v7
v_cmp_gt_u32 vcc, 32, v1
s_cmp_eq_u32 s42, 0
s_cbranch_scc1 mega_kernelA_h0
ds_write_b128 v19, v[224:227] offset:0
ds_write_b128 v19, v[228:231] offset:1024
ds_write_b128 v19, v[232:235] offset:2048
ds_write_b128 v19, v[236:239] offset:3072
ds_write_b128 v19, v[32:35] offset:4096
s_waitcnt lgkmcnt(0)
s_barrier
ds_read_b128 v[64:67], v18 offset:0
ds_read_b128 v[68:71], v18 offset:1024
ds_read_b128 v[72:75], v18 offset:2048
ds_read_b128 v[76:79], v18 offset:3072
ds_read_b128 v[80:83], v18 offset:4096
s_waitcnt lgkmcnt(0)
v_min_f32 v2, v48, v80
v_sub_f32 v3, v2, v48
v_sub_f32 v4, v2, v80
v_exp_f32 v3, v3
v_exp_f32 v4, v4
s_nop 0
v_mul_f32 v5, v252, v3
v_fmac_f32 v5, v76, v4
v_mov_b32 v6, v5
s_nop 1
v_permlane32_swap_b32 v5, v6
s_nop 1
v_rcp_f32 v6, v6
s_nop 0
v_mul_f32 v3, v3, v6
v_mul_f32 v4, v4, v6
v_mul_f32 v240, v240, v3
v_mul_f32 v241, v241, v3
v_mul_f32 v242, v242, v3
v_mul_f32 v243, v243, v3
v_mul_f32 v244, v244, v3
v_mul_f32 v245, v245, v3
v_mul_f32 v246, v246, v3
v_mul_f32 v247, v247, v3
v_mul_f32 v248, v248, v3
v_mul_f32 v249, v249, v3
v_mul_f32 v250, v250, v3
v_mul_f32 v251, v251, v3
v_mul_f32 v252, v252, v3
v_mul_f32 v253, v253, v3
v_mul_f32 v254, v254, v3
v_mul_f32 v255, v255, v3
v_fmac_f32 v240, v64, v4
v_fmac_f32 v241, v65, v4
v_fmac_f32 v242, v66, v4
v_fmac_f32 v243, v67, v4
v_fmac_f32 v244, v68, v4
v_fmac_f32 v245, v69, v4
v_fmac_f32 v246, v70, v4
v_fmac_f32 v247, v71, v4
v_fmac_f32 v248, v72, v4
v_fmac_f32 v249, v73, v4
v_fmac_f32 v250, v74, v4
v_fmac_f32 v251, v75, v4
v_fmac_f32 v252, v76, v4
v_fmac_f32 v253, v77, v4
v_fmac_f32 v254, v78, v4
v_fmac_f32 v255, v79, v4
v_cndmask_b32 v252, 0, v252, vcc
v_cndmask_b32 v253, 0, v253, vcc
v_cndmask_b32 v254, 0, v254, vcc
v_cndmask_b32 v255, 0, v255, vcc
v_cvt_pk_bf16_f32 v128, v240, v241
v_cvt_pk_bf16_f32 v129, v242, v243
v_cvt_pk_bf16_f32 v130, v248, v249
v_cvt_pk_bf16_f32 v131, v250, v251
buffer_store_dwordx4 v[128:131], v7, s[12:15], s74 offen offset:0 sc0 sc1
v_cvt_pk_bf16_f32 v132, v244, v245
v_cvt_pk_bf16_f32 v133, v246, v247
v_cvt_pk_bf16_f32 v134, v252, v253
v_cvt_pk_bf16_f32 v135, v254, v255
buffer_store_dwordx4 v[132:135], v7, s[12:15], s74 offen offset:512 sc0 sc1
s_branch mega_kernelA_done
mega_kernelA_h0:
ds_write_b128 v19, v[240:243] offset:0
ds_write_b128 v19, v[244:247] offset:1024
ds_write_b128 v19, v[248:251] offset:2048
ds_write_b128 v19, v[252:255] offset:3072
ds_write_b128 v19, v[48:51] offset:4096
s_waitcnt lgkmcnt(0)
s_barrier
ds_read_b128 v[64:67], v18 offset:0
ds_read_b128 v[68:71], v18 offset:1024
ds_read_b128 v[72:75], v18 offset:2048
ds_read_b128 v[76:79], v18 offset:3072
ds_read_b128 v[80:83], v18 offset:4096
s_waitcnt lgkmcnt(0)
v_min_f32 v2, v32, v80
v_sub_f32 v3, v2, v32
v_sub_f32 v4, v2, v80
v_exp_f32 v3, v3
v_exp_f32 v4, v4
s_nop 0
v_mul_f32 v5, v236, v3
v_fmac_f32 v5, v76, v4
v_mov_b32 v6, v5
s_nop 1
v_permlane32_swap_b32 v5, v6
s_nop 1
v_rcp_f32 v6, v6
s_nop 0
v_mul_f32 v3, v3, v6
v_mul_f32 v4, v4, v6
v_mul_f32 v224, v224, v3
v_mul_f32 v225, v225, v3
v_mul_f32 v226, v226, v3
v_mul_f32 v227, v227, v3
v_mul_f32 v228, v228, v3
v_mul_f32 v229, v229, v3
v_mul_f32 v230, v230, v3
v_mul_f32 v231, v231, v3
v_mul_f32 v232, v232, v3
v_mul_f32 v233, v233, v3
v_mul_f32 v234, v234, v3
v_mul_f32 v235, v235, v3
v_mul_f32 v236, v236, v3
v_mul_f32 v237, v237, v3
v_mul_f32 v238, v238, v3
v_mul_f32 v239, v239, v3
v_fmac_f32 v224, v64, v4
v_fmac_f32 v225, v65, v4
v_fmac_f32 v226, v66, v4
v_fmac_f32 v227, v67, v4
v_fmac_f32 v228, v68, v4
v_fmac_f32 v229, v69, v4
v_fmac_f32 v230, v70, v4
v_fmac_f32 v231, v71, v4
v_fmac_f32 v232, v72, v4
v_fmac_f32 v233, v73, v4
v_fmac_f32 v234, v74, v4
v_fmac_f32 v235, v75, v4
v_fmac_f32 v236, v76, v4
v_fmac_f32 v237, v77, v4
v_fmac_f32 v238, v78, v4
v_fmac_f32 v239, v79, v4
v_cndmask_b32 v236, 0, v236, vcc
v_cndmask_b32 v237, 0, v237, vcc
v_cndmask_b32 v238, 0, v238, vcc
v_cndmask_b32 v239, 0, v239, vcc
v_cvt_pk_bf16_f32 v128, v224, v225
v_cvt_pk_bf16_f32 v129, v226, v227
v_cvt_pk_bf16_f32 v130, v232, v233
v_cvt_pk_bf16_f32 v131, v234, v235
buffer_store_dwordx4 v[128:131], v7, s[12:15], s74 offen offset:0 sc0 sc1
v_cvt_pk_bf16_f32 v132, v228, v229
v_cvt_pk_bf16_f32 v133, v230, v231
v_cvt_pk_bf16_f32 v134, v236, v237
v_cvt_pk_bf16_f32 v135, v238, v239
buffer_store_dwordx4 v[132:135], v7, s[12:15], s74 offen offset:512 sc0 sc1
mega_kernelA_done:
s_add_u32 s74, s74, 131072
s_xor_b32 s62, s62, 32768
s_sub_u32 s59, s59, 1
s_mov_b32 s76, s77
s_add_u32 s77, s77, 128
s_waitcnt vmcnt(2)
s_cmp_lg_u32 s59, 0
s_cbranch_scc1 mega_kernel_anext
mega_kernel_end:
s_waitcnt vmcnt(0)
s_barrier
s_cmp_eq_u32 s20, 0
s_cbranch_scc0 mega_kernel_fs
v_mov_b32 v3, s76
v_mov_b32 v2, 4
s_mov_b64 exec, 1
global_atomic_add v3, v2, s[12:13] sc1
s_mov_b64 exec, -1
mega_kernel_fs:
s_cmp_ge_u32 s56, 14
s_cbranch_scc1 mega_kernel_fin
s_load_dwordx2 s[8:9], s[0:1], 16
s_load_dwordx2 s[24:25], s[0:1], 72
s_mov_b32 s27, 0x20000
s_mov_b32 s10, 401408
s_mov_b32 s26, 3670016
v_lshrrev_b32 v3, 4, v1
s_lshl_b32 s18, s20, 14
s_mov_b32 s22, 0x3f80
s_mov_b32 s23, 0x3f800000
v_lshrrev_b32 v2, 3, v1
v_mul_u32_u24 v2, 896, v2
v_lshlrev_b32 v4, 1, v3
v_and_b32 v5, 7, v1
v_xor_b32 v4, v4, v5
v_lshl_add_u32 v24, v4, 4, v2
v_add_u32 v25, 6144, v24
v_add_u32 v26, 12288, v24
v_add_u32 v27, 18432, v24
v_bfe_u32 v4, v1, 2, 2
v_lshl_add_u32 v5, v3, 2, v4
v_lshrrev_b32 v6, 1, v5
v_and_b32 v6, 3, v6
v_lshlrev_b32 v5, 7, v5
v_lshl_add_u32 v5, v6, 5, v5
v_and_b32 v6, 3, v1
v_lshl_add_u32 v20, v6, 3, v5
v_xor_b32 v21, 32, v20
v_xor_b32 v22, 64, v20
v_xor_b32 v23, 96, v20
v_and_b32 v2, 15, v1
v_mul_u32_u24 v2, 1792, v2
v_and_b32 v4, 1, v3
v_lshl_add_u32 v2, v4, 5, v2
v_lshrrev_b32 v4, 1, v3
v_lshl_add_u32 v2, v4, 4, v2
s_waitcnt lgkmcnt(0)
s_lshr_b32 s57, s55, 1
s_lshl_b32 s58, s57, 2
s_lshl_b32 s57, s57, 1
s_mov_b32 s41, s56
s_mov_b32 s63, 0
mega_kernel_tnext:
s_mov_b32 s60, 0x65543210
s_mov_b32 s61, 0xa0ba9b87
s_mov_b32 s78, 0x4a9aa6aa
s_cmp_eq_u32 s63, 0
s_cbranch_scc1 mega_kernel_tgo
s_mov_b32 s60, 0x200e9740
s_mov_b32 s61, 0xcf103c
s_mov_b32 s78, 0x9455154
s_cmp_eq_u32 s63, 1
s_cbranch_scc1 mega_kernel_tgo
s_mov_b32 s60, 0x600fd000
s_mov_b32 s61, 0x8000ed
s_mov_b32 s78, 0x40a4240
s_cmp_eq_u32 s63, 2
s_cbranch_scc1 mega_kernel_tgo
s_branch mega_kernel_fin
mega_kernel_tgo:
s_add_u32 s63, s63, 1
s_lshr_b64 s[60:61], s[60:61], s58
s_and_b32 s40, s60, 15
s_lshr_b32 s78, s78, s57
s_and_b32 s78, s78, 3
s_cmp_eq_u32 s78, 0
s_cbranch_scc1 mega_kernel_fin
s_cmp_eq_u32 s78, 1
s_cbranch_scc1 mega_kernel_ta
s_mul_i32 s42, s40, 56
s_lshl_b32 s43, s41, 2
s_add_u32 s42, s42, s43
s_add_u32 s46, s42, s20
s_lshl_b32 s47, s46, 11
s_add_u32 s47, s47, 83886080
s_mul_i32 s42, s46, 9363
s_lshr_b32 s42, s42, 16
s_mul_i32 s43, s42, 7
s_sub_u32 s43, s46, s43
s_mul_i32 s45, s42, 28672
s_lshl_b32 s44, s43, 7
s_add_u32 s45, s45, s44
s_lshl_b32 s44, s40, 7
s_add_u32 s44, s44, 117440512
s_cmp_eq_u32 s20, 0
s_cbranch_scc0 mega_kernel_fb_ok
v_mov_b32 v60, s44
s_mov_b32 s62, 200000
mega_kernel_fb_spin:
global_load_dword v59, v60, s[12:13] sc1
s_waitcnt vmcnt(0)
v_readfirstlane_b32 s61, v59
s_cmp_ge_u32 s61, 64
s_cbranch_scc1 mega_kernel_fb_ok
s_sleep 8
s_sub_u32 s62, s62, 1
s_cmp_lg_u32 s62, 0
s_cbranch_scc1 mega_kernel_fb_spin
mega_kernel_fb_ok:
s_barrier
buffer_load_dwordx4 v[64:67], v16, s[12:15], s47 offen offset:0 sc1
buffer_load_dwordx4 v[68:71], v16, s[12:15], s47 offen offset:1024 sc1
s_add_u32 s47, s47, 1835008
buffer_load_dwordx4 v[72:75], v16, s[12:15], s47 offen offset:0 sc1
buffer_load_dwordx4 v[76:79], v16, s[12:15], s47 offen offset:1024 sc1
s_add_u32 s47, s47, 1835008
buffer_load_dwordx4 v[80:83], v16, s[12:15], s47 offen offset:0 sc1
buffer_load_dwordx4 v[84:87], v16, s[12:15], s47 offen offset:1024 sc1
s_add_u32 s47, s47, 1835008
buffer_load_dwordx4 v[88:91], v16, s[12:15], s47 offen offset:0 sc1
buffer_load_dwordx4 v[92:95], v16, s[12:15], s47 offen offset:1024 sc1
s_add_u32 s47, s47, 1835008
buffer_load_dwordx4 v[96:99], v16, s[12:15], s47 offen offset:0 sc1
buffer_load_dwordx4 v[100:103], v16, s[12:15], s47 offen offset:1024 sc1
s_add_u32 s47, s47, 1835008
buffer_load_dwordx4 v[104:107], v16, s[12:15], s47 offen offset:0 sc1
buffer_load_dwordx4 v[108:111], v16, s[12:15], s47 offen offset:1024 sc1
s_add_u32 s47, s47, 1835008
buffer_load_dwordx4 v[112:115], v16, s[12:15], s47 offen offset:0 sc1
buffer_load_dwordx4 v[116:119], v16, s[12:15], s47 offen offset:1024 sc1
s_add_u32 s47, s47, 1835008
buffer_load_dwordx4 v[120:123], v16, s[12:15], s47 offen offset:0 sc1
buffer_load_dwordx4 v[124:127], v16, s[12:15], s47 offen offset:1024 sc1
s_add_u32 s47, s47, 1835008
buffer_load_dwordx4 v[128:131], v16, s[12:15], s47 offen offset:0 sc1
buffer_load_dwordx4 v[132:135], v16, s[12:15], s47 offen offset:1024 sc1
s_add_u32 s47, s47, 1835008
buffer_load_dwordx4 v[136:139], v16, s[12:15], s47 offen offset:0 sc1
buffer_load_dwordx4 v[140:143], v16, s[12:15], s47 offen offset:1024 sc1
s_add_u32 s47, s47, 1835008
buffer_load_dwordx4 v[144:147], v16, s[12:15], s47 offen offset:0 sc1
buffer_load_dwordx4 v[148:151], v16, s[12:15], s47 offen offset:1024 sc1
s_add_u32 s47, s47, 1835008
buffer_load_dwordx4 v[152:155], v16, s[12:15], s47 offen offset:0 sc1
buffer_load_dwordx4 v[156:159], v16, s[12:15], s47 offen offset:1024 sc1
s_add_u32 s47, s47, 1835008
buffer_load_dwordx4 v[160:163], v16, s[12:15], s47 offen offset:0 sc1
buffer_load_dwordx4 v[164:167], v16, s[12:15], s47 offen offset:1024 sc1
s_add_u32 s47, s47, 1835008
buffer_load_dwordx4 v[168:171], v16, s[12:15], s47 offen offset:0 sc1
buffer_load_dwordx4 v[172:175], v16, s[12:15], s47 offen offset:1024 sc1
s_add_u32 s47, s47, 1835008
buffer_load_dwordx4 v[176:179], v16, s[12:15], s47 offen offset:0 sc1
buffer_load_dwordx4 v[180:183], v16, s[12:15], s47 offen offset:1024 sc1
s_add_u32 s47, s47, 1835008
buffer_load_dwordx4 v[184:187], v16, s[12:15], s47 offen offset:0 sc1
buffer_load_dwordx4 v[188:191], v16, s[12:15], s47 offen offset:1024 sc1
v_mov_b32 v32, 0
v_mov_b32 v33, 0
v_mov_b32 v34, 0
v_mov_b32 v35, 0
v_mov_b32 v36, 0
v_mov_b32 v37, 0
v_mov_b32 v38, 0
v_mov_b32 v39, 0
v_mov_b32 v40, 0
v_mov_b32 v41, 0
v_mov_b32 v42, 0
v_mov_b32 v43, 0
v_mov_b32 v44, 0
v_mov_b32 v45, 0
v_mov_b32 v46, 0
v_mov_b32 v47, 0
s_waitcnt vmcnt(28)
v_dot2c_f32_bf16 v32, s22, v64
v_dot2c_f32_bf16 v33, s23, v64
v_dot2c_f32_bf16 v34, s22, v65
v_dot2c_f32_bf16 v35, s23, v65
v_dot2c_f32_bf16 v36, s22, v66
v_dot2c_f32_bf16 v37, s23, v66
v_dot2c_f32_bf16 v38, s22, v67
v_dot2c_f32_bf16 v39, s23, v67
v_dot2c_f32_bf16 v40, s22, v68
v_dot2c_f32_bf16 v41, s23, v68
v_dot2c_f32_bf16 v42, s22, v69
v_dot2c_f32_bf16 v43, s23, v69
v_dot2c_f32_bf16 v44, s22, v70
v_dot2c_f32_bf16 v45, s23, v70
v_dot2c_f32_bf16 v46, s22, v71
v_dot2c_f32_bf16 v47, s23, v71
v_dot2c_f32_bf16 v32, s22, v72
v_dot2c_f32_bf16 v33, s23, v72
v_dot2c_f32_bf16 v34, s22, v73
v_dot2c_f32_bf16 v35, s23, v73
v_dot2c_f32_bf16 v36, s22, v74
v_dot2c_f32_bf16 v37, s23, v74
v_dot2c_f32_bf16 v38, s22, v75
v_dot2c_f32_bf16 v39, s23, v75
v_dot2c_f32_bf16 v40, s22, v76
v_dot2c_f32_bf16 v41, s23, v76
v_dot2c_f32_bf16 v42, s22, v77
v_dot2c_f32_bf16 v43, s23, v77
v_dot2c_f32_bf16 v44, s22, v78
v_dot2c_f32_bf16 v45, s23, v78
v_dot2c_f32_bf16 v46, s22, v79
v_dot2c_f32_bf16 v47, s23, v79
s_waitcnt vmcnt(24)
v_dot2c_f32_bf16 v32, s22, v80
v_dot2c_f32_bf16 v33, s23, v80
v_dot2c_f32_bf16 v34, s22, v81
v_dot2c_f32_bf16 v35, s23, v81
v_dot2c_f32_bf16 v36, s22, v82
v_dot2c_f32_bf16 v37, s23, v82
v_dot2c_f32_bf16 v38, s22, v83
v_dot2c_f32_bf16 v39, s23, v83
v_dot2c_f32_bf16 v40, s22, v84
v_dot2c_f32_bf16 v41, s23, v84
v_dot2c_f32_bf16 v42, s22, v85
v_dot2c_f32_bf16 v43, s23, v85
v_dot2c_f32_bf16 v44, s22, v86
v_dot2c_f32_bf16 v45, s23, v86
v_dot2c_f32_bf16 v46, s22, v87
v_dot2c_f32_bf16 v47, s23, v87
v_dot2c_f32_bf16 v32, s22, v88
v_dot2c_f32_bf16 v33, s23, v88
v_dot2c_f32_bf16 v34, s22, v89
v_dot2c_f32_bf16 v35, s23, v89
v_dot2c_f32_bf16 v36, s22, v90
v_dot2c_f32_bf16 v37, s23, v90
v_dot2c_f32_bf16 v38, s22, v91
v_dot2c_f32_bf16 v39, s23, v91
v_dot2c_f32_bf16 v40, s22, v92
v_dot2c_f32_bf16 v41, s23, v92
v_dot2c_f32_bf16 v42, s22, v93
v_dot2c_f32_bf16 v43, s23, v93
v_dot2c_f32_bf16 v44, s22, v94
v_dot2c_f32_bf16 v45, s23, v94
v_dot2c_f32_bf16 v46, s22, v95
v_dot2c_f32_bf16 v47, s23, v95
s_waitcnt vmcnt(20)
v_dot2c_f32_bf16 v32, s22, v96
v_dot2c_f32_bf16 v33, s23, v96
v_dot2c_f32_bf16 v34, s22, v97
v_dot2c_f32_bf16 v35, s23, v97
v_dot2c_f32_bf16 v36, s22, v98
v_dot2c_f32_bf16 v37, s23, v98
v_dot2c_f32_bf16 v38, s22, v99
v_dot2c_f32_bf16 v39, s23, v99
v_dot2c_f32_bf16 v40, s22, v100
v_dot2c_f32_bf16 v41, s23, v100
v_dot2c_f32_bf16 v42, s22, v101
v_dot2c_f32_bf16 v43, s23, v101
v_dot2c_f32_bf16 v44, s22, v102
v_dot2c_f32_bf16 v45, s23, v102
v_dot2c_f32_bf16 v46, s22, v103
v_dot2c_f32_bf16 v47, s23, v103
v_dot2c_f32_bf16 v32, s22, v104
v_dot2c_f32_bf16 v33, s23, v104
v_dot2c_f32_bf16 v34, s22, v105
v_dot2c_f32_bf16 v35, s23, v105
v_dot2c_f32_bf16 v36, s22, v106
v_dot2c_f32_bf16 v37, s23, v106
v_dot2c_f32_bf16 v38, s22, v107
v_dot2c_f32_bf16 v39, s23, v107
v_dot2c_f32_bf16 v40, s22, v108
v_dot2c_f32_bf16 v41, s23, v108
v_dot2c_f32_bf16 v42, s22, v109
v_dot2c_f32_bf16 v43, s23, v109
v_dot2c_f32_bf16 v44, s22, v110
v_dot2c_f32_bf16 v45, s23, v110
v_dot2c_f32_bf16 v46, s22, v111
v_dot2c_f32_bf16 v47, s23, v111
s_waitcnt vmcnt(16)
v_dot2c_f32_bf16 v32, s22, v112
v_dot2c_f32_bf16 v33, s23, v112
v_dot2c_f32_bf16 v34, s22, v113
v_dot2c_f32_bf16 v35, s23, v113
v_dot2c_f32_bf16 v36, s22, v114
v_dot2c_f32_bf16 v37, s23, v114
v_dot2c_f32_bf16 v38, s22, v115
v_dot2c_f32_bf16 v39, s23, v115
v_dot2c_f32_bf16 v40, s22, v116
v_dot2c_f32_bf16 v41, s23, v116
v_dot2c_f32_bf16 v42, s22, v117
v_dot2c_f32_bf16 v43, s23, v117
v_dot2c_f32_bf16 v44, s22, v118
v_dot2c_f32_bf16 v45, s23, v118
v_dot2c_f32_bf16 v46, s22, v119
v_dot2c_f32_bf16 v47, s23, v119
v_dot2c_f32_bf16 v32, s22, v120
v_dot2c_f32_bf16 v33, s23, v120
v_dot2c_f32_bf16 v34, s22, v121
v_dot2c_f32_bf16 v35, s23, v121
v_dot2c_f32_bf16 v36, s22, v122
v_dot2c_f32_bf16 v37, s23, v122
v_dot2c_f32_bf16 v38, s22, v123
v_dot2c_f32_bf16 v39, s23, v123
v_dot2c_f32_bf16 v40, s22, v124
v_dot2c_f32_bf16 v41, s23, v124
v_dot2c_f32_bf16 v42, s22, v125
v_dot2c_f32_bf16 v43, s23, v125
v_dot2c_f32_bf16 v44, s22, v126
v_dot2c_f32_bf16 v45, s23, v126
v_dot2c_f32_bf16 v46, s22, v127
v_dot2c_f32_bf16 v47, s23, v127
s_waitcnt vmcnt(12)
v_dot2c_f32_bf16 v32, s22, v128
v_dot2c_f32_bf16 v33, s23, v128
v_dot2c_f32_bf16 v34, s22, v129
v_dot2c_f32_bf16 v35, s23, v129
v_dot2c_f32_bf16 v36, s22, v130
v_dot2c_f32_bf16 v37, s23, v130
v_dot2c_f32_bf16 v38, s22, v131
v_dot2c_f32_bf16 v39, s23, v131
v_dot2c_f32_bf16 v40, s22, v132
v_dot2c_f32_bf16 v41, s23, v132
v_dot2c_f32_bf16 v42, s22, v133
v_dot2c_f32_bf16 v43, s23, v133
v_dot2c_f32_bf16 v44, s22, v134
v_dot2c_f32_bf16 v45, s23, v134
v_dot2c_f32_bf16 v46, s22, v135
v_dot2c_f32_bf16 v47, s23, v135
v_dot2c_f32_bf16 v32, s22, v136
v_dot2c_f32_bf16 v33, s23, v136
v_dot2c_f32_bf16 v34, s22, v137
v_dot2c_f32_bf16 v35, s23, v137
v_dot2c_f32_bf16 v36, s22, v138
v_dot2c_f32_bf16 v37, s23, v138
v_dot2c_f32_bf16 v38, s22, v139
v_dot2c_f32_bf16 v39, s23, v139
v_dot2c_f32_bf16 v40, s22, v140
v_dot2c_f32_bf16 v41, s23, v140
v_dot2c_f32_bf16 v42, s22, v141
v_dot2c_f32_bf16 v43, s23, v141
v_dot2c_f32_bf16 v44, s22, v142
v_dot2c_f32_bf16 v45, s23, v142
v_dot2c_f32_bf16 v46, s22, v143
v_dot2c_f32_bf16 v47, s23, v143
s_waitcnt vmcnt(8)
v_dot2c_f32_bf16 v32, s22, v144
v_dot2c_f32_bf16 v33, s23, v144
v_dot2c_f32_bf16 v34, s22, v145
v_dot2c_f32_bf16 v35, s23, v145
v_dot2c_f32_bf16 v36, s22, v146
v_dot2c_f32_bf16 v37, s23, v146
v_dot2c_f32_bf16 v38, s22, v147
v_dot2c_f32_bf16 v39, s23, v147
v_dot2c_f32_bf16 v40, s22, v148
v_dot2c_f32_bf16 v41, s23, v148
v_dot2c_f32_bf16 v42, s22, v149
v_dot2c_f32_bf16 v43, s23, v149
v_dot2c_f32_bf16 v44, s22, v150
v_dot2c_f32_bf16 v45, s23, v150
v_dot2c_f32_bf16 v46, s22, v151
v_dot2c_f32_bf16 v47, s23, v151
v_dot2c_f32_bf16 v32, s22, v152
v_dot2c_f32_bf16 v33, s23, v152
v_dot2c_f32_bf16 v34, s22, v153
v_dot2c_f32_bf16 v35, s23, v153
v_dot2c_f32_bf16 v36, s22, v154
v_dot2c_f32_bf16 v37, s23, v154
v_dot2c_f32_bf16 v38, s22, v155
v_dot2c_f32_bf16 v39, s23, v155
v_dot2c_f32_bf16 v40, s22, v156
v_dot2c_f32_bf16 v41, s23, v156
v_dot2c_f32_bf16 v42, s22, v157
v_dot2c_f32_bf16 v43, s23, v157
v_dot2c_f32_bf16 v44, s22, v158
v_dot2c_f32_bf16 v45, s23, v158
v_dot2c_f32_bf16 v46, s22, v159
v_dot2c_f32_bf16 v47, s23, v159
s_waitcnt vmcnt(4)
v_dot2c_f32_bf16 v32, s22, v160
v_dot2c_f32_bf16 v33, s23, v160
v_dot2c_f32_bf16 v34, s22, v161
v_dot2c_f32_bf16 v35, s23, v161
v_dot2c_f32_bf16 v36, s22, v162
v_dot2c_f32_bf16 v37, s23, v162
v_dot2c_f32_bf16 v38, s22, v163
v_dot2c_f32_bf16 v39, s23, v163
v_dot2c_f32_bf16 v40, s22, v164
v_dot2c_f32_bf16 v41, s23, v164
v_dot2c_f32_bf16 v42, s22, v165
v_dot2c_f32_bf16 v43, s23, v165
v_dot2c_f32_bf16 v44, s22, v166
v_dot2c_f32_bf16 v45, s23, v166
v_dot2c_f32_bf16 v46, s22, v167
v_dot2c_f32_bf16 v47, s23, v167
v_dot2c_f32_bf16 v32, s22, v168
v_dot2c_f32_bf16 v33, s23, v168
v_dot2c_f32_bf16 v34, s22, v169
v_dot2c_f32_bf16 v35, s23, v169
v_dot2c_f32_bf16 v36, s22, v170
v_dot2c_f32_bf16 v37, s23, v170
v_dot2c_f32_bf16 v38, s22, v171
v_dot2c_f32_bf16 v39, s23, v171
v_dot2c_f32_bf16 v40, s22, v172
v_dot2c_f32_bf16 v41, s23, v172
v_dot2c_f32_bf16 v42, s22, v173
v_dot2c_f32_bf16 v43, s23, v173
v_dot2c_f32_bf16 v44, s22, v174
v_dot2c_f32_bf16 v45, s23, v174
v_dot2c_f32_bf16 v46, s22, v175
v_dot2c_f32_bf16 v47, s23, v175
s_waitcnt vmcnt(0)
v_dot2c_f32_bf16 v32, s22, v176
v_dot2c_f32_bf16 v33, s23, v176
v_dot2c_f32_bf16 v34, s22, v177
v_dot2c_f32_bf16 v35, s23, v177
v_dot2c_f32_bf16 v36, s22, v178
v_dot2c_f32_bf16 v37, s23, v178
v_dot2c_f32_bf16 v38, s22, v179
v_dot2c_f32_bf16 v39, s23, v179
v_dot2c_f32_bf16 v40, s22, v180
v_dot2c_f32_bf16 v41, s23, v180
v_dot2c_f32_bf16 v42, s22, v181
v_dot2c_f32_bf16 v43, s23, v181
v_dot2c_f32_bf16 v44, s22, v182
v_dot2c_f32_bf16 v45, s23, v182
v_dot2c_f32_bf16 v46, s22, v183
v_dot2c_f32_bf16 v47, s23, v183
v_dot2c_f32_bf16 v32, s22, v184
v_dot2c_f32_bf16 v33, s23, v184
v_dot2c_f32_bf16 v34, s22, v185
v_dot2c_f32_bf16 v35, s23, v185
v_dot2c_f32_bf16 v36, s22, v186
v_dot2c_f32_bf16 v37, s23, v186
v_dot2c_f32_bf16 v38, s22, v187
v_dot2c_f32_bf16 v39, s23, v187
v_dot2c_f32_bf16 v40, s22, v188
v_dot2c_f32_bf16 v41, s23, v188
v_dot2c_f32_bf16 v42, s22, v189
v_dot2c_f32_bf16 v43, s23, v189
v_dot2c_f32_bf16 v44, s22, v190
v_dot2c_f32_bf16 v45, s23, v190
v_dot2c_f32_bf16 v46, s22, v191
v_dot2c_f32_bf16 v47, s23, v191
s_nop 2
v_cvt_pk_bf16_f32 v192, v32, v33
v_cvt_pk_bf16_f32 v193, v34, v35
v_cvt_pk_bf16_f32 v194, v36, v37
v_cvt_pk_bf16_f32 v195, v38, v39
v_cvt_pk_bf16_f32 v196, v40, v41
v_cvt_pk_bf16_f32 v197, v42, v43
v_cvt_pk_bf16_f32 v198, v44, v45
v_cvt_pk_bf16_f32 v199, v46, v47
s_nop 1
v_permlane16_swap_b32 v192, v194
v_permlane16_swap_b32 v193, v195
v_permlane16_swap_b32 v196, v198
v_permlane16_swap_b32 v197, v199
buffer_store_dwordx4 v[192:195], v2, s[24:27], s45 offen offset:896
buffer_store_dwordx4 v[196:199], v2, s[24:27], s45 offen offset:960
s_branch mega_kernel_tnext
mega_kernel_ta:
s_cmp_ge_u32 s41, 7
s_cselect_b32 s42, 1, 0
s_mul_i32 s43, s42, 7
s_sub_u32 s43, s41, s43
s_lshl_b32 s44, s43, 7
s_mul_i32 s21, s20, 100352
s_add_u32 s21, s21, s44
s_barrier
s_add_u32 m0, s18, 0
s_nop 0
buffer_load_dwordx4 v24, s[8:11], s21 offen offset:0 lds
buffer_load_dwordx4 v25, s[8:11], s21 offen offset:1024 lds
buffer_load_dwordx4 v26, s[8:11], s21 offen offset:2048 lds
buffer_load_dwordx4 v27, s[8:11], s21 offen offset:3072 lds
s_add_u32 s21, s21, 25088
s_add_u32 m0, s18, 4096
s_nop 0
buffer_load_dwordx4 v24, s[8:11], s21 offen offset:0 lds
buffer_load_dwordx4 v25, s[8:11], s21 offen offset:1024 lds
buffer_load_dwordx4 v26, s[8:11], s21 offen offset:2048 lds
buffer_load_dwordx4 v27, s[8:11], s21 offen offset:3072 lds
s_add_u32 s21, s21, 25088
s_add_u32 m0, s18, 8192
s_nop 0
buffer_load_dwordx4 v24, s[8:11], s21 offen offset:0 lds
buffer_load_dwordx4 v25, s[8:11], s21 offen offset:1024 lds
buffer_load_dwordx4 v26, s[8:11], s21 offen offset:2048 lds
buffer_load_dwordx4 v27, s[8:11], s21 offen offset:3072 lds
s_add_u32 s21, s21, 25088
s_add_u32 m0, s18, 12288
s_nop 0
buffer_load_dwordx4 v24, s[8:11], s21 offen offset:0 lds
buffer_load_dwordx4 v25, s[8:11], s21 offen offset:1024 lds
buffer_load_dwordx4 v26, s[8:11], s21 offen offset:2048 lds
buffer_load_dwordx4 v27, s[8:11], s21 offen offset:3072 lds
s_add_u32 s21, s21, 25088
s_lshl_b32 s46, s40, 3
s_lshl_b32 s42, s42, 2
s_add_u32 s42, s42, s46
s_add_u32 s42, s42, s20
s_lshl_b32 s19, s42, 14
s_add_u32 s19, s19, 73400320
s_mul_i32 s45, s42, 28672
s_add_u32 s45, s45, s44
s_lshl_b32 s44, s40, 7
s_add_u32 s44, s44, 117442560
s_waitcnt vmcnt(0)
s_cmp_eq_u32 s20, 0
s_cbranch_scc0 mega_kernel_fa_ok
v_mov_b32 v60, s44
s_mov_b32 s62, 200000
mega_kernel_fa_spin:
global_load_dword v59, v60, s[12:13] sc1
s_waitcnt vmcnt(0)
v_readfirstlane_b32 s61, v59
s_cmp_ge_u32 s61, 64
s_cbranch_scc1 mega_kernel_fa_ok
s_sleep 8
s_sub_u32 s62, s62, 1
s_cmp_lg_u32 s62, 0
s_cbranch_scc1 mega_kernel_fa_spin
mega_kernel_fa_ok:
s_barrier
buffer_load_dwordx4 v[64:67], v16, s[12:15], s19 offen offset:0 sc1
buffer_load_dwordx4 v[68:71], v16, s[12:15], s19 offen offset:1024 sc1
buffer_load_dwordx4 v[72:75], v16, s[12:15], s19 offen offset:2048 sc1
buffer_load_dwordx4 v[76:79], v16, s[12:15], s19 offen offset:3072 sc1
s_add_u32 s19, s19, 4096
buffer_load_dwordx4 v[80:83], v16, s[12:15], s19 offen offset:0 sc1
buffer_load_dwordx4 v[84:87], v16, s[12:15], s19 offen offset:1024 sc1
buffer_load_dwordx4 v[88:91], v16, s[12:15], s19 offen offset:2048 sc1
buffer_load_dwordx4 v[92:95], v16, s[12:15], s19 offen offset:3072 sc1
s_add_u32 s19, s19, 4096
buffer_load_dwordx4 v[96:99], v16, s[12:15], s19 offen offset:0 sc1
buffer_load_dwordx4 v[100:103], v16, s[12:15], s19 offen offset:1024 sc1
buffer_load_dwordx4 v[104:107], v16, s[12:15], s19 offen offset:2048 sc1
buffer_load_dwordx4 v[108:111], v16, s[12:15], s19 offen offset:3072 sc1
s_add_u32 s19, s19, 4096
buffer_load_dwordx4 v[112:115], v16, s[12:15], s19 offen offset:0 sc1
buffer_load_dwordx4 v[116:119], v16, s[12:15], s19 offen offset:1024 sc1
buffer_load_dwordx4 v[120:123], v16, s[12:15], s19 offen offset:2048 sc1
buffer_load_dwordx4 v[124:127], v16, s[12:15], s19 offen offset:3072 sc1
ds_read_b64_tr_b16 a[0:1], v20 offset:0
ds_read_b64_tr_b16 a[2:3], v20 offset:2048
ds_read_b64_tr_b16 a[4:5], v21 offset:0
ds_read_b64_tr_b16 a[6:7], v21 offset:2048
ds_read_b64_tr_b16 a[8:9], v22 offset:0
ds_read_b64_tr_b16 a[10:11], v22 offset:2048
ds_read_b64_tr_b16 a[12:13], v23 offset:0
ds_read_b64_tr_b16 a[14:15], v23 offset:2048
ds_read_b64_tr_b16 a[16:17], v20 offset:4096
ds_read_b64_tr_b16 a[18:19], v20 offset:6144
ds_read_b64_tr_b16 a[20:21], v21 offset:4096
ds_read_b64_tr_b16 a[22:23], v21 offset:6144
ds_read_b64_tr_b16 a[24:25], v22 offset:4096
ds_read_b64_tr_b16 a[26:27], v22 offset:6144
ds_read_b64_tr_b16 a[28:29], v23 offset:4096
ds_read_b64_tr_b16 a[30:31], v23 offset:6144
ds_read_b64_tr_b16 a[32:33], v20 offset:8192
ds_read_b64_tr_b16 a[34:35], v20 offset:10240
ds_read_b64_tr_b16 a[36:37], v21 offset:8192
ds_read_b64_tr_b16 a[38:39], v21 offset:10240
ds_read_b64_tr_b16 a[40:41], v22 offset:8192
ds_read_b64_tr_b16 a[42:43], v22 offset:10240
ds_read_b64_tr_b16 a[44:45], v23 offset:8192
ds_read_b64_tr_b16 a[46:47], v23 offset:10240
ds_read_b64_tr_b16 a[48:49], v20 offset:12288
ds_read_b64_tr_b16 a[50:51], v20 offset:14336
ds_read_b64_tr_b16 a[52:53], v21 offset:12288
ds_read_b64_tr_b16 a[54:55], v21 offset:14336
ds_read_b64_tr_b16 a[56:57], v22 offset:12288
ds_read_b64_tr_b16 a[58:59], v22 offset:14336
ds_read_b64_tr_b16 a[60:61], v23 offset:12288
ds_read_b64_tr_b16 a[62:63], v23 offset:14336
ds_read_b64_tr_b16 a[64:65], v20 offset:16384
ds_read_b64_tr_b16 a[66:67], v20 offset:18432
ds_read_b64_tr_b16 a[68:69], v21 offset:16384
ds_read_b64_tr_b16 a[70:71], v21 offset:18432
ds_read_b64_tr_b16 a[72:73], v22 offset:16384
ds_read_b64_tr_b16 a[74:75], v22 offset:18432
ds_read_b64_tr_b16 a[76:77], v23 offset:16384
ds_read_b64_tr_b16 a[78:79], v23 offset:18432
ds_read_b64_tr_b16 a[80:81], v20 offset:20480
ds_read_b64_tr_b16 a[82:83], v20 offset:22528
ds_read_b64_tr_b16 a[84:85], v21 offset:20480
ds_read_b64_tr_b16 a[86:87], v21 offset:22528
ds_read_b64_tr_b16 a[88:89], v22 offset:20480
ds_read_b64_tr_b16 a[90:91], v22 offset:22528
ds_read_b64_tr_b16 a[92:93], v23 offset:20480
ds_read_b64_tr_b16 a[94:95], v23 offset:22528
ds_read_b64_tr_b16 a[96:97], v20 offset:24576
ds_read_b64_tr_b16 a[98:99], v20 offset:26624
ds_read_b64_tr_b16 a[100:101], v21 offset:24576
ds_read_b64_tr_b16 a[102:103], v21 offset:26624
ds_read_b64_tr_b16 a[104:105], v22 offset:24576
ds_read_b64_tr_b16 a[106:107], v22 offset:26624
ds_read_b64_tr_b16 a[108:109], v23 offset:24576
ds_read_b64_tr_b16 a[110:111], v23 offset:26624
ds_read_b64_tr_b16 a[112:113], v20 offset:28672
ds_read_b64_tr_b16 a[114:115], v20 offset:30720
ds_read_b64_tr_b16 a[116:117], v21 offset:28672
ds_read_b64_tr_b16 a[118:119], v21 offset:30720
ds_read_b64_tr_b16 a[120:121], v22 offset:28672
ds_read_b64_tr_b16 a[122:123], v22 offset:30720
ds_read_b64_tr_b16 a[124:125], v23 offset:28672
ds_read_b64_tr_b16 a[126:127], v23 offset:30720
ds_read_b64_tr_b16 a[128:129], v20 offset:32768
ds_read_b64_tr_b16 a[130:131], v20 offset:34816
ds_read_b64_tr_b16 a[132:133], v21 offset:32768
ds_read_b64_tr_b16 a[134:135], v21 offset:34816
ds_read_b64_tr_b16 a[136:137], v22 offset:32768
ds_read_b64_tr_b16 a[138:139], v22 offset:34816
ds_read_b64_tr_b16 a[140:141], v23 offset:32768
ds_read_b64_tr_b16 a[142:143], v23 offset:34816
ds_read_b64_tr_b16 a[144:145], v20 offset:36864
ds_read_b64_tr_b16 a[146:147], v20 offset:38912
ds_read_b64_tr_b16 a[148:149], v21 offset:36864
ds_read_b64_tr_b16 a[150:151], v21 offset:38912
ds_read_b64_tr_b16 a[152:153], v22 offset:36864
ds_read_b64_tr_b16 a[154:155], v22 offset:38912
ds_read_b64_tr_b16 a[156:157], v23 offset:36864
ds_read_b64_tr_b16 a[158:159], v23 offset:38912
ds_read_b64_tr_b16 a[160:161], v20 offset:40960
ds_read_b64_tr_b16 a[162:163], v20 offset:43008
ds_read_b64_tr_b16 a[164:165], v21 offset:40960
ds_read_b64_tr_b16 a[166:167], v21 offset:43008
ds_read_b64_tr_b16 a[168:169], v22 offset:40960
ds_read_b64_tr_b16 a[170:171], v22 offset:43008
ds_read_b64_tr_b16 a[172:173], v23 offset:40960
ds_read_b64_tr_b16 a[174:175], v23 offset:43008
ds_read_b64_tr_b16 a[176:177], v20 offset:45056
ds_read_b64_tr_b16 a[178:179], v20 offset:47104
ds_read_b64_tr_b16 a[180:181], v21 offset:45056
ds_read_b64_tr_b16 a[182:183], v21 offset:47104
ds_read_b64_tr_b16 a[184:185], v22 offset:45056
ds_read_b64_tr_b16 a[186:187], v22 offset:47104
ds_read_b64_tr_b16 a[188:189], v23 offset:45056
ds_read_b64_tr_b16 a[190:191], v23 offset:47104
ds_read_b64_tr_b16 a[192:193], v20 offset:49152
ds_read_b64_tr_b16 a[194:195], v20 offset:51200
ds_read_b64_tr_b16 a[196:197], v21 offset:49152
ds_read_b64_tr_b16 a[198:199], v21 offset:51200
ds_read_b64_tr_b16 a[200:201], v22 offset:49152
ds_read_b64_tr_b16 a[202:203], v22 offset:51200
ds_read_b64_tr_b16 a[204:205], v23 offset:49152
ds_read_b64_tr_b16 a[206:207], v23 offset:51200
ds_read_b64_tr_b16 a[208:209], v20 offset:53248
ds_read_b64_tr_b16 a[210:211], v20 offset:55296
ds_read_b64_tr_b16 a[212:213], v21 offset:53248
ds_read_b64_tr_b16 a[214:215], v21 offset:55296
ds_read_b64_tr_b16 a[216:217], v22 offset:53248
ds_read_b64_tr_b16 a[218:219], v22 offset:55296
ds_read_b64_tr_b16 a[220:221], v23 offset:53248
ds_read_b64_tr_b16 a[222:223], v23 offset:55296
ds_read_b64_tr_b16 a[224:225], v20 offset:57344
ds_read_b64_tr_b16 a[226:227], v20 offset:59392
ds_read_b64_tr_b16 a[228:229], v21 offset:57344
ds_read_b64_tr_b16 a[230:231], v21 offset:59392
ds_read_b64_tr_b16 a[232:233], v22 offset:57344
ds_read_b64_tr_b16 a[234:235], v22 offset:59392
ds_read_b64_tr_b16 a[236:237], v23 offset:57344
ds_read_b64_tr_b16 a[238:239], v23 offset:59392
ds_read_b64_tr_b16 a[240:241], v20 offset:61440
ds_read_b64_tr_b16 a[242:243], v20 offset:63488
ds_read_b64_tr_b16 a[244:245], v21 offset:61440
ds_read_b64_tr_b16 a[246:247], v21 offset:63488
ds_read_b64_tr_b16 a[248:249], v22 offset:61440
ds_read_b64_tr_b16 a[250:251], v22 offset:63488
ds_read_b64_tr_b16 a[252:253], v23 offset:61440
ds_read_b64_tr_b16 a[254:255], v23 offset:63488
s_waitcnt lgkmcnt(0)
s_waitcnt vmcnt(14)
v_mfma_f32_16x16x32_bf16 v[32:35], a[0:3], v[64:67], 0
v_mfma_f32_16x16x32_bf16 v[36:39], a[4:7], v[64:67], 0
v_mfma_f32_16x16x32_bf16 v[40:43], a[8:11], v[64:67], 0
v_mfma_f32_16x16x32_bf16 v[44:47], a[12:15], v[64:67], 0
v_mfma_f32_16x16x32_bf16 v[32:35], a[16:19], v[68:71], v[32:35]
v_mfma_f32_16x16x32_bf16 v[36:39], a[20:23], v[68:71], v[36:39]
v_mfma_f32_16x16x32_bf16 v[40:43], a[24:27], v[68:71], v[40:43]
v_mfma_f32_16x16x32_bf16 v[44:47], a[28:31], v[68:71], v[44:47]
s_waitcnt vmcnt(12)
v_mfma_f32_16x16x32_bf16 v[32:35], a[32:35], v[72:75], v[32:35]
v_mfma_f32_16x16x32_bf16 v[36:39], a[36:39], v[72:75], v[36:39]
v_mfma_f32_16x16x32_bf16 v[40:43], a[40:43], v[72:75], v[40:43]
v_mfma_f32_16x16x32_bf16 v[44:47], a[44:47], v[72:75], v[44:47]
v_mfma_f32_16x16x32_bf16 v[32:35], a[48:51], v[76:79], v[32:35]
v_mfma_f32_16x16x32_bf16 v[36:39], a[52:55], v[76:79], v[36:39]
v_mfma_f32_16x16x32_bf16 v[40:43], a[56:59], v[76:79], v[40:43]
v_mfma_f32_16x16x32_bf16 v[44:47], a[60:63], v[76:79], v[44:47]
s_waitcnt vmcnt(10)
v_mfma_f32_16x16x32_bf16 v[32:35], a[64:67], v[80:83], v[32:35]
v_mfma_f32_16x16x32_bf16 v[36:39], a[68:71], v[80:83], v[36:39]
v_mfma_f32_16x16x32_bf16 v[40:43], a[72:75], v[80:83], v[40:43]
v_mfma_f32_16x16x32_bf16 v[44:47], a[76:79], v[80:83], v[44:47]
v_mfma_f32_16x16x32_bf16 v[32:35], a[80:83], v[84:87], v[32:35]
v_mfma_f32_16x16x32_bf16 v[36:39], a[84:87], v[84:87], v[36:39]
v_mfma_f32_16x16x32_bf16 v[40:43], a[88:91], v[84:87], v[40:43]
v_mfma_f32_16x16x32_bf16 v[44:47], a[92:95], v[84:87], v[44:47]
s_waitcnt vmcnt(8)
v_mfma_f32_16x16x32_bf16 v[32:35], a[96:99], v[88:91], v[32:35]
v_mfma_f32_16x16x32_bf16 v[36:39], a[100:103], v[88:91], v[36:39]
v_mfma_f32_16x16x32_bf16 v[40:43], a[104:107], v[88:91], v[40:43]
v_mfma_f32_16x16x32_bf16 v[44:47], a[108:111], v[88:91], v[44:47]
v_mfma_f32_16x16x32_bf16 v[32:35], a[112:115], v[92:95], v[32:35]
v_mfma_f32_16x16x32_bf16 v[36:39], a[116:119], v[92:95], v[36:39]
v_mfma_f32_16x16x32_bf16 v[40:43], a[120:123], v[92:95], v[40:43]
v_mfma_f32_16x16x32_bf16 v[44:47], a[124:127], v[92:95], v[44:47]
s_waitcnt vmcnt(6)
v_mfma_f32_16x16x32_bf16 v[32:35], a[128:131], v[96:99], v[32:35]
v_mfma_f32_16x16x32_bf16 v[36:39], a[132:135], v[96:99], v[36:39]
v_mfma_f32_16x16x32_bf16 v[40:43], a[136:139], v[96:99], v[40:43]
v_mfma_f32_16x16x32_bf16 v[44:47], a[140:143], v[96:99], v[44:47]
v_mfma_f32_16x16x32_bf16 v[32:35], a[144:147], v[100:103], v[32:35]
v_mfma_f32_16x16x32_bf16 v[36:39], a[148:151], v[100:103], v[36:39]
v_mfma_f32_16x16x32_bf16 v[40:43], a[152:155], v[100:103], v[40:43]
v_mfma_f32_16x16x32_bf16 v[44:47], a[156:159], v[100:103], v[44:47]
s_waitcnt vmcnt(4)
v_mfma_f32_16x16x32_bf16 v[32:35], a[160:163], v[104:107], v[32:35]
v_mfma_f32_16x16x32_bf16 v[36:39], a[164:167], v[104:107], v[36:39]
v_mfma_f32_16x16x32_bf16 v[40:43], a[168:171], v[104:107], v[40:43]
v_mfma_f32_16x16x32_bf16 v[44:47], a[172:175], v[104:107], v[44:47]
v_mfma_f32_16x16x32_bf16 v[32:35], a[176:179], v[108:111], v[32:35]
v_mfma_f32_16x16x32_bf16 v[36:39], a[180:183], v[108:111], v[36:39]
v_mfma_f32_16x16x32_bf16 v[40:43], a[184:187], v[108:111], v[40:43]
v_mfma_f32_16x16x32_bf16 v[44:47], a[188:191], v[108:111], v[44:47]
s_waitcnt vmcnt(2)
v_mfma_f32_16x16x32_bf16 v[32:35], a[192:195], v[112:115], v[32:35]
v_mfma_f32_16x16x32_bf16 v[36:39], a[196:199], v[112:115], v[36:39]
v_mfma_f32_16x16x32_bf16 v[40:43], a[200:203], v[112:115], v[40:43]
v_mfma_f32_16x16x32_bf16 v[44:47], a[204:207], v[112:115], v[44:47]
v_mfma_f32_16x16x32_bf16 v[32:35], a[208:211], v[116:119], v[32:35]
v_mfma_f32_16x16x32_bf16 v[36:39], a[212:215], v[116:119], v[36:39]
v_mfma_f32_16x16x32_bf16 v[40:43], a[216:219], v[116:119], v[40:43]
v_mfma_f32_16x16x32_bf16 v[44:47], a[220:223], v[116:119], v[44:47]
s_waitcnt vmcnt(0)
v_mfma_f32_16x16x32_bf16 v[32:35], a[224:227], v[120:123], v[32:35]
v_mfma_f32_16x16x32_bf16 v[36:39], a[228:231], v[120:123], v[36:39]
v_mfma_f32_16x16x32_bf16 v[40:43], a[232:235], v[120:123], v[40:43]
v_mfma_f32_16x16x32_bf16 v[44:47], a[236:239], v[120:123], v[44:47]
v_mfma_f32_16x16x32_bf16 v[32:35], a[240:243], v[124:127], v[32:35]
v_mfma_f32_16x16x32_bf16 v[36:39], a[244:247], v[124:127], v[36:39]
v_mfma_f32_16x16x32_bf16 v[40:43], a[248:251], v[124:127], v[40:43]
v_mfma_f32_16x16x32_bf16 v[44:47], a[252:255], v[124:127], v[44:47]
s_nop 7
v_cvt_pk_bf16_f32 v192, v32, v33
v_cvt_pk_bf16_f32 v193, v34, v35
v_cvt_pk_bf16_f32 v194, v36, v37
v_cvt_pk_bf16_f32 v195, v38, v39
v_cvt_pk_bf16_f32 v196, v40, v41
v_cvt_pk_bf16_f32 v197, v42, v43
v_cvt_pk_bf16_f32 v198, v44, v45
v_cvt_pk_bf16_f32 v199, v46, v47
s_nop 1
v_permlane16_swap_b32 v192, v194
v_permlane16_swap_b32 v193, v195
v_permlane16_swap_b32 v196, v198
v_permlane16_swap_b32 v197, v199
buffer_store_dwordx4 v[192:195], v2, s[24:27], s45 offen offset:0
buffer_store_dwordx4 v[196:199], v2, s[24:27], s45 offen offset:64
s_branch mega_kernel_tnext
mega_kernel_fin:
s_endpgm
mega_kernel_t0_h0_far:
s_cmp_eq_u32 s21, 16
s_cbranch_scc0 mega_kernel_t0_h0_c
s_mov_b32 s4, s40
s_mov_b32 s5, s41
s_mov_b32 s32, 896
s_mov_b32 s16, s42
s_mov_b32 s8, s44
s_mov_b32 s9, s45
s_mov_b32 s17, s48
s_mov_b32 s33, s43
s_mov_b32 s34, s49
s_mov_b32 s39, 18
v_lshrrev_b32 v2, 3, v1
s_lshl_b32 s61, s20, 6
v_add_u32 v2, s61, v2
v_mul_lo_u32 v2, v2, s32
v_and_b32 v3, 7, v1
v_lshrrev_b32 v4, 4, v1
v_xor_b32 v3, v3, v4
v_lshlrev_b32 v3, 4, v3
v_xor_b32 v5, 64, v3
v_add_u32 v16, v2, v3
v_add_u32 v5, v2, v5
s_lshl_b32 s61, s32, 3
s_mov_b32 s64, 0
s_add_u32 s64, s64, s61
s_sub_u32 s65, s64, 1024
v_add_u32 v17, s65, v5
s_add_u32 s64, s64, s61
s_sub_u32 s65, s64, 2048
v_add_u32 v18, s65, v16
s_add_u32 s64, s64, s61
s_sub_u32 s65, s64, 3072
v_add_u32 v19, s65, v5
s_add_u32 s64, s64, s61
s_sub_u32 s65, s64, 0
v_add_u32 v20, s65, v16
s_add_u32 s64, s64, s61
s_sub_u32 s65, s64, 1024
v_add_u32 v21, s65, v5
s_add_u32 s64, s64, s61
s_sub_u32 s65, s64, 2048
v_add_u32 v22, s65, v16
s_add_u32 s64, s64, s61
s_sub_u32 s65, s64, 3072
v_add_u32 v23, s65, v5
s_mov_b32 s18, 0
s_mov_b32 s6, s16
v_lshrrev_b32 v2, 5, v1
s_lshl_b32 s61, s20, 4
v_add_u32 v3, s61, v2
v_mul_lo_u32 v3, v3, s33
v_bfe_u32 v4, v1, 1, 4
v_xor_b32 v4, v4, v2
v_and_b32 v5, 1, v4
v_lshlrev_b32 v5, 5, v5
v_and_b32 v6, 1, v1
v_lshl_add_u32 v5, v6, 4, v5
v_add_u32 v3, v3, v5
v_lshrrev_b32 v4, 1, v4
v_xor_b32 v5, 0, v4
v_mul_lo_u32 v5, v5, s34
v_add_u32 v6, v3, v5
v_xor_b32 v5, 1, v4
v_mul_lo_u32 v5, v5, s34
v_add_u32 v7, v3, v5
v_xor_b32 v5, 2, v4
v_mul_lo_u32 v5, v5, s34
v_add_u32 v8, v3, v5
v_xor_b32 v5, 3, v4
v_mul_lo_u32 v5, v5, s34
v_add_u32 v9, v3, v5
s_lshl_b32 s61, s33, 1
s_mov_b32 s64, 0
s_sub_u32 s65, s64, 0
v_add_u32 v24, s65, v6
s_add_u32 s64, s64, s61
s_sub_u32 s65, s64, 1024
v_add_u32 v25, s65, v7
s_add_u32 s64, s64, s61
s_sub_u32 s65, s64, 2048
v_add_u32 v26, s65, v6
s_add_u32 s64, s64, s61
s_sub_u32 s65, s64, 3072
v_add_u32 v27, s65, v7
s_add_u32 s64, s64, s61
s_sub_u32 s65, s64, 0
v_add_u32 v28, s65, v8
s_add_u32 s64, s64, s61
s_sub_u32 s65, s64, 1024
v_add_u32 v29, s65, v9
s_add_u32 s64, s64, s61
s_sub_u32 s65, s64, 2048
v_add_u32 v30, s65, v8
s_add_u32 s64, s64, s61
s_sub_u32 s65, s64, 3072
v_add_u32 v31, s65, v9
s_lshl_b32 s23, s33, 6
s_mov_b32 s19, 0
s_mov_b32 s10, s17
s_branch mega_kernel_t0_hkr0
mega_kernel_t0_h0_c:
s_cmp_eq_u32 s21, 18
s_cbranch_scc0 mega_kernel_t0_h0_d
s_mov_b32 s39, 23
s_cmp_eq_u32 s20, 0
s_cbranch_scc0 mega_kernel_t0_hkr0
s_lshl_b32 s61, s56, 2
v_mov_b32 v3, s61
v_mov_b32 v2, 1
s_mov_b64 exec, 1
global_atomic_add v3, v2, s[52:53] sc1
s_mov_b64 exec, -1
s_branch mega_kernel_t0_hkr0
mega_kernel_t0_h0_d:
s_mov_b32 s6, 0
s_mov_b32 s10, 0
s_mov_b32 s82, 0
s_branch mega_kernel_t0_hkr0
mega_kernel_t0_hk1:
s_cmp_eq_u32 s21, 16
s_cbranch_scc0 mega_kernel_t0_h1_c
s_mov_b32 s4, s40
s_mov_b32 s5, s41
s_mov_b32 s32, 896
s_mov_b32 s16, s42
s_mov_b32 s8, s44
s_mov_b32 s9, s45
s_mov_b32 s17, s48
s_mov_b32 s33, s43
s_mov_b32 s34, s49
s_mov_b32 s39, 18
v_lshrrev_b32 v2, 3, v1
s_lshl_b32 s61, s20, 6
v_add_u32 v2, s61, v2
v_mul_lo_u32 v2, v2, s32
v_and_b32 v3, 7, v1
v_lshrrev_b32 v4, 4, v1
v_xor_b32 v3, v3, v4
v_lshlrev_b32 v3, 4, v3
v_xor_b32 v5, 64, v3
v_add_u32 v16, v2, v3
v_add_u32 v5, v2, v5
s_lshl_b32 s61, s32, 3
s_mov_b32 s64, 0
s_add_u32 s64, s64, s61
s_sub_u32 s65, s64, 1024
v_add_u32 v17, s65, v5
s_add_u32 s64, s64, s61
s_sub_u32 s65, s64, 2048
v_add_u32 v18, s65, v16
s_add_u32 s64, s64, s61
s_sub_u32 s65, s64, 3072
v_add_u32 v19, s65, v5
s_add_u32 s64, s64, s61
s_sub_u32 s65, s64, 0
v_add_u32 v20, s65, v16
s_add_u32 s64, s64, s61
s_sub_u32 s65, s64, 1024
v_add_u32 v21, s65, v5
s_add_u32 s64, s64, s61
s_sub_u32 s65, s64, 2048
v_add_u32 v22, s65, v16
s_add_u32 s64, s64, s61
s_sub_u32 s65, s64, 3072
v_add_u32 v23, s65, v5
s_mov_b32 s18, 0
s_mov_b32 s6, s16
v_lshrrev_b32 v2, 5, v1
s_lshl_b32 s61, s20, 4
v_add_u32 v3, s61, v2
v_mul_lo_u32 v3, v3, s33
v_bfe_u32 v4, v1, 1, 4
v_xor_b32 v4, v4, v2
v_and_b32 v5, 1, v4
v_lshlrev_b32 v5, 5, v5
v_and_b32 v6, 1, v1
v_lshl_add_u32 v5, v6, 4, v5
v_add_u32 v3, v3, v5
v_lshrrev_b32 v4, 1, v4
v_xor_b32 v5, 0, v4
v_mul_lo_u32 v5, v5, s34
v_add_u32 v6, v3, v5
v_xor_b32 v5, 1, v4
v_mul_lo_u32 v5, v5, s34
v_add_u32 v7, v3, v5
v_xor_b32 v5, 2, v4
v_mul_lo_u32 v5, v5, s34
v_add_u32 v8, v3, v5
v_xor_b32 v5, 3, v4
v_mul_lo_u32 v5, v5, s34
v_add_u32 v9, v3, v5
s_lshl_b32 s61, s33, 1
s_mov_b32 s64, 0
s_sub_u32 s65, s64, 0
v_add_u32 v24, s65, v6
s_add_u32 s64, s64, s61
s_sub_u32 s65, s64, 1024
v_add_u32 v25, s65, v7
s_add_u32 s64, s64, s61
s_sub_u32 s65, s64, 2048
v_add_u32 v26, s65, v6
s_add_u32 s64, s64, s61
s_sub_u32 s65, s64, 3072
v_add_u32 v27, s65, v7
s_add_u32 s64, s64, s61
s_sub_u32 s65, s64, 0
v_add_u32 v28, s65, v8
s_add_u32 s64, s64, s61
s_sub_u32 s65, s64, 1024
v_add_u32 v29, s65, v9
s_add_u32 s64, s64, s61
s_sub_u32 s65, s64, 2048
v_add_u32 v30, s65, v8
s_add_u32 s64, s64, s61
s_sub_u32 s65, s64, 3072
v_add_u32 v31, s65, v9
s_lshl_b32 s23, s33, 6
s_mov_b32 s19, 0
s_mov_b32 s10, s17
s_branch mega_kernel_t0_hkr1
mega_kernel_t0_h1_c:
s_cmp_eq_u32 s21, 18
s_cbranch_scc0 mega_kernel_t0_h1_d
s_mov_b32 s39, 23
s_cmp_eq_u32 s20, 0
s_cbranch_scc0 mega_kernel_t0_hkr1
s_lshl_b32 s61, s56, 2
v_mov_b32 v3, s61
v_mov_b32 v2, 1
s_mov_b64 exec, 1
global_atomic_add v3, v2, s[52:53] sc1
s_mov_b64 exec, -1
s_branch mega_kernel_t0_hkr1
mega_kernel_t0_h1_d:
s_mov_b32 s6, 0
s_mov_b32 s10, 0
s_mov_b32 s82, 0
s_branch mega_kernel_t0_hkr1
mega_kernel_t0_epi2:
s_cmp_eq_u32 s79, 0
s_cbranch_scc0 mega_kernel_t0_epifix
s_nop 7
v_cvt_pk_bf16_f32 v48, v64, v65
v_cvt_pk_bf16_f32 v49, v66, v67
v_cvt_pk_bf16_f32 v50, v68, v69
v_cvt_pk_bf16_f32 v51, v70, v71
s_mov_b32 s30, s26
s_mov_b32 s31, s30
buffer_store_dwordx4 v[48:51], v42, s[12:15], s31 offen sc0 sc1
v_cvt_pk_bf16_f32 v52, v96, v97
v_cvt_pk_bf16_f32 v53, v98, v99
v_cvt_pk_bf16_f32 v54, v100, v101
v_cvt_pk_bf16_f32 v55, v102, v103
s_add_u32 s36, s31, s28
buffer_store_dwordx4 v[52:55], v42, s[12:15], s36 offen sc0 sc1
v_cvt_pk_bf16_f32 v56, v128, v129
v_cvt_pk_bf16_f32 v57, v130, v131
v_cvt_pk_bf16_f32 v58, v132, v133
v_cvt_pk_bf16_f32 v59, v134, v135
s_add_u32 s31, s31, s27
buffer_store_dwordx4 v[56:59], v42, s[12:15], s31 offen sc0 sc1
v_cvt_pk_bf16_f32 v60, v160, v161
v_cvt_pk_bf16_f32 v61, v162, v163
v_cvt_pk_bf16_f32 v62, v164, v165
v_cvt_pk_bf16_f32 v63, v166, v167
s_add_u32 s36, s31, s28
buffer_store_dwordx4 v[60:63], v42, s[12:15], s36 offen sc0 sc1
v_cvt_pk_bf16_f32 v48, v192, v193
v_cvt_pk_bf16_f32 v49, v194, v195
v_cvt_pk_bf16_f32 v50, v196, v197
v_cvt_pk_bf16_f32 v51, v198, v199
s_add_u32 s31, s31, s27
buffer_store_dwordx4 v[48:51], v42, s[12:15], s31 offen sc0 sc1
v_cvt_pk_bf16_f32 v52, v224, v225
v_cvt_pk_bf16_f32 v53, v226, v227
v_cvt_pk_bf16_f32 v54, v228, v229
v_cvt_pk_bf16_f32 v55, v230, v231
s_add_u32 s36, s31, s28
buffer_store_dwordx4 v[52:55], v42, s[12:15], s36 offen sc0 sc1
v_accvgpr_read_b32 v2, a128
v_accvgpr_read_b32 v3, a129
v_accvgpr_read_b32 v4, a130
v_accvgpr_read_b32 v5, a131
v_accvgpr_read_b32 v6, a132
v_accvgpr_read_b32 v7, a133
v_accvgpr_read_b32 v8, a134
v_accvgpr_read_b32 v9, a135
v_cvt_pk_bf16_f32 v56, v2, v3
v_cvt_pk_bf16_f32 v57, v4, v5
v_cvt_pk_bf16_f32 v58, v6, v7
v_cvt_pk_bf16_f32 v59, v8, v9
s_add_u32 s31, s31, s27
buffer_store_dwordx4 v[56:59], v42, s[12:15], s31 offen sc0 sc1
v_accvgpr_read_b32 v2, a160
v_accvgpr_read_b32 v3, a161
v_accvgpr_read_b32 v4, a162
v_accvgpr_read_b32 v5, a163
v_accvgpr_read_b32 v6, a164
v_accvgpr_read_b32 v7, a165
v_accvgpr_read_b32 v8, a166
v_accvgpr_read_b32 v9, a167
v_cvt_pk_bf16_f32 v60, v2, v3
v_cvt_pk_bf16_f32 v61, v4, v5
v_cvt_pk_bf16_f32 v62, v6, v7
v_cvt_pk_bf16_f32 v63, v8, v9
s_add_u32 s36, s31, s28
buffer_store_dwordx4 v[60:63], v42, s[12:15], s36 offen sc0 sc1
v_cvt_pk_bf16_f32 v48, v72, v73
v_cvt_pk_bf16_f32 v49, v74, v75
v_cvt_pk_bf16_f32 v50, v76, v77
v_cvt_pk_bf16_f32 v51, v78, v79
s_add_u32 s30, s30, s29
s_mov_b32 s31, s30
buffer_store_dwordx4 v[48:51], v42, s[12:15], s31 offen sc0 sc1
v_cvt_pk_bf16_f32 v52, v104, v105
v_cvt_pk_bf16_f32 v53, v106, v107
v_cvt_pk_bf16_f32 v54, v108, v109
v_cvt_pk_bf16_f32 v55, v110, v111
s_add_u32 s36, s31, s28
buffer_store_dwordx4 v[52:55], v42, s[12:15], s36 offen sc0 sc1
v_cvt_pk_bf16_f32 v56, v136, v137
v_cvt_pk_bf16_f32 v57, v138, v139
v_cvt_pk_bf16_f32 v58, v140, v141
v_cvt_pk_bf16_f32 v59, v142, v143
s_add_u32 s31, s31, s27
buffer_store_dwordx4 v[56:59], v42, s[12:15], s31 offen sc0 sc1
v_cvt_pk_bf16_f32 v60, v168, v169
v_cvt_pk_bf16_f32 v61, v170, v171
v_cvt_pk_bf16_f32 v62, v172, v173
v_cvt_pk_bf16_f32 v63, v174, v175
s_add_u32 s36, s31, s28
buffer_store_dwordx4 v[60:63], v42, s[12:15], s36 offen sc0 sc1
v_cvt_pk_bf16_f32 v48, v200, v201
v_cvt_pk_bf16_f32 v49, v202, v203
v_cvt_pk_bf16_f32 v50, v204, v205
v_cvt_pk_bf16_f32 v51, v206, v207
s_add_u32 s31, s31, s27
buffer_store_dwordx4 v[48:51], v42, s[12:15], s31 offen sc0 sc1
v_cvt_pk_bf16_f32 v52, v232, v233
v_cvt_pk_bf16_f32 v53, v234, v235
v_cvt_pk_bf16_f32 v54, v236, v237
v_cvt_pk_bf16_f32 v55, v238, v239
s_add_u32 s36, s31, s28
buffer_store_dwordx4 v[52:55], v42, s[12:15], s36 offen sc0 sc1
v_accvgpr_read_b32 v2, a136
v_accvgpr_read_b32 v3, a137
v_accvgpr_read_b32 v4, a138
v_accvgpr_read_b32 v5, a139
v_accvgpr_read_b32 v6, a140
v_accvgpr_read_b32 v7, a141
v_accvgpr_read_b32 v8, a142
v_accvgpr_read_b32 v9, a143
v_cvt_pk_bf16_f32 v56, v2, v3
v_cvt_pk_bf16_f32 v57, v4, v5
v_cvt_pk_bf16_f32 v58, v6, v7
v_cvt_pk_bf16_f32 v59, v8, v9
s_add_u32 s31, s31, s27
buffer_store_dwordx4 v[56:59], v42, s[12:15], s31 offen sc0 sc1
v_accvgpr_read_b32 v2, a168
v_accvgpr_read_b32 v3, a169
v_accvgpr_read_b32 v4, a170
v_accvgpr_read_b32 v5, a171
v_accvgpr_read_b32 v6, a172
v_accvgpr_read_b32 v7, a173
v_accvgpr_read_b32 v8, a174
v_accvgpr_read_b32 v9, a175
v_cvt_pk_bf16_f32 v60, v2, v3
v_cvt_pk_bf16_f32 v61, v4, v5
v_cvt_pk_bf16_f32 v62, v6, v7
v_cvt_pk_bf16_f32 v63, v8, v9
s_add_u32 s36, s31, s28
buffer_store_dwordx4 v[60:63], v42, s[12:15], s36 offen sc0 sc1
v_cvt_pk_bf16_f32 v48, v80, v81
v_cvt_pk_bf16_f32 v49, v82, v83
v_cvt_pk_bf16_f32 v50, v84, v85
v_cvt_pk_bf16_f32 v51, v86, v87
s_add_u32 s30, s30, s29
s_mov_b32 s31, s30
buffer_store_dwordx4 v[48:51], v42, s[12:15], s31 offen sc0 sc1
v_cvt_pk_bf16_f32 v52, v112, v113
v_cvt_pk_bf16_f32 v53, v114, v115
v_cvt_pk_bf16_f32 v54, v116, v117
v_cvt_pk_bf16_f32 v55, v118, v119
s_add_u32 s36, s31, s28
buffer_store_dwordx4 v[52:55], v42, s[12:15], s36 offen sc0 sc1
v_cvt_pk_bf16_f32 v56, v144, v145
v_cvt_pk_bf16_f32 v57, v146, v147
v_cvt_pk_bf16_f32 v58, v148, v149
v_cvt_pk_bf16_f32 v59, v150, v151
s_add_u32 s31, s31, s27
buffer_store_dwordx4 v[56:59], v42, s[12:15], s31 offen sc0 sc1
v_cvt_pk_bf16_f32 v60, v176, v177
v_cvt_pk_bf16_f32 v61, v178, v179
v_cvt_pk_bf16_f32 v62, v180, v181
v_cvt_pk_bf16_f32 v63, v182, v183
s_add_u32 s36, s31, s28
buffer_store_dwordx4 v[60:63], v42, s[12:15], s36 offen sc0 sc1
v_cvt_pk_bf16_f32 v48, v208, v209
v_cvt_pk_bf16_f32 v49, v210, v211
v_cvt_pk_bf16_f32 v50, v212, v213
v_cvt_pk_bf16_f32 v51, v214, v215
s_add_u32 s31, s31, s27
buffer_store_dwordx4 v[48:51], v42, s[12:15], s31 offen sc0 sc1
v_cvt_pk_bf16_f32 v52, v240, v241
v_cvt_pk_bf16_f32 v53, v242, v243
v_cvt_pk_bf16_f32 v54, v244, v245
v_cvt_pk_bf16_f32 v55, v246, v247
s_add_u32 s36, s31, s28
buffer_store_dwordx4 v[52:55], v42, s[12:15], s36 offen sc0 sc1
v_accvgpr_read_b32 v2, a144
v_accvgpr_read_b32 v3, a145
v_accvgpr_read_b32 v4, a146
v_accvgpr_read_b32 v5, a147
v_accvgpr_read_b32 v6, a148
v_accvgpr_read_b32 v7, a149
v_accvgpr_read_b32 v8, a150
v_accvgpr_read_b32 v9, a151
v_cvt_pk_bf16_f32 v56, v2, v3
v_cvt_pk_bf16_f32 v57, v4, v5
v_cvt_pk_bf16_f32 v58, v6, v7
v_cvt_pk_bf16_f32 v59, v8, v9
s_add_u32 s31, s31, s27
buffer_store_dwordx4 v[56:59], v42, s[12:15], s31 offen sc0 sc1
v_accvgpr_read_b32 v2, a176
v_accvgpr_read_b32 v3, a177
v_accvgpr_read_b32 v4, a178
v_accvgpr_read_b32 v5, a179
v_accvgpr_read_b32 v6, a180
v_accvgpr_read_b32 v7, a181
v_accvgpr_read_b32 v8, a182
v_accvgpr_read_b32 v9, a183
v_cvt_pk_bf16_f32 v60, v2, v3
v_cvt_pk_bf16_f32 v61, v4, v5
v_cvt_pk_bf16_f32 v62, v6, v7
v_cvt_pk_bf16_f32 v63, v8, v9
s_add_u32 s36, s31, s28
buffer_store_dwordx4 v[60:63], v42, s[12:15], s36 offen sc0 sc1
v_cvt_pk_bf16_f32 v48, v88, v89
v_cvt_pk_bf16_f32 v49, v90, v91
v_cvt_pk_bf16_f32 v50, v92, v93
v_cvt_pk_bf16_f32 v51, v94, v95
s_add_u32 s30, s30, s29
s_mov_b32 s31, s30
buffer_store_dwordx4 v[48:51], v42, s[12:15], s31 offen sc0 sc1
v_cvt_pk_bf16_f32 v52, v120, v121
v_cvt_pk_bf16_f32 v53, v122, v123
v_cvt_pk_bf16_f32 v54, v124, v125
v_cvt_pk_bf16_f32 v55, v126, v127
s_add_u32 s36, s31, s28
buffer_store_dwordx4 v[52:55], v42, s[12:15], s36 offen sc0 sc1
v_cvt_pk_bf16_f32 v56, v152, v153
v_cvt_pk_bf16_f32 v57, v154, v155
v_cvt_pk_bf16_f32 v58, v156, v157
v_cvt_pk_bf16_f32 v59, v158, v159
s_add_u32 s31, s31, s27
buffer_store_dwordx4 v[56:59], v42, s[12:15], s31 offen sc0 sc1
v_cvt_pk_bf16_f32 v60, v184, v185
v_cvt_pk_bf16_f32 v61, v186, v187
v_cvt_pk_bf16_f32 v62, v188, v189
v_cvt_pk_bf16_f32 v63, v190, v191
s_add_u32 s36, s31, s28
buffer_store_dwordx4 v[60:63], v42, s[12:15], s36 offen sc0 sc1
v_cvt_pk_bf16_f32 v48, v216, v217
v_cvt_pk_bf16_f32 v49, v218, v219
v_cvt_pk_bf16_f32 v50, v220, v221
v_cvt_pk_bf16_f32 v51, v222, v223
s_add_u32 s31, s31, s27
buffer_store_dwordx4 v[48:51], v42, s[12:15], s31 offen sc0 sc1
v_cvt_pk_bf16_f32 v52, v248, v249
v_cvt_pk_bf16_f32 v53, v250, v251
v_cvt_pk_bf16_f32 v54, v252, v253
v_cvt_pk_bf16_f32 v55, v254, v255
s_add_u32 s36, s31, s28
buffer_store_dwordx4 v[52:55], v42, s[12:15], s36 offen sc0 sc1
v_accvgpr_read_b32 v2, a152
v_accvgpr_read_b32 v3, a153
v_accvgpr_read_b32 v4, a154
v_accvgpr_read_b32 v5, a155
v_accvgpr_read_b32 v6, a156
v_accvgpr_read_b32 v7, a157
v_accvgpr_read_b32 v8, a158
v_accvgpr_read_b32 v9, a159
v_cvt_pk_bf16_f32 v56, v2, v3
v_cvt_pk_bf16_f32 v57, v4, v5
v_cvt_pk_bf16_f32 v58, v6, v7
v_cvt_pk_bf16_f32 v59, v8, v9
s_add_u32 s31, s31, s27
buffer_store_dwordx4 v[56:59], v42, s[12:15], s31 offen sc0 sc1
v_accvgpr_read_b32 v2, a184
v_accvgpr_read_b32 v3, a185
v_accvgpr_read_b32 v4, a186
v_accvgpr_read_b32 v5, a187
v_accvgpr_read_b32 v6, a188
v_accvgpr_read_b32 v7, a189
v_accvgpr_read_b32 v8, a190
v_accvgpr_read_b32 v9, a191
v_cvt_pk_bf16_f32 v60, v2, v3
v_cvt_pk_bf16_f32 v61, v4, v5
v_cvt_pk_bf16_f32 v62, v6, v7
v_cvt_pk_bf16_f32 v63, v8, v9
s_add_u32 s36, s31, s28
buffer_store_dwordx4 v[60:63], v42, s[12:15], s36 offen sc0 sc1
s_branch mega_kernel_next
mega_kernel_t0_epifix:
s_waitcnt lgkmcnt(0)
s_load_dwordx2 s[68:69], s[0:1], 24
s_load_dwordx2 s[48:49], s[0:1], 64
s_load_dwordx2 s[50:51], s[0:1], 16
s_load_dwordx2 s[8:9], s[0:1], 40
s_mov_b32 s33, 8192
s_mov_b32 s34, 64
s_lshl_b32 s17, s56, 9
v_lshrrev_b32 v2, 5, v1
s_lshl_b32 s61, s20, 4
v_add_u32 v3, s61, v2
v_mul_lo_u32 v3, v3, s33
v_bfe_u32 v4, v1, 1, 4
v_xor_b32 v4, v4, v2
v_and_b32 v5, 1, v4
v_lshlrev_b32 v5, 5, v5
v_and_b32 v6, 1, v1
v_lshl_add_u32 v5, v6, 4, v5
v_add_u32 v3, v3, v5
v_lshrrev_b32 v4, 1, v4
v_xor_b32 v5, 0, v4
v_mul_lo_u32 v5, v5, s34
v_add_u32 v6, v3, v5
v_xor_b32 v5, 1, v4
v_mul_lo_u32 v5, v5, s34
v_add_u32 v7, v3, v5
v_xor_b32 v5, 2, v4
v_mul_lo_u32 v5, v5, s34
v_add_u32 v8, v3, v5
v_xor_b32 v5, 3, v4
v_mul_lo_u32 v5, v5, s34
v_add_u32 v9, v3, v5
s_lshl_b32 s61, s33, 1
s_mov_b32 s64, 0
s_sub_u32 s65, s64, 0
v_add_u32 v24, s65, v6
s_add_u32 s64, s64, s61
s_sub_u32 s65, s64, 1024
v_add_u32 v25, s65, v7
s_add_u32 s64, s64, s61
s_sub_u32 s65, s64, 2048
v_add_u32 v26, s65, v6
s_add_u32 s64, s64, s61
s_sub_u32 s65, s64, 3072
v_add_u32 v27, s65, v7
s_add_u32 s64, s64, s61
s_sub_u32 s65, s64, 0
v_add_u32 v28, s65, v8
s_add_u32 s64, s64, s61
s_sub_u32 s65, s64, 1024
v_add_u32 v29, s65, v9
s_add_u32 s64, s64, s61
s_sub_u32 s65, s64, 2048
v_add_u32 v30, s65, v8
s_add_u32 s64, s64, s61
s_sub_u32 s65, s64, 3072
v_add_u32 v31, s65, v9
s_lshl_b32 s23, s33, 6
s_mov_b32 s19, 0
s_lshl_b32 s18, s20, 13
s_lshr_b32 s41, s55, 1
s_sub_u32 s41, 15, s41
s_mul_i32 s61, s41, 114688
s_mov_b32 s70, 172032
s_lshl_b32 s25, s20, 12
s_add_u32 s25, s25, 32768
s_mov_b32 s65, 57344
v_lshrrev_b32 v2, 3, v1
s_lshl_b32 s64, s20, 5
v_add_u32 v2, s64, v2
v_mul_u32_u24 v2, 896, v2
v_and_b32 v3, 7, v1
v_lshrrev_b32 v4, 4, v1
v_xor_b32 v3, v3, v4
v_lshlrev_b32 v3, 4, v3
v_xor_b32 v4, 64, v3
v_add_u32 v14, v2, v3
v_add_u32 v4, v2, v4
v_add_u32 v15, 6144, v4
v_add_u32 v59, 12288, v14
v_add_u32 v61, 18432, v4
s_waitcnt lgkmcnt(0)
s_add_u32 s68, s68, s61
s_addc_u32 s69, s69, 0
s_sub_u32 s68, s68, 57344
s_subb_u32 s69, s69, 0
s_add_u32 s8, s8, s17
s_addc_u32 s9, s9, 0
s_sub_u32 s10, 3670016, s17
s_add_u32 m0, s18, 65536
s_nop 0
buffer_load_dwordx4 v24, s[8:11], s19 offen offset:0 lds
buffer_load_dwordx4 v25, s[8:11], s19 offen offset:1024 lds
buffer_load_dwordx4 v26, s[8:11], s19 offen offset:2048 lds
buffer_load_dwordx4 v27, s[8:11], s19 offen offset:3072 lds
s_add_u32 m0, s18, 69632
s_nop 0
buffer_load_dwordx4 v28, s[8:11], s19 offen offset:0 lds
buffer_load_dwordx4 v29, s[8:11], s19 offen offset:1024 lds
buffer_load_dwordx4 v30, s[8:11], s19 offen offset:2048 lds
buffer_load_dwordx4 v31, s[8:11], s19 offen offset:3072 lds
s_add_u32 s19, s19, s23
s_add_u32 m0, s18, 98304
s_nop 0
buffer_load_dwordx4 v24, s[8:11], s19 offen offset:0 lds
buffer_load_dwordx4 v25, s[8:11], s19 offen offset:1024 lds
buffer_load_dwordx4 v26, s[8:11], s19 offen offset:2048 lds
buffer_load_dwordx4 v27, s[8:11], s19 offen offset:3072 lds
s_add_u32 m0, s18, 102400
s_nop 0
buffer_load_dwordx4 v28, s[8:11], s19 offen offset:0 lds
buffer_load_dwordx4 v29, s[8:11], s19 offen offset:1024 lds
buffer_load_dwordx4 v30, s[8:11], s19 offen offset:2048 lds
buffer_load_dwordx4 v31, s[8:11], s19 offen offset:3072 lds
s_add_u32 s19, s19, s23
s_add_u32 m0, s25, 98304
s_nop 0
buffer_load_dwordx4 v14, s[68:71], s65 offen offset:0 lds
buffer_load_dwordx4 v15, s[68:71], s65 offen offset:1024 lds
buffer_load_dwordx4 v59, s[68:71], s65 offen offset:2048 lds
buffer_load_dwordx4 v61, s[68:71], s65 offen offset:3072 lds
s_add_u32 s65, s65, 128
s_add_u32 m0, s25, 114688
s_nop 0
buffer_load_dwordx4 v14, s[68:71], s65 offen offset:0 lds
buffer_load_dwordx4 v15, s[68:71], s65 offen offset:1024 lds
buffer_load_dwordx4 v59, s[68:71], s65 offen offset:2048 lds
buffer_load_dwordx4 v61, s[68:71], s65 offen offset:3072 lds
s_add_u32 s65, s65, 128
s_mul_i32 s86, s87, 3
buffer_load_dword v45, v47, s[80:83], s86 offen
s_add_u32 s86, s86, s87
buffer_load_dword v45, v47, s[80:83], s86 offen
s_add_u32 s86, s86, s87
buffer_load_dword v45, v47, s[80:83], s86 offen
s_add_u32 s86, s86, s87
buffer_load_dword v45, v47, s[80:83], s86 offen
s_add_u32 s86, s86, s87
v_mov_b32 v10, 0
v_mov_b32 v11, 0
v_mov_b32 v12, 0
v_mov_b32 v13, 0
v_mul_f32 v192, s78, v192
v_mul_f32 v193, s78, v193
v_mul_f32 v194, s78, v194
v_mul_f32 v195, s78, v195
v_mul_f32 v196, s78, v196
v_mul_f32 v197, s78, v197
v_mul_f32 v198, s78, v198
v_mul_f32 v199, s78, v199
v_cvt_pk_bf16_f32 v192, v192, v193
v_cvt_pk_bf16_f32 v193, v194, v195
v_cvt_pk_bf16_f32 v194, v196, v197
v_cvt_pk_bf16_f32 v195, v198, v199
v_and_b32 v194, v194, v43
v_and_b32 v195, v195, v43
v_mul_f32 v200, s78, v200
v_mul_f32 v201, s78, v201
v_mul_f32 v202, s78, v202
v_mul_f32 v203, s78, v203
v_mul_f32 v204, s78, v204
v_mul_f32 v205, s78, v205
v_mul_f32 v206, s78, v206
v_mul_f32 v207, s78, v207
v_cvt_pk_bf16_f32 v196, v200, v201
v_cvt_pk_bf16_f32 v197, v202, v203
v_cvt_pk_bf16_f32 v198, v204, v205
v_cvt_pk_bf16_f32 v199, v206, v207
v_and_b32 v198, v198, v43
v_and_b32 v199, v199, v43
v_mul_f32 v208, s78, v208
v_mul_f32 v209, s78, v209
v_mul_f32 v210, s78, v210
v_mul_f32 v211, s78, v211
v_mul_f32 v212, s78, v212
v_mul_f32 v213, s78, v213
v_mul_f32 v214, s78, v214
v_mul_f32 v215, s78, v215
v_cvt_pk_bf16_f32 v200, v208, v209
v_cvt_pk_bf16_f32 v201, v210, v211
v_cvt_pk_bf16_f32 v202, v212, v213
v_cvt_pk_bf16_f32 v203, v214, v215
v_and_b32 v202, v202, v43
v_and_b32 v203, v203, v43
v_mul_f32 v216, s78, v216
v_mul_f32 v217, s78, v217
v_mul_f32 v218, s78, v218
v_mul_f32 v219, s78, v219
v_mul_f32 v220, s78, v220
v_mul_f32 v221, s78, v221
v_mul_f32 v222, s78, v222
v_mul_f32 v223, s78, v223
v_cvt_pk_bf16_f32 v204, v216, v217
v_cvt_pk_bf16_f32 v205, v218, v219
v_cvt_pk_bf16_f32 v206, v220, v221
v_cvt_pk_bf16_f32 v207, v222, v223
v_and_b32 v206, v206, v43
v_and_b32 v207, v207, v43
v_mul_f32 v224, s78, v224
v_mul_f32 v225, s78, v225
v_mul_f32 v226, s78, v226
v_mul_f32 v227, s78, v227
v_mul_f32 v228, s78, v228
v_mul_f32 v229, s78, v229
v_mul_f32 v230, s78, v230
v_mul_f32 v231, s78, v231
v_cvt_pk_bf16_f32 v208, v224, v225
v_cvt_pk_bf16_f32 v209, v226, v227
v_cvt_pk_bf16_f32 v210, v228, v229
v_cvt_pk_bf16_f32 v211, v230, v231
v_and_b32 v210, v210, v43
v_and_b32 v211, v211, v43
v_mul_f32 v232, s78, v232
v_mul_f32 v233, s78, v233
v_mul_f32 v234, s78, v234
v_mul_f32 v235, s78, v235
v_mul_f32 v236, s78, v236
v_mul_f32 v237, s78, v237
v_mul_f32 v238, s78, v238
v_mul_f32 v239, s78, v239
v_cvt_pk_bf16_f32 v212, v232, v233
v_cvt_pk_bf16_f32 v213, v234, v235
v_cvt_pk_bf16_f32 v214, v236, v237
v_cvt_pk_bf16_f32 v215, v238, v239
v_and_b32 v214, v214, v43
v_and_b32 v215, v215, v43
v_mul_f32 v240, s78, v240
v_mul_f32 v241, s78, v241
v_mul_f32 v242, s78, v242
v_mul_f32 v243, s78, v243
v_mul_f32 v244, s78, v244
v_mul_f32 v245, s78, v245
v_mul_f32 v246, s78, v246
v_mul_f32 v247, s78, v247
v_cvt_pk_bf16_f32 v216, v240, v241
v_cvt_pk_bf16_f32 v217, v242, v243
v_cvt_pk_bf16_f32 v218, v244, v245
v_cvt_pk_bf16_f32 v219, v246, v247
v_and_b32 v218, v218, v43
v_and_b32 v219, v219, v43
v_mul_f32 v248, s78, v248
v_mul_f32 v249, s78, v249
v_mul_f32 v250, s78, v250
v_mul_f32 v251, s78, v251
v_mul_f32 v252, s78, v252
v_mul_f32 v253, s78, v253
v_mul_f32 v254, s78, v254
v_mul_f32 v255, s78, v255
v_cvt_pk_bf16_f32 v220, v248, v249
v_cvt_pk_bf16_f32 v221, v250, v251
v_cvt_pk_bf16_f32 v222, v252, v253
v_cvt_pk_bf16_f32 v223, v254, v255
v_and_b32 v222, v222, v43
v_and_b32 v223, v223, v43
v_accvgpr_read_b32 v2, a128
v_accvgpr_read_b32 v3, a129
v_accvgpr_read_b32 v4, a130
v_accvgpr_read_b32 v5, a131
v_accvgpr_read_b32 v6, a132
v_accvgpr_read_b32 v7, a133
v_accvgpr_read_b32 v8, a134
v_accvgpr_read_b32 v9, a135
v_mul_f32 v2, s78, v2
v_mul_f32 v3, s78, v3
v_mul_f32 v4, s78, v4
v_mul_f32 v5, s78, v5
v_mul_f32 v6, s78, v6
v_mul_f32 v7, s78, v7
v_mul_f32 v8, s78, v8
v_mul_f32 v9, s78, v9
v_cvt_pk_bf16_f32 v224, v2, v3
v_cvt_pk_bf16_f32 v225, v4, v5
v_cvt_pk_bf16_f32 v226, v6, v7
v_cvt_pk_bf16_f32 v227, v8, v9
v_and_b32 v226, v226, v43
v_and_b32 v227, v227, v43
v_accvgpr_read_b32 v2, a136
v_accvgpr_read_b32 v3, a137
v_accvgpr_read_b32 v4, a138
v_accvgpr_read_b32 v5, a139
v_accvgpr_read_b32 v6, a140
v_accvgpr_read_b32 v7, a141
v_accvgpr_read_b32 v8, a142
v_accvgpr_read_b32 v9, a143
v_mul_f32 v2, s78, v2
v_mul_f32 v3, s78, v3
v_mul_f32 v4, s78, v4
v_mul_f32 v5, s78, v5
v_mul_f32 v6, s78, v6
v_mul_f32 v7, s78, v7
v_mul_f32 v8, s78, v8
v_mul_f32 v9, s78, v9
v_cvt_pk_bf16_f32 v228, v2, v3
v_cvt_pk_bf16_f32 v229, v4, v5
v_cvt_pk_bf16_f32 v230, v6, v7
v_cvt_pk_bf16_f32 v231, v8, v9
v_and_b32 v230, v230, v43
v_and_b32 v231, v231, v43
v_accvgpr_read_b32 v2, a144
v_accvgpr_read_b32 v3, a145
v_accvgpr_read_b32 v4, a146
v_accvgpr_read_b32 v5, a147
v_accvgpr_read_b32 v6, a148
v_accvgpr_read_b32 v7, a149
v_accvgpr_read_b32 v8, a150
v_accvgpr_read_b32 v9, a151
v_mul_f32 v2, s78, v2
v_mul_f32 v3, s78, v3
v_mul_f32 v4, s78, v4
v_mul_f32 v5, s78, v5
v_mul_f32 v6, s78, v6
v_mul_f32 v7, s78, v7
v_mul_f32 v8, s78, v8
v_mul_f32 v9, s78, v9
v_cvt_pk_bf16_f32 v232, v2, v3
v_cvt_pk_bf16_f32 v233, v4, v5
v_cvt_pk_bf16_f32 v234, v6, v7
v_cvt_pk_bf16_f32 v235, v8, v9
v_and_b32 v234, v234, v43
v_and_b32 v235, v235, v43
v_accvgpr_read_b32 v2, a152
v_accvgpr_read_b32 v3, a153
v_accvgpr_read_b32 v4, a154
v_accvgpr_read_b32 v5, a155
v_accvgpr_read_b32 v6, a156
v_accvgpr_read_b32 v7, a157
v_accvgpr_read_b32 v8, a158
v_accvgpr_read_b32 v9, a159
v_mul_f32 v2, s78, v2
v_mul_f32 v3, s78, v3
v_mul_f32 v4, s78, v4
v_mul_f32 v5, s78, v5
v_mul_f32 v6, s78, v6
v_mul_f32 v7, s78, v7
v_mul_f32 v8, s78, v8
v_mul_f32 v9, s78, v9
v_cvt_pk_bf16_f32 v236, v2, v3
v_cvt_pk_bf16_f32 v237, v4, v5
v_cvt_pk_bf16_f32 v238, v6, v7
v_cvt_pk_bf16_f32 v239, v8, v9
v_and_b32 v238, v238, v43
v_and_b32 v239, v239, v43
v_accvgpr_read_b32 v2, a160
v_accvgpr_read_b32 v3, a161
v_accvgpr_read_b32 v4, a162
v_accvgpr_read_b32 v5, a163
v_accvgpr_read_b32 v6, a164
v_accvgpr_read_b32 v7, a165
v_accvgpr_read_b32 v8, a166
v_accvgpr_read_b32 v9, a167
v_mul_f32 v2, s78, v2
v_mul_f32 v3, s78, v3
v_mul_f32 v4, s78, v4
v_mul_f32 v5, s78, v5
v_mul_f32 v6, s78, v6
v_mul_f32 v7, s78, v7
v_mul_f32 v8, s78, v8
v_mul_f32 v9, s78, v9
v_cvt_pk_bf16_f32 v240, v2, v3
v_cvt_pk_bf16_f32 v241, v4, v5
v_cvt_pk_bf16_f32 v242, v6, v7
v_cvt_pk_bf16_f32 v243, v8, v9
v_and_b32 v242, v242, v43
v_and_b32 v243, v243, v43
v_accvgpr_read_b32 v2, a168
v_accvgpr_read_b32 v3, a169
v_accvgpr_read_b32 v4, a170
v_accvgpr_read_b32 v5, a171
v_accvgpr_read_b32 v6, a172
v_accvgpr_read_b32 v7, a173
v_accvgpr_read_b32 v8, a174
v_accvgpr_read_b32 v9, a175
v_mul_f32 v2, s78, v2
v_mul_f32 v3, s78, v3
v_mul_f32 v4, s78, v4
v_mul_f32 v5, s78, v5
v_mul_f32 v6, s78, v6
v_mul_f32 v7, s78, v7
v_mul_f32 v8, s78, v8
v_mul_f32 v9, s78, v9
v_cvt_pk_bf16_f32 v244, v2, v3
v_cvt_pk_bf16_f32 v245, v4, v5
v_cvt_pk_bf16_f32 v246, v6, v7
v_cvt_pk_bf16_f32 v247, v8, v9
v_and_b32 v246, v246, v43
v_and_b32 v247, v247, v43
v_accvgpr_read_b32 v2, a176
v_accvgpr_read_b32 v3, a177
v_accvgpr_read_b32 v4, a178
v_accvgpr_read_b32 v5, a179
v_accvgpr_read_b32 v6, a180
v_accvgpr_read_b32 v7, a181
v_accvgpr_read_b32 v8, a182
v_accvgpr_read_b32 v9, a183
v_mul_f32 v2, s78, v2
v_mul_f32 v3, s78, v3
v_mul_f32 v4, s78, v4
v_mul_f32 v5, s78, v5
v_mul_f32 v6, s78, v6
v_mul_f32 v7, s78, v7
v_mul_f32 v8, s78, v8
v_mul_f32 v9, s78, v9
v_cvt_pk_bf16_f32 v248, v2, v3
v_cvt_pk_bf16_f32 v249, v4, v5
v_cvt_pk_bf16_f32 v250, v6, v7
v_cvt_pk_bf16_f32 v251, v8, v9
v_and_b32 v250, v250, v43
v_and_b32 v251, v251, v43
v_accvgpr_read_b32 v2, a184
v_accvgpr_read_b32 v3, a185
v_accvgpr_read_b32 v4, a186
v_accvgpr_read_b32 v5, a187
v_accvgpr_read_b32 v6, a188
v_accvgpr_read_b32 v7, a189
v_accvgpr_read_b32 v8, a190
v_accvgpr_read_b32 v9, a191
v_mul_f32 v2, s78, v2
v_mul_f32 v3, s78, v3
v_mul_f32 v4, s78, v4
v_mul_f32 v5, s78, v5
v_mul_f32 v6, s78, v6
v_mul_f32 v7, s78, v7
v_mul_f32 v8, s78, v8
v_mul_f32 v9, s78, v9
v_cvt_pk_bf16_f32 v252, v2, v3
v_cvt_pk_bf16_f32 v253, v4, v5
v_cvt_pk_bf16_f32 v254, v6, v7
v_cvt_pk_bf16_f32 v255, v8, v9
v_and_b32 v254, v254, v43
v_and_b32 v255, v255, v43
v_mfma_f32_32x32x16_bf16 a[128:143], v[10:13], v[10:13], 0
v_mul_f32 v184, s78, v184
v_mul_f32 v185, s78, v185
v_mul_f32 v186, s78, v186
v_mul_f32 v187, s78, v187
v_mul_f32 v188, s78, v188
v_mul_f32 v189, s78, v189
v_mul_f32 v190, s78, v190
v_mul_f32 v191, s78, v191
v_mfma_f32_32x32x16_bf16 a[144:159], v[10:13], v[10:13], 0
v_cvt_pk_bf16_f32 v191, v190, v191
v_cvt_pk_bf16_f32 v190, v188, v189
v_cvt_pk_bf16_f32 v189, v186, v187
v_cvt_pk_bf16_f32 v188, v184, v185
v_and_b32 v190, v190, v43
v_and_b32 v191, v191, v43
v_mul_f32 v176, s78, v176
v_mul_f32 v177, s78, v177
v_mfma_f32_32x32x16_bf16 a[160:175], v[10:13], v[10:13], 0
v_mul_f32 v178, s78, v178
v_mul_f32 v179, s78, v179
v_mul_f32 v180, s78, v180
v_mul_f32 v181, s78, v181
v_mul_f32 v182, s78, v182
v_mul_f32 v183, s78, v183
v_cvt_pk_bf16_f32 v187, v182, v183
v_cvt_pk_bf16_f32 v186, v180, v181
v_mfma_f32_32x32x16_bf16 a[176:191], v[10:13], v[10:13], 0
v_cvt_pk_bf16_f32 v185, v178, v179
v_cvt_pk_bf16_f32 v184, v176, v177
v_and_b32 v186, v186, v43
v_and_b32 v187, v187, v43
v_mul_f32 v168, s78, v168
v_mul_f32 v169, s78, v169
v_mul_f32 v170, s78, v170
v_mul_f32 v171, s78, v171
v_mfma_f32_32x32x16_bf16 a[192:207], v[10:13], v[10:13], 0
v_mul_f32 v172, s78, v172
v_mul_f32 v173, s78, v173
v_mul_f32 v174, s78, v174
v_mul_f32 v175, s78, v175
v_cvt_pk_bf16_f32 v183, v174, v175
v_cvt_pk_bf16_f32 v182, v172, v173
v_cvt_pk_bf16_f32 v181, v170, v171
v_cvt_pk_bf16_f32 v180, v168, v169
v_mfma_f32_32x32x16_bf16 a[208:223], v[10:13], v[10:13], 0
v_and_b32 v182, v182, v43
v_and_b32 v183, v183, v43
v_mul_f32 v160, s78, v160
v_mul_f32 v161, s78, v161
v_mul_f32 v162, s78, v162
v_mul_f32 v163, s78, v163
v_mul_f32 v164, s78, v164
v_mul_f32 v165, s78, v165
v_mfma_f32_32x32x16_bf16 a[224:239], v[10:13], v[10:13], 0
v_mul_f32 v166, s78, v166
v_mul_f32 v167, s78, v167
v_cvt_pk_bf16_f32 v179, v166, v167
v_cvt_pk_bf16_f32 v178, v164, v165
v_cvt_pk_bf16_f32 v177, v162, v163
v_cvt_pk_bf16_f32 v176, v160, v161
v_and_b32 v178, v178, v43
v_and_b32 v179, v179, v43
v_mfma_f32_32x32x16_bf16 a[240:255], v[10:13], v[10:13], 0
v_mul_f32 v152, s78, v152
v_mul_f32 v153, s78, v153
v_mul_f32 v154, s78, v154
v_mul_f32 v155, s78, v155
v_mul_f32 v156, s78, v156
v_mul_f32 v157, s78, v157
v_mul_f32 v158, s78, v158
v_mul_f32 v159, s78, v159
v_cvt_pk_bf16_f32 v175, v158, v159
v_cvt_pk_bf16_f32 v174, v156, v157
v_cvt_pk_bf16_f32 v173, v154, v155
v_cvt_pk_bf16_f32 v172, v152, v153
v_and_b32 v174, v174, v43
v_and_b32 v175, v175, v43
v_mul_f32 v144, s78, v144
v_mul_f32 v145, s78, v145
v_mul_f32 v146, s78, v146
v_mul_f32 v147, s78, v147
v_mul_f32 v148, s78, v148
v_mul_f32 v149, s78, v149
v_mul_f32 v150, s78, v150
v_mul_f32 v151, s78, v151
v_cvt_pk_bf16_f32 v171, v150, v151
v_cvt_pk_bf16_f32 v170, v148, v149
v_cvt_pk_bf16_f32 v169, v146, v147
v_cvt_pk_bf16_f32 v168, v144, v145
v_and_b32 v170, v170, v43
v_and_b32 v171, v171, v43
v_mul_f32 v136, s78, v136
v_mul_f32 v137, s78, v137
v_mul_f32 v138, s78, v138
v_mul_f32 v139, s78, v139
v_mul_f32 v140, s78, v140
v_mul_f32 v141, s78, v141
v_mul_f32 v142, s78, v142
v_mul_f32 v143, s78, v143
v_cvt_pk_bf16_f32 v167, v142, v143
v_cvt_pk_bf16_f32 v166, v140, v141
v_cvt_pk_bf16_f32 v165, v138, v139
v_cvt_pk_bf16_f32 v164, v136, v137
v_and_b32 v166, v166, v43
v_and_b32 v167, v167, v43
v_mul_f32 v128, s78, v128
v_mul_f32 v129, s78, v129
v_mul_f32 v130, s78, v130
v_mul_f32 v131, s78, v131
v_mul_f32 v132, s78, v132
v_mul_f32 v133, s78, v133
v_mul_f32 v134, s78, v134
v_mul_f32 v135, s78, v135
v_cvt_pk_bf16_f32 v163, v134, v135
v_cvt_pk_bf16_f32 v162, v132, v133
v_cvt_pk_bf16_f32 v161, v130, v131
v_cvt_pk_bf16_f32 v160, v128, v129
v_and_b32 v162, v162, v43
v_and_b32 v163, v163, v43
v_mul_f32 v64, s78, v64
v_mul_f32 v65, s78, v65
v_mul_f32 v66, s78, v66
v_mul_f32 v67, s78, v67
v_mul_f32 v68, s78, v68
v_mul_f32 v69, s78, v69
v_mul_f32 v70, s78, v70
v_mul_f32 v71, s78, v71
v_cvt_pk_bf16_f32 v128, v64, v65
v_cvt_pk_bf16_f32 v129, v66, v67
v_cvt_pk_bf16_f32 v130, v68, v69
v_cvt_pk_bf16_f32 v131, v70, v71
v_and_b32 v130, v130, v43
v_and_b32 v131, v131, v43
v_mul_f32 v72, s78, v72
v_mul_f32 v73, s78, v73
v_mul_f32 v74, s78, v74
v_mul_f32 v75, s78, v75
v_mul_f32 v76, s78, v76
v_mul_f32 v77, s78, v77
v_mul_f32 v78, s78, v78
v_mul_f32 v79, s78, v79
v_cvt_pk_bf16_f32 v132, v72, v73
v_cvt_pk_bf16_f32 v133, v74, v75
v_cvt_pk_bf16_f32 v134, v76, v77
v_cvt_pk_bf16_f32 v135, v78, v79
v_and_b32 v134, v134, v43
v_and_b32 v135, v135, v43
v_mul_f32 v80, s78, v80
v_mul_f32 v81, s78, v81
v_mul_f32 v82, s78, v82
v_mul_f32 v83, s78, v83
v_mul_f32 v84, s78, v84
v_mul_f32 v85, s78, v85
v_mul_f32 v86, s78, v86
v_mul_f32 v87, s78, v87
v_cvt_pk_bf16_f32 v136, v80, v81
v_cvt_pk_bf16_f32 v137, v82, v83
v_cvt_pk_bf16_f32 v138, v84, v85
v_cvt_pk_bf16_f32 v139, v86, v87
v_and_b32 v138, v138, v43
v_and_b32 v139, v139, v43
v_mul_f32 v88, s78, v88
v_mul_f32 v89, s78, v89
v_mul_f32 v90, s78, v90
v_mul_f32 v91, s78, v91
v_mul_f32 v92, s78, v92
v_mul_f32 v93, s78, v93
v_mul_f32 v94, s78, v94
v_mul_f32 v95, s78, v95
v_cvt_pk_bf16_f32 v140, v88, v89
v_cvt_pk_bf16_f32 v141, v90, v91
v_cvt_pk_bf16_f32 v142, v92, v93
v_cvt_pk_bf16_f32 v143, v94, v95
v_and_b32 v142, v142, v43
v_and_b32 v143, v143, v43
v_mul_f32 v96, s78, v96
v_mul_f32 v97, s78, v97
v_mul_f32 v98, s78, v98
v_mul_f32 v99, s78, v99
v_mul_f32 v100, s78, v100
v_mul_f32 v101, s78, v101
v_mul_f32 v102, s78, v102
v_mul_f32 v103, s78, v103
v_cvt_pk_bf16_f32 v144, v96, v97
v_cvt_pk_bf16_f32 v145, v98, v99
v_cvt_pk_bf16_f32 v146, v100, v101
v_cvt_pk_bf16_f32 v147, v102, v103
v_and_b32 v146, v146, v43
v_and_b32 v147, v147, v43
v_mul_f32 v104, s78, v104
v_mul_f32 v105, s78, v105
v_mul_f32 v106, s78, v106
v_mul_f32 v107, s78, v107
v_mul_f32 v108, s78, v108
v_mul_f32 v109, s78, v109
v_mul_f32 v110, s78, v110
v_mul_f32 v111, s78, v111
v_cvt_pk_bf16_f32 v148, v104, v105
v_cvt_pk_bf16_f32 v149, v106, v107
v_cvt_pk_bf16_f32 v150, v108, v109
v_cvt_pk_bf16_f32 v151, v110, v111
v_and_b32 v150, v150, v43
v_and_b32 v151, v151, v43
v_mul_f32 v112, s78, v112
v_mul_f32 v113, s78, v113
v_mul_f32 v114, s78, v114
v_mul_f32 v115, s78, v115
v_mul_f32 v116, s78, v116
v_mul_f32 v117, s78, v117
v_mul_f32 v118, s78, v118
v_mul_f32 v119, s78, v119
v_cvt_pk_bf16_f32 v152, v112, v113
v_cvt_pk_bf16_f32 v153, v114, v115
v_cvt_pk_bf16_f32 v154, v116, v117
v_cvt_pk_bf16_f32 v155, v118, v119
v_and_b32 v154, v154, v43
v_and_b32 v155, v155, v43
v_mul_f32 v120, s78, v120
v_mul_f32 v121, s78, v121
v_mul_f32 v122, s78, v122
v_mul_f32 v123, s78, v123
v_mul_f32 v124, s78, v124
v_mul_f32 v125, s78, v125
v_mul_f32 v126, s78, v126
v_mul_f32 v127, s78, v127
v_cvt_pk_bf16_f32 v156, v120, v121
v_cvt_pk_bf16_f32 v157, v122, v123
v_cvt_pk_bf16_f32 v158, v124, v125
v_cvt_pk_bf16_f32 v159, v126, v127
v_and_b32 v158, v158, v43
v_and_b32 v159, v159, v43
s_mov_b32 s43, 8192
s_mov_b32 s44, 0
s_mov_b32 s73, s29
s_lshl_b32 s74, s29, 1
s_mov_b32 s76, s28
s_mov_b32 s72, 0
s_add_u32 s75, s74, s73
s_add_u32 s77, s76, s73
s_add_u32 s78, s76, s74
s_add_u32 s79, s76, s75
s_branch mega_kernel_qproj
mega_kernel_t1_h0_far:
s_cmp_eq_u32 s21, 16
s_cbranch_scc0 mega_kernel_t1_h0_c
s_mov_b32 s4, s40
s_mov_b32 s5, s41
s_mov_b32 s32, 896
s_mov_b32 s16, s42
s_mov_b32 s8, s44
s_mov_b32 s9, s45
s_mov_b32 s17, s48
s_mov_b32 s33, s43
s_mov_b32 s34, s49
s_mov_b32 s39, 18
v_lshrrev_b32 v2, 3, v1
s_lshl_b32 s61, s20, 6
v_add_u32 v2, s61, v2
v_mul_lo_u32 v2, v2, s32
v_and_b32 v3, 7, v1
v_lshrrev_b32 v4, 4, v1
v_xor_b32 v3, v3, v4
v_lshlrev_b32 v3, 4, v3
v_xor_b32 v5, 64, v3
v_add_u32 v16, v2, v3
v_add_u32 v5, v2, v5
s_lshl_b32 s61, s32, 3
s_mov_b32 s64, 0
s_add_u32 s64, s64, s61
s_sub_u32 s65, s64, 1024
v_add_u32 v17, s65, v5
s_add_u32 s64, s64, s61
s_sub_u32 s65, s64, 2048
v_add_u32 v18, s65, v16
s_add_u32 s64, s64, s61
s_sub_u32 s65, s64, 3072
v_add_u32 v19, s65, v5
s_add_u32 s64, s64, s61
s_sub_u32 s65, s64, 0
v_add_u32 v20, s65, v16
s_add_u32 s64, s64, s61
s_sub_u32 s65, s64, 1024
v_add_u32 v21, s65, v5
s_add_u32 s64, s64, s61
s_sub_u32 s65, s64, 2048
v_add_u32 v22, s65, v16
s_add_u32 s64, s64, s61
s_sub_u32 s65, s64, 3072
v_add_u32 v23, s65, v5
s_mov_b32 s18, 0
s_mov_b32 s6, s16
v_lshrrev_b32 v2, 5, v1
s_lshl_b32 s61, s20, 4
v_add_u32 v3, s61, v2
v_mul_lo_u32 v3, v3, s33
v_bfe_u32 v4, v1, 1, 4
v_xor_b32 v4, v4, v2
v_and_b32 v5, 1, v4
v_lshlrev_b32 v5, 5, v5
v_and_b32 v6, 1, v1
v_lshl_add_u32 v5, v6, 4, v5
v_add_u32 v3, v3, v5
v_lshrrev_b32 v4, 1, v4
v_xor_b32 v5, 0, v4
v_mul_lo_u32 v5, v5, s34
v_add_u32 v6, v3, v5
v_xor_b32 v5, 1, v4
v_mul_lo_u32 v5, v5, s34
v_add_u32 v7, v3, v5
v_xor_b32 v5, 2, v4
v_mul_lo_u32 v5, v5, s34
v_add_u32 v8, v3, v5
v_xor_b32 v5, 3, v4
v_mul_lo_u32 v5, v5, s34
v_add_u32 v9, v3, v5
s_lshl_b32 s61, s33, 1
s_mov_b32 s64, 0
s_sub_u32 s65, s64, 0
v_add_u32 v24, s65, v6
s_add_u32 s64, s64, s61
s_sub_u32 s65, s64, 1024
v_add_u32 v25, s65, v7
s_add_u32 s64, s64, s61
s_sub_u32 s65, s64, 2048
v_add_u32 v26, s65, v6
s_add_u32 s64, s64, s61
s_sub_u32 s65, s64, 3072
v_add_u32 v27, s65, v7
s_add_u32 s64, s64, s61
s_sub_u32 s65, s64, 0
v_add_u32 v28, s65, v8
s_add_u32 s64, s64, s61
s_sub_u32 s65, s64, 1024
v_add_u32 v29, s65, v9
s_add_u32 s64, s64, s61
s_sub_u32 s65, s64, 2048
v_add_u32 v30, s65, v8
s_add_u32 s64, s64, s61
s_sub_u32 s65, s64, 3072
v_add_u32 v31, s65, v9
s_lshl_b32 s23, s33, 6
s_mov_b32 s19, 0
s_mov_b32 s10, s17
s_branch mega_kernel_t1_hkr0
mega_kernel_t1_h0_c:
s_cmp_eq_u32 s21, 18
s_cbranch_scc0 mega_kernel_t1_h0_d
s_mov_b32 s39, 23
s_cmp_eq_u32 s20, 0
s_cbranch_scc0 mega_kernel_t1_hkr0
s_lshl_b32 s61, s56, 2
v_mov_b32 v3, s61
v_mov_b32 v2, 1
s_mov_b64 exec, 1
global_atomic_add v3, v2, s[52:53] sc1
s_mov_b64 exec, -1
s_branch mega_kernel_t1_hkr0
mega_kernel_t1_h0_d:
s_mov_b32 s6, 0
s_mov_b32 s10, 0
s_mov_b32 s82, 0
s_branch mega_kernel_t1_hkr0
mega_kernel_t1_hk1:
s_cmp_eq_u32 s21, 16
s_cbranch_scc0 mega_kernel_t1_h1_c
s_mov_b32 s4, s40
s_mov_b32 s5, s41
s_mov_b32 s32, 896
s_mov_b32 s16, s42
s_mov_b32 s8, s44
s_mov_b32 s9, s45
s_mov_b32 s17, s48
s_mov_b32 s33, s43
s_mov_b32 s34, s49
s_mov_b32 s39, 18
v_lshrrev_b32 v2, 3, v1
s_lshl_b32 s61, s20, 6
v_add_u32 v2, s61, v2
v_mul_lo_u32 v2, v2, s32
v_and_b32 v3, 7, v1
v_lshrrev_b32 v4, 4, v1
v_xor_b32 v3, v3, v4
v_lshlrev_b32 v3, 4, v3
v_xor_b32 v5, 64, v3
v_add_u32 v16, v2, v3
v_add_u32 v5, v2, v5
s_lshl_b32 s61, s32, 3
s_mov_b32 s64, 0
s_add_u32 s64, s64, s61
s_sub_u32 s65, s64, 1024
v_add_u32 v17, s65, v5
s_add_u32 s64, s64, s61
s_sub_u32 s65, s64, 2048
v_add_u32 v18, s65, v16
s_add_u32 s64, s64, s61
s_sub_u32 s65, s64, 3072
v_add_u32 v19, s65, v5
s_add_u32 s64, s64, s61
s_sub_u32 s65, s64, 0
v_add_u32 v20, s65, v16
s_add_u32 s64, s64, s61
s_sub_u32 s65, s64, 1024
v_add_u32 v21, s65, v5
s_add_u32 s64, s64, s61
s_sub_u32 s65, s64, 2048
v_add_u32 v22, s65, v16
s_add_u32 s64, s64, s61
s_sub_u32 s65, s64, 3072
v_add_u32 v23, s65, v5
s_mov_b32 s18, 0
s_mov_b32 s6, s16
v_lshrrev_b32 v2, 5, v1
s_lshl_b32 s61, s20, 4
v_add_u32 v3, s61, v2
v_mul_lo_u32 v3, v3, s33
v_bfe_u32 v4, v1, 1, 4
v_xor_b32 v4, v4, v2
v_and_b32 v5, 1, v4
v_lshlrev_b32 v5, 5, v5
v_and_b32 v6, 1, v1
v_lshl_add_u32 v5, v6, 4, v5
v_add_u32 v3, v3, v5
v_lshrrev_b32 v4, 1, v4
v_xor_b32 v5, 0, v4
v_mul_lo_u32 v5, v5, s34
v_add_u32 v6, v3, v5
v_xor_b32 v5, 1, v4
v_mul_lo_u32 v5, v5, s34
v_add_u32 v7, v3, v5
v_xor_b32 v5, 2, v4
v_mul_lo_u32 v5, v5, s34
v_add_u32 v8, v3, v5
v_xor_b32 v5, 3, v4
v_mul_lo_u32 v5, v5, s34
v_add_u32 v9, v3, v5
s_lshl_b32 s61, s33, 1
s_mov_b32 s64, 0
s_sub_u32 s65, s64, 0
v_add_u32 v24, s65, v6
s_add_u32 s64, s64, s61
s_sub_u32 s65, s64, 1024
v_add_u32 v25, s65, v7
s_add_u32 s64, s64, s61
s_sub_u32 s65, s64, 2048
v_add_u32 v26, s65, v6
s_add_u32 s64, s64, s61
s_sub_u32 s65, s64, 3072
v_add_u32 v27, s65, v7
s_add_u32 s64, s64, s61
s_sub_u32 s65, s64, 0
v_add_u32 v28, s65, v8
s_add_u32 s64, s64, s61
s_sub_u32 s65, s64, 1024
v_add_u32 v29, s65, v9
s_add_u32 s64, s64, s61
s_sub_u32 s65, s64, 2048
v_add_u32 v30, s65, v8
s_add_u32 s64, s64, s61
s_sub_u32 s65, s64, 3072
v_add_u32 v31, s65, v9
s_lshl_b32 s23, s33, 6
s_mov_b32 s19, 0
s_mov_b32 s10, s17
s_branch mega_kernel_t1_hkr1
mega_kernel_t1_h1_c:
s_cmp_eq_u32 s21, 18
s_cbranch_scc0 mega_kernel_t1_h1_d
s_mov_b32 s39, 23
s_cmp_eq_u32 s20, 0
s_cbranch_scc0 mega_kernel_t1_hkr1
s_lshl_b32 s61, s56, 2
v_mov_b32 v3, s61
v_mov_b32 v2, 1
s_mov_b64 exec, 1
global_atomic_add v3, v2, s[52:53] sc1
s_mov_b64 exec, -1
s_branch mega_kernel_t1_hkr1
mega_kernel_t1_h1_d:
s_mov_b32 s6, 0
s_mov_b32 s10, 0
s_mov_b32 s82, 0
s_branch mega_kernel_t1_hkr1
mega_kernel_t1_epi2:
s_cmp_eq_u32 s79, 0
s_cbranch_scc0 mega_kernel_t1_epifix
s_nop 7
v_cvt_pk_bf16_f32 v48, v64, v65
v_cvt_pk_bf16_f32 v49, v66, v67
v_cvt_pk_bf16_f32 v50, v96, v97
v_cvt_pk_bf16_f32 v51, v98, v99
s_mov_b32 s30, s26
s_mov_b32 s31, s30
buffer_store_dwordx4 v[48:51], v42, s[12:15], s31 offen sc0 sc1
v_cvt_pk_bf16_f32 v52, v68, v69
v_cvt_pk_bf16_f32 v53, v70, v71
v_cvt_pk_bf16_f32 v54, v100, v101
v_cvt_pk_bf16_f32 v55, v102, v103
s_add_u32 s36, s31, s28
buffer_store_dwordx4 v[52:55], v42, s[12:15], s36 offen sc0 sc1
v_cvt_pk_bf16_f32 v56, v72, v73
v_cvt_pk_bf16_f32 v57, v74, v75
v_cvt_pk_bf16_f32 v58, v104, v105
v_cvt_pk_bf16_f32 v59, v106, v107
s_add_u32 s31, s31, s27
buffer_store_dwordx4 v[56:59], v42, s[12:15], s31 offen sc0 sc1
v_cvt_pk_bf16_f32 v60, v76, v77
v_cvt_pk_bf16_f32 v61, v78, v79
v_cvt_pk_bf16_f32 v62, v108, v109
v_cvt_pk_bf16_f32 v63, v110, v111
s_add_u32 s36, s31, s28
buffer_store_dwordx4 v[60:63], v42, s[12:15], s36 offen sc0 sc1
v_cvt_pk_bf16_f32 v48, v80, v81
v_cvt_pk_bf16_f32 v49, v82, v83
v_cvt_pk_bf16_f32 v50, v112, v113
v_cvt_pk_bf16_f32 v51, v114, v115
s_add_u32 s31, s31, s27
buffer_store_dwordx4 v[48:51], v42, s[12:15], s31 offen sc0 sc1
v_cvt_pk_bf16_f32 v52, v84, v85
v_cvt_pk_bf16_f32 v53, v86, v87
v_cvt_pk_bf16_f32 v54, v116, v117
v_cvt_pk_bf16_f32 v55, v118, v119
s_add_u32 s36, s31, s28
buffer_store_dwordx4 v[52:55], v42, s[12:15], s36 offen sc0 sc1
v_cvt_pk_bf16_f32 v56, v88, v89
v_cvt_pk_bf16_f32 v57, v90, v91
v_cvt_pk_bf16_f32 v58, v120, v121
v_cvt_pk_bf16_f32 v59, v122, v123
s_add_u32 s31, s31, s27
buffer_store_dwordx4 v[56:59], v42, s[12:15], s31 offen sc0 sc1
v_cvt_pk_bf16_f32 v60, v92, v93
v_cvt_pk_bf16_f32 v61, v94, v95
v_cvt_pk_bf16_f32 v62, v124, v125
v_cvt_pk_bf16_f32 v63, v126, v127
s_add_u32 s36, s31, s28
buffer_store_dwordx4 v[60:63], v42, s[12:15], s36 offen sc0 sc1
v_cvt_pk_bf16_f32 v48, v128, v129
v_cvt_pk_bf16_f32 v49, v130, v131
v_cvt_pk_bf16_f32 v50, v160, v161
v_cvt_pk_bf16_f32 v51, v162, v163
s_add_u32 s30, s30, s29
s_mov_b32 s31, s30
buffer_store_dwordx4 v[48:51], v42, s[12:15], s31 offen sc0 sc1
v_cvt_pk_bf16_f32 v52, v132, v133
v_cvt_pk_bf16_f32 v53, v134, v135
v_cvt_pk_bf16_f32 v54, v164, v165
v_cvt_pk_bf16_f32 v55, v166, v167
s_add_u32 s36, s31, s28
buffer_store_dwordx4 v[52:55], v42, s[12:15], s36 offen sc0 sc1
v_cvt_pk_bf16_f32 v56, v136, v137
v_cvt_pk_bf16_f32 v57, v138, v139
v_cvt_pk_bf16_f32 v58, v168, v169
v_cvt_pk_bf16_f32 v59, v170, v171
s_add_u32 s31, s31, s27
buffer_store_dwordx4 v[56:59], v42, s[12:15], s31 offen sc0 sc1
v_cvt_pk_bf16_f32 v60, v140, v141
v_cvt_pk_bf16_f32 v61, v142, v143
v_cvt_pk_bf16_f32 v62, v172, v173
v_cvt_pk_bf16_f32 v63, v174, v175
s_add_u32 s36, s31, s28
buffer_store_dwordx4 v[60:63], v42, s[12:15], s36 offen sc0 sc1
v_cvt_pk_bf16_f32 v48, v144, v145
v_cvt_pk_bf16_f32 v49, v146, v147
v_cvt_pk_bf16_f32 v50, v176, v177
v_cvt_pk_bf16_f32 v51, v178, v179
s_add_u32 s31, s31, s27
buffer_store_dwordx4 v[48:51], v42, s[12:15], s31 offen sc0 sc1
v_cvt_pk_bf16_f32 v52, v148, v149
v_cvt_pk_bf16_f32 v53, v150, v151
v_cvt_pk_bf16_f32 v54, v180, v181
v_cvt_pk_bf16_f32 v55, v182, v183
s_add_u32 s36, s31, s28
buffer_store_dwordx4 v[52:55], v42, s[12:15], s36 offen sc0 sc1
v_cvt_pk_bf16_f32 v56, v152, v153
v_cvt_pk_bf16_f32 v57, v154, v155
v_cvt_pk_bf16_f32 v58, v184, v185
v_cvt_pk_bf16_f32 v59, v186, v187
s_add_u32 s31, s31, s27
buffer_store_dwordx4 v[56:59], v42, s[12:15], s31 offen sc0 sc1
v_cvt_pk_bf16_f32 v60, v156, v157
v_cvt_pk_bf16_f32 v61, v158, v159
v_cvt_pk_bf16_f32 v62, v188, v189
v_cvt_pk_bf16_f32 v63, v190, v191
s_add_u32 s36, s31, s28
buffer_store_dwordx4 v[60:63], v42, s[12:15], s36 offen sc0 sc1
v_cvt_pk_bf16_f32 v48, v192, v193
v_cvt_pk_bf16_f32 v49, v194, v195
v_cvt_pk_bf16_f32 v50, v224, v225
v_cvt_pk_bf16_f32 v51, v226, v227
s_add_u32 s30, s30, s29
s_mov_b32 s31, s30
buffer_store_dwordx4 v[48:51], v42, s[12:15], s31 offen sc0 sc1
v_cvt_pk_bf16_f32 v52, v196, v197
v_cvt_pk_bf16_f32 v53, v198, v199
v_cvt_pk_bf16_f32 v54, v228, v229
v_cvt_pk_bf16_f32 v55, v230, v231
s_add_u32 s36, s31, s28
buffer_store_dwordx4 v[52:55], v42, s[12:15], s36 offen sc0 sc1
v_cvt_pk_bf16_f32 v56, v200, v201
v_cvt_pk_bf16_f32 v57, v202, v203
v_cvt_pk_bf16_f32 v58, v232, v233
v_cvt_pk_bf16_f32 v59, v234, v235
s_add_u32 s31, s31, s27
buffer_store_dwordx4 v[56:59], v42, s[12:15], s31 offen sc0 sc1
v_cvt_pk_bf16_f32 v60, v204, v205
v_cvt_pk_bf16_f32 v61, v206, v207
v_cvt_pk_bf16_f32 v62, v236, v237
v_cvt_pk_bf16_f32 v63, v238, v239
s_add_u32 s36, s31, s28
buffer_store_dwordx4 v[60:63], v42, s[12:15], s36 offen sc0 sc1
v_cvt_pk_bf16_f32 v48, v208, v209
v_cvt_pk_bf16_f32 v49, v210, v211
v_cvt_pk_bf16_f32 v50, v240, v241
v_cvt_pk_bf16_f32 v51, v242, v243
s_add_u32 s31, s31, s27
buffer_store_dwordx4 v[48:51], v42, s[12:15], s31 offen sc0 sc1
v_cvt_pk_bf16_f32 v52, v212, v213
v_cvt_pk_bf16_f32 v53, v214, v215
v_cvt_pk_bf16_f32 v54, v244, v245
v_cvt_pk_bf16_f32 v55, v246, v247
s_add_u32 s36, s31, s28
buffer_store_dwordx4 v[52:55], v42, s[12:15], s36 offen sc0 sc1
v_cvt_pk_bf16_f32 v56, v216, v217
v_cvt_pk_bf16_f32 v57, v218, v219
v_cvt_pk_bf16_f32 v58, v248, v249
v_cvt_pk_bf16_f32 v59, v250, v251
s_add_u32 s31, s31, s27
buffer_store_dwordx4 v[56:59], v42, s[12:15], s31 offen sc0 sc1
v_cvt_pk_bf16_f32 v60, v220, v221
v_cvt_pk_bf16_f32 v61, v222, v223
v_cvt_pk_bf16_f32 v62, v252, v253
v_cvt_pk_bf16_f32 v63, v254, v255
s_add_u32 s36, s31, s28
buffer_store_dwordx4 v[60:63], v42, s[12:15], s36 offen sc0 sc1
v_accvgpr_read_b32 v2, a128
v_accvgpr_read_b32 v3, a129
v_accvgpr_read_b32 v4, a130
v_accvgpr_read_b32 v5, a131
v_accvgpr_read_b32 v6, a160
v_accvgpr_read_b32 v7, a161
v_accvgpr_read_b32 v8, a162
v_accvgpr_read_b32 v9, a163
v_cvt_pk_bf16_f32 v48, v2, v3
v_cvt_pk_bf16_f32 v49, v4, v5
v_cvt_pk_bf16_f32 v50, v6, v7
v_cvt_pk_bf16_f32 v51, v8, v9
s_add_u32 s30, s30, s29
s_mov_b32 s31, s30
buffer_store_dwordx4 v[48:51], v42, s[12:15], s31 offen sc0 sc1
v_accvgpr_read_b32 v2, a132
v_accvgpr_read_b32 v3, a133
v_accvgpr_read_b32 v4, a134
v_accvgpr_read_b32 v5, a135
v_accvgpr_read_b32 v6, a164
v_accvgpr_read_b32 v7, a165
v_accvgpr_read_b32 v8, a166
v_accvgpr_read_b32 v9, a167
v_cvt_pk_bf16_f32 v52, v2, v3
v_cvt_pk_bf16_f32 v53, v4, v5
v_cvt_pk_bf16_f32 v54, v6, v7
v_cvt_pk_bf16_f32 v55, v8, v9
s_add_u32 s36, s31, s28
buffer_store_dwordx4 v[52:55], v42, s[12:15], s36 offen sc0 sc1
v_accvgpr_read_b32 v2, a136
v_accvgpr_read_b32 v3, a137
v_accvgpr_read_b32 v4, a138
v_accvgpr_read_b32 v5, a139
v_accvgpr_read_b32 v6, a168
v_accvgpr_read_b32 v7, a169
v_accvgpr_read_b32 v8, a170
v_accvgpr_read_b32 v9, a171
v_cvt_pk_bf16_f32 v56, v2, v3
v_cvt_pk_bf16_f32 v57, v4, v5
v_cvt_pk_bf16_f32 v58, v6, v7
v_cvt_pk_bf16_f32 v59, v8, v9
s_add_u32 s31, s31, s27
buffer_store_dwordx4 v[56:59], v42, s[12:15], s31 offen sc0 sc1
v_accvgpr_read_b32 v2, a140
v_accvgpr_read_b32 v3, a141
v_accvgpr_read_b32 v4, a142
v_accvgpr_read_b32 v5, a143
v_accvgpr_read_b32 v6, a172
v_accvgpr_read_b32 v7, a173
v_accvgpr_read_b32 v8, a174
v_accvgpr_read_b32 v9, a175
v_cvt_pk_bf16_f32 v60, v2, v3
v_cvt_pk_bf16_f32 v61, v4, v5
v_cvt_pk_bf16_f32 v62, v6, v7
v_cvt_pk_bf16_f32 v63, v8, v9
s_add_u32 s36, s31, s28
buffer_store_dwordx4 v[60:63], v42, s[12:15], s36 offen sc0 sc1
v_accvgpr_read_b32 v2, a144
v_accvgpr_read_b32 v3, a145
v_accvgpr_read_b32 v4, a146
v_accvgpr_read_b32 v5, a147
v_accvgpr_read_b32 v6, a176
v_accvgpr_read_b32 v7, a177
v_accvgpr_read_b32 v8, a178
v_accvgpr_read_b32 v9, a179
v_cvt_pk_bf16_f32 v48, v2, v3
v_cvt_pk_bf16_f32 v49, v4, v5
v_cvt_pk_bf16_f32 v50, v6, v7
v_cvt_pk_bf16_f32 v51, v8, v9
s_add_u32 s31, s31, s27
buffer_store_dwordx4 v[48:51], v42, s[12:15], s31 offen sc0 sc1
v_accvgpr_read_b32 v2, a148
v_accvgpr_read_b32 v3, a149
v_accvgpr_read_b32 v4, a150
v_accvgpr_read_b32 v5, a151
v_accvgpr_read_b32 v6, a180
v_accvgpr_read_b32 v7, a181
v_accvgpr_read_b32 v8, a182
v_accvgpr_read_b32 v9, a183
v_cvt_pk_bf16_f32 v52, v2, v3
v_cvt_pk_bf16_f32 v53, v4, v5
v_cvt_pk_bf16_f32 v54, v6, v7
v_cvt_pk_bf16_f32 v55, v8, v9
s_add_u32 s36, s31, s28
buffer_store_dwordx4 v[52:55], v42, s[12:15], s36 offen sc0 sc1
v_accvgpr_read_b32 v2, a152
v_accvgpr_read_b32 v3, a153
v_accvgpr_read_b32 v4, a154
v_accvgpr_read_b32 v5, a155
v_accvgpr_read_b32 v6, a184
v_accvgpr_read_b32 v7, a185
v_accvgpr_read_b32 v8, a186
v_accvgpr_read_b32 v9, a187
v_cvt_pk_bf16_f32 v56, v2, v3
v_cvt_pk_bf16_f32 v57, v4, v5
v_cvt_pk_bf16_f32 v58, v6, v7
v_cvt_pk_bf16_f32 v59, v8, v9
s_add_u32 s31, s31, s27
buffer_store_dwordx4 v[56:59], v42, s[12:15], s31 offen sc0 sc1
v_accvgpr_read_b32 v2, a156
v_accvgpr_read_b32 v3, a157
v_accvgpr_read_b32 v4, a158
v_accvgpr_read_b32 v5, a159
v_accvgpr_read_b32 v6, a188
v_accvgpr_read_b32 v7, a189
v_accvgpr_read_b32 v8, a190
v_accvgpr_read_b32 v9, a191
v_cvt_pk_bf16_f32 v60, v2, v3
v_cvt_pk_bf16_f32 v61, v4, v5
v_cvt_pk_bf16_f32 v62, v6, v7
v_cvt_pk_bf16_f32 v63, v8, v9
s_add_u32 s36, s31, s28
buffer_store_dwordx4 v[60:63], v42, s[12:15], s36 offen sc0 sc1
s_branch mega_kernel_next
mega_kernel_t1_epifix:
s_waitcnt lgkmcnt(0)
s_load_dwordx2 s[68:69], s[0:1], 24
s_load_dwordx2 s[48:49], s[0:1], 64
s_load_dwordx2 s[50:51], s[0:1], 16
s_load_dwordx2 s[8:9], s[0:1], 40
s_mov_b32 s33, 8192
s_mov_b32 s34, 64
s_lshl_b32 s17, s56, 9
v_lshrrev_b32 v2, 5, v1
s_lshl_b32 s61, s20, 4
v_add_u32 v3, s61, v2
v_mul_lo_u32 v3, v3, s33
v_bfe_u32 v4, v1, 1, 4
v_xor_b32 v4, v4, v2
v_and_b32 v5, 1, v4
v_lshlrev_b32 v5, 5, v5
v_and_b32 v6, 1, v1
v_lshl_add_u32 v5, v6, 4, v5
v_add_u32 v3, v3, v5
v_lshrrev_b32 v4, 1, v4
v_xor_b32 v5, 0, v4
v_mul_lo_u32 v5, v5, s34
v_add_u32 v6, v3, v5
v_xor_b32 v5, 1, v4
v_mul_lo_u32 v5, v5, s34
v_add_u32 v7, v3, v5
v_xor_b32 v5, 2, v4
v_mul_lo_u32 v5, v5, s34
v_add_u32 v8, v3, v5
v_xor_b32 v5, 3, v4
v_mul_lo_u32 v5, v5, s34
v_add_u32 v9, v3, v5
s_lshl_b32 s61, s33, 1
s_mov_b32 s64, 0
s_sub_u32 s65, s64, 0
v_add_u32 v24, s65, v6
s_add_u32 s64, s64, s61
s_sub_u32 s65, s64, 1024
v_add_u32 v25, s65, v7
s_add_u32 s64, s64, s61
s_sub_u32 s65, s64, 2048
v_add_u32 v26, s65, v6
s_add_u32 s64, s64, s61
s_sub_u32 s65, s64, 3072
v_add_u32 v27, s65, v7
s_add_u32 s64, s64, s61
s_sub_u32 s65, s64, 0
v_add_u32 v28, s65, v8
s_add_u32 s64, s64, s61
s_sub_u32 s65, s64, 1024
v_add_u32 v29, s65, v9
s_add_u32 s64, s64, s61
s_sub_u32 s65, s64, 2048
v_add_u32 v30, s65, v8
s_add_u32 s64, s64, s61
s_sub_u32 s65, s64, 3072
v_add_u32 v31, s65, v9
s_lshl_b32 s23, s33, 6
s_mov_b32 s19, 0
s_lshl_b32 s18, s20, 13
s_lshr_b32 s41, s55, 1
s_sub_u32 s41, 15, s41
s_mul_i32 s61, s41, 114688
s_mov_b32 s70, 172032
s_lshl_b32 s25, s20, 12
s_add_u32 s25, s25, 32768
s_mov_b32 s65, 57344
v_lshrrev_b32 v2, 3, v1
s_lshl_b32 s64, s20, 5
v_add_u32 v2, s64, v2
v_mul_u32_u24 v2, 896, v2
v_and_b32 v3, 7, v1
v_lshrrev_b32 v4, 4, v1
v_xor_b32 v3, v3, v4
v_lshlrev_b32 v3, 4, v3
v_xor_b32 v4, 64, v3
v_add_u32 v14, v2, v3
v_add_u32 v4, v2, v4
v_add_u32 v15, 6144, v4
v_add_u32 v59, 12288, v14
v_add_u32 v61, 18432, v4
s_waitcnt lgkmcnt(0)
s_add_u32 s68, s68, s61
s_addc_u32 s69, s69, 0
s_sub_u32 s68, s68, 57344
s_subb_u32 s69, s69, 0
s_add_u32 s8, s8, s17
s_addc_u32 s9, s9, 0
s_sub_u32 s10, 3670016, s17
s_add_u32 m0, s18, 65536
s_nop 0
buffer_load_dwordx4 v24, s[8:11], s19 offen offset:0 lds
buffer_load_dwordx4 v25, s[8:11], s19 offen offset:1024 lds
buffer_load_dwordx4 v26, s[8:11], s19 offen offset:2048 lds
buffer_load_dwordx4 v27, s[8:11], s19 offen offset:3072 lds
s_add_u32 m0, s18, 69632
s_nop 0
buffer_load_dwordx4 v28, s[8:11], s19 offen offset:0 lds
buffer_load_dwordx4 v29, s[8:11], s19 offen offset:1024 lds
buffer_load_dwordx4 v30, s[8:11], s19 offen offset:2048 lds
buffer_load_dwordx4 v31, s[8:11], s19 offen offset:3072 lds
s_add_u32 s19, s19, s23
s_add_u32 m0, s18, 98304
s_nop 0
buffer_load_dwordx4 v24, s[8:11], s19 offen offset:0 lds
buffer_load_dwordx4 v25, s[8:11], s19 offen offset:1024 lds
buffer_load_dwordx4 v26, s[8:11], s19 offen offset:2048 lds
buffer_load_dwordx4 v27, s[8:11], s19 offen offset:3072 lds
s_add_u32 m0, s18, 102400
s_nop 0
buffer_load_dwordx4 v28, s[8:11], s19 offen offset:0 lds
buffer_load_dwordx4 v29, s[8:11], s19 offen offset:1024 lds
buffer_load_dwordx4 v30, s[8:11], s19 offen offset:2048 lds
buffer_load_dwordx4 v31, s[8:11], s19 offen offset:3072 lds
s_add_u32 s19, s19, s23
s_add_u32 m0, s25, 98304
s_nop 0
buffer_load_dwordx4 v14, s[68:71], s65 offen offset:0 lds
buffer_load_dwordx4 v15, s[68:71], s65 offen offset:1024 lds
buffer_load_dwordx4 v59, s[68:71], s65 offen offset:2048 lds
buffer_load_dwordx4 v61, s[68:71], s65 offen offset:3072 lds
s_add_u32 s65, s65, 128
s_add_u32 m0, s25, 114688
s_nop 0
buffer_load_dwordx4 v14, s[68:71], s65 offen offset:0 lds
buffer_load_dwordx4 v15, s[68:71], s65 offen offset:1024 lds
buffer_load_dwordx4 v59, s[68:71], s65 offen offset:2048 lds
buffer_load_dwordx4 v61, s[68:71], s65 offen offset:3072 lds
s_add_u32 s65, s65, 128
s_mul_i32 s86, s87, 3
buffer_load_dword v45, v47, s[80:83], s86 offen
s_add_u32 s86, s86, s87
buffer_load_dword v45, v47, s[80:83], s86 offen
s_add_u32 s86, s86, s87
buffer_load_dword v45, v47, s[80:83], s86 offen
s_add_u32 s86, s86, s87
buffer_load_dword v45, v47, s[80:83], s86 offen
s_add_u32 s86, s86, s87
v_mov_b32 v10, 0
v_mov_b32 v11, 0
v_mov_b32 v12, 0
v_mov_b32 v13, 0
v_cvt_pk_bf16_f32 v192, v192, v193
v_cvt_pk_bf16_f32 v193, v194, v195
v_cvt_pk_bf16_f32 v194, v224, v225
v_cvt_pk_bf16_f32 v195, v226, v227
v_cvt_pk_bf16_f32 v196, v196, v197
v_cvt_pk_bf16_f32 v197, v198, v199
v_cvt_pk_bf16_f32 v198, v228, v229
v_cvt_pk_bf16_f32 v199, v230, v231
v_and_or_b32 v196, v196, v43, v44
v_and_or_b32 v197, v197, v43, v44
v_and_or_b32 v198, v198, v43, v44
v_and_or_b32 v199, v199, v43, v44
v_cvt_pk_bf16_f32 v200, v200, v201
v_cvt_pk_bf16_f32 v201, v202, v203
v_cvt_pk_bf16_f32 v202, v232, v233
v_cvt_pk_bf16_f32 v203, v234, v235
v_cvt_pk_bf16_f32 v204, v204, v205
v_cvt_pk_bf16_f32 v205, v206, v207
v_cvt_pk_bf16_f32 v206, v236, v237
v_cvt_pk_bf16_f32 v207, v238, v239
v_and_or_b32 v204, v204, v43, v44
v_and_or_b32 v205, v205, v43, v44
v_and_or_b32 v206, v206, v43, v44
v_and_or_b32 v207, v207, v43, v44
v_cvt_pk_bf16_f32 v208, v208, v209
v_cvt_pk_bf16_f32 v209, v210, v211
v_cvt_pk_bf16_f32 v210, v240, v241
v_cvt_pk_bf16_f32 v211, v242, v243
v_cvt_pk_bf16_f32 v212, v212, v213
v_cvt_pk_bf16_f32 v213, v214, v215
v_cvt_pk_bf16_f32 v214, v244, v245
v_cvt_pk_bf16_f32 v215, v246, v247
v_and_or_b32 v212, v212, v43, v44
v_and_or_b32 v213, v213, v43, v44
v_and_or_b32 v214, v214, v43, v44
v_and_or_b32 v215, v215, v43, v44
v_cvt_pk_bf16_f32 v216, v216, v217
v_cvt_pk_bf16_f32 v217, v218, v219
v_cvt_pk_bf16_f32 v218, v248, v249
v_cvt_pk_bf16_f32 v219, v250, v251
v_cvt_pk_bf16_f32 v220, v220, v221
v_cvt_pk_bf16_f32 v221, v222, v223
v_cvt_pk_bf16_f32 v222, v252, v253
v_cvt_pk_bf16_f32 v223, v254, v255
v_and_or_b32 v220, v220, v43, v44
v_and_or_b32 v221, v221, v43, v44
v_and_or_b32 v222, v222, v43, v44
v_and_or_b32 v223, v223, v43, v44
v_accvgpr_read_b32 v2, a128
v_accvgpr_read_b32 v3, a129
v_accvgpr_read_b32 v4, a130
v_accvgpr_read_b32 v5, a131
v_accvgpr_read_b32 v6, a160
v_accvgpr_read_b32 v7, a161
v_accvgpr_read_b32 v8, a162
v_accvgpr_read_b32 v9, a163
v_cvt_pk_bf16_f32 v224, v2, v3
v_cvt_pk_bf16_f32 v225, v4, v5
v_cvt_pk_bf16_f32 v226, v6, v7
v_cvt_pk_bf16_f32 v227, v8, v9
v_accvgpr_read_b32 v2, a132
v_accvgpr_read_b32 v3, a133
v_accvgpr_read_b32 v4, a134
v_accvgpr_read_b32 v5, a135
v_accvgpr_read_b32 v6, a164
v_accvgpr_read_b32 v7, a165
v_accvgpr_read_b32 v8, a166
v_accvgpr_read_b32 v9, a167
v_cvt_pk_bf16_f32 v228, v2, v3
v_cvt_pk_bf16_f32 v229, v4, v5
v_cvt_pk_bf16_f32 v230, v6, v7
v_cvt_pk_bf16_f32 v231, v8, v9
v_and_or_b32 v228, v228, v43, v44
v_and_or_b32 v229, v229, v43, v44
v_and_or_b32 v230, v230, v43, v44
v_and_or_b32 v231, v231, v43, v44
v_accvgpr_read_b32 v2, a136
v_accvgpr_read_b32 v3, a137
v_accvgpr_read_b32 v4, a138
v_accvgpr_read_b32 v5, a139
v_accvgpr_read_b32 v6, a168
v_accvgpr_read_b32 v7, a169
v_accvgpr_read_b32 v8, a170
v_accvgpr_read_b32 v9, a171
v_cvt_pk_bf16_f32 v232, v2, v3
v_cvt_pk_bf16_f32 v233, v4, v5
v_cvt_pk_bf16_f32 v234, v6, v7
v_cvt_pk_bf16_f32 v235, v8, v9
v_accvgpr_read_b32 v2, a140
v_accvgpr_read_b32 v3, a141
v_accvgpr_read_b32 v4, a142
v_accvgpr_read_b32 v5, a143
v_accvgpr_read_b32 v6, a172
v_accvgpr_read_b32 v7, a173
v_accvgpr_read_b32 v8, a174
v_accvgpr_read_b32 v9, a175
v_cvt_pk_bf16_f32 v236, v2, v3
v_cvt_pk_bf16_f32 v237, v4, v5
v_cvt_pk_bf16_f32 v238, v6, v7
v_cvt_pk_bf16_f32 v239, v8, v9
v_and_or_b32 v236, v236, v43, v44
v_and_or_b32 v237, v237, v43, v44
v_and_or_b32 v238, v238, v43, v44
v_and_or_b32 v239, v239, v43, v44
v_accvgpr_read_b32 v2, a144
v_accvgpr_read_b32 v3, a145
v_accvgpr_read_b32 v4, a146
v_accvgpr_read_b32 v5, a147
v_accvgpr_read_b32 v6, a176
v_accvgpr_read_b32 v7, a177
v_accvgpr_read_b32 v8, a178
v_accvgpr_read_b32 v9, a179
v_cvt_pk_bf16_f32 v240, v2, v3
v_cvt_pk_bf16_f32 v241, v4, v5
v_cvt_pk_bf16_f32 v242, v6, v7
v_cvt_pk_bf16_f32 v243, v8, v9
v_accvgpr_read_b32 v2, a148
v_accvgpr_read_b32 v3, a149
v_accvgpr_read_b32 v4, a150
v_accvgpr_read_b32 v5, a151
v_accvgpr_read_b32 v6, a180
v_accvgpr_read_b32 v7, a181
v_accvgpr_read_b32 v8, a182
v_accvgpr_read_b32 v9, a183
v_cvt_pk_bf16_f32 v244, v2, v3
v_cvt_pk_bf16_f32 v245, v4, v5
v_cvt_pk_bf16_f32 v246, v6, v7
v_cvt_pk_bf16_f32 v247, v8, v9
v_and_or_b32 v244, v244, v43, v44
v_and_or_b32 v245, v245, v43, v44
v_and_or_b32 v246, v246, v43, v44
v_and_or_b32 v247, v247, v43, v44
v_accvgpr_read_b32 v2, a152
v_accvgpr_read_b32 v3, a153
v_accvgpr_read_b32 v4, a154
v_accvgpr_read_b32 v5, a155
v_accvgpr_read_b32 v6, a184
v_accvgpr_read_b32 v7, a185
v_accvgpr_read_b32 v8, a186
v_accvgpr_read_b32 v9, a187
v_cvt_pk_bf16_f32 v248, v2, v3
v_cvt_pk_bf16_f32 v249, v4, v5
v_cvt_pk_bf16_f32 v250, v6, v7
v_cvt_pk_bf16_f32 v251, v8, v9
v_accvgpr_read_b32 v2, a156
v_accvgpr_read_b32 v3, a157
v_accvgpr_read_b32 v4, a158
v_accvgpr_read_b32 v5, a159
v_accvgpr_read_b32 v6, a188
v_accvgpr_read_b32 v7, a189
v_accvgpr_read_b32 v8, a190
v_accvgpr_read_b32 v9, a191
v_cvt_pk_bf16_f32 v252, v2, v3
v_cvt_pk_bf16_f32 v253, v4, v5
v_cvt_pk_bf16_f32 v254, v6, v7
v_cvt_pk_bf16_f32 v255, v8, v9
v_and_or_b32 v252, v252, v43, v44
v_and_or_b32 v253, v253, v43, v44
v_and_or_b32 v254, v254, v43, v44
v_and_or_b32 v255, v255, v43, v44
v_mfma_f32_32x32x16_bf16 a[128:143], v[10:13], v[10:13], 0
v_cvt_pk_bf16_f32 v191, v190, v191
v_cvt_pk_bf16_f32 v190, v188, v189
v_cvt_pk_bf16_f32 v189, v158, v159
v_cvt_pk_bf16_f32 v188, v156, v157
v_and_or_b32 v188, v188, v43, v44
v_and_or_b32 v189, v189, v43, v44
v_and_or_b32 v190, v190, v43, v44
v_and_or_b32 v191, v191, v43, v44
v_mfma_f32_32x32x16_bf16 a[144:159], v[10:13], v[10:13], 0
v_cvt_pk_bf16_f32 v187, v186, v187
v_cvt_pk_bf16_f32 v186, v184, v185
v_cvt_pk_bf16_f32 v185, v154, v155
v_cvt_pk_bf16_f32 v184, v152, v153
v_cvt_pk_bf16_f32 v183, v182, v183
v_cvt_pk_bf16_f32 v182, v180, v181
v_cvt_pk_bf16_f32 v181, v150, v151
v_cvt_pk_bf16_f32 v180, v148, v149
v_mfma_f32_32x32x16_bf16 a[160:175], v[10:13], v[10:13], 0
v_and_or_b32 v180, v180, v43, v44
v_and_or_b32 v181, v181, v43, v44
v_and_or_b32 v182, v182, v43, v44
v_and_or_b32 v183, v183, v43, v44
v_cvt_pk_bf16_f32 v179, v178, v179
v_cvt_pk_bf16_f32 v178, v176, v177
v_cvt_pk_bf16_f32 v177, v146, v147
v_cvt_pk_bf16_f32 v176, v144, v145
v_mfma_f32_32x32x16_bf16 a[176:191], v[10:13], v[10:13], 0
v_cvt_pk_bf16_f32 v175, v174, v175
v_cvt_pk_bf16_f32 v174, v172, v173
v_cvt_pk_bf16_f32 v173, v142, v143
v_cvt_pk_bf16_f32 v172, v140, v141
v_and_or_b32 v172, v172, v43, v44
v_and_or_b32 v173, v173, v43, v44
v_and_or_b32 v174, v174, v43, v44
v_and_or_b32 v175, v175, v43, v44
v_mfma_f32_32x32x16_bf16 a[192:207], v[10:13], v[10:13], 0
v_cvt_pk_bf16_f32 v171, v170, v171
v_cvt_pk_bf16_f32 v170, v168, v169
v_cvt_pk_bf16_f32 v169, v138, v139
v_cvt_pk_bf16_f32 v168, v136, v137
v_cvt_pk_bf16_f32 v167, v166, v167
v_cvt_pk_bf16_f32 v166, v164, v165
v_cvt_pk_bf16_f32 v165, v134, v135
v_cvt_pk_bf16_f32 v164, v132, v133
v_mfma_f32_32x32x16_bf16 a[208:223], v[10:13], v[10:13], 0
v_and_or_b32 v164, v164, v43, v44
v_and_or_b32 v165, v165, v43, v44
v_and_or_b32 v166, v166, v43, v44
v_and_or_b32 v167, v167, v43, v44
v_cvt_pk_bf16_f32 v163, v162, v163
v_cvt_pk_bf16_f32 v162, v160, v161
v_cvt_pk_bf16_f32 v161, v130, v131
v_cvt_pk_bf16_f32 v160, v128, v129
v_mfma_f32_32x32x16_bf16 a[224:239], v[10:13], v[10:13], 0
v_cvt_pk_bf16_f32 v128, v64, v65
v_cvt_pk_bf16_f32 v129, v66, v67
v_cvt_pk_bf16_f32 v130, v96, v97
v_cvt_pk_bf16_f32 v131, v98, v99
v_cvt_pk_bf16_f32 v132, v68, v69
v_cvt_pk_bf16_f32 v133, v70, v71
v_cvt_pk_bf16_f32 v134, v100, v101
v_cvt_pk_bf16_f32 v135, v102, v103
v_mfma_f32_32x32x16_bf16 a[240:255], v[10:13], v[10:13], 0
v_and_or_b32 v132, v132, v43, v44
v_and_or_b32 v133, v133, v43, v44
v_and_or_b32 v134, v134, v43, v44
v_and_or_b32 v135, v135, v43, v44
v_cvt_pk_bf16_f32 v136, v72, v73
v_cvt_pk_bf16_f32 v137, v74, v75
v_cvt_pk_bf16_f32 v138, v104, v105
v_cvt_pk_bf16_f32 v139, v106, v107
v_cvt_pk_bf16_f32 v140, v76, v77
v_cvt_pk_bf16_f32 v141, v78, v79
v_cvt_pk_bf16_f32 v142, v108, v109
v_cvt_pk_bf16_f32 v143, v110, v111
v_and_or_b32 v140, v140, v43, v44
v_and_or_b32 v141, v141, v43, v44
v_and_or_b32 v142, v142, v43, v44
v_and_or_b32 v143, v143, v43, v44
v_cvt_pk_bf16_f32 v144, v80, v81
v_cvt_pk_bf16_f32 v145, v82, v83
v_cvt_pk_bf16_f32 v146, v112, v113
v_cvt_pk_bf16_f32 v147, v114, v115
v_cvt_pk_bf16_f32 v148, v84, v85
v_cvt_pk_bf16_f32 v149, v86, v87
v_cvt_pk_bf16_f32 v150, v116, v117
v_cvt_pk_bf16_f32 v151, v118, v119
v_and_or_b32 v148, v148, v43, v44
v_and_or_b32 v149, v149, v43, v44
v_and_or_b32 v150, v150, v43, v44
v_and_or_b32 v151, v151, v43, v44
v_cvt_pk_bf16_f32 v152, v88, v89
v_cvt_pk_bf16_f32 v153, v90, v91
v_cvt_pk_bf16_f32 v154, v120, v121
v_cvt_pk_bf16_f32 v155, v122, v123
v_cvt_pk_bf16_f32 v156, v92, v93
v_cvt_pk_bf16_f32 v157, v94, v95
v_cvt_pk_bf16_f32 v158, v124, v125
v_cvt_pk_bf16_f32 v159, v126, v127
v_and_or_b32 v156, v156, v43, v44
v_and_or_b32 v157, v157, v43, v44
v_and_or_b32 v158, v158, v43, v44
v_and_or_b32 v159, v159, v43, v44
s_mov_b32 s43, 4096
s_mov_b32 s44, 8192
s_mov_b32 s73, s28
s_mov_b32 s74, s27
s_lshl_b32 s76, s27, 1
s_mov_b32 s27, s29
s_mov_b32 s72, 0
s_add_u32 s75, s74, s73
s_add_u32 s77, s76, s73
s_add_u32 s78, s76, s74
s_add_u32 s79, s76, s75
s_branch mega_kernel_qproj
mega_kernel_next:
s_mov_b32 s26, s58
s_mov_b32 s27, s59
s_mov_b32 s28, s60
s_mov_b32 s29, s62
s_mov_b32 s37, s63
s_mov_b32 s79, 1
s_mov_b32 s38, 24
s_add_u32 s21, s21, 1
v_lshrrev_b32 v4, 4, v1
v_and_b32 v2, 15, v1
v_lshlrev_b32 v42, 9, v4
v_lshl_add_u32 v42, v2, 4, v42
s_cmp_eq_u32 s35, 1
s_cbranch_scc1 mega_kernel_lm1
v_and_b32 v5, 8, v1
v_lshl_add_u32 v42, v5, 4, v42
mega_kernel_lm1:
v_mov_b32 v44, 0
s_cmp_eq_u32 s37, 0
s_cselect_b32 s61, 48, 12
v_mov_b32 v5, v2
s_cbranch_scc0 mega_kernel_lm2
v_mov_b32 v5, v1
mega_kernel_lm2:
v_cmp_gt_u32 vcc, s61, v5
v_mov_b32 v6, 0x3f803f80
s_nop 0
v_cndmask_b32 v43, 0, -1, vcc
v_cmp_eq_u32 vcc, 12, v2
s_nop 1
v_cndmask_b32 v44, v44, v6, vcc
v_mov_b32 v10, 0
v_mov_b32 v11, 0
v_mov_b32 v12, 0
v_mov_b32 v13, 0
s_nop 1
v_mfma_f32_32x32x16_bf16 v[64:79], v[10:13], v[10:13], 0
v_mfma_f32_32x32x16_bf16 v[80:95], v[10:13], v[10:13], 0
v_mfma_f32_32x32x16_bf16 v[96:111], v[10:13], v[10:13], 0
v_mfma_f32_32x32x16_bf16 v[112:127], v[10:13], v[10:13], 0
v_mfma_f32_32x32x16_bf16 v[128:143], v[10:13], v[10:13], 0
v_mfma_f32_32x32x16_bf16 v[144:159], v[10:13], v[10:13], 0
v_mfma_f32_32x32x16_bf16 v[160:175], v[10:13], v[10:13], 0
v_mfma_f32_32x32x16_bf16 v[176:191], v[10:13], v[10:13], 0
v_mfma_f32_32x32x16_bf16 v[192:207], v[10:13], v[10:13], 0
v_mfma_f32_32x32x16_bf16 v[208:223], v[10:13], v[10:13], 0
v_mfma_f32_32x32x16_bf16 v[224:239], v[10:13], v[10:13], 0
v_mfma_f32_32x32x16_bf16 v[240:255], v[10:13], v[10:13], 0
v_mfma_f32_32x32x16_bf16 a[128:143], v[10:13], v[10:13], 0
v_mfma_f32_32x32x16_bf16 a[144:159], v[10:13], v[10:13], 0
v_mfma_f32_32x32x16_bf16 a[160:175], v[10:13], v[10:13], 0
v_mfma_f32_32x32x16_bf16 a[176:191], v[10:13], v[10:13], 0
s_cmp_eq_u32 s37, 0
s_cbranch_scc0 mega_kernel_t1_bz
s_branch mega_kernel_t0_bz
mega_kernel_k1:
s_nop 7
v_exp_f32 v123, v123
v_add_f32 v24, v122, v24
buffer_load_dwordx4 v57, s[8:11], s17 offen offset:1024 sc1 lds
s_waitcnt lgkmcnt(4)
v_exp_f32 v116, v116
v_add_f32 v24, v123, v24
v_exp_f32 v117, v117
v_cvt_pk_bf16_f32 v155, v122, v123
buffer_load_dwordx4 v57, s[8:11], s17 offen offset:2048 sc1 lds
v_exp_f32 v118, v118
v_add_f32 v25, v116, v25
v_add_f32 v25, v117, v25
v_exp_f32 v119, v119
v_exp_f32 v124, v124
buffer_load_dwordx4 v57, s[8:11], s17 offen offset:3072 sc1 lds
s_waitcnt vmcnt(16) lgkmcnt(0)
s_barrier
v_exp_f32 v125, v125
ds_read_b128 a[192:195], v16 offset:32768
v_cvt_pk_bf16_f32 v156, v116, v117
ds_read_b128 a[196:199], v16 offset:49152
v_add_f32 v25, v118, v25
v_exp_f32 v126, v126
ds_read_b128 a[200:203], v16 offset:33792
v_add_f32 v25, v119, v25
v_exp_f32 v127, v127
ds_read_b128 a[204:207], v16 offset:50176
v_cvt_pk_bf16_f32 v157, v118, v119
ds_read_b128 a[208:211], v16 offset:34816
v_add_f32 v25, v124, v25
s_add_u32 s17, s17, 32768
v_add_f32 v25, v125, v25
ds_read_b128 a[212:215], v16 offset:51200
v_cvt_pk_bf16_f32 v158, v124, v125
v_add_f32 v25, v126, v25
v_cvt_pk_bf16_f32 v159, v126, v127
ds_read_b128 a[216:219], v16 offset:35840
v_add_f32 v25, v127, v25
ds_read_b128 a[220:223], v16 offset:52224
s_nop 1
s_branch mega_kernel_k1r
mega_kernel_k0a:
s_nop 7
s_waitcnt lgkmcnt(4)
s_add_u32 m0, s18, 32768
v_exp_f32 v78, v78
s_nop 0
v_add_f32 v25, v78, v25
s_waitcnt lgkmcnt(3)
buffer_load_dwordx4 v56, s[8:11], s17 offen offset:0 sc1 lds
v_exp_f32 v79, v79
s_nop 0
v_add_f32 v25, v79, v25
v_cvt_pk_bf16_f32 v135, v78, v79
v_exp_f32 v80, v80
buffer_load_dwordx4 v56, s[8:11], s17 offen offset:1024 sc1 lds
v_add_f32 v24, v80, v24
v_exp_f32 v81, v81
s_nop 0
v_add_f32 v24, v81, v24
v_cvt_pk_bf16_f32 v136, v80, v81
v_exp_f32 v82, v82
s_waitcnt lgkmcnt(5)
buffer_load_dwordx4 v56, s[8:11], s17 offen offset:2048 sc1 lds
v_add_f32 v24, v82, v24
v_exp_f32 v83, v83
s_waitcnt lgkmcnt(3)
v_exp_f32 v88, v88
v_add_f32 v24, v83, v24
buffer_load_dwordx4 v56, s[8:11], s17 offen offset:3072 sc1 lds
v_cvt_pk_bf16_f32 v137, v82, v83
v_exp_f32 v89, v89
s_add_u32 m0, s18, 36864
v_add_f32 v24, v88, v24
v_exp_f32 v90, v90
buffer_load_dwordx4 v57, s[8:11], s17 offen offset:0 sc1 lds
v_add_f32 v24, v89, v24
v_cvt_pk_bf16_f32 v138, v88, v89
s_waitcnt lgkmcnt(6)
s_nop 1
mega_kernel_k0b:
s_nop 7
v_exp_f32 v91, v91
v_add_f32 v24, v90, v24
buffer_load_dwordx4 v57, s[8:11], s17 offen offset:1024 sc1 lds
s_waitcnt lgkmcnt(4)
v_exp_f32 v84, v84
v_add_f32 v24, v91, v24
v_exp_f32 v85, v85
v_cvt_pk_bf16_f32 v139, v90, v91
buffer_load_dwordx4 v57, s[8:11], s17 offen offset:2048 sc1 lds
v_exp_f32 v86, v86
v_add_f32 v25, v84, v25
v_add_f32 v25, v85, v25
v_exp_f32 v87, v87
v_exp_f32 v92, v92
buffer_load_dwordx4 v57, s[8:11], s17 offen offset:3072 sc1 lds
s_waitcnt vmcnt(16) lgkmcnt(0)
s_barrier
v_exp_f32 v93, v93
ds_read_b128 a[192:195], v16 offset:0
v_cvt_pk_bf16_f32 v140, v84, v85
ds_read_b128 a[196:199], v16 offset:16384
v_add_f32 v25, v86, v25
v_exp_f32 v94, v94
ds_read_b128 a[200:203], v16 offset:1024
v_add_f32 v25, v87, v25
v_exp_f32 v95, v95
ds_read_b128 a[204:207], v16 offset:17408
v_cvt_pk_bf16_f32 v141, v86, v87
ds_read_b128 a[208:211], v16 offset:2048
v_add_f32 v25, v92, v25
s_add_u32 s17, s17, 32768
v_add_f32 v25, v93, v25
ds_read_b128 a[212:215], v16 offset:18432
v_cvt_pk_bf16_f32 v142, v92, v93
v_add_f32 v25, v94, v25
v_cvt_pk_bf16_f32 v143, v94, v95
ds_read_b128 a[216:219], v16 offset:3072
v_add_f32 v25, v95, v25
ds_read_b128 a[220:223], v16 offset:19456
s_nop 1
s_branch mega_kernel_k0r
mega_kernel_kt:
s_nop 7
s_waitcnt lgkmcnt(4)
s_add_u32 m0, s18, 0
v_mov_b32 v2, v24
v_mov_b32 v3, v25
s_nop 0
v_permlane16_swap_b32 v2, v24
v_permlane16_swap_b32 v3, v25
v_add_f32 v24, v24, v2
v_mov_b32 v2, v24
v_add_f32 v25, v25, v3
v_mov_b32 v3, v25
s_waitcnt lgkmcnt(6)
v_permlane32_swap_b32 v2, v24
v_permlane32_swap_b32 v3, v25
v_add_f32 v24, v24, v2
v_rcp_f32 v20, v24
v_add_f32 v25, v25, v3
v_rcp_f32 v22, v25
buffer_load_dwordx4 v48, s[4:7], s16 offen offset:0 sc1 lds
buffer_load_dwordx4 v49, s[4:7], s16 offen offset:1024 sc1 lds
s_waitcnt lgkmcnt(6)
v_accvgpr_read_b32 v4, a0
v_accvgpr_read_b32 v5, a1
v_accvgpr_read_b32 v6, a2
v_accvgpr_read_b32 v7, a3
v_accvgpr_read_b32 v8, a8
v_accvgpr_read_b32 v9, a9
v_accvgpr_read_b32 v10, a10
v_accvgpr_read_b32 v11, a11
v_mul_f32 v4, v4, v20
v_mul_f32 v5, v5, v20
v_mul_f32 v6, v6, v20
v_mul_f32 v7, v7, v20
v_mul_f32 v8, v8, v20
v_mul_f32 v9, v9, v20
v_mul_f32 v10, v10, v20
v_mul_f32 v11, v11, v20
v_cvt_pk_bf16_f32 v64, v4, v5
v_cvt_pk_bf16_f32 v65, v6, v7
v_cvt_pk_bf16_f32 v66, v8, v9
v_cvt_pk_bf16_f32 v67, v10, v11
s_waitcnt lgkmcnt(2)
v_accvgpr_read_b32 v4, a4
v_accvgpr_read_b32 v5, a5
v_accvgpr_read_b32 v6, a6
v_accvgpr_read_b32 v7, a7
v_accvgpr_read_b32 v8, a12
v_accvgpr_read_b32 v9, a13
v_accvgpr_read_b32 v10, a14
v_accvgpr_read_b32 v11, a15
v_mul_f32 v4, v4, v22
v_mul_f32 v5, v5, v22
v_mul_f32 v6, v6, v22
v_mul_f32 v7, v7, v22
v_mul_f32 v8, v8, v22
v_mul_f32 v9, v9, v22
v_mul_f32 v10, v10, v22
v_mul_f32 v11, v11, v22
v_cvt_pk_bf16_f32 v96, v4, v5
v_cvt_pk_bf16_f32 v97, v6, v7
v_cvt_pk_bf16_f32 v98, v8, v9
v_cvt_pk_bf16_f32 v99, v10, v11
s_waitcnt lgkmcnt(0)
buffer_load_dwordx4 v50, s[4:7], s16 offen offset:2048 sc1 lds
v_accvgpr_read_b32 v4, a16
v_accvgpr_read_b32 v5, a17
v_accvgpr_read_b32 v6, a18
v_accvgpr_read_b32 v7, a19
v_accvgpr_read_b32 v8, a24
v_accvgpr_read_b32 v9, a25
v_accvgpr_read_b32 v10, a26
v_accvgpr_read_b32 v11, a27
v_mul_f32 v4, v4, v20
v_mul_f32 v5, v5, v20
v_mul_f32 v6, v6, v20
v_mul_f32 v7, v7, v20
v_mul_f32 v8, v8, v20
v_mul_f32 v9, v9, v20
v_mul_f32 v10, v10, v20
v_mul_f32 v11, v11, v20
v_cvt_pk_bf16_f32 v68, v4, v5
v_cvt_pk_bf16_f32 v69, v6, v7
s_waitcnt lgkmcnt(1)
v_cvt_pk_bf16_f32 v70, v8, v9
v_cvt_pk_bf16_f32 v71, v10, v11
v_accvgpr_read_b32 v4, a20
v_accvgpr_read_b32 v5, a21
v_accvgpr_read_b32 v6, a22
v_accvgpr_read_b32 v7, a23
v_accvgpr_read_b32 v8, a28
v_accvgpr_read_b32 v9, a29
v_accvgpr_read_b32 v10, a30
v_accvgpr_read_b32 v11, a31
v_mul_f32 v4, v4, v22
v_mul_f32 v5, v5, v22
v_mul_f32 v6, v6, v22
v_mul_f32 v7, v7, v22
v_mul_f32 v8, v8, v22
v_mul_f32 v9, v9, v22
v_mul_f32 v10, v10, v22
s_waitcnt lgkmcnt(0)
s_barrier
v_mul_f32 v11, v11, v22
v_cvt_pk_bf16_f32 v100, v4, v5
v_cvt_pk_bf16_f32 v101, v6, v7
ds_read_b64_tr_b16 a[192:193], v165 offset:32768
v_cvt_pk_bf16_f32 v102, v8, v9
v_cvt_pk_bf16_f32 v103, v10, v11
ds_read_b64_tr_b16 a[194:195], v165 offset:34816
v_accvgpr_read_b32 v4, a32
ds_read_b64_tr_b16 a[196:197], v166 offset:32768
v_accvgpr_read_b32 v5, a33
v_accvgpr_read_b32 v6, a34
ds_read_b64_tr_b16 a[198:199], v166 offset:34816
v_accvgpr_read_b32 v7, a35
v_accvgpr_read_b32 v8, a40
ds_read_b64_tr_b16 a[200:201], v167 offset:32768
v_accvgpr_read_b32 v9, a41
v_accvgpr_read_b32 v10, a42
v_accvgpr_read_b32 v11, a43
ds_read_b64_tr_b16 a[202:203], v167 offset:34816
v_mul_f32 v4, v4, v20
v_mul_f32 v5, v5, v20
ds_read_b64_tr_b16 a[204:205], v168 offset:32768
v_mul_f32 v6, v6, v20
v_mul_f32 v7, v7, v20
v_mul_f32 v8, v8, v20
ds_read_b64_tr_b16 a[206:207], v168 offset:34816
v_mul_f32 v9, v9, v20
v_mul_f32 v10, v10, v20
buffer_load_dwordx4 v51, s[4:7], s16 offen offset:3072 sc1 lds
ds_read_b64_tr_b16 a[208:209], v165 offset:36864
s_add_u32 m0, s18, 4096
v_mul_f32 v11, v11, v20
v_cvt_pk_bf16_f32 v72, v4, v5
v_cvt_pk_bf16_f32 v73, v6, v7
buffer_load_dwordx4 v52, s[4:7], s16 offen offset:0 sc1 lds
ds_read_b64_tr_b16 a[210:211], v165 offset:38912
v_cvt_pk_bf16_f32 v74, v8, v9
v_cvt_pk_bf16_f32 v75, v10, v11
buffer_load_dwordx4 v53, s[4:7], s16 offen offset:1024 sc1 lds
ds_read_b64_tr_b16 a[212:213], v166 offset:36864
v_accvgpr_read_b32 v4, a36
v_accvgpr_read_b32 v5, a37
v_accvgpr_read_b32 v6, a38
buffer_load_dwordx4 v54, s[4:7], s16 offen offset:2048 sc1 lds
ds_read_b64_tr_b16 a[214:215], v166 offset:38912
v_accvgpr_read_b32 v7, a39
v_accvgpr_read_b32 v8, a44
buffer_load_dwordx4 v55, s[4:7], s16 offen offset:3072 sc1 lds
ds_read_b64_tr_b16 a[216:217], v167 offset:36864
v_accvgpr_read_b32 v9, a45
v_accvgpr_read_b32 v10, a46
v_accvgpr_read_b32 v11, a47
ds_read_b64_tr_b16 a[218:219], v167 offset:38912
v_mul_f32 v4, v4, v22
v_mul_f32 v5, v5, v22
ds_read_b64_tr_b16 a[220:221], v168 offset:36864
v_mul_f32 v6, v6, v22
v_mul_f32 v7, v7, v22
v_mul_f32 v8, v8, v22
v_mul_f32 v9, v9, v22
v_mul_f32 v10, v10, v22
v_mul_f32 v11, v11, v22
v_cvt_pk_bf16_f32 v104, v4, v5
v_cvt_pk_bf16_f32 v105, v6, v7
v_cvt_pk_bf16_f32 v106, v8, v9
v_cvt_pk_bf16_f32 v107, v10, v11
s_add_u32 s16, s16, s26
s_nop 1
s_branch mega_kernel_ktr
mega_kernel_chk:
s_mov_b32 s62, 200000
mega_kernel_qspin:
v_readfirstlane_b32 s61, v2
s_and_b32 s61, s61, 255
s_cmp_ge_u32 s61, 4
s_cbranch_scc1 mega_kernel_qok
s_sleep 4
global_load_dword v2, v3, s[52:53] sc1
s_waitcnt vmcnt(0)
s_sub_u32 s62, s62, 1
s_cmp_lg_u32 s62, 0
s_cbranch_scc1 mega_kernel_qspin
mega_kernel_qok:
s_branch mega_kernel_chkr
mega_kernel_early:
s_waitcnt vmcnt(12)
s_add_u32 s31, s26, s72
buffer_store_dwordx4 v[128:131], v42, s[12:15], s31 offen sc0 sc1
s_add_u32 s31, s26, s73
buffer_store_dwordx4 v[132:135], v42, s[12:15], s31 offen sc0 sc1
s_add_u32 s31, s26, s74
buffer_store_dwordx4 v[136:139], v42, s[12:15], s31 offen sc0 sc1
s_add_u32 s31, s26, s75
buffer_store_dwordx4 v[140:143], v42, s[12:15], s31 offen sc0 sc1
s_add_u32 s31, s26, s76
buffer_store_dwordx4 v[144:147], v42, s[12:15], s31 offen sc0 sc1
s_add_u32 s31, s26, s77
buffer_store_dwordx4 v[148:151], v42, s[12:15], s31 offen sc0 sc1
s_add_u32 s31, s26, s78
buffer_store_dwordx4 v[152:155], v42, s[12:15], s31 offen sc0 sc1
s_add_u32 s31, s26, s79
buffer_store_dwordx4 v[156:159], v42, s[12:15], s31 offen sc0 sc1
s_add_u32 s26, s26, s27
s_add_u32 s31, s26, s72
buffer_store_dwordx4 v[160:163], v42, s[12:15], s31 offen sc0 sc1
s_add_u32 s31, s26, s73
buffer_store_dwordx4 v[164:167], v42, s[12:15], s31 offen sc0 sc1
s_add_u32 s31, s26, s74
buffer_store_dwordx4 v[168:171], v42, s[12:15], s31 offen sc0 sc1
s_add_u32 s31, s26, s75
buffer_store_dwordx4 v[172:175], v42, s[12:15], s31 offen sc0 sc1
s_add_u32 s31, s26, s76
buffer_store_dwordx4 v[176:179], v42, s[12:15], s31 offen sc0 sc1
s_add_u32 s31, s26, s77
buffer_store_dwordx4 v[180:183], v42, s[12:15], s31 offen sc0 sc1
s_add_u32 s31, s26, s78
buffer_store_dwordx4 v[184:187], v42, s[12:15], s31 offen sc0 sc1
s_add_u32 s31, s26, s79
buffer_store_dwordx4 v[188:191], v42, s[12:15], s31 offen sc0 sc1
s_add_u32 s26, s26, s27
s_add_u32 s31, s26, s72
buffer_store_dwordx4 v[192:195], v42, s[12:15], s31 offen sc0 sc1
s_add_u32 s31, s26, s73
buffer_store_dwordx4 v[196:199], v42, s[12:15], s31 offen sc0 sc1
s_add_u32 s31, s26, s74
buffer_store_dwordx4 v[200:203], v42, s[12:15], s31 offen sc0 sc1
s_add_u32 s31, s26, s75
buffer_store_dwordx4 v[204:207], v42, s[12:15], s31 offen sc0 sc1
s_add_u32 s31, s26, s76
buffer_store_dwordx4 v[208:211], v42, s[12:15], s31 offen sc0 sc1
s_add_u32 s31, s26, s77
buffer_store_dwordx4 v[212:215], v42, s[12:15], s31 offen sc0 sc1
s_add_u32 s31, s26, s78
buffer_store_dwordx4 v[216:219], v42, s[12:15], s31 offen sc0 sc1
s_add_u32 s31, s26, s79
buffer_store_dwordx4 v[220:223], v42, s[12:15], s31 offen sc0 sc1
s_add_u32 s26, s26, s27
s_add_u32 s31, s26, s72
buffer_store_dwordx4 v[224:227], v42, s[12:15], s31 offen sc0 sc1
s_add_u32 s31, s26, s73
buffer_store_dwordx4 v[228:231], v42, s[12:15], s31 offen sc0 sc1
s_add_u32 s31, s26, s74
buffer_store_dwordx4 v[232:235], v42, s[12:15], s31 offen sc0 sc1
s_add_u32 s31, s26, s75
buffer_store_dwordx4 v[236:239], v42, s[12:15], s31 offen sc0 sc1
s_add_u32 s31, s26, s76
buffer_store_dwordx4 v[240:243], v42, s[12:15], s31 offen sc0 sc1
s_add_u32 s31, s26, s77
buffer_store_dwordx4 v[244:247], v42, s[12:15], s31 offen sc0 sc1
s_add_u32 s31, s26, s78
buffer_store_dwordx4 v[248:251], v42, s[12:15], s31 offen sc0 sc1
s_add_u32 s31, s26, s79
buffer_store_dwordx4 v[252:255], v42, s[12:15], s31 offen sc0 sc1
s_waitcnt vmcnt(0)
s_barrier
s_mov_b32 s42, 128
s_cmp_eq_u32 s20, 0
s_cbranch_scc0 mega_kernel_late
v_mov_b32 v3, s3
v_mov_b32 v2, 1
s_mov_b64 exec, 1
global_atomic_add v3, v2, s[52:53] sc1
s_mov_b64 exec, -1
s_branch mega_kernel_late
mega_kernel_i0_r1:
s_nop 7
v_mov_b32 v2, v21
s_nop 1
v_permlane16_swap_b32 v2, v21
s_nop 1
v_max_f32 v21, v21, v2
v_mov_b32 v2, v21
s_nop 1
v_permlane32_swap_b32 v2, v21
s_nop 1
v_max_f32 v21, v21, v2
v_max_f32 v21, 0, v21
v_exp_f32 v26, -v21
v_sub_f32 v32, v32, v21
v_sub_f32 v33, v33, v21
v_sub_f32 v34, v34, v21
v_sub_f32 v35, v35, v21
v_sub_f32 v96, v96, v21
v_sub_f32 v97, v97, v21
v_sub_f32 v98, v98, v21
v_sub_f32 v99, v99, v21
v_sub_f32 v104, v104, v21
v_sub_f32 v105, v105, v21
v_sub_f32 v106, v106, v21
v_sub_f32 v107, v107, v21
v_sub_f32 v112, v112, v21
v_sub_f32 v113, v113, v21
v_sub_f32 v114, v114, v21
v_sub_f32 v115, v115, v21
v_sub_f32 v120, v120, v21
v_sub_f32 v121, v121, v21
v_sub_f32 v122, v122, v21
v_sub_f32 v123, v123, v21
v_mul_f32 v24, v24, v26
v_mov_b32 v2, v22
s_nop 1
v_permlane16_swap_b32 v2, v22
s_nop 1
v_max_f32 v22, v22, v2
v_mov_b32 v2, v22
s_nop 1
v_permlane32_swap_b32 v2, v22
s_nop 1
v_max_f32 v22, v22, v2
v_max_f32 v22, 0, v22
v_exp_f32 v27, -v22
v_sub_f32 v36, v36, v22
v_sub_f32 v37, v37, v22
v_sub_f32 v38, v38, v22
v_sub_f32 v39, v39, v22
v_sub_f32 v100, v100, v22
v_sub_f32 v101, v101, v22
v_sub_f32 v102, v102, v22
v_sub_f32 v103, v103, v22
v_sub_f32 v108, v108, v22
v_sub_f32 v109, v109, v22
v_sub_f32 v110, v110, v22
v_sub_f32 v111, v111, v22
v_sub_f32 v116, v116, v22
v_sub_f32 v117, v117, v22
v_sub_f32 v118, v118, v22
v_sub_f32 v119, v119, v22
v_sub_f32 v124, v124, v22
v_sub_f32 v125, v125, v22
v_sub_f32 v126, v126, v22
v_sub_f32 v127, v127, v22
v_mul_f32 v25, v25, v27
s_mov_b32 s23, 1
v_mfma_f32_16x16x32_bf16 a[24:27], a[220:223], v[136:139], a[24:27]
buffer_load_dwordx4 v49, s[4:7], s16 offen offset:1024 sc1 lds
v_mfma_f32_16x16x32_bf16 a[28:31], a[216:219], v[132:135], a[28:31]
v_exp_f32 v96, v96
v_mfma_f32_16x16x32_bf16 a[28:31], a[220:223], v[140:143], a[28:31]
ds_read_b128 a[196:199], v16 offset:24576
s_waitcnt lgkmcnt(6)
v_mfma_f32_16x16x32_bf16 a[32:35], a[224:227], v[128:131], a[32:35]
buffer_load_dwordx4 v50, s[4:7], s16 offen offset:2048 sc1 lds
v_mfma_f32_16x16x32_bf16 a[32:35], a[228:231], v[136:139], a[32:35]
v_exp_f32 v97, v97
v_mfma_f32_16x16x32_bf16 a[36:39], a[224:227], v[132:135], a[36:39]
ds_read_b128 a[200:203], v16 offset:9216
v_add_f32 v24, v96, v24
v_mfma_f32_16x16x32_bf16 a[36:39], a[228:231], v[140:143], a[36:39]
ds_read_b128 a[204:207], v16 offset:25600
v_add_f32 v24, v97, v24
v_mfma_f32_16x16x32_bf16 a[40:43], a[232:235], v[128:131], a[40:43]
v_exp_f32 v98, v98
v_mfma_f32_16x16x32_bf16 a[40:43], a[236:239], v[136:139], a[40:43]
ds_read_b128 a[208:211], v16 offset:10240
v_cvt_pk_bf16_f32 v144, v96, v97
v_mfma_f32_16x16x32_bf16 a[44:47], a[232:235], v[132:135], a[44:47]
buffer_load_dwordx4 v51, s[4:7], s16 offen offset:3072 sc1 lds
v_mfma_f32_16x16x32_bf16 a[44:47], a[236:239], v[140:143], a[44:47]
ds_read_b128 a[212:215], v16 offset:26624
s_waitcnt lgkmcnt(6)
v_mfma_f32_16x16x32_bf16 a[48:51], a[240:243], v[128:131], a[48:51]
v_exp_f32 v99, v99
v_mfma_f32_16x16x32_bf16 a[48:51], a[244:247], v[136:139], a[48:51]
s_add_u32 m0, s18, 69632
ds_read_b128 a[216:219], v16 offset:11264
v_mfma_f32_16x16x32_bf16 a[52:55], a[240:243], v[132:135], a[52:55]
ds_read_b128 a[220:223], v16 offset:27648
v_add_f32 v24, v98, v24
v_mfma_f32_16x16x32_bf16 a[52:55], a[244:247], v[140:143], a[52:55]
buffer_load_dwordx4 v52, s[4:7], s16 offen offset:0 sc1 lds
v_mfma_f32_16x16x32_bf16 a[56:59], a[248:251], v[128:131], a[56:59]
v_exp_f32 v104, v104
v_mfma_f32_16x16x32_bf16 a[56:59], a[252:255], v[136:139], a[56:59]
ds_read_b128 a[224:227], v16 offset:12288
v_add_f32 v24, v99, v24
v_mfma_f32_16x16x32_bf16 a[60:63], a[248:251], v[132:135], a[60:63]
ds_read_b128 a[228:231], v16 offset:28672
v_cvt_pk_bf16_f32 v145, v98, v99
v_mfma_f32_16x16x32_bf16 a[60:63], a[252:255], v[140:143], a[60:63]
ds_read_b128 a[232:235], v16 offset:13312
s_waitcnt lgkmcnt(7)
v_mfma_f32_16x16x32_bf16 a[64:67], a[192:195], v[128:131], a[64:67]
v_exp_f32 v105, v105
v_mfma_f32_16x16x32_bf16 a[64:67], a[196:199], v[136:139], a[64:67]
buffer_load_dwordx4 v53, s[4:7], s16 offen offset:1024 sc1 lds
v_mfma_f32_16x16x32_bf16 a[68:71], a[192:195], v[132:135], a[68:71]
ds_read_b128 a[236:239], v16 offset:29696
v_add_f32 v24, v104, v24
v_mfma_f32_16x16x32_bf16 a[68:71], a[196:199], v[140:143], a[68:71]
v_exp_f32 v106, v106
v_mfma_f32_16x16x32_bf16 a[72:75], a[200:203], v[128:131], a[72:75]
ds_read_b128 a[240:243], v16 offset:14336
v_add_f32 v24, v105, v24
v_mfma_f32_16x16x32_bf16 a[72:75], a[204:207], v[136:139], a[72:75]
ds_read_b128 a[244:247], v16 offset:30720
v_cvt_pk_bf16_f32 v146, v104, v105
v_mfma_f32_16x16x32_bf16 a[76:79], a[200:203], v[132:135], a[76:79]
v_exp_f32 v107, v107
v_mfma_f32_16x16x32_bf16 a[76:79], a[204:207], v[140:143], a[76:79]
ds_read_b128 a[248:251], v16 offset:15360
s_waitcnt lgkmcnt(7)
v_mfma_f32_16x16x32_bf16 a[80:83], a[208:211], v[128:131], a[80:83]
buffer_load_dwordx4 v54, s[4:7], s16 offen offset:2048 sc1 lds
v_mfma_f32_16x16x32_bf16 a[80:83], a[212:215], v[136:139], a[80:83]
v_exp_f32 v100, v100
v_mfma_f32_16x16x32_bf16 a[84:87], a[208:211], v[132:135], a[84:87]
ds_read_b128 a[252:255], v16 offset:31744
v_add_f32 v24, v106, v24
v_mfma_f32_16x16x32_bf16 a[84:87], a[212:215], v[140:143], a[84:87]
v_exp_f32 v101, v101
v_mfma_f32_16x16x32_bf16 a[88:91], a[216:219], v[128:131], a[88:91]
buffer_load_dwordx4 v55, s[4:7], s16 offen offset:3072 sc1 lds
v_mfma_f32_16x16x32_bf16 a[88:91], a[220:223], v[136:139], a[88:91]
v_add_f32 v24, v107, v24
v_cvt_pk_bf16_f32 v147, v106, v107
v_mfma_f32_16x16x32_bf16 a[92:95], a[216:219], v[132:135], a[92:95]
v_exp_f32 v102, v102
v_mfma_f32_16x16x32_bf16 a[92:95], a[220:223], v[140:143], a[92:95]
s_waitcnt vmcnt(16) lgkmcnt(0)
s_barrier
v_mfma_f32_16x16x32_bf16 a[96:99], a[224:227], v[128:131], a[96:99]
ds_read_b128 a[192:195], v17 offset:32768
v_add_f32 v25, v100, v25
v_mfma_f32_16x16x32_bf16 a[96:99], a[228:231], v[136:139], a[96:99]
ds_read_b128 a[196:199], v17 offset:33792
v_add_f32 v25, v101, v25
v_mfma_f32_16x16x32_bf16 a[100:103], a[224:227], v[132:135], a[100:103]
v_exp_f32 v103, v103
v_mfma_f32_16x16x32_bf16 a[100:103], a[228:231], v[140:143], a[100:103]
ds_read_b128 a[200:203], v17 offset:34816
v_cvt_pk_bf16_f32 v148, v100, v101
v_mfma_f32_16x16x32_bf16 a[104:107], a[232:235], v[128:131], a[104:107]
s_add_u32 s16, s16, s26
v_add_f32 v25, v102, v25
v_mfma_f32_16x16x32_bf16 a[104:107], a[236:239], v[136:139], a[104:107]
s_add_u32 s19, s19, 1
ds_read_b128 a[204:207], v17 offset:35840
v_mfma_f32_16x16x32_bf16 a[108:111], a[232:235], v[132:135], a[108:111]
v_exp_f32 v108, v108
v_mfma_f32_16x16x32_bf16 a[108:111], a[236:239], v[140:143], a[108:111]
ds_read_b128 a[208:211], v17 offset:36864
v_add_f32 v25, v103, v25
v_mfma_f32_16x16x32_bf16 a[112:115], a[240:243], v[128:131], a[112:115]
v_exp_f32 v109, v109
v_mfma_f32_16x16x32_bf16 a[112:115], a[244:247], v[136:139], a[112:115]
ds_read_b128 a[212:215], v17 offset:37888
v_cvt_pk_bf16_f32 v149, v102, v103
v_mfma_f32_16x16x32_bf16 a[116:119], a[240:243], v[132:135], a[116:119]
v_add_f32 v25, v108, v25
v_cvt_pk_bf16_f32 v150, v108, v109
v_mfma_f32_16x16x32_bf16 a[116:119], a[244:247], v[140:143], a[116:119]
ds_read_b128 a[216:219], v17 offset:38912
v_add_f32 v25, v109, v25
v_mfma_f32_16x16x32_bf16 a[120:123], a[248:251], v[128:131], a[120:123]
ds_read_b128 a[220:223], v17 offset:39936
v_mfma_f32_16x16x32_bf16 a[120:123], a[252:255], v[136:139], a[120:123]
v_mfma_f32_16x16x32_bf16 a[124:127], a[248:251], v[132:135], a[124:127]
v_mfma_f32_16x16x32_bf16 a[124:127], a[252:255], v[140:143], a[124:127]
s_nop 7
v_accvgpr_read_b32 v4, a0
v_accvgpr_read_b32 v5, a1
v_accvgpr_read_b32 v6, a2
v_accvgpr_read_b32 v7, a3
v_mul_f32 v4, v4, v26
v_mul_f32 v5, v5, v26
v_mul_f32 v6, v6, v26
v_mul_f32 v7, v7, v26
v_accvgpr_write_b32 a0, v4
v_accvgpr_write_b32 a1, v5
v_accvgpr_write_b32 a2, v6
v_accvgpr_write_b32 a3, v7
v_accvgpr_read_b32 v4, a4
v_accvgpr_read_b32 v5, a5
v_accvgpr_read_b32 v6, a6
v_accvgpr_read_b32 v7, a7
v_mul_f32 v4, v4, v27
v_mul_f32 v5, v5, v27
v_mul_f32 v6, v6, v27
v_mul_f32 v7, v7, v27
v_accvgpr_write_b32 a4, v4
v_accvgpr_write_b32 a5, v5
v_accvgpr_write_b32 a6, v6
v_accvgpr_write_b32 a7, v7
v_accvgpr_read_b32 v4, a8
v_accvgpr_read_b32 v5, a9
v_accvgpr_read_b32 v6, a10
v_accvgpr_read_b32 v7, a11
v_mul_f32 v4, v4, v26
v_mul_f32 v5, v5, v26
v_mul_f32 v6, v6, v26
v_mul_f32 v7, v7, v26
v_accvgpr_write_b32 a8, v4
v_accvgpr_write_b32 a9, v5
v_accvgpr_write_b32 a10, v6
v_accvgpr_write_b32 a11, v7
v_accvgpr_read_b32 v4, a12
v_accvgpr_read_b32 v5, a13
v_accvgpr_read_b32 v6, a14
v_accvgpr_read_b32 v7, a15
v_mul_f32 v4, v4, v27
v_mul_f32 v5, v5, v27
v_mul_f32 v6, v6, v27
v_mul_f32 v7, v7, v27
v_accvgpr_write_b32 a12, v4
v_accvgpr_write_b32 a13, v5
v_accvgpr_write_b32 a14, v6
v_accvgpr_write_b32 a15, v7
v_accvgpr_read_b32 v4, a16
v_accvgpr_read_b32 v5, a17
v_accvgpr_read_b32 v6, a18
v_accvgpr_read_b32 v7, a19
v_mul_f32 v4, v4, v26
v_mul_f32 v5, v5, v26
v_mul_f32 v6, v6, v26
v_mul_f32 v7, v7, v26
v_accvgpr_write_b32 a16, v4
v_accvgpr_write_b32 a17, v5
v_accvgpr_write_b32 a18, v6
v_accvgpr_write_b32 a19, v7
v_accvgpr_read_b32 v4, a20
v_accvgpr_read_b32 v5, a21
v_accvgpr_read_b32 v6, a22
v_accvgpr_read_b32 v7, a23
v_mul_f32 v4, v4, v27
v_mul_f32 v5, v5, v27
v_mul_f32 v6, v6, v27
v_mul_f32 v7, v7, v27
v_accvgpr_write_b32 a20, v4
v_accvgpr_write_b32 a21, v5
v_accvgpr_write_b32 a22, v6
v_accvgpr_write_b32 a23, v7
v_accvgpr_read_b32 v4, a24
v_accvgpr_read_b32 v5, a25
v_accvgpr_read_b32 v6, a26
v_accvgpr_read_b32 v7, a27
v_mul_f32 v4, v4, v26
v_mul_f32 v5, v5, v26
v_mul_f32 v6, v6, v26
v_mul_f32 v7, v7, v26
v_accvgpr_write_b32 a24, v4
v_accvgpr_write_b32 a25, v5
v_accvgpr_write_b32 a26, v6
v_accvgpr_write_b32 a27, v7
v_accvgpr_read_b32 v4, a28
v_accvgpr_read_b32 v5, a29
v_accvgpr_read_b32 v6, a30
v_accvgpr_read_b32 v7, a31
v_mul_f32 v4, v4, v27
v_mul_f32 v5, v5, v27
v_mul_f32 v6, v6, v27
v_mul_f32 v7, v7, v27
v_accvgpr_write_b32 a28, v4
v_accvgpr_write_b32 a29, v5
v_accvgpr_write_b32 a30, v6
v_accvgpr_write_b32 a31, v7
v_accvgpr_read_b32 v4, a32
v_accvgpr_read_b32 v5, a33
v_accvgpr_read_b32 v6, a34
v_accvgpr_read_b32 v7, a35
v_mul_f32 v4, v4, v26
v_mul_f32 v5, v5, v26
v_mul_f32 v6, v6, v26
v_mul_f32 v7, v7, v26
v_accvgpr_write_b32 a32, v4
v_accvgpr_write_b32 a33, v5
v_accvgpr_write_b32 a34, v6
v_accvgpr_write_b32 a35, v7
v_accvgpr_read_b32 v4, a36
v_accvgpr_read_b32 v5, a37
v_accvgpr_read_b32 v6, a38
v_accvgpr_read_b32 v7, a39
v_mul_f32 v4, v4, v27
v_mul_f32 v5, v5, v27
v_mul_f32 v6, v6, v27
v_mul_f32 v7, v7, v27
v_accvgpr_write_b32 a36, v4
v_accvgpr_write_b32 a37, v5
v_accvgpr_write_b32 a38, v6
v_accvgpr_write_b32 a39, v7
v_accvgpr_read_b32 v4, a40
v_accvgpr_read_b32 v5, a41
v_accvgpr_read_b32 v6, a42
v_accvgpr_read_b32 v7, a43
v_mul_f32 v4, v4, v26
v_mul_f32 v5, v5, v26
v_mul_f32 v6, v6, v26
v_mul_f32 v7, v7, v26
v_accvgpr_write_b32 a40, v4
v_accvgpr_write_b32 a41, v5
v_accvgpr_write_b32 a42, v6
v_accvgpr_write_b32 a43, v7
v_accvgpr_read_b32 v4, a44
v_accvgpr_read_b32 v5, a45
v_accvgpr_read_b32 v6, a46
v_accvgpr_read_b32 v7, a47
v_mul_f32 v4, v4, v27
v_mul_f32 v5, v5, v27
v_mul_f32 v6, v6, v27
v_mul_f32 v7, v7, v27
v_accvgpr_write_b32 a44, v4
v_accvgpr_write_b32 a45, v5
v_accvgpr_write_b32 a46, v6
v_accvgpr_write_b32 a47, v7
v_accvgpr_read_b32 v4, a48
v_accvgpr_read_b32 v5, a49
v_accvgpr_read_b32 v6, a50
v_accvgpr_read_b32 v7, a51
v_mul_f32 v4, v4, v26
v_mul_f32 v5, v5, v26
v_mul_f32 v6, v6, v26
v_mul_f32 v7, v7, v26
v_accvgpr_write_b32 a48, v4
v_accvgpr_write_b32 a49, v5
v_accvgpr_write_b32 a50, v6
v_accvgpr_write_b32 a51, v7
v_accvgpr_read_b32 v4, a52
v_accvgpr_read_b32 v5, a53
v_accvgpr_read_b32 v6, a54
v_accvgpr_read_b32 v7, a55
v_mul_f32 v4, v4, v27
v_mul_f32 v5, v5, v27
v_mul_f32 v6, v6, v27
v_mul_f32 v7, v7, v27
v_accvgpr_write_b32 a52, v4
v_accvgpr_write_b32 a53, v5
v_accvgpr_write_b32 a54, v6
v_accvgpr_write_b32 a55, v7
v_accvgpr_read_b32 v4, a56
v_accvgpr_read_b32 v5, a57
v_accvgpr_read_b32 v6, a58
v_accvgpr_read_b32 v7, a59
v_mul_f32 v4, v4, v26
v_mul_f32 v5, v5, v26
v_mul_f32 v6, v6, v26
v_mul_f32 v7, v7, v26
v_accvgpr_write_b32 a56, v4
v_accvgpr_write_b32 a57, v5
v_accvgpr_write_b32 a58, v6
v_accvgpr_write_b32 a59, v7
v_accvgpr_read_b32 v4, a60
v_accvgpr_read_b32 v5, a61
v_accvgpr_read_b32 v6, a62
v_accvgpr_read_b32 v7, a63
v_mul_f32 v4, v4, v27
v_mul_f32 v5, v5, v27
v_mul_f32 v6, v6, v27
v_mul_f32 v7, v7, v27
v_accvgpr_write_b32 a60, v4
v_accvgpr_write_b32 a61, v5
v_accvgpr_write_b32 a62, v6
v_accvgpr_write_b32 a63, v7
v_accvgpr_read_b32 v4, a64
v_accvgpr_read_b32 v5, a65
v_accvgpr_read_b32 v6, a66
v_accvgpr_read_b32 v7, a67
v_mul_f32 v4, v4, v26
v_mul_f32 v5, v5, v26
v_mul_f32 v6, v6, v26
v_mul_f32 v7, v7, v26
v_accvgpr_write_b32 a64, v4
v_accvgpr_write_b32 a65, v5
v_accvgpr_write_b32 a66, v6
v_accvgpr_write_b32 a67, v7
v_accvgpr_read_b32 v4, a68
v_accvgpr_read_b32 v5, a69
v_accvgpr_read_b32 v6, a70
v_accvgpr_read_b32 v7, a71
v_mul_f32 v4, v4, v27
v_mul_f32 v5, v5, v27
v_mul_f32 v6, v6, v27
v_mul_f32 v7, v7, v27
v_accvgpr_write_b32 a68, v4
v_accvgpr_write_b32 a69, v5
v_accvgpr_write_b32 a70, v6
v_accvgpr_write_b32 a71, v7
v_accvgpr_read_b32 v4, a72
v_accvgpr_read_b32 v5, a73
v_accvgpr_read_b32 v6, a74
v_accvgpr_read_b32 v7, a75
v_mul_f32 v4, v4, v26
v_mul_f32 v5, v5, v26
v_mul_f32 v6, v6, v26
v_mul_f32 v7, v7, v26
v_accvgpr_write_b32 a72, v4
v_accvgpr_write_b32 a73, v5
v_accvgpr_write_b32 a74, v6
v_accvgpr_write_b32 a75, v7
v_accvgpr_read_b32 v4, a76
v_accvgpr_read_b32 v5, a77
v_accvgpr_read_b32 v6, a78
v_accvgpr_read_b32 v7, a79
v_mul_f32 v4, v4, v27
v_mul_f32 v5, v5, v27
v_mul_f32 v6, v6, v27
v_mul_f32 v7, v7, v27
v_accvgpr_write_b32 a76, v4
v_accvgpr_write_b32 a77, v5
v_accvgpr_write_b32 a78, v6
v_accvgpr_write_b32 a79, v7
v_accvgpr_read_b32 v4, a80
v_accvgpr_read_b32 v5, a81
v_accvgpr_read_b32 v6, a82
v_accvgpr_read_b32 v7, a83
v_mul_f32 v4, v4, v26
v_mul_f32 v5, v5, v26
v_mul_f32 v6, v6, v26
v_mul_f32 v7, v7, v26
v_accvgpr_write_b32 a80, v4
v_accvgpr_write_b32 a81, v5
v_accvgpr_write_b32 a82, v6
v_accvgpr_write_b32 a83, v7
v_accvgpr_read_b32 v4, a84
v_accvgpr_read_b32 v5, a85
v_accvgpr_read_b32 v6, a86
v_accvgpr_read_b32 v7, a87
v_mul_f32 v4, v4, v27
v_mul_f32 v5, v5, v27
v_mul_f32 v6, v6, v27
v_mul_f32 v7, v7, v27
v_accvgpr_write_b32 a84, v4
v_accvgpr_write_b32 a85, v5
v_accvgpr_write_b32 a86, v6
v_accvgpr_write_b32 a87, v7
v_accvgpr_read_b32 v4, a88
v_accvgpr_read_b32 v5, a89
v_accvgpr_read_b32 v6, a90
v_accvgpr_read_b32 v7, a91
v_mul_f32 v4, v4, v26
v_mul_f32 v5, v5, v26
v_mul_f32 v6, v6, v26
v_mul_f32 v7, v7, v26
v_accvgpr_write_b32 a88, v4
v_accvgpr_write_b32 a89, v5
v_accvgpr_write_b32 a90, v6
v_accvgpr_write_b32 a91, v7
v_accvgpr_read_b32 v4, a92
v_accvgpr_read_b32 v5, a93
v_accvgpr_read_b32 v6, a94
v_accvgpr_read_b32 v7, a95
v_mul_f32 v4, v4, v27
v_mul_f32 v5, v5, v27
v_mul_f32 v6, v6, v27
v_mul_f32 v7, v7, v27
v_accvgpr_write_b32 a92, v4
v_accvgpr_write_b32 a93, v5
v_accvgpr_write_b32 a94, v6
v_accvgpr_write_b32 a95, v7
v_accvgpr_read_b32 v4, a96
v_accvgpr_read_b32 v5, a97
v_accvgpr_read_b32 v6, a98
v_accvgpr_read_b32 v7, a99
v_mul_f32 v4, v4, v26
v_mul_f32 v5, v5, v26
v_mul_f32 v6, v6, v26
v_mul_f32 v7, v7, v26
v_accvgpr_write_b32 a96, v4
v_accvgpr_write_b32 a97, v5
v_accvgpr_write_b32 a98, v6
v_accvgpr_write_b32 a99, v7
v_accvgpr_read_b32 v4, a100
v_accvgpr_read_b32 v5, a101
v_accvgpr_read_b32 v6, a102
v_accvgpr_read_b32 v7, a103
v_mul_f32 v4, v4, v27
v_mul_f32 v5, v5, v27
v_mul_f32 v6, v6, v27
v_mul_f32 v7, v7, v27
v_accvgpr_write_b32 a100, v4
v_accvgpr_write_b32 a101, v5
v_accvgpr_write_b32 a102, v6
v_accvgpr_write_b32 a103, v7
v_accvgpr_read_b32 v4, a104
v_accvgpr_read_b32 v5, a105
v_accvgpr_read_b32 v6, a106
v_accvgpr_read_b32 v7, a107
v_mul_f32 v4, v4, v26
v_mul_f32 v5, v5, v26
v_mul_f32 v6, v6, v26
v_mul_f32 v7, v7, v26
v_accvgpr_write_b32 a104, v4
v_accvgpr_write_b32 a105, v5
v_accvgpr_write_b32 a106, v6
v_accvgpr_write_b32 a107, v7
v_accvgpr_read_b32 v4, a108
v_accvgpr_read_b32 v5, a109
v_accvgpr_read_b32 v6, a110
v_accvgpr_read_b32 v7, a111
v_mul_f32 v4, v4, v27
v_mul_f32 v5, v5, v27
v_mul_f32 v6, v6, v27
v_mul_f32 v7, v7, v27
v_accvgpr_write_b32 a108, v4
v_accvgpr_write_b32 a109, v5
v_accvgpr_write_b32 a110, v6
v_accvgpr_write_b32 a111, v7
v_accvgpr_read_b32 v4, a112
v_accvgpr_read_b32 v5, a113
v_accvgpr_read_b32 v6, a114
v_accvgpr_read_b32 v7, a115
v_mul_f32 v4, v4, v26
v_mul_f32 v5, v5, v26
v_mul_f32 v6, v6, v26
v_mul_f32 v7, v7, v26
v_accvgpr_write_b32 a112, v4
v_accvgpr_write_b32 a113, v5
v_accvgpr_write_b32 a114, v6
v_accvgpr_write_b32 a115, v7
v_accvgpr_read_b32 v4, a116
v_accvgpr_read_b32 v5, a117
v_accvgpr_read_b32 v6, a118
v_accvgpr_read_b32 v7, a119
v_mul_f32 v4, v4, v27
v_mul_f32 v5, v5, v27
v_mul_f32 v6, v6, v27
v_mul_f32 v7, v7, v27
v_accvgpr_write_b32 a116, v4
v_accvgpr_write_b32 a117, v5
v_accvgpr_write_b32 a118, v6
v_accvgpr_write_b32 a119, v7
v_accvgpr_read_b32 v4, a120
v_accvgpr_read_b32 v5, a121
v_accvgpr_read_b32 v6, a122
v_accvgpr_read_b32 v7, a123
v_mul_f32 v4, v4, v26
v_mul_f32 v5, v5, v26
v_mul_f32 v6, v6, v26
v_mul_f32 v7, v7, v26
v_accvgpr_write_b32 a120, v4
v_accvgpr_write_b32 a121, v5
v_accvgpr_write_b32 a122, v6
v_accvgpr_write_b32 a123, v7
v_accvgpr_read_b32 v4, a124
v_accvgpr_read_b32 v5, a125
v_accvgpr_read_b32 v6, a126
v_accvgpr_read_b32 v7, a127
v_mul_f32 v4, v4, v27
v_mul_f32 v5, v5, v27
v_mul_f32 v6, v6, v27
v_mul_f32 v7, v7, v27
v_accvgpr_write_b32 a124, v4
v_accvgpr_write_b32 a125, v5
v_accvgpr_write_b32 a126, v6
v_accvgpr_write_b32 a127, v7
s_mov_b32 s23, 0
s_nop 1
s_branch mega_kernel_i0_end
mega_kernel_i1_r1:
s_nop 7
v_mov_b32 v2, v21
s_nop 1
v_permlane16_swap_b32 v2, v21
s_nop 1
v_max_f32 v21, v21, v2
v_mov_b32 v2, v21
s_nop 1
v_permlane32_swap_b32 v2, v21
s_nop 1
v_max_f32 v21, v21, v2
v_max_f32 v21, 0, v21
v_exp_f32 v26, -v21
v_sub_f32 v32, v32, v21
v_sub_f32 v33, v33, v21
v_sub_f32 v34, v34, v21
v_sub_f32 v35, v35, v21
v_sub_f32 v64, v64, v21
v_sub_f32 v65, v65, v21
v_sub_f32 v66, v66, v21
v_sub_f32 v67, v67, v21
v_sub_f32 v72, v72, v21
v_sub_f32 v73, v73, v21
v_sub_f32 v74, v74, v21
v_sub_f32 v75, v75, v21
v_sub_f32 v80, v80, v21
v_sub_f32 v81, v81, v21
v_sub_f32 v82, v82, v21
v_sub_f32 v83, v83, v21
v_sub_f32 v88, v88, v21
v_sub_f32 v89, v89, v21
v_sub_f32 v90, v90, v21
v_sub_f32 v91, v91, v21
v_mul_f32 v24, v24, v26
v_mov_b32 v2, v22
s_nop 1
v_permlane16_swap_b32 v2, v22
s_nop 1
v_max_f32 v22, v22, v2
v_mov_b32 v2, v22
s_nop 1
v_permlane32_swap_b32 v2, v22
s_nop 1
v_max_f32 v22, v22, v2
v_max_f32 v22, 0, v22
v_exp_f32 v27, -v22
v_sub_f32 v36, v36, v22
v_sub_f32 v37, v37, v22
v_sub_f32 v38, v38, v22
v_sub_f32 v39, v39, v22
v_sub_f32 v68, v68, v22
v_sub_f32 v69, v69, v22
v_sub_f32 v70, v70, v22
v_sub_f32 v71, v71, v22
v_sub_f32 v76, v76, v22
v_sub_f32 v77, v77, v22
v_sub_f32 v78, v78, v22
v_sub_f32 v79, v79, v22
v_sub_f32 v84, v84, v22
v_sub_f32 v85, v85, v22
v_sub_f32 v86, v86, v22
v_sub_f32 v87, v87, v22
v_sub_f32 v92, v92, v22
v_sub_f32 v93, v93, v22
v_sub_f32 v94, v94, v22
v_sub_f32 v95, v95, v22
v_mul_f32 v25, v25, v27
s_mov_b32 s23, 1
v_mfma_f32_16x16x32_bf16 a[24:27], a[220:223], v[152:155], a[24:27]
buffer_load_dwordx4 v49, s[4:7], s16 offen offset:1024 sc1 lds
v_mfma_f32_16x16x32_bf16 a[28:31], a[216:219], v[148:151], a[28:31]
v_exp_f32 v64, v64
v_mfma_f32_16x16x32_bf16 a[28:31], a[220:223], v[156:159], a[28:31]
ds_read_b128 a[196:199], v16 offset:57344
s_waitcnt lgkmcnt(6)
v_mfma_f32_16x16x32_bf16 a[32:35], a[224:227], v[144:147], a[32:35]
buffer_load_dwordx4 v50, s[4:7], s16 offen offset:2048 sc1 lds
v_mfma_f32_16x16x32_bf16 a[32:35], a[228:231], v[152:155], a[32:35]
v_exp_f32 v65, v65
v_mfma_f32_16x16x32_bf16 a[36:39], a[224:227], v[148:151], a[36:39]
ds_read_b128 a[200:203], v16 offset:41984
v_add_f32 v24, v64, v24
v_mfma_f32_16x16x32_bf16 a[36:39], a[228:231], v[156:159], a[36:39]
ds_read_b128 a[204:207], v16 offset:58368
v_add_f32 v24, v65, v24
v_mfma_f32_16x16x32_bf16 a[40:43], a[232:235], v[144:147], a[40:43]
v_exp_f32 v66, v66
v_mfma_f32_16x16x32_bf16 a[40:43], a[236:239], v[152:155], a[40:43]
ds_read_b128 a[208:211], v16 offset:43008
v_cvt_pk_bf16_f32 v128, v64, v65
v_mfma_f32_16x16x32_bf16 a[44:47], a[232:235], v[148:151], a[44:47]
buffer_load_dwordx4 v51, s[4:7], s16 offen offset:3072 sc1 lds
v_mfma_f32_16x16x32_bf16 a[44:47], a[236:239], v[156:159], a[44:47]
ds_read_b128 a[212:215], v16 offset:59392
s_waitcnt lgkmcnt(6)
v_mfma_f32_16x16x32_bf16 a[48:51], a[240:243], v[144:147], a[48:51]
v_exp_f32 v67, v67
v_mfma_f32_16x16x32_bf16 a[48:51], a[244:247], v[152:155], a[48:51]
s_add_u32 m0, s18, 102400
ds_read_b128 a[216:219], v16 offset:44032
v_mfma_f32_16x16x32_bf16 a[52:55], a[240:243], v[148:151], a[52:55]
ds_read_b128 a[220:223], v16 offset:60416
v_add_f32 v24, v66, v24
v_mfma_f32_16x16x32_bf16 a[52:55], a[244:247], v[156:159], a[52:55]
buffer_load_dwordx4 v52, s[4:7], s16 offen offset:0 sc1 lds
v_mfma_f32_16x16x32_bf16 a[56:59], a[248:251], v[144:147], a[56:59]
v_exp_f32 v72, v72
v_mfma_f32_16x16x32_bf16 a[56:59], a[252:255], v[152:155], a[56:59]
ds_read_b128 a[224:227], v16 offset:45056
v_add_f32 v24, v67, v24
v_mfma_f32_16x16x32_bf16 a[60:63], a[248:251], v[148:151], a[60:63]
ds_read_b128 a[228:231], v16 offset:61440
v_cvt_pk_bf16_f32 v129, v66, v67
v_mfma_f32_16x16x32_bf16 a[60:63], a[252:255], v[156:159], a[60:63]
ds_read_b128 a[232:235], v16 offset:46080
s_waitcnt lgkmcnt(7)
v_mfma_f32_16x16x32_bf16 a[64:67], a[192:195], v[144:147], a[64:67]
v_exp_f32 v73, v73
v_mfma_f32_16x16x32_bf16 a[64:67], a[196:199], v[152:155], a[64:67]
buffer_load_dwordx4 v53, s[4:7], s16 offen offset:1024 sc1 lds
v_mfma_f32_16x16x32_bf16 a[68:71], a[192:195], v[148:151], a[68:71]
ds_read_b128 a[236:239], v16 offset:62464
v_add_f32 v24, v72, v24
v_mfma_f32_16x16x32_bf16 a[68:71], a[196:199], v[156:159], a[68:71]
v_exp_f32 v74, v74
v_mfma_f32_16x16x32_bf16 a[72:75], a[200:203], v[144:147], a[72:75]
ds_read_b128 a[240:243], v16 offset:47104
v_add_f32 v24, v73, v24
v_mfma_f32_16x16x32_bf16 a[72:75], a[204:207], v[152:155], a[72:75]
ds_read_b128 a[244:247], v16 offset:63488
v_cvt_pk_bf16_f32 v130, v72, v73
v_mfma_f32_16x16x32_bf16 a[76:79], a[200:203], v[148:151], a[76:79]
v_exp_f32 v75, v75
v_mfma_f32_16x16x32_bf16 a[76:79], a[204:207], v[156:159], a[76:79]
ds_read_b128 a[248:251], v16 offset:48128
s_waitcnt lgkmcnt(7)
v_mfma_f32_16x16x32_bf16 a[80:83], a[208:211], v[144:147], a[80:83]
buffer_load_dwordx4 v54, s[4:7], s16 offen offset:2048 sc1 lds
v_mfma_f32_16x16x32_bf16 a[80:83], a[212:215], v[152:155], a[80:83]
v_exp_f32 v68, v68
v_mfma_f32_16x16x32_bf16 a[84:87], a[208:211], v[148:151], a[84:87]
ds_read_b128 a[252:255], v16 offset:64512
v_add_f32 v24, v74, v24
v_mfma_f32_16x16x32_bf16 a[84:87], a[212:215], v[156:159], a[84:87]
v_exp_f32 v69, v69
v_mfma_f32_16x16x32_bf16 a[88:91], a[216:219], v[144:147], a[88:91]
buffer_load_dwordx4 v55, s[4:7], s16 offen offset:3072 sc1 lds
v_mfma_f32_16x16x32_bf16 a[88:91], a[220:223], v[152:155], a[88:91]
v_add_f32 v24, v75, v24
v_cvt_pk_bf16_f32 v131, v74, v75
v_mfma_f32_16x16x32_bf16 a[92:95], a[216:219], v[148:151], a[92:95]
v_exp_f32 v70, v70
v_mfma_f32_16x16x32_bf16 a[92:95], a[220:223], v[156:159], a[92:95]
s_waitcnt vmcnt(16) lgkmcnt(0)
s_barrier
v_mfma_f32_16x16x32_bf16 a[96:99], a[224:227], v[144:147], a[96:99]
ds_read_b128 a[192:195], v17 offset:0
v_add_f32 v25, v68, v25
v_mfma_f32_16x16x32_bf16 a[96:99], a[228:231], v[152:155], a[96:99]
ds_read_b128 a[196:199], v17 offset:1024
v_add_f32 v25, v69, v25
v_mfma_f32_16x16x32_bf16 a[100:103], a[224:227], v[148:151], a[100:103]
v_exp_f32 v71, v71
v_mfma_f32_16x16x32_bf16 a[100:103], a[228:231], v[156:159], a[100:103]
ds_read_b128 a[200:203], v17 offset:2048
v_cvt_pk_bf16_f32 v132, v68, v69
v_mfma_f32_16x16x32_bf16 a[104:107], a[232:235], v[144:147], a[104:107]
s_add_u32 s16, s16, s26
v_add_f32 v25, v70, v25
v_mfma_f32_16x16x32_bf16 a[104:107], a[236:239], v[152:155], a[104:107]
s_add_u32 s19, s19, 1
ds_read_b128 a[204:207], v17 offset:3072
v_mfma_f32_16x16x32_bf16 a[108:111], a[232:235], v[148:151], a[108:111]
v_exp_f32 v76, v76
v_mfma_f32_16x16x32_bf16 a[108:111], a[236:239], v[156:159], a[108:111]
ds_read_b128 a[208:211], v17 offset:4096
v_add_f32 v25, v71, v25
v_mfma_f32_16x16x32_bf16 a[112:115], a[240:243], v[144:147], a[112:115]
v_exp_f32 v77, v77
v_mfma_f32_16x16x32_bf16 a[112:115], a[244:247], v[152:155], a[112:115]
ds_read_b128 a[212:215], v17 offset:5120
v_cvt_pk_bf16_f32 v133, v70, v71
v_mfma_f32_16x16x32_bf16 a[116:119], a[240:243], v[148:151], a[116:119]
v_add_f32 v25, v76, v25
v_cvt_pk_bf16_f32 v134, v76, v77
v_mfma_f32_16x16x32_bf16 a[116:119], a[244:247], v[156:159], a[116:119]
ds_read_b128 a[216:219], v17 offset:6144
v_add_f32 v25, v77, v25
v_mfma_f32_16x16x32_bf16 a[120:123], a[248:251], v[144:147], a[120:123]
ds_read_b128 a[220:223], v17 offset:7168
v_mfma_f32_16x16x32_bf16 a[120:123], a[252:255], v[152:155], a[120:123]
v_mfma_f32_16x16x32_bf16 a[124:127], a[248:251], v[148:151], a[124:127]
v_mfma_f32_16x16x32_bf16 a[124:127], a[252:255], v[156:159], a[124:127]
s_nop 7
v_accvgpr_read_b32 v4, a0
v_accvgpr_read_b32 v5, a1
v_accvgpr_read_b32 v6, a2
v_accvgpr_read_b32 v7, a3
v_mul_f32 v4, v4, v26
v_mul_f32 v5, v5, v26
v_mul_f32 v6, v6, v26
v_mul_f32 v7, v7, v26
v_accvgpr_write_b32 a0, v4
v_accvgpr_write_b32 a1, v5
v_accvgpr_write_b32 a2, v6
v_accvgpr_write_b32 a3, v7
v_accvgpr_read_b32 v4, a4
v_accvgpr_read_b32 v5, a5
v_accvgpr_read_b32 v6, a6
v_accvgpr_read_b32 v7, a7
v_mul_f32 v4, v4, v27
v_mul_f32 v5, v5, v27
v_mul_f32 v6, v6, v27
v_mul_f32 v7, v7, v27
v_accvgpr_write_b32 a4, v4
v_accvgpr_write_b32 a5, v5
v_accvgpr_write_b32 a6, v6
v_accvgpr_write_b32 a7, v7
v_accvgpr_read_b32 v4, a8
v_accvgpr_read_b32 v5, a9
v_accvgpr_read_b32 v6, a10
v_accvgpr_read_b32 v7, a11
v_mul_f32 v4, v4, v26
v_mul_f32 v5, v5, v26
v_mul_f32 v6, v6, v26
v_mul_f32 v7, v7, v26
v_accvgpr_write_b32 a8, v4
v_accvgpr_write_b32 a9, v5
v_accvgpr_write_b32 a10, v6
v_accvgpr_write_b32 a11, v7
v_accvgpr_read_b32 v4, a12
v_accvgpr_read_b32 v5, a13
v_accvgpr_read_b32 v6, a14
v_accvgpr_read_b32 v7, a15
v_mul_f32 v4, v4, v27
v_mul_f32 v5, v5, v27
v_mul_f32 v6, v6, v27
v_mul_f32 v7, v7, v27
v_accvgpr_write_b32 a12, v4
v_accvgpr_write_b32 a13, v5
v_accvgpr_write_b32 a14, v6
v_accvgpr_write_b32 a15, v7
v_accvgpr_read_b32 v4, a16
v_accvgpr_read_b32 v5, a17
v_accvgpr_read_b32 v6, a18
v_accvgpr_read_b32 v7, a19
v_mul_f32 v4, v4, v26
v_mul_f32 v5, v5, v26
v_mul_f32 v6, v6, v26
v_mul_f32 v7, v7, v26
v_accvgpr_write_b32 a16, v4
v_accvgpr_write_b32 a17, v5
v_accvgpr_write_b32 a18, v6
v_accvgpr_write_b32 a19, v7
v_accvgpr_read_b32 v4, a20
v_accvgpr_read_b32 v5, a21
v_accvgpr_read_b32 v6, a22
v_accvgpr_read_b32 v7, a23
v_mul_f32 v4, v4, v27
v_mul_f32 v5, v5, v27
v_mul_f32 v6, v6, v27
v_mul_f32 v7, v7, v27
v_accvgpr_write_b32 a20, v4
v_accvgpr_write_b32 a21, v5
v_accvgpr_write_b32 a22, v6
v_accvgpr_write_b32 a23, v7
v_accvgpr_read_b32 v4, a24
v_accvgpr_read_b32 v5, a25
v_accvgpr_read_b32 v6, a26
v_accvgpr_read_b32 v7, a27
v_mul_f32 v4, v4, v26
v_mul_f32 v5, v5, v26
v_mul_f32 v6, v6, v26
v_mul_f32 v7, v7, v26
v_accvgpr_write_b32 a24, v4
v_accvgpr_write_b32 a25, v5
v_accvgpr_write_b32 a26, v6
v_accvgpr_write_b32 a27, v7
v_accvgpr_read_b32 v4, a28
v_accvgpr_read_b32 v5, a29
v_accvgpr_read_b32 v6, a30
v_accvgpr_read_b32 v7, a31
v_mul_f32 v4, v4, v27
v_mul_f32 v5, v5, v27
v_mul_f32 v6, v6, v27
v_mul_f32 v7, v7, v27
v_accvgpr_write_b32 a28, v4
v_accvgpr_write_b32 a29, v5
v_accvgpr_write_b32 a30, v6
v_accvgpr_write_b32 a31, v7
v_accvgpr_read_b32 v4, a32
v_accvgpr_read_b32 v5, a33
v_accvgpr_read_b32 v6, a34
v_accvgpr_read_b32 v7, a35
v_mul_f32 v4, v4, v26
v_mul_f32 v5, v5, v26
v_mul_f32 v6, v6, v26
v_mul_f32 v7, v7, v26
v_accvgpr_write_b32 a32, v4
v_accvgpr_write_b32 a33, v5
v_accvgpr_write_b32 a34, v6
v_accvgpr_write_b32 a35, v7
v_accvgpr_read_b32 v4, a36
v_accvgpr_read_b32 v5, a37
v_accvgpr_read_b32 v6, a38
v_accvgpr_read_b32 v7, a39
v_mul_f32 v4, v4, v27
v_mul_f32 v5, v5, v27
v_mul_f32 v6, v6, v27
v_mul_f32 v7, v7, v27
v_accvgpr_write_b32 a36, v4
v_accvgpr_write_b32 a37, v5
v_accvgpr_write_b32 a38, v6
v_accvgpr_write_b32 a39, v7
v_accvgpr_read_b32 v4, a40
v_accvgpr_read_b32 v5, a41
v_accvgpr_read_b32 v6, a42
v_accvgpr_read_b32 v7, a43
v_mul_f32 v4, v4, v26
v_mul_f32 v5, v5, v26
v_mul_f32 v6, v6, v26
v_mul_f32 v7, v7, v26
v_accvgpr_write_b32 a40, v4
v_accvgpr_write_b32 a41, v5
v_accvgpr_write_b32 a42, v6
v_accvgpr_write_b32 a43, v7
v_accvgpr_read_b32 v4, a44
v_accvgpr_read_b32 v5, a45
v_accvgpr_read_b32 v6, a46
v_accvgpr_read_b32 v7, a47
v_mul_f32 v4, v4, v27
v_mul_f32 v5, v5, v27
v_mul_f32 v6, v6, v27
v_mul_f32 v7, v7, v27
v_accvgpr_write_b32 a44, v4
v_accvgpr_write_b32 a45, v5
v_accvgpr_write_b32 a46, v6
v_accvgpr_write_b32 a47, v7
v_accvgpr_read_b32 v4, a48
v_accvgpr_read_b32 v5, a49
v_accvgpr_read_b32 v6, a50
v_accvgpr_read_b32 v7, a51
v_mul_f32 v4, v4, v26
v_mul_f32 v5, v5, v26
v_mul_f32 v6, v6, v26
v_mul_f32 v7, v7, v26
v_accvgpr_write_b32 a48, v4
v_accvgpr_write_b32 a49, v5
v_accvgpr_write_b32 a50, v6
v_accvgpr_write_b32 a51, v7
v_accvgpr_read_b32 v4, a52
v_accvgpr_read_b32 v5, a53
v_accvgpr_read_b32 v6, a54
v_accvgpr_read_b32 v7, a55
v_mul_f32 v4, v4, v27
v_mul_f32 v5, v5, v27
v_mul_f32 v6, v6, v27
v_mul_f32 v7, v7, v27
v_accvgpr_write_b32 a52, v4
v_accvgpr_write_b32 a53, v5
v_accvgpr_write_b32 a54, v6
v_accvgpr_write_b32 a55, v7
v_accvgpr_read_b32 v4, a56
v_accvgpr_read_b32 v5, a57
v_accvgpr_read_b32 v6, a58
v_accvgpr_read_b32 v7, a59
v_mul_f32 v4, v4, v26
v_mul_f32 v5, v5, v26
v_mul_f32 v6, v6, v26
v_mul_f32 v7, v7, v26
v_accvgpr_write_b32 a56, v4
v_accvgpr_write_b32 a57, v5
v_accvgpr_write_b32 a58, v6
v_accvgpr_write_b32 a59, v7
v_accvgpr_read_b32 v4, a60
v_accvgpr_read_b32 v5, a61
v_accvgpr_read_b32 v6, a62
v_accvgpr_read_b32 v7, a63
v_mul_f32 v4, v4, v27
v_mul_f32 v5, v5, v27
v_mul_f32 v6, v6, v27
v_mul_f32 v7, v7, v27
v_accvgpr_write_b32 a60, v4
v_accvgpr_write_b32 a61, v5
v_accvgpr_write_b32 a62, v6
v_accvgpr_write_b32 a63, v7
v_accvgpr_read_b32 v4, a64
v_accvgpr_read_b32 v5, a65
v_accvgpr_read_b32 v6, a66
v_accvgpr_read_b32 v7, a67
v_mul_f32 v4, v4, v26
v_mul_f32 v5, v5, v26
v_mul_f32 v6, v6, v26
v_mul_f32 v7, v7, v26
v_accvgpr_write_b32 a64, v4
v_accvgpr_write_b32 a65, v5
v_accvgpr_write_b32 a66, v6
v_accvgpr_write_b32 a67, v7
v_accvgpr_read_b32 v4, a68
v_accvgpr_read_b32 v5, a69
v_accvgpr_read_b32 v6, a70
v_accvgpr_read_b32 v7, a71
v_mul_f32 v4, v4, v27
v_mul_f32 v5, v5, v27
v_mul_f32 v6, v6, v27
v_mul_f32 v7, v7, v27
v_accvgpr_write_b32 a68, v4
v_accvgpr_write_b32 a69, v5
v_accvgpr_write_b32 a70, v6
v_accvgpr_write_b32 a71, v7
v_accvgpr_read_b32 v4, a72
v_accvgpr_read_b32 v5, a73
v_accvgpr_read_b32 v6, a74
v_accvgpr_read_b32 v7, a75
v_mul_f32 v4, v4, v26
v_mul_f32 v5, v5, v26
v_mul_f32 v6, v6, v26
v_mul_f32 v7, v7, v26
v_accvgpr_write_b32 a72, v4
v_accvgpr_write_b32 a73, v5
v_accvgpr_write_b32 a74, v6
v_accvgpr_write_b32 a75, v7
v_accvgpr_read_b32 v4, a76
v_accvgpr_read_b32 v5, a77
v_accvgpr_read_b32 v6, a78
v_accvgpr_read_b32 v7, a79
v_mul_f32 v4, v4, v27
v_mul_f32 v5, v5, v27
v_mul_f32 v6, v6, v27
v_mul_f32 v7, v7, v27
v_accvgpr_write_b32 a76, v4
v_accvgpr_write_b32 a77, v5
v_accvgpr_write_b32 a78, v6
v_accvgpr_write_b32 a79, v7
v_accvgpr_read_b32 v4, a80
v_accvgpr_read_b32 v5, a81
v_accvgpr_read_b32 v6, a82
v_accvgpr_read_b32 v7, a83
v_mul_f32 v4, v4, v26
v_mul_f32 v5, v5, v26
v_mul_f32 v6, v6, v26
v_mul_f32 v7, v7, v26
v_accvgpr_write_b32 a80, v4
v_accvgpr_write_b32 a81, v5
v_accvgpr_write_b32 a82, v6
v_accvgpr_write_b32 a83, v7
v_accvgpr_read_b32 v4, a84
v_accvgpr_read_b32 v5, a85
v_accvgpr_read_b32 v6, a86
v_accvgpr_read_b32 v7, a87
v_mul_f32 v4, v4, v27
v_mul_f32 v5, v5, v27
v_mul_f32 v6, v6, v27
v_mul_f32 v7, v7, v27
v_accvgpr_write_b32 a84, v4
v_accvgpr_write_b32 a85, v5
v_accvgpr_write_b32 a86, v6
v_accvgpr_write_b32 a87, v7
v_accvgpr_read_b32 v4, a88
v_accvgpr_read_b32 v5, a89
v_accvgpr_read_b32 v6, a90
v_accvgpr_read_b32 v7, a91
v_mul_f32 v4, v4, v26
v_mul_f32 v5, v5, v26
v_mul_f32 v6, v6, v26
v_mul_f32 v7, v7, v26
v_accvgpr_write_b32 a88, v4
v_accvgpr_write_b32 a89, v5
v_accvgpr_write_b32 a90, v6
v_accvgpr_write_b32 a91, v7
v_accvgpr_read_b32 v4, a92
v_accvgpr_read_b32 v5, a93
v_accvgpr_read_b32 v6, a94
v_accvgpr_read_b32 v7, a95
v_mul_f32 v4, v4, v27
v_mul_f32 v5, v5, v27
v_mul_f32 v6, v6, v27
v_mul_f32 v7, v7, v27
v_accvgpr_write_b32 a92, v4
v_accvgpr_write_b32 a93, v5
v_accvgpr_write_b32 a94, v6
v_accvgpr_write_b32 a95, v7
v_accvgpr_read_b32 v4, a96
v_accvgpr_read_b32 v5, a97
v_accvgpr_read_b32 v6, a98
v_accvgpr_read_b32 v7, a99
v_mul_f32 v4, v4, v26
v_mul_f32 v5, v5, v26
v_mul_f32 v6, v6, v26
v_mul_f32 v7, v7, v26
v_accvgpr_write_b32 a96, v4
v_accvgpr_write_b32 a97, v5
v_accvgpr_write_b32 a98, v6
v_accvgpr_write_b32 a99, v7
v_accvgpr_read_b32 v4, a100
v_accvgpr_read_b32 v5, a101
v_accvgpr_read_b32 v6, a102
v_accvgpr_read_b32 v7, a103
v_mul_f32 v4, v4, v27
v_mul_f32 v5, v5, v27
v_mul_f32 v6, v6, v27
v_mul_f32 v7, v7, v27
v_accvgpr_write_b32 a100, v4
v_accvgpr_write_b32 a101, v5
v_accvgpr_write_b32 a102, v6
v_accvgpr_write_b32 a103, v7
v_accvgpr_read_b32 v4, a104
v_accvgpr_read_b32 v5, a105
v_accvgpr_read_b32 v6, a106
v_accvgpr_read_b32 v7, a107
v_mul_f32 v4, v4, v26
v_mul_f32 v5, v5, v26
v_mul_f32 v6, v6, v26
v_mul_f32 v7, v7, v26
v_accvgpr_write_b32 a104, v4
v_accvgpr_write_b32 a105, v5
v_accvgpr_write_b32 a106, v6
v_accvgpr_write_b32 a107, v7
v_accvgpr_read_b32 v4, a108
v_accvgpr_read_b32 v5, a109
v_accvgpr_read_b32 v6, a110
v_accvgpr_read_b32 v7, a111
v_mul_f32 v4, v4, v27
v_mul_f32 v5, v5, v27
v_mul_f32 v6, v6, v27
v_mul_f32 v7, v7, v27
v_accvgpr_write_b32 a108, v4
v_accvgpr_write_b32 a109, v5
v_accvgpr_write_b32 a110, v6
v_accvgpr_write_b32 a111, v7
v_accvgpr_read_b32 v4, a112
v_accvgpr_read_b32 v5, a113
v_accvgpr_read_b32 v6, a114
v_accvgpr_read_b32 v7, a115
v_mul_f32 v4, v4, v26
v_mul_f32 v5, v5, v26
v_mul_f32 v6, v6, v26
v_mul_f32 v7, v7, v26
v_accvgpr_write_b32 a112, v4
v_accvgpr_write_b32 a113, v5
v_accvgpr_write_b32 a114, v6
v_accvgpr_write_b32 a115, v7
v_accvgpr_read_b32 v4, a116
v_accvgpr_read_b32 v5, a117
v_accvgpr_read_b32 v6, a118
v_accvgpr_read_b32 v7, a119
v_mul_f32 v4, v4, v27
v_mul_f32 v5, v5, v27
v_mul_f32 v6, v6, v27
v_mul_f32 v7, v7, v27
v_accvgpr_write_b32 a116, v4
v_accvgpr_write_b32 a117, v5
v_accvgpr_write_b32 a118, v6
v_accvgpr_write_b32 a119, v7
v_accvgpr_read_b32 v4, a120
v_accvgpr_read_b32 v5, a121
v_accvgpr_read_b32 v6, a122
v_accvgpr_read_b32 v7, a123
v_mul_f32 v4, v4, v26
v_mul_f32 v5, v5, v26
v_mul_f32 v6, v6, v26
v_mul_f32 v7, v7, v26
v_accvgpr_write_b32 a120, v4
v_accvgpr_write_b32 a121, v5
v_accvgpr_write_b32 a122, v6
v_accvgpr_write_b32 a123, v7
v_accvgpr_read_b32 v4, a124
v_accvgpr_read_b32 v5, a125
v_accvgpr_read_b32 v6, a126
v_accvgpr_read_b32 v7, a127
v_mul_f32 v4, v4, v27
v_mul_f32 v5, v5, v27
v_mul_f32 v6, v6, v27
v_mul_f32 v7, v7, v27
v_accvgpr_write_b32 a124, v4
v_accvgpr_write_b32 a125, v5
v_accvgpr_write_b32 a126, v6
v_accvgpr_write_b32 a127, v7
s_mov_b32 s23, 0
s_nop 1
s_branch mega_kernel_i1_end
mega_kernel_m1_r1:
s_nop 7
v_mov_b32 v2, v21
s_nop 1
v_permlane16_swap_b32 v2, v21
s_nop 1
v_max_f32 v21, v21, v2
v_mov_b32 v2, v21
s_nop 1
v_permlane32_swap_b32 v2, v21
s_nop 1
v_max_f32 v21, v21, v2
v_max_f32 v21, 0, v21
v_exp_f32 v26, -v21
v_sub_f32 v32, v32, v21
v_sub_f32 v33, v33, v21
v_sub_f32 v34, v34, v21
v_sub_f32 v35, v35, v21
v_sub_f32 v64, v64, v21
v_sub_f32 v65, v65, v21
v_sub_f32 v66, v66, v21
v_sub_f32 v67, v67, v21
v_sub_f32 v72, v72, v21
v_sub_f32 v73, v73, v21
v_sub_f32 v74, v74, v21
v_sub_f32 v75, v75, v21
v_sub_f32 v80, v80, v21
v_sub_f32 v81, v81, v21
v_sub_f32 v82, v82, v21
v_sub_f32 v83, v83, v21
v_sub_f32 v88, v88, v21
v_sub_f32 v89, v89, v21
v_sub_f32 v90, v90, v21
v_sub_f32 v91, v91, v21
v_mul_f32 v24, v24, v26
v_mov_b32 v2, v22
s_nop 1
v_permlane16_swap_b32 v2, v22
s_nop 1
v_max_f32 v22, v22, v2
v_mov_b32 v2, v22
s_nop 1
v_permlane32_swap_b32 v2, v22
s_nop 1
v_max_f32 v22, v22, v2
v_max_f32 v22, 0, v22
v_exp_f32 v27, -v22
v_sub_f32 v36, v36, v22
v_sub_f32 v37, v37, v22
v_sub_f32 v38, v38, v22
v_sub_f32 v39, v39, v22
v_sub_f32 v68, v68, v22
v_sub_f32 v69, v69, v22
v_sub_f32 v70, v70, v22
v_sub_f32 v71, v71, v22
v_sub_f32 v76, v76, v22
v_sub_f32 v77, v77, v22
v_sub_f32 v78, v78, v22
v_sub_f32 v79, v79, v22
v_sub_f32 v84, v84, v22
v_sub_f32 v85, v85, v22
v_sub_f32 v86, v86, v22
v_sub_f32 v87, v87, v22
v_sub_f32 v92, v92, v22
v_sub_f32 v93, v93, v22
v_sub_f32 v94, v94, v22
v_sub_f32 v95, v95, v22
v_mul_f32 v25, v25, v27
s_mov_b32 s23, 1
v_mfma_f32_16x16x32_bf16 a[28:31], a[220:223], v[156:159], a[28:31]
ds_read_b128 a[252:255], v16 offset:56320
s_waitcnt lgkmcnt(4)
v_mfma_f32_16x16x32_bf16 a[32:35], a[224:227], v[144:147], a[32:35]
buffer_load_dwordx4 v49, s[4:7], s16 offen offset:1024 sc1 lds
v_mfma_f32_16x16x32_bf16 a[32:35], a[228:231], v[152:155], a[32:35]
ds_read_b128 a[192:195], v16 offset:40960
v_mfma_f32_16x16x32_bf16 a[36:39], a[224:227], v[148:151], a[36:39]
v_exp_f32 v64, v64
v_mfma_f32_16x16x32_bf16 a[36:39], a[228:231], v[156:159], a[36:39]
buffer_load_dwordx4 v50, s[4:7], s16 offen offset:2048 sc1 lds
v_mfma_f32_16x16x32_bf16 a[40:43], a[232:235], v[144:147], a[40:43]
ds_read_b128 a[196:199], v16 offset:57344
v_add_f32 v24, v64, v24
v_mfma_f32_16x16x32_bf16 a[40:43], a[236:239], v[152:155], a[40:43]
v_exp_f32 v65, v65
v_mfma_f32_16x16x32_bf16 a[44:47], a[232:235], v[148:151], a[44:47]
ds_read_b128 a[200:203], v16 offset:41984
v_add_f32 v24, v65, v24
v_mfma_f32_16x16x32_bf16 a[44:47], a[236:239], v[156:159], a[44:47]
ds_read_b128 a[204:207], v16 offset:58368
s_waitcnt lgkmcnt(4)
v_mfma_f32_16x16x32_bf16 a[48:51], a[240:243], v[144:147], a[48:51]
v_exp_f32 v66, v66
v_mfma_f32_16x16x32_bf16 a[48:51], a[244:247], v[152:155], a[48:51]
ds_read_b128 a[208:211], v16 offset:43008
v_cvt_pk_bf16_f32 v128, v64, v65
v_mfma_f32_16x16x32_bf16 a[52:55], a[240:243], v[148:151], a[52:55]
buffer_load_dwordx4 v51, s[4:7], s16 offen offset:3072 sc1 lds
v_mfma_f32_16x16x32_bf16 a[52:55], a[244:247], v[156:159], a[52:55]
s_add_u32 m0, s18, 102400
ds_read_b128 a[212:215], v16 offset:59392
v_mfma_f32_16x16x32_bf16 a[56:59], a[248:251], v[144:147], a[56:59]
v_exp_f32 v67, v67
v_mfma_f32_16x16x32_bf16 a[56:59], a[252:255], v[152:155], a[56:59]
ds_read_b128 a[216:219], v16 offset:44032
v_add_f32 v24, v66, v24
v_mfma_f32_16x16x32_bf16 a[60:63], a[248:251], v[148:151], a[60:63]
ds_read_b128 a[220:223], v16 offset:60416
v_add_f32 v24, v67, v24
v_mfma_f32_16x16x32_bf16 a[60:63], a[252:255], v[156:159], a[60:63]
ds_read_b128 a[224:227], v16 offset:45056
s_waitcnt lgkmcnt(5)
v_mfma_f32_16x16x32_bf16 a[64:67], a[192:195], v[144:147], a[64:67]
buffer_load_dwordx4 v52, s[4:7], s16 offen offset:0 sc1 lds
v_mfma_f32_16x16x32_bf16 a[64:67], a[196:199], v[152:155], a[64:67]
v_exp_f32 v72, v72
v_mfma_f32_16x16x32_bf16 a[68:71], a[192:195], v[148:151], a[68:71]
ds_read_b128 a[228:231], v16 offset:61440
v_cvt_pk_bf16_f32 v129, v66, v67
v_mfma_f32_16x16x32_bf16 a[68:71], a[196:199], v[156:159], a[68:71]
v_exp_f32 v73, v73
v_mfma_f32_16x16x32_bf16 a[72:75], a[200:203], v[144:147], a[72:75]
ds_read_b128 a[232:235], v16 offset:46080
v_add_f32 v24, v72, v24
v_mfma_f32_16x16x32_bf16 a[72:75], a[204:207], v[152:155], a[72:75]
buffer_load_dwordx4 v53, s[4:7], s16 offen offset:1024 sc1 lds
v_mfma_f32_16x16x32_bf16 a[76:79], a[200:203], v[148:151], a[76:79]
ds_read_b128 a[236:239], v16 offset:62464
v_add_f32 v24, v73, v24
v_mfma_f32_16x16x32_bf16 a[76:79], a[204:207], v[156:159], a[76:79]
ds_read_b128 a[240:243], v16 offset:47104
s_waitcnt lgkmcnt(5)
v_mfma_f32_16x16x32_bf16 a[80:83], a[208:211], v[144:147], a[80:83]
v_exp_f32 v74, v74
v_mfma_f32_16x16x32_bf16 a[80:83], a[212:215], v[152:155], a[80:83]
ds_read_b128 a[244:247], v16 offset:63488
v_cvt_pk_bf16_f32 v130, v72, v73
v_mfma_f32_16x16x32_bf16 a[84:87], a[208:211], v[148:151], a[84:87]
ds_read_b128 a[248:251], v16 offset:48128
v_add_f32 v24, v74, v24
v_mfma_f32_16x16x32_bf16 a[84:87], a[212:215], v[156:159], a[84:87]
s_add_u32 s19, s19, 1
ds_read_b128 a[252:255], v16 offset:64512
v_mfma_f32_16x16x32_bf16 a[88:91], a[216:219], v[144:147], a[88:91]
v_exp_f32 v75, v75
v_mfma_f32_16x16x32_bf16 a[88:91], a[220:223], v[152:155], a[88:91]
buffer_load_dwordx4 v54, s[4:7], s16 offen offset:2048 sc1 lds
v_mfma_f32_16x16x32_bf16 a[92:95], a[216:219], v[148:151], a[92:95]
buffer_load_dwordx4 v55, s[4:7], s16 offen offset:3072 sc1 lds
v_mfma_f32_16x16x32_bf16 a[92:95], a[220:223], v[156:159], a[92:95]
s_waitcnt vmcnt(16) lgkmcnt(0)
s_barrier
v_mfma_f32_16x16x32_bf16 a[96:99], a[224:227], v[144:147], a[96:99]
v_exp_f32 v68, v68
v_mfma_f32_16x16x32_bf16 a[96:99], a[228:231], v[152:155], a[96:99]
v_exp_f32 v69, v69
v_mfma_f32_16x16x32_bf16 a[100:103], a[224:227], v[148:151], a[100:103]
v_exp_f32 v70, v70
v_mfma_f32_16x16x32_bf16 a[100:103], a[228:231], v[156:159], a[100:103]
ds_read_b128 a[192:195], v17 offset:0
v_add_f32 v24, v75, v24
v_mfma_f32_16x16x32_bf16 a[104:107], a[232:235], v[144:147], a[104:107]
ds_read_b128 a[196:199], v17 offset:1024
v_cvt_pk_bf16_f32 v131, v74, v75
v_mfma_f32_16x16x32_bf16 a[104:107], a[236:239], v[152:155], a[104:107]
v_exp_f32 v71, v71
v_mfma_f32_16x16x32_bf16 a[108:111], a[232:235], v[148:151], a[108:111]
ds_read_b128 a[200:203], v17 offset:2048
v_add_f32 v25, v68, v25
v_mfma_f32_16x16x32_bf16 a[108:111], a[236:239], v[156:159], a[108:111]
ds_read_b128 a[204:207], v17 offset:3072
v_add_f32 v25, v69, v25
v_mfma_f32_16x16x32_bf16 a[112:115], a[240:243], v[144:147], a[112:115]
v_exp_f32 v76, v76
v_mfma_f32_16x16x32_bf16 a[112:115], a[244:247], v[152:155], a[112:115]
ds_read_b128 a[208:211], v17 offset:4096
v_cvt_pk_bf16_f32 v132, v68, v69
v_mfma_f32_16x16x32_bf16 a[116:119], a[240:243], v[148:151], a[116:119]
v_exp_f32 v77, v77
v_mfma_f32_16x16x32_bf16 a[116:119], a[244:247], v[156:159], a[116:119]
s_add_u32 s16, s16, s26
ds_read_b128 a[212:215], v17 offset:5120
v_mfma_f32_16x16x32_bf16 a[120:123], a[248:251], v[144:147], a[120:123]
ds_read_b128 a[216:219], v17 offset:6144
v_add_f32 v25, v70, v25
v_mfma_f32_16x16x32_bf16 a[120:123], a[252:255], v[152:155], a[120:123]
ds_read_b128 a[220:223], v17 offset:7168
v_add_f32 v25, v71, v25
v_mfma_f32_16x16x32_bf16 a[124:127], a[248:251], v[148:151], a[124:127]
v_cvt_pk_bf16_f32 v133, v70, v71
v_add_f32 v25, v76, v25
v_mfma_f32_16x16x32_bf16 a[124:127], a[252:255], v[156:159], a[124:127]
v_add_f32 v25, v77, v25
v_cvt_pk_bf16_f32 v134, v76, v77
s_nop 7
v_accvgpr_read_b32 v4, a0
v_accvgpr_read_b32 v5, a1
v_accvgpr_read_b32 v6, a2
v_accvgpr_read_b32 v7, a3
v_mul_f32 v4, v4, v26
v_mul_f32 v5, v5, v26
v_mul_f32 v6, v6, v26
v_mul_f32 v7, v7, v26
v_accvgpr_write_b32 a0, v4
v_accvgpr_write_b32 a1, v5
v_accvgpr_write_b32 a2, v6
v_accvgpr_write_b32 a3, v7
v_accvgpr_read_b32 v4, a4
v_accvgpr_read_b32 v5, a5
v_accvgpr_read_b32 v6, a6
v_accvgpr_read_b32 v7, a7
v_mul_f32 v4, v4, v27
v_mul_f32 v5, v5, v27
v_mul_f32 v6, v6, v27
v_mul_f32 v7, v7, v27
v_accvgpr_write_b32 a4, v4
v_accvgpr_write_b32 a5, v5
v_accvgpr_write_b32 a6, v6
v_accvgpr_write_b32 a7, v7
v_accvgpr_read_b32 v4, a8
v_accvgpr_read_b32 v5, a9
v_accvgpr_read_b32 v6, a10
v_accvgpr_read_b32 v7, a11
v_mul_f32 v4, v4, v26
v_mul_f32 v5, v5, v26
v_mul_f32 v6, v6, v26
v_mul_f32 v7, v7, v26
v_accvgpr_write_b32 a8, v4
v_accvgpr_write_b32 a9, v5
v_accvgpr_write_b32 a10, v6
v_accvgpr_write_b32 a11, v7
v_accvgpr_read_b32 v4, a12
v_accvgpr_read_b32 v5, a13
v_accvgpr_read_b32 v6, a14
v_accvgpr_read_b32 v7, a15
v_mul_f32 v4, v4, v27
v_mul_f32 v5, v5, v27
v_mul_f32 v6, v6, v27
v_mul_f32 v7, v7, v27
v_accvgpr_write_b32 a12, v4
v_accvgpr_write_b32 a13, v5
v_accvgpr_write_b32 a14, v6
v_accvgpr_write_b32 a15, v7
v_accvgpr_read_b32 v4, a16
v_accvgpr_read_b32 v5, a17
v_accvgpr_read_b32 v6, a18
v_accvgpr_read_b32 v7, a19
v_mul_f32 v4, v4, v26
v_mul_f32 v5, v5, v26
v_mul_f32 v6, v6, v26
v_mul_f32 v7, v7, v26
v_accvgpr_write_b32 a16, v4
v_accvgpr_write_b32 a17, v5
v_accvgpr_write_b32 a18, v6
v_accvgpr_write_b32 a19, v7
v_accvgpr_read_b32 v4, a20
v_accvgpr_read_b32 v5, a21
v_accvgpr_read_b32 v6, a22
v_accvgpr_read_b32 v7, a23
v_mul_f32 v4, v4, v27
v_mul_f32 v5, v5, v27
v_mul_f32 v6, v6, v27
v_mul_f32 v7, v7, v27
v_accvgpr_write_b32 a20, v4
v_accvgpr_write_b32 a21, v5
v_accvgpr_write_b32 a22, v6
v_accvgpr_write_b32 a23, v7
v_accvgpr_read_b32 v4, a24
v_accvgpr_read_b32 v5, a25
v_accvgpr_read_b32 v6, a26
v_accvgpr_read_b32 v7, a27
v_mul_f32 v4, v4, v26
v_mul_f32 v5, v5, v26
v_mul_f32 v6, v6, v26
v_mul_f32 v7, v7, v26
v_accvgpr_write_b32 a24, v4
v_accvgpr_write_b32 a25, v5
v_accvgpr_write_b32 a26, v6
v_accvgpr_write_b32 a27, v7
v_accvgpr_read_b32 v4, a28
v_accvgpr_read_b32 v5, a29
v_accvgpr_read_b32 v6, a30
v_accvgpr_read_b32 v7, a31
v_mul_f32 v4, v4, v27
v_mul_f32 v5, v5, v27
v_mul_f32 v6, v6, v27
v_mul_f32 v7, v7, v27
v_accvgpr_write_b32 a28, v4
v_accvgpr_write_b32 a29, v5
v_accvgpr_write_b32 a30, v6
v_accvgpr_write_b32 a31, v7
v_accvgpr_read_b32 v4, a32
v_accvgpr_read_b32 v5, a33
v_accvgpr_read_b32 v6, a34
v_accvgpr_read_b32 v7, a35
v_mul_f32 v4, v4, v26
v_mul_f32 v5, v5, v26
v_mul_f32 v6, v6, v26
v_mul_f32 v7, v7, v26
v_accvgpr_write_b32 a32, v4
v_accvgpr_write_b32 a33, v5
v_accvgpr_write_b32 a34, v6
v_accvgpr_write_b32 a35, v7
v_accvgpr_read_b32 v4, a36
v_accvgpr_read_b32 v5, a37
v_accvgpr_read_b32 v6, a38
v_accvgpr_read_b32 v7, a39
v_mul_f32 v4, v4, v27
v_mul_f32 v5, v5, v27
v_mul_f32 v6, v6, v27
v_mul_f32 v7, v7, v27
v_accvgpr_write_b32 a36, v4
v_accvgpr_write_b32 a37, v5
v_accvgpr_write_b32 a38, v6
v_accvgpr_write_b32 a39, v7
v_accvgpr_read_b32 v4, a40
v_accvgpr_read_b32 v5, a41
v_accvgpr_read_b32 v6, a42
v_accvgpr_read_b32 v7, a43
v_mul_f32 v4, v4, v26
v_mul_f32 v5, v5, v26
v_mul_f32 v6, v6, v26
v_mul_f32 v7, v7, v26
v_accvgpr_write_b32 a40, v4
v_accvgpr_write_b32 a41, v5
v_accvgpr_write_b32 a42, v6
v_accvgpr_write_b32 a43, v7
v_accvgpr_read_b32 v4, a44
v_accvgpr_read_b32 v5, a45
v_accvgpr_read_b32 v6, a46
v_accvgpr_read_b32 v7, a47
v_mul_f32 v4, v4, v27
v_mul_f32 v5, v5, v27
v_mul_f32 v6, v6, v27
v_mul_f32 v7, v7, v27
v_accvgpr_write_b32 a44, v4
v_accvgpr_write_b32 a45, v5
v_accvgpr_write_b32 a46, v6
v_accvgpr_write_b32 a47, v7
v_accvgpr_read_b32 v4, a48
v_accvgpr_read_b32 v5, a49
v_accvgpr_read_b32 v6, a50
v_accvgpr_read_b32 v7, a51
v_mul_f32 v4, v4, v26
v_mul_f32 v5, v5, v26
v_mul_f32 v6, v6, v26
v_mul_f32 v7, v7, v26
v_accvgpr_write_b32 a48, v4
v_accvgpr_write_b32 a49, v5
v_accvgpr_write_b32 a50, v6
v_accvgpr_write_b32 a51, v7
v_accvgpr_read_b32 v4, a52
v_accvgpr_read_b32 v5, a53
v_accvgpr_read_b32 v6, a54
v_accvgpr_read_b32 v7, a55
v_mul_f32 v4, v4, v27
v_mul_f32 v5, v5, v27
v_mul_f32 v6, v6, v27
v_mul_f32 v7, v7, v27
v_accvgpr_write_b32 a52, v4
v_accvgpr_write_b32 a53, v5
v_accvgpr_write_b32 a54, v6
v_accvgpr_write_b32 a55, v7
v_accvgpr_read_b32 v4, a56
v_accvgpr_read_b32 v5, a57
v_accvgpr_read_b32 v6, a58
v_accvgpr_read_b32 v7, a59
v_mul_f32 v4, v4, v26
v_mul_f32 v5, v5, v26
v_mul_f32 v6, v6, v26
v_mul_f32 v7, v7, v26
v_accvgpr_write_b32 a56, v4
v_accvgpr_write_b32 a57, v5
v_accvgpr_write_b32 a58, v6
v_accvgpr_write_b32 a59, v7
v_accvgpr_read_b32 v4, a60
v_accvgpr_read_b32 v5, a61
v_accvgpr_read_b32 v6, a62
v_accvgpr_read_b32 v7, a63
v_mul_f32 v4, v4, v27
v_mul_f32 v5, v5, v27
v_mul_f32 v6, v6, v27
v_mul_f32 v7, v7, v27
v_accvgpr_write_b32 a60, v4
v_accvgpr_write_b32 a61, v5
v_accvgpr_write_b32 a62, v6
v_accvgpr_write_b32 a63, v7
v_accvgpr_read_b32 v4, a64
v_accvgpr_read_b32 v5, a65
v_accvgpr_read_b32 v6, a66
v_accvgpr_read_b32 v7, a67
v_mul_f32 v4, v4, v26
v_mul_f32 v5, v5, v26
v_mul_f32 v6, v6, v26
v_mul_f32 v7, v7, v26
v_accvgpr_write_b32 a64, v4
v_accvgpr_write_b32 a65, v5
v_accvgpr_write_b32 a66, v6
v_accvgpr_write_b32 a67, v7
v_accvgpr_read_b32 v4, a68
v_accvgpr_read_b32 v5, a69
v_accvgpr_read_b32 v6, a70
v_accvgpr_read_b32 v7, a71
v_mul_f32 v4, v4, v27
v_mul_f32 v5, v5, v27
v_mul_f32 v6, v6, v27
v_mul_f32 v7, v7, v27
v_accvgpr_write_b32 a68, v4
v_accvgpr_write_b32 a69, v5
v_accvgpr_write_b32 a70, v6
v_accvgpr_write_b32 a71, v7
v_accvgpr_read_b32 v4, a72
v_accvgpr_read_b32 v5, a73
v_accvgpr_read_b32 v6, a74
v_accvgpr_read_b32 v7, a75
v_mul_f32 v4, v4, v26
v_mul_f32 v5, v5, v26
v_mul_f32 v6, v6, v26
v_mul_f32 v7, v7, v26
v_accvgpr_write_b32 a72, v4
v_accvgpr_write_b32 a73, v5
v_accvgpr_write_b32 a74, v6
v_accvgpr_write_b32 a75, v7
v_accvgpr_read_b32 v4, a76
v_accvgpr_read_b32 v5, a77
v_accvgpr_read_b32 v6, a78
v_accvgpr_read_b32 v7, a79
v_mul_f32 v4, v4, v27
v_mul_f32 v5, v5, v27
v_mul_f32 v6, v6, v27
v_mul_f32 v7, v7, v27
v_accvgpr_write_b32 a76, v4
v_accvgpr_write_b32 a77, v5
v_accvgpr_write_b32 a78, v6
v_accvgpr_write_b32 a79, v7
v_accvgpr_read_b32 v4, a80
v_accvgpr_read_b32 v5, a81
v_accvgpr_read_b32 v6, a82
v_accvgpr_read_b32 v7, a83
v_mul_f32 v4, v4, v26
v_mul_f32 v5, v5, v26
v_mul_f32 v6, v6, v26
v_mul_f32 v7, v7, v26
v_accvgpr_write_b32 a80, v4
v_accvgpr_write_b32 a81, v5
v_accvgpr_write_b32 a82, v6
v_accvgpr_write_b32 a83, v7
v_accvgpr_read_b32 v4, a84
v_accvgpr_read_b32 v5, a85
v_accvgpr_read_b32 v6, a86
v_accvgpr_read_b32 v7, a87
v_mul_f32 v4, v4, v27
v_mul_f32 v5, v5, v27
v_mul_f32 v6, v6, v27
v_mul_f32 v7, v7, v27
v_accvgpr_write_b32 a84, v4
v_accvgpr_write_b32 a85, v5
v_accvgpr_write_b32 a86, v6
v_accvgpr_write_b32 a87, v7
v_accvgpr_read_b32 v4, a88
v_accvgpr_read_b32 v5, a89
v_accvgpr_read_b32 v6, a90
v_accvgpr_read_b32 v7, a91
v_mul_f32 v4, v4, v26
v_mul_f32 v5, v5, v26
v_mul_f32 v6, v6, v26
v_mul_f32 v7, v7, v26
v_accvgpr_write_b32 a88, v4
v_accvgpr_write_b32 a89, v5
v_accvgpr_write_b32 a90, v6
v_accvgpr_write_b32 a91, v7
v_accvgpr_read_b32 v4, a92
v_accvgpr_read_b32 v5, a93
v_accvgpr_read_b32 v6, a94
v_accvgpr_read_b32 v7, a95
v_mul_f32 v4, v4, v27
v_mul_f32 v5, v5, v27
v_mul_f32 v6, v6, v27
v_mul_f32 v7, v7, v27
v_accvgpr_write_b32 a92, v4
v_accvgpr_write_b32 a93, v5
v_accvgpr_write_b32 a94, v6
v_accvgpr_write_b32 a95, v7
v_accvgpr_read_b32 v4, a96
v_accvgpr_read_b32 v5, a97
v_accvgpr_read_b32 v6, a98
v_accvgpr_read_b32 v7, a99
v_mul_f32 v4, v4, v26
v_mul_f32 v5, v5, v26
v_mul_f32 v6, v6, v26
v_mul_f32 v7, v7, v26
v_accvgpr_write_b32 a96, v4
v_accvgpr_write_b32 a97, v5
v_accvgpr_write_b32 a98, v6
v_accvgpr_write_b32 a99, v7
v_accvgpr_read_b32 v4, a100
v_accvgpr_read_b32 v5, a101
v_accvgpr_read_b32 v6, a102
v_accvgpr_read_b32 v7, a103
v_mul_f32 v4, v4, v27
v_mul_f32 v5, v5, v27
v_mul_f32 v6, v6, v27
v_mul_f32 v7, v7, v27
v_accvgpr_write_b32 a100, v4
v_accvgpr_write_b32 a101, v5
v_accvgpr_write_b32 a102, v6
v_accvgpr_write_b32 a103, v7
v_accvgpr_read_b32 v4, a104
v_accvgpr_read_b32 v5, a105
v_accvgpr_read_b32 v6, a106
v_accvgpr_read_b32 v7, a107
v_mul_f32 v4, v4, v26
v_mul_f32 v5, v5, v26
v_mul_f32 v6, v6, v26
v_mul_f32 v7, v7, v26
v_accvgpr_write_b32 a104, v4
v_accvgpr_write_b32 a105, v5
v_accvgpr_write_b32 a106, v6
v_accvgpr_write_b32 a107, v7
v_accvgpr_read_b32 v4, a108
v_accvgpr_read_b32 v5, a109
v_accvgpr_read_b32 v6, a110
v_accvgpr_read_b32 v7, a111
v_mul_f32 v4, v4, v27
v_mul_f32 v5, v5, v27
v_mul_f32 v6, v6, v27
v_mul_f32 v7, v7, v27
v_accvgpr_write_b32 a108, v4
v_accvgpr_write_b32 a109, v5
v_accvgpr_write_b32 a110, v6
v_accvgpr_write_b32 a111, v7
v_accvgpr_read_b32 v4, a112
v_accvgpr_read_b32 v5, a113
v_accvgpr_read_b32 v6, a114
v_accvgpr_read_b32 v7, a115
v_mul_f32 v4, v4, v26
v_mul_f32 v5, v5, v26
v_mul_f32 v6, v6, v26
v_mul_f32 v7, v7, v26
v_accvgpr_write_b32 a112, v4
v_accvgpr_write_b32 a113, v5
v_accvgpr_write_b32 a114, v6
v_accvgpr_write_b32 a115, v7
v_accvgpr_read_b32 v4, a116
v_accvgpr_read_b32 v5, a117
v_accvgpr_read_b32 v6, a118
v_accvgpr_read_b32 v7, a119
v_mul_f32 v4, v4, v27
v_mul_f32 v5, v5, v27
v_mul_f32 v6, v6, v27
v_mul_f32 v7, v7, v27
v_accvgpr_write_b32 a116, v4
v_accvgpr_write_b32 a117, v5
v_accvgpr_write_b32 a118, v6
v_accvgpr_write_b32 a119, v7
v_accvgpr_read_b32 v4, a120
v_accvgpr_read_b32 v5, a121
v_accvgpr_read_b32 v6, a122
v_accvgpr_read_b32 v7, a123
v_mul_f32 v4, v4, v26
v_mul_f32 v5, v5, v26
v_mul_f32 v6, v6, v26
v_mul_f32 v7, v7, v26
v_accvgpr_write_b32 a120, v4
v_accvgpr_write_b32 a121, v5
v_accvgpr_write_b32 a122, v6
v_accvgpr_write_b32 a123, v7
v_accvgpr_read_b32 v4, a124
v_accvgpr_read_b32 v5, a125
v_accvgpr_read_b32 v6, a126
v_accvgpr_read_b32 v7, a127
v_mul_f32 v4, v4, v27
v_mul_f32 v5, v5, v27
v_mul_f32 v6, v6, v27
v_mul_f32 v7, v7, v27
v_accvgpr_write_b32 a124, v4
v_accvgpr_write_b32 a125, v5
v_accvgpr_write_b32 a126, v6
v_accvgpr_write_b32 a127, v7
s_mov_b32 s23, 0
s_nop 1
s_branch mega_kernel_m1_end
mega_kernel_m0_r1:
s_nop 7
v_mov_b32 v2, v21
s_nop 1
v_permlane16_swap_b32 v2, v21
s_nop 1
v_max_f32 v21, v21, v2
v_mov_b32 v2, v21
s_nop 1
v_permlane32_swap_b32 v2, v21
s_nop 1
v_max_f32 v21, v21, v2
v_max_f32 v21, 0, v21
v_exp_f32 v26, -v21
v_sub_f32 v32, v32, v21
v_sub_f32 v33, v33, v21
v_sub_f32 v34, v34, v21
v_sub_f32 v35, v35, v21
v_sub_f32 v96, v96, v21
v_sub_f32 v97, v97, v21
v_sub_f32 v98, v98, v21
v_sub_f32 v99, v99, v21
v_sub_f32 v104, v104, v21
v_sub_f32 v105, v105, v21
v_sub_f32 v106, v106, v21
v_sub_f32 v107, v107, v21
v_sub_f32 v112, v112, v21
v_sub_f32 v113, v113, v21
v_sub_f32 v114, v114, v21
v_sub_f32 v115, v115, v21
v_sub_f32 v120, v120, v21
v_sub_f32 v121, v121, v21
v_sub_f32 v122, v122, v21
v_sub_f32 v123, v123, v21
v_mul_f32 v24, v24, v26
v_mov_b32 v2, v22
s_nop 1
v_permlane16_swap_b32 v2, v22
s_nop 1
v_max_f32 v22, v22, v2
v_mov_b32 v2, v22
s_nop 1
v_permlane32_swap_b32 v2, v22
s_nop 1
v_max_f32 v22, v22, v2
v_max_f32 v22, 0, v22
v_exp_f32 v27, -v22
v_sub_f32 v36, v36, v22
v_sub_f32 v37, v37, v22
v_sub_f32 v38, v38, v22
v_sub_f32 v39, v39, v22
v_sub_f32 v100, v100, v22
v_sub_f32 v101, v101, v22
v_sub_f32 v102, v102, v22
v_sub_f32 v103, v103, v22
v_sub_f32 v108, v108, v22
v_sub_f32 v109, v109, v22
v_sub_f32 v110, v110, v22
v_sub_f32 v111, v111, v22
v_sub_f32 v116, v116, v22
v_sub_f32 v117, v117, v22
v_sub_f32 v118, v118, v22
v_sub_f32 v119, v119, v22
v_sub_f32 v124, v124, v22
v_sub_f32 v125, v125, v22
v_sub_f32 v126, v126, v22
v_sub_f32 v127, v127, v22
v_mul_f32 v25, v25, v27
s_mov_b32 s23, 1
v_mfma_f32_16x16x32_bf16 a[28:31], a[220:223], v[140:143], a[28:31]
ds_read_b128 a[252:255], v16 offset:23552
s_waitcnt lgkmcnt(4)
v_mfma_f32_16x16x32_bf16 a[32:35], a[224:227], v[128:131], a[32:35]
buffer_load_dwordx4 v49, s[4:7], s16 offen offset:1024 sc1 lds
v_mfma_f32_16x16x32_bf16 a[32:35], a[228:231], v[136:139], a[32:35]
ds_read_b128 a[192:195], v16 offset:8192
v_mfma_f32_16x16x32_bf16 a[36:39], a[224:227], v[132:135], a[36:39]
v_exp_f32 v96, v96
v_mfma_f32_16x16x32_bf16 a[36:39], a[228:231], v[140:143], a[36:39]
buffer_load_dwordx4 v50, s[4:7], s16 offen offset:2048 sc1 lds
v_mfma_f32_16x16x32_bf16 a[40:43], a[232:235], v[128:131], a[40:43]
ds_read_b128 a[196:199], v16 offset:24576
v_add_f32 v24, v96, v24
v_mfma_f32_16x16x32_bf16 a[40:43], a[236:239], v[136:139], a[40:43]
v_exp_f32 v97, v97
v_mfma_f32_16x16x32_bf16 a[44:47], a[232:235], v[132:135], a[44:47]
ds_read_b128 a[200:203], v16 offset:9216
v_add_f32 v24, v97, v24
v_mfma_f32_16x16x32_bf16 a[44:47], a[236:239], v[140:143], a[44:47]
ds_read_b128 a[204:207], v16 offset:25600
s_waitcnt lgkmcnt(4)
v_mfma_f32_16x16x32_bf16 a[48:51], a[240:243], v[128:131], a[48:51]
v_exp_f32 v98, v98
v_mfma_f32_16x16x32_bf16 a[48:51], a[244:247], v[136:139], a[48:51]
ds_read_b128 a[208:211], v16 offset:10240
v_cvt_pk_bf16_f32 v144, v96, v97
v_mfma_f32_16x16x32_bf16 a[52:55], a[240:243], v[132:135], a[52:55]
buffer_load_dwordx4 v51, s[4:7], s16 offen offset:3072 sc1 lds
v_mfma_f32_16x16x32_bf16 a[52:55], a[244:247], v[140:143], a[52:55]
s_add_u32 m0, s18, 69632
ds_read_b128 a[212:215], v16 offset:26624
v_mfma_f32_16x16x32_bf16 a[56:59], a[248:251], v[128:131], a[56:59]
v_exp_f32 v99, v99
v_mfma_f32_16x16x32_bf16 a[56:59], a[252:255], v[136:139], a[56:59]
ds_read_b128 a[216:219], v16 offset:11264
v_add_f32 v24, v98, v24
v_mfma_f32_16x16x32_bf16 a[60:63], a[248:251], v[132:135], a[60:63]
ds_read_b128 a[220:223], v16 offset:27648
v_add_f32 v24, v99, v24
v_mfma_f32_16x16x32_bf16 a[60:63], a[252:255], v[140:143], a[60:63]
ds_read_b128 a[224:227], v16 offset:12288
s_waitcnt lgkmcnt(5)
v_mfma_f32_16x16x32_bf16 a[64:67], a[192:195], v[128:131], a[64:67]
buffer_load_dwordx4 v52, s[4:7], s16 offen offset:0 sc1 lds
v_mfma_f32_16x16x32_bf16 a[64:67], a[196:199], v[136:139], a[64:67]
v_exp_f32 v104, v104
v_mfma_f32_16x16x32_bf16 a[68:71], a[192:195], v[132:135], a[68:71]
ds_read_b128 a[228:231], v16 offset:28672
v_cvt_pk_bf16_f32 v145, v98, v99
v_mfma_f32_16x16x32_bf16 a[68:71], a[196:199], v[140:143], a[68:71]
v_exp_f32 v105, v105
v_mfma_f32_16x16x32_bf16 a[72:75], a[200:203], v[128:131], a[72:75]
ds_read_b128 a[232:235], v16 offset:13312
v_add_f32 v24, v104, v24
v_mfma_f32_16x16x32_bf16 a[72:75], a[204:207], v[136:139], a[72:75]
buffer_load_dwordx4 v53, s[4:7], s16 offen offset:1024 sc1 lds
v_mfma_f32_16x16x32_bf16 a[76:79], a[200:203], v[132:135], a[76:79]
ds_read_b128 a[236:239], v16 offset:29696
v_add_f32 v24, v105, v24
v_mfma_f32_16x16x32_bf16 a[76:79], a[204:207], v[140:143], a[76:79]
ds_read_b128 a[240:243], v16 offset:14336
s_waitcnt lgkmcnt(5)
v_mfma_f32_16x16x32_bf16 a[80:83], a[208:211], v[128:131], a[80:83]
v_exp_f32 v106, v106
v_mfma_f32_16x16x32_bf16 a[80:83], a[212:215], v[136:139], a[80:83]
ds_read_b128 a[244:247], v16 offset:30720
v_cvt_pk_bf16_f32 v146, v104, v105
v_mfma_f32_16x16x32_bf16 a[84:87], a[208:211], v[132:135], a[84:87]
ds_read_b128 a[248:251], v16 offset:15360
v_add_f32 v24, v106, v24
v_mfma_f32_16x16x32_bf16 a[84:87], a[212:215], v[140:143], a[84:87]
s_add_u32 s19, s19, 1
ds_read_b128 a[252:255], v16 offset:31744
v_mfma_f32_16x16x32_bf16 a[88:91], a[216:219], v[128:131], a[88:91]
v_exp_f32 v107, v107
v_mfma_f32_16x16x32_bf16 a[88:91], a[220:223], v[136:139], a[88:91]
buffer_load_dwordx4 v54, s[4:7], s16 offen offset:2048 sc1 lds
v_mfma_f32_16x16x32_bf16 a[92:95], a[216:219], v[132:135], a[92:95]
buffer_load_dwordx4 v55, s[4:7], s16 offen offset:3072 sc1 lds
v_mfma_f32_16x16x32_bf16 a[92:95], a[220:223], v[140:143], a[92:95]
s_waitcnt vmcnt(16) lgkmcnt(0)
s_barrier
v_mfma_f32_16x16x32_bf16 a[96:99], a[224:227], v[128:131], a[96:99]
v_exp_f32 v100, v100
v_mfma_f32_16x16x32_bf16 a[96:99], a[228:231], v[136:139], a[96:99]
v_exp_f32 v101, v101
v_mfma_f32_16x16x32_bf16 a[100:103], a[224:227], v[132:135], a[100:103]
v_exp_f32 v102, v102
v_mfma_f32_16x16x32_bf16 a[100:103], a[228:231], v[140:143], a[100:103]
ds_read_b128 a[192:195], v17 offset:32768
v_add_f32 v24, v107, v24
v_mfma_f32_16x16x32_bf16 a[104:107], a[232:235], v[128:131], a[104:107]
ds_read_b128 a[196:199], v17 offset:33792
v_cvt_pk_bf16_f32 v147, v106, v107
v_mfma_f32_16x16x32_bf16 a[104:107], a[236:239], v[136:139], a[104:107]
v_exp_f32 v103, v103
v_mfma_f32_16x16x32_bf16 a[108:111], a[232:235], v[132:135], a[108:111]
ds_read_b128 a[200:203], v17 offset:34816
v_add_f32 v25, v100, v25
v_mfma_f32_16x16x32_bf16 a[108:111], a[236:239], v[140:143], a[108:111]
ds_read_b128 a[204:207], v17 offset:35840
v_add_f32 v25, v101, v25
v_mfma_f32_16x16x32_bf16 a[112:115], a[240:243], v[128:131], a[112:115]
v_exp_f32 v108, v108
v_mfma_f32_16x16x32_bf16 a[112:115], a[244:247], v[136:139], a[112:115]
ds_read_b128 a[208:211], v17 offset:36864
v_cvt_pk_bf16_f32 v148, v100, v101
v_mfma_f32_16x16x32_bf16 a[116:119], a[240:243], v[132:135], a[116:119]
v_exp_f32 v109, v109
v_mfma_f32_16x16x32_bf16 a[116:119], a[244:247], v[140:143], a[116:119]
s_add_u32 s16, s16, s26
ds_read_b128 a[212:215], v17 offset:37888
v_mfma_f32_16x16x32_bf16 a[120:123], a[248:251], v[128:131], a[120:123]
ds_read_b128 a[216:219], v17 offset:38912
v_add_f32 v25, v102, v25
v_mfma_f32_16x16x32_bf16 a[120:123], a[252:255], v[136:139], a[120:123]
ds_read_b128 a[220:223], v17 offset:39936
v_add_f32 v25, v103, v25
v_mfma_f32_16x16x32_bf16 a[124:127], a[248:251], v[132:135], a[124:127]
v_cvt_pk_bf16_f32 v149, v102, v103
v_add_f32 v25, v108, v25
v_mfma_f32_16x16x32_bf16 a[124:127], a[252:255], v[140:143], a[124:127]
v_add_f32 v25, v109, v25
v_cvt_pk_bf16_f32 v150, v108, v109
s_nop 7
v_accvgpr_read_b32 v4, a0
v_accvgpr_read_b32 v5, a1
v_accvgpr_read_b32 v6, a2
v_accvgpr_read_b32 v7, a3
v_mul_f32 v4, v4, v26
v_mul_f32 v5, v5, v26
v_mul_f32 v6, v6, v26
v_mul_f32 v7, v7, v26
v_accvgpr_write_b32 a0, v4
v_accvgpr_write_b32 a1, v5
v_accvgpr_write_b32 a2, v6
v_accvgpr_write_b32 a3, v7
v_accvgpr_read_b32 v4, a4
v_accvgpr_read_b32 v5, a5
v_accvgpr_read_b32 v6, a6
v_accvgpr_read_b32 v7, a7
v_mul_f32 v4, v4, v27
v_mul_f32 v5, v5, v27
v_mul_f32 v6, v6, v27
v_mul_f32 v7, v7, v27
v_accvgpr_write_b32 a4, v4
v_accvgpr_write_b32 a5, v5
v_accvgpr_write_b32 a6, v6
v_accvgpr_write_b32 a7, v7
v_accvgpr_read_b32 v4, a8
v_accvgpr_read_b32 v5, a9
v_accvgpr_read_b32 v6, a10
v_accvgpr_read_b32 v7, a11
v_mul_f32 v4, v4, v26
v_mul_f32 v5, v5, v26
v_mul_f32 v6, v6, v26
v_mul_f32 v7, v7, v26
v_accvgpr_write_b32 a8, v4
v_accvgpr_write_b32 a9, v5
v_accvgpr_write_b32 a10, v6
v_accvgpr_write_b32 a11, v7
v_accvgpr_read_b32 v4, a12
v_accvgpr_read_b32 v5, a13
v_accvgpr_read_b32 v6, a14
v_accvgpr_read_b32 v7, a15
v_mul_f32 v4, v4, v27
v_mul_f32 v5, v5, v27
v_mul_f32 v6, v6, v27
v_mul_f32 v7, v7, v27
v_accvgpr_write_b32 a12, v4
v_accvgpr_write_b32 a13, v5
v_accvgpr_write_b32 a14, v6
v_accvgpr_write_b32 a15, v7
v_accvgpr_read_b32 v4, a16
v_accvgpr_read_b32 v5, a17
v_accvgpr_read_b32 v6, a18
v_accvgpr_read_b32 v7, a19
v_mul_f32 v4, v4, v26
v_mul_f32 v5, v5, v26
v_mul_f32 v6, v6, v26
v_mul_f32 v7, v7, v26
v_accvgpr_write_b32 a16, v4
v_accvgpr_write_b32 a17, v5
v_accvgpr_write_b32 a18, v6
v_accvgpr_write_b32 a19, v7
v_accvgpr_read_b32 v4, a20
v_accvgpr_read_b32 v5, a21
v_accvgpr_read_b32 v6, a22
v_accvgpr_read_b32 v7, a23
v_mul_f32 v4, v4, v27
v_mul_f32 v5, v5, v27
v_mul_f32 v6, v6, v27
v_mul_f32 v7, v7, v27
v_accvgpr_write_b32 a20, v4
v_accvgpr_write_b32 a21, v5
v_accvgpr_write_b32 a22, v6
v_accvgpr_write_b32 a23, v7
v_accvgpr_read_b32 v4, a24
v_accvgpr_read_b32 v5, a25
v_accvgpr_read_b32 v6, a26
v_accvgpr_read_b32 v7, a27
v_mul_f32 v4, v4, v26
v_mul_f32 v5, v5, v26
v_mul_f32 v6, v6, v26
v_mul_f32 v7, v7, v26
v_accvgpr_write_b32 a24, v4
v_accvgpr_write_b32 a25, v5
v_accvgpr_write_b32 a26, v6
v_accvgpr_write_b32 a27, v7
v_accvgpr_read_b32 v4, a28
v_accvgpr_read_b32 v5, a29
v_accvgpr_read_b32 v6, a30
v_accvgpr_read_b32 v7, a31
v_mul_f32 v4, v4, v27
v_mul_f32 v5, v5, v27
v_mul_f32 v6, v6, v27
v_mul_f32 v7, v7, v27
v_accvgpr_write_b32 a28, v4
v_accvgpr_write_b32 a29, v5
v_accvgpr_write_b32 a30, v6
v_accvgpr_write_b32 a31, v7
v_accvgpr_read_b32 v4, a32
v_accvgpr_read_b32 v5, a33
v_accvgpr_read_b32 v6, a34
v_accvgpr_read_b32 v7, a35
v_mul_f32 v4, v4, v26
v_mul_f32 v5, v5, v26
v_mul_f32 v6, v6, v26
v_mul_f32 v7, v7, v26
v_accvgpr_write_b32 a32, v4
v_accvgpr_write_b32 a33, v5
v_accvgpr_write_b32 a34, v6
v_accvgpr_write_b32 a35, v7
v_accvgpr_read_b32 v4, a36
v_accvgpr_read_b32 v5, a37
v_accvgpr_read_b32 v6, a38
v_accvgpr_read_b32 v7, a39
v_mul_f32 v4, v4, v27
v_mul_f32 v5, v5, v27
v_mul_f32 v6, v6, v27
v_mul_f32 v7, v7, v27
v_accvgpr_write_b32 a36, v4
v_accvgpr_write_b32 a37, v5
v_accvgpr_write_b32 a38, v6
v_accvgpr_write_b32 a39, v7
v_accvgpr_read_b32 v4, a40
v_accvgpr_read_b32 v5, a41
v_accvgpr_read_b32 v6, a42
v_accvgpr_read_b32 v7, a43
v_mul_f32 v4, v4, v26
v_mul_f32 v5, v5, v26
v_mul_f32 v6, v6, v26
v_mul_f32 v7, v7, v26
v_accvgpr_write_b32 a40, v4
v_accvgpr_write_b32 a41, v5
v_accvgpr_write_b32 a42, v6
v_accvgpr_write_b32 a43, v7
v_accvgpr_read_b32 v4, a44
v_accvgpr_read_b32 v5, a45
v_accvgpr_read_b32 v6, a46
v_accvgpr_read_b32 v7, a47
v_mul_f32 v4, v4, v27
v_mul_f32 v5, v5, v27
v_mul_f32 v6, v6, v27
v_mul_f32 v7, v7, v27
v_accvgpr_write_b32 a44, v4
v_accvgpr_write_b32 a45, v5
v_accvgpr_write_b32 a46, v6
v_accvgpr_write_b32 a47, v7
v_accvgpr_read_b32 v4, a48
v_accvgpr_read_b32 v5, a49
v_accvgpr_read_b32 v6, a50
v_accvgpr_read_b32 v7, a51
v_mul_f32 v4, v4, v26
v_mul_f32 v5, v5, v26
v_mul_f32 v6, v6, v26
v_mul_f32 v7, v7, v26
v_accvgpr_write_b32 a48, v4
v_accvgpr_write_b32 a49, v5
v_accvgpr_write_b32 a50, v6
v_accvgpr_write_b32 a51, v7
v_accvgpr_read_b32 v4, a52
v_accvgpr_read_b32 v5, a53
v_accvgpr_read_b32 v6, a54
v_accvgpr_read_b32 v7, a55
v_mul_f32 v4, v4, v27
v_mul_f32 v5, v5, v27
v_mul_f32 v6, v6, v27
v_mul_f32 v7, v7, v27
v_accvgpr_write_b32 a52, v4
v_accvgpr_write_b32 a53, v5
v_accvgpr_write_b32 a54, v6
v_accvgpr_write_b32 a55, v7
v_accvgpr_read_b32 v4, a56
v_accvgpr_read_b32 v5, a57
v_accvgpr_read_b32 v6, a58
v_accvgpr_read_b32 v7, a59
v_mul_f32 v4, v4, v26
v_mul_f32 v5, v5, v26
v_mul_f32 v6, v6, v26
v_mul_f32 v7, v7, v26
v_accvgpr_write_b32 a56, v4
v_accvgpr_write_b32 a57, v5
v_accvgpr_write_b32 a58, v6
v_accvgpr_write_b32 a59, v7
v_accvgpr_read_b32 v4, a60
v_accvgpr_read_b32 v5, a61
v_accvgpr_read_b32 v6, a62
v_accvgpr_read_b32 v7, a63
v_mul_f32 v4, v4, v27
v_mul_f32 v5, v5, v27
v_mul_f32 v6, v6, v27
v_mul_f32 v7, v7, v27
v_accvgpr_write_b32 a60, v4
v_accvgpr_write_b32 a61, v5
v_accvgpr_write_b32 a62, v6
v_accvgpr_write_b32 a63, v7
v_accvgpr_read_b32 v4, a64
v_accvgpr_read_b32 v5, a65
v_accvgpr_read_b32 v6, a66
v_accvgpr_read_b32 v7, a67
v_mul_f32 v4, v4, v26
v_mul_f32 v5, v5, v26
v_mul_f32 v6, v6, v26
v_mul_f32 v7, v7, v26
v_accvgpr_write_b32 a64, v4
v_accvgpr_write_b32 a65, v5
v_accvgpr_write_b32 a66, v6
v_accvgpr_write_b32 a67, v7
v_accvgpr_read_b32 v4, a68
v_accvgpr_read_b32 v5, a69
v_accvgpr_read_b32 v6, a70
v_accvgpr_read_b32 v7, a71
v_mul_f32 v4, v4, v27
v_mul_f32 v5, v5, v27
v_mul_f32 v6, v6, v27
v_mul_f32 v7, v7, v27
v_accvgpr_write_b32 a68, v4
v_accvgpr_write_b32 a69, v5
v_accvgpr_write_b32 a70, v6
v_accvgpr_write_b32 a71, v7
v_accvgpr_read_b32 v4, a72
v_accvgpr_read_b32 v5, a73
v_accvgpr_read_b32 v6, a74
v_accvgpr_read_b32 v7, a75
v_mul_f32 v4, v4, v26
v_mul_f32 v5, v5, v26
v_mul_f32 v6, v6, v26
v_mul_f32 v7, v7, v26
v_accvgpr_write_b32 a72, v4
v_accvgpr_write_b32 a73, v5
v_accvgpr_write_b32 a74, v6
v_accvgpr_write_b32 a75, v7
v_accvgpr_read_b32 v4, a76
v_accvgpr_read_b32 v5, a77
v_accvgpr_read_b32 v6, a78
v_accvgpr_read_b32 v7, a79
v_mul_f32 v4, v4, v27
v_mul_f32 v5, v5, v27
v_mul_f32 v6, v6, v27
v_mul_f32 v7, v7, v27
v_accvgpr_write_b32 a76, v4
v_accvgpr_write_b32 a77, v5
v_accvgpr_write_b32 a78, v6
v_accvgpr_write_b32 a79, v7
v_accvgpr_read_b32 v4, a80
v_accvgpr_read_b32 v5, a81
v_accvgpr_read_b32 v6, a82
v_accvgpr_read_b32 v7, a83
v_mul_f32 v4, v4, v26
v_mul_f32 v5, v5, v26
v_mul_f32 v6, v6, v26
v_mul_f32 v7, v7, v26
v_accvgpr_write_b32 a80, v4
v_accvgpr_write_b32 a81, v5
v_accvgpr_write_b32 a82, v6
v_accvgpr_write_b32 a83, v7
v_accvgpr_read_b32 v4, a84
v_accvgpr_read_b32 v5, a85
v_accvgpr_read_b32 v6, a86
v_accvgpr_read_b32 v7, a87
v_mul_f32 v4, v4, v27
v_mul_f32 v5, v5, v27
v_mul_f32 v6, v6, v27
v_mul_f32 v7, v7, v27
v_accvgpr_write_b32 a84, v4
v_accvgpr_write_b32 a85, v5
v_accvgpr_write_b32 a86, v6
v_accvgpr_write_b32 a87, v7
v_accvgpr_read_b32 v4, a88
v_accvgpr_read_b32 v5, a89
v_accvgpr_read_b32 v6, a90
v_accvgpr_read_b32 v7, a91
v_mul_f32 v4, v4, v26
v_mul_f32 v5, v5, v26
v_mul_f32 v6, v6, v26
v_mul_f32 v7, v7, v26
v_accvgpr_write_b32 a88, v4
v_accvgpr_write_b32 a89, v5
v_accvgpr_write_b32 a90, v6
v_accvgpr_write_b32 a91, v7
v_accvgpr_read_b32 v4, a92
v_accvgpr_read_b32 v5, a93
v_accvgpr_read_b32 v6, a94
v_accvgpr_read_b32 v7, a95
v_mul_f32 v4, v4, v27
v_mul_f32 v5, v5, v27
v_mul_f32 v6, v6, v27
v_mul_f32 v7, v7, v27
v_accvgpr_write_b32 a92, v4
v_accvgpr_write_b32 a93, v5
v_accvgpr_write_b32 a94, v6
v_accvgpr_write_b32 a95, v7
v_accvgpr_read_b32 v4, a96
v_accvgpr_read_b32 v5, a97
v_accvgpr_read_b32 v6, a98
v_accvgpr_read_b32 v7, a99
v_mul_f32 v4, v4, v26
v_mul_f32 v5, v5, v26
v_mul_f32 v6, v6, v26
v_mul_f32 v7, v7, v26
v_accvgpr_write_b32 a96, v4
v_accvgpr_write_b32 a97, v5
v_accvgpr_write_b32 a98, v6
v_accvgpr_write_b32 a99, v7
v_accvgpr_read_b32 v4, a100
v_accvgpr_read_b32 v5, a101
v_accvgpr_read_b32 v6, a102
v_accvgpr_read_b32 v7, a103
v_mul_f32 v4, v4, v27
v_mul_f32 v5, v5, v27
v_mul_f32 v6, v6, v27
v_mul_f32 v7, v7, v27
v_accvgpr_write_b32 a100, v4
v_accvgpr_write_b32 a101, v5
v_accvgpr_write_b32 a102, v6
v_accvgpr_write_b32 a103, v7
v_accvgpr_read_b32 v4, a104
v_accvgpr_read_b32 v5, a105
v_accvgpr_read_b32 v6, a106
v_accvgpr_read_b32 v7, a107
v_mul_f32 v4, v4, v26
v_mul_f32 v5, v5, v26
v_mul_f32 v6, v6, v26
v_mul_f32 v7, v7, v26
v_accvgpr_write_b32 a104, v4
v_accvgpr_write_b32 a105, v5
v_accvgpr_write_b32 a106, v6
v_accvgpr_write_b32 a107, v7
v_accvgpr_read_b32 v4, a108
v_accvgpr_read_b32 v5, a109
v_accvgpr_read_b32 v6, a110
v_accvgpr_read_b32 v7, a111
v_mul_f32 v4, v4, v27
v_mul_f32 v5, v5, v27
v_mul_f32 v6, v6, v27
v_mul_f32 v7, v7, v27
v_accvgpr_write_b32 a108, v4
v_accvgpr_write_b32 a109, v5
v_accvgpr_write_b32 a110, v6
v_accvgpr_write_b32 a111, v7
v_accvgpr_read_b32 v4, a112
v_accvgpr_read_b32 v5, a113
v_accvgpr_read_b32 v6, a114
v_accvgpr_read_b32 v7, a115
v_mul_f32 v4, v4, v26
v_mul_f32 v5, v5, v26
v_mul_f32 v6, v6, v26
v_mul_f32 v7, v7, v26
v_accvgpr_write_b32 a112, v4
v_accvgpr_write_b32 a113, v5
v_accvgpr_write_b32 a114, v6
v_accvgpr_write_b32 a115, v7
v_accvgpr_read_b32 v4, a116
v_accvgpr_read_b32 v5, a117
v_accvgpr_read_b32 v6, a118
v_accvgpr_read_b32 v7, a119
v_mul_f32 v4, v4, v27
v_mul_f32 v5, v5, v27
v_mul_f32 v6, v6, v27
v_mul_f32 v7, v7, v27
v_accvgpr_write_b32 a116, v4
v_accvgpr_write_b32 a117, v5
v_accvgpr_write_b32 a118, v6
v_accvgpr_write_b32 a119, v7
v_accvgpr_read_b32 v4, a120
v_accvgpr_read_b32 v5, a121
v_accvgpr_read_b32 v6, a122
v_accvgpr_read_b32 v7, a123
v_mul_f32 v4, v4, v26
v_mul_f32 v5, v5, v26
v_mul_f32 v6, v6, v26
v_mul_f32 v7, v7, v26
v_accvgpr_write_b32 a120, v4
v_accvgpr_write_b32 a121, v5
v_accvgpr_write_b32 a122, v6
v_accvgpr_write_b32 a123, v7
v_accvgpr_read_b32 v4, a124
v_accvgpr_read_b32 v5, a125
v_accvgpr_read_b32 v6, a126
v_accvgpr_read_b32 v7, a127
v_mul_f32 v4, v4, v27
v_mul_f32 v5, v5, v27
v_mul_f32 v6, v6, v27
v_mul_f32 v7, v7, v27
v_accvgpr_write_b32 a124, v4
v_accvgpr_write_b32 a125, v5
v_accvgpr_write_b32 a126, v6
v_accvgpr_write_b32 a127, v7
s_mov_b32 s23, 0
s_nop 1
s_branch mega_kernel_m0_end
mega_kernel_achk:
s_mov_b32 s62, 200000
mega_kernel_aspin:
v_readfirstlane_b32 s61, v59
s_and_b32 s61, s61, -1
s_cmp_ge_u32 s61, 48
s_cbranch_scc1 mega_kernel_aok
s_sleep 4
global_load_dword v59, v60, s[52:53] sc1
s_waitcnt vmcnt(0)
s_sub_u32 s62, s62, 1
s_cmp_lg_u32 s62, 0
s_cbranch_scc1 mega_kernel_aspin
mega_kernel_aok:
s_branch mega_kernel_achkr
mega_kernel_psig:
v_mov_b32 v3, s76
v_mov_b32 v2, 1
s_mov_b64 exec, 1
global_atomic_add v3, v2, s[12:13] sc1
s_mov_b64 exec, -1
s_branch mega_kernel_psigr
mega_kernelA_u0_rs:
s_nop 15
v_mov_b32 v2, v21
s_nop 1
v_permlane32_swap_b32 v2, v21
s_nop 1
v_max_f32 v21, v21, v2
v_max_f32 v21, 0, v21
v_exp_f32 v23, -v21
s_nop 0
v_mul_f32 v224, v224, v23
v_mul_f32 v225, v225, v23
v_mul_f32 v226, v226, v23
v_mul_f32 v227, v227, v23
v_mul_f32 v228, v228, v23
v_mul_f32 v229, v229, v23
v_mul_f32 v230, v230, v23
v_mul_f32 v231, v231, v23
v_mul_f32 v232, v232, v23
v_mul_f32 v233, v233, v23
v_mul_f32 v234, v234, v23
v_mul_f32 v235, v235, v23
v_mul_f32 v236, v236, v23
v_mul_f32 v237, v237, v23
v_mul_f32 v238, v238, v23
v_mul_f32 v239, v239, v23
v_sub_f32 v32, v32, v21
v_sub_f32 v33, v33, v21
v_sub_f32 v34, v34, v21
v_sub_f32 v35, v35, v21
v_sub_f32 v36, v36, v21
v_sub_f32 v37, v37, v21
v_sub_f32 v38, v38, v21
v_sub_f32 v39, v39, v21
v_sub_f32 v40, v40, v21
v_sub_f32 v41, v41, v21
v_sub_f32 v42, v42, v21
v_sub_f32 v43, v43, v21
v_sub_f32 v44, v44, v21
v_sub_f32 v45, v45, v21
v_sub_f32 v46, v46, v21
v_sub_f32 v47, v47, v21
v_sub_f32 v128, v128, v21
v_sub_f32 v129, v129, v21
v_sub_f32 v130, v130, v21
v_sub_f32 v131, v131, v21
v_sub_f32 v132, v132, v21
v_sub_f32 v133, v133, v21
v_sub_f32 v134, v134, v21
v_sub_f32 v135, v135, v21
v_sub_f32 v136, v136, v21
v_sub_f32 v137, v137, v21
v_sub_f32 v138, v138, v21
v_sub_f32 v139, v139, v21
v_sub_f32 v140, v140, v21
v_sub_f32 v141, v141, v21
v_sub_f32 v142, v142, v21
v_sub_f32 v143, v143, v21
v_sub_f32 v160, v160, v21
v_sub_f32 v161, v161, v21
v_sub_f32 v162, v162, v21
v_sub_f32 v163, v163, v21
v_sub_f32 v164, v164, v21
v_sub_f32 v165, v165, v21
v_sub_f32 v166, v166, v21
v_sub_f32 v167, v167, v21
v_sub_f32 v168, v168, v21
v_sub_f32 v169, v169, v21
v_sub_f32 v170, v170, v21
v_sub_f32 v171, v171, v21
v_sub_f32 v172, v172, v21
v_sub_f32 v173, v173, v21
v_sub_f32 v174, v174, v21
v_sub_f32 v175, v175, v21
v_mov_b32 v2, v22
s_nop 1
v_permlane32_swap_b32 v2, v22
s_nop 1
v_max_f32 v22, v22, v2
v_max_f32 v22, 0, v22
v_exp_f32 v23, -v22
s_nop 0
v_mul_f32 v240, v240, v23
v_mul_f32 v241, v241, v23
v_mul_f32 v242, v242, v23
v_mul_f32 v243, v243, v23
v_mul_f32 v244, v244, v23
v_mul_f32 v245, v245, v23
v_mul_f32 v246, v246, v23
v_mul_f32 v247, v247, v23
v_mul_f32 v248, v248, v23
v_mul_f32 v249, v249, v23
v_mul_f32 v250, v250, v23
v_mul_f32 v251, v251, v23
v_mul_f32 v252, v252, v23
v_mul_f32 v253, v253, v23
v_mul_f32 v254, v254, v23
v_mul_f32 v255, v255, v23
v_sub_f32 v48, v48, v22
v_sub_f32 v49, v49, v22
v_sub_f32 v50, v50, v22
v_sub_f32 v51, v51, v22
v_sub_f32 v52, v52, v22
v_sub_f32 v53, v53, v22
v_sub_f32 v54, v54, v22
v_sub_f32 v55, v55, v22
v_sub_f32 v56, v56, v22
v_sub_f32 v57, v57, v22
v_sub_f32 v58, v58, v22
v_sub_f32 v59, v59, v22
v_sub_f32 v60, v60, v22
v_sub_f32 v61, v61, v22
v_sub_f32 v62, v62, v22
v_sub_f32 v63, v63, v22
v_sub_f32 v144, v144, v22
v_sub_f32 v145, v145, v22
v_sub_f32 v146, v146, v22
v_sub_f32 v147, v147, v22
v_sub_f32 v148, v148, v22
v_sub_f32 v149, v149, v22
v_sub_f32 v150, v150, v22
v_sub_f32 v151, v151, v22
v_sub_f32 v152, v152, v22
v_sub_f32 v153, v153, v22
v_sub_f32 v154, v154, v22
v_sub_f32 v155, v155, v22
v_sub_f32 v156, v156, v22
v_sub_f32 v157, v157, v22
v_sub_f32 v158, v158, v22
v_sub_f32 v159, v159, v22
v_sub_f32 v176, v176, v22
v_sub_f32 v177, v177, v22
v_sub_f32 v178, v178, v22
v_sub_f32 v179, v179, v22
v_sub_f32 v180, v180, v22
v_sub_f32 v181, v181, v22
v_sub_f32 v182, v182, v22
v_sub_f32 v183, v183, v22
v_sub_f32 v184, v184, v22
v_sub_f32 v185, v185, v22
v_sub_f32 v186, v186, v22
v_sub_f32 v187, v187, v22
v_sub_f32 v188, v188, v22
v_sub_f32 v189, v189, v22
v_sub_f32 v190, v190, v22
v_sub_f32 v191, v191, v22
s_nop 1
s_branch mega_kernelA_u0_rsret
mega_kernelA_u1_rs:
s_nop 15
v_mov_b32 v2, v21
s_nop 1
v_permlane32_swap_b32 v2, v21
s_nop 1
v_max_f32 v21, v21, v2
v_max_f32 v21, 0, v21
v_exp_f32 v23, -v21
s_nop 0
v_mul_f32 v224, v224, v23
v_mul_f32 v225, v225, v23
v_mul_f32 v226, v226, v23
v_mul_f32 v227, v227, v23
v_mul_f32 v228, v228, v23
v_mul_f32 v229, v229, v23
v_mul_f32 v230, v230, v23
v_mul_f32 v231, v231, v23
v_mul_f32 v232, v232, v23
v_mul_f32 v233, v233, v23
v_mul_f32 v234, v234, v23
v_mul_f32 v235, v235, v23
v_mul_f32 v236, v236, v23
v_mul_f32 v237, v237, v23
v_mul_f32 v238, v238, v23
v_mul_f32 v239, v239, v23
v_sub_f32 v32, v32, v21
v_sub_f32 v33, v33, v21
v_sub_f32 v34, v34, v21
v_sub_f32 v35, v35, v21
v_sub_f32 v36, v36, v21
v_sub_f32 v37, v37, v21
v_sub_f32 v38, v38, v21
v_sub_f32 v39, v39, v21
v_sub_f32 v40, v40, v21
v_sub_f32 v41, v41, v21
v_sub_f32 v42, v42, v21
v_sub_f32 v43, v43, v21
v_sub_f32 v44, v44, v21
v_sub_f32 v45, v45, v21
v_sub_f32 v46, v46, v21
v_sub_f32 v47, v47, v21
v_sub_f32 v64, v64, v21
v_sub_f32 v65, v65, v21
v_sub_f32 v66, v66, v21
v_sub_f32 v67, v67, v21
v_sub_f32 v68, v68, v21
v_sub_f32 v69, v69, v21
v_sub_f32 v70, v70, v21
v_sub_f32 v71, v71, v21
v_sub_f32 v72, v72, v21
v_sub_f32 v73, v73, v21
v_sub_f32 v74, v74, v21
v_sub_f32 v75, v75, v21
v_sub_f32 v76, v76, v21
v_sub_f32 v77, v77, v21
v_sub_f32 v78, v78, v21
v_sub_f32 v79, v79, v21
v_sub_f32 v96, v96, v21
v_sub_f32 v97, v97, v21
v_sub_f32 v98, v98, v21
v_sub_f32 v99, v99, v21
v_sub_f32 v100, v100, v21
v_sub_f32 v101, v101, v21
v_sub_f32 v102, v102, v21
v_sub_f32 v103, v103, v21
v_sub_f32 v104, v104, v21
v_sub_f32 v105, v105, v21
v_sub_f32 v106, v106, v21
v_sub_f32 v107, v107, v21
v_sub_f32 v108, v108, v21
v_sub_f32 v109, v109, v21
v_sub_f32 v110, v110, v21
v_sub_f32 v111, v111, v21
v_mov_b32 v2, v22
s_nop 1
v_permlane32_swap_b32 v2, v22
s_nop 1
v_max_f32 v22, v22, v2
v_max_f32 v22, 0, v22
v_exp_f32 v23, -v22
s_nop 0
v_mul_f32 v240, v240, v23
v_mul_f32 v241, v241, v23
v_mul_f32 v242, v242, v23
v_mul_f32 v243, v243, v23
v_mul_f32 v244, v244, v23
v_mul_f32 v245, v245, v23
v_mul_f32 v246, v246, v23
v_mul_f32 v247, v247, v23
v_mul_f32 v248, v248, v23
v_mul_f32 v249, v249, v23
v_mul_f32 v250, v250, v23
v_mul_f32 v251, v251, v23
v_mul_f32 v252, v252, v23
v_mul_f32 v253, v253, v23
v_mul_f32 v254, v254, v23
v_mul_f32 v255, v255, v23
v_sub_f32 v48, v48, v22
v_sub_f32 v49, v49, v22
v_sub_f32 v50, v50, v22
v_sub_f32 v51, v51, v22
v_sub_f32 v52, v52, v22
v_sub_f32 v53, v53, v22
v_sub_f32 v54, v54, v22
v_sub_f32 v55, v55, v22
v_sub_f32 v56, v56, v22
v_sub_f32 v57, v57, v22
v_sub_f32 v58, v58, v22
v_sub_f32 v59, v59, v22
v_sub_f32 v60, v60, v22
v_sub_f32 v61, v61, v22
v_sub_f32 v62, v62, v22
v_sub_f32 v63, v63, v22
v_sub_f32 v80, v80, v22
v_sub_f32 v81, v81, v22
v_sub_f32 v82, v82, v22
v_sub_f32 v83, v83, v22
v_sub_f32 v84, v84, v22
v_sub_f32 v85, v85, v22
v_sub_f32 v86, v86, v22
v_sub_f32 v87, v87, v22
v_sub_f32 v88, v88, v22
v_sub_f32 v89, v89, v22
v_sub_f32 v90, v90, v22
v_sub_f32 v91, v91, v22
v_sub_f32 v92, v92, v22
v_sub_f32 v93, v93, v22
v_sub_f32 v94, v94, v22
v_sub_f32 v95, v95, v22
v_sub_f32 v112, v112, v22
v_sub_f32 v113, v113, v22
v_sub_f32 v114, v114, v22
v_sub_f32 v115, v115, v22
v_sub_f32 v116, v116, v22
v_sub_f32 v117, v117, v22
v_sub_f32 v118, v118, v22
v_sub_f32 v119, v119, v22
v_sub_f32 v120, v120, v22
v_sub_f32 v121, v121, v22
v_sub_f32 v122, v122, v22
v_sub_f32 v123, v123, v22
v_sub_f32 v124, v124, v22
v_sub_f32 v125, v125, v22
v_sub_f32 v126, v126, v22
v_sub_f32 v127, v127, v22
s_nop 1
s_branch mega_kernelA_u1_rsret
mega_kernelA_u2_rs:
s_nop 15
v_mov_b32 v2, v21
s_nop 1
v_permlane32_swap_b32 v2, v21
s_nop 1
v_max_f32 v21, v21, v2
v_max_f32 v21, 0, v21
v_exp_f32 v23, -v21
s_nop 0
v_mul_f32 v224, v224, v23
v_mul_f32 v225, v225, v23
v_mul_f32 v226, v226, v23
v_mul_f32 v227, v227, v23
v_mul_f32 v228, v228, v23
v_mul_f32 v229, v229, v23
v_mul_f32 v230, v230, v23
v_mul_f32 v231, v231, v23
v_mul_f32 v232, v232, v23
v_mul_f32 v233, v233, v23
v_mul_f32 v234, v234, v23
v_mul_f32 v235, v235, v23
v_mul_f32 v236, v236, v23
v_mul_f32 v237, v237, v23
v_mul_f32 v238, v238, v23
v_mul_f32 v239, v239, v23
v_sub_f32 v32, v32, v21
v_sub_f32 v33, v33, v21
v_sub_f32 v34, v34, v21
v_sub_f32 v35, v35, v21
v_sub_f32 v36, v36, v21
v_sub_f32 v37, v37, v21
v_sub_f32 v38, v38, v21
v_sub_f32 v39, v39, v21
v_sub_f32 v40, v40, v21
v_sub_f32 v41, v41, v21
v_sub_f32 v42, v42, v21
v_sub_f32 v43, v43, v21
v_sub_f32 v44, v44, v21
v_sub_f32 v45, v45, v21
v_sub_f32 v46, v46, v21
v_sub_f32 v47, v47, v21
v_sub_f32 v128, v128, v21
v_sub_f32 v129, v129, v21
v_sub_f32 v130, v130, v21
v_sub_f32 v131, v131, v21
v_sub_f32 v132, v132, v21
v_sub_f32 v133, v133, v21
v_sub_f32 v134, v134, v21
v_sub_f32 v135, v135, v21
v_sub_f32 v136, v136, v21
v_sub_f32 v137, v137, v21
v_sub_f32 v138, v138, v21
v_sub_f32 v139, v139, v21
v_sub_f32 v140, v140, v21
v_sub_f32 v141, v141, v21
v_sub_f32 v142, v142, v21
v_sub_f32 v143, v143, v21
v_sub_f32 v160, v160, v21
v_sub_f32 v161, v161, v21
v_sub_f32 v162, v162, v21
v_sub_f32 v163, v163, v21
v_sub_f32 v164, v164, v21
v_sub_f32 v165, v165, v21
v_sub_f32 v166, v166, v21
v_sub_f32 v167, v167, v21
v_sub_f32 v168, v168, v21
v_sub_f32 v169, v169, v21
v_sub_f32 v170, v170, v21
v_sub_f32 v171, v171, v21
v_sub_f32 v172, v172, v21
v_sub_f32 v173, v173, v21
v_sub_f32 v174, v174, v21
v_sub_f32 v175, v175, v21
v_mov_b32 v2, v22
s_nop 1
v_permlane32_swap_b32 v2, v22
s_nop 1
v_max_f32 v22, v22, v2
v_max_f32 v22, 0, v22
v_exp_f32 v23, -v22
s_nop 0
v_mul_f32 v240, v240, v23
v_mul_f32 v241, v241, v23
v_mul_f32 v242, v242, v23
v_mul_f32 v243, v243, v23
v_mul_f32 v244, v244, v23
v_mul_f32 v245, v245, v23
v_mul_f32 v246, v246, v23
v_mul_f32 v247, v247, v23
v_mul_f32 v248, v248, v23
v_mul_f32 v249, v249, v23
v_mul_f32 v250, v250, v23
v_mul_f32 v251, v251, v23
v_mul_f32 v252, v252, v23
v_mul_f32 v253, v253, v23
v_mul_f32 v254, v254, v23
v_mul_f32 v255, v255, v23
v_sub_f32 v48, v48, v22
v_sub_f32 v49, v49, v22
v_sub_f32 v50, v50, v22
v_sub_f32 v51, v51, v22
v_sub_f32 v52, v52, v22
v_sub_f32 v53, v53, v22
v_sub_f32 v54, v54, v22
v_sub_f32 v55, v55, v22
v_sub_f32 v56, v56, v22
v_sub_f32 v57, v57, v22
v_sub_f32 v58, v58, v22
v_sub_f32 v59, v59, v22
v_sub_f32 v60, v60, v22
v_sub_f32 v61, v61, v22
v_sub_f32 v62, v62, v22
v_sub_f32 v63, v63, v22
v_sub_f32 v144, v144, v22
v_sub_f32 v145, v145, v22
v_sub_f32 v146, v146, v22
v_sub_f32 v147, v147, v22
v_sub_f32 v148, v148, v22
v_sub_f32 v149, v149, v22
v_sub_f32 v150, v150, v22
v_sub_f32 v151, v151, v22
v_sub_f32 v152, v152, v22
v_sub_f32 v153, v153, v22
v_sub_f32 v154, v154, v22
v_sub_f32 v155, v155, v22
v_sub_f32 v156, v156, v22
v_sub_f32 v157, v157, v22
v_sub_f32 v158, v158, v22
v_sub_f32 v159, v159, v22
v_sub_f32 v176, v176, v22
v_sub_f32 v177, v177, v22
v_sub_f32 v178, v178, v22
v_sub_f32 v179, v179, v22
v_sub_f32 v180, v180, v22
v_sub_f32 v181, v181, v22
v_sub_f32 v182, v182, v22
v_sub_f32 v183, v183, v22
v_sub_f32 v184, v184, v22
v_sub_f32 v185, v185, v22
v_sub_f32 v186, v186, v22
v_sub_f32 v187, v187, v22
v_sub_f32 v188, v188, v22
v_sub_f32 v189, v189, v22
v_sub_f32 v190, v190, v22
v_sub_f32 v191, v191, v22
s_nop 1
s_branch mega_kernelA_u2_rsret
mega_kernelA_u3_rs:
s_nop 15
v_mov_b32 v2, v21
s_nop 1
v_permlane32_swap_b32 v2, v21
s_nop 1
v_max_f32 v21, v21, v2
v_max_f32 v21, 0, v21
v_exp_f32 v23, -v21
s_nop 0
v_mul_f32 v224, v224, v23
v_mul_f32 v225, v225, v23
v_mul_f32 v226, v226, v23
v_mul_f32 v227, v227, v23
v_mul_f32 v228, v228, v23
v_mul_f32 v229, v229, v23
v_mul_f32 v230, v230, v23
v_mul_f32 v231, v231, v23
v_mul_f32 v232, v232, v23
v_mul_f32 v233, v233, v23
v_mul_f32 v234, v234, v23
v_mul_f32 v235, v235, v23
v_mul_f32 v236, v236, v23
v_mul_f32 v237, v237, v23
v_mul_f32 v238, v238, v23
v_mul_f32 v239, v239, v23
v_sub_f32 v32, v32, v21
v_sub_f32 v33, v33, v21
v_sub_f32 v34, v34, v21
v_sub_f32 v35, v35, v21
v_sub_f32 v36, v36, v21
v_sub_f32 v37, v37, v21
v_sub_f32 v38, v38, v21
v_sub_f32 v39, v39, v21
v_sub_f32 v40, v40, v21
v_sub_f32 v41, v41, v21
v_sub_f32 v42, v42, v21
v_sub_f32 v43, v43, v21
v_sub_f32 v44, v44, v21
v_sub_f32 v45, v45, v21
v_sub_f32 v46, v46, v21
v_sub_f32 v47, v47, v21
v_sub_f32 v64, v64, v21
v_sub_f32 v65, v65, v21
v_sub_f32 v66, v66, v21
v_sub_f32 v67, v67, v21
v_sub_f32 v68, v68, v21
v_sub_f32 v69, v69, v21
v_sub_f32 v70, v70, v21
v_sub_f32 v71, v71, v21
v_sub_f32 v72, v72, v21
v_sub_f32 v73, v73, v21
v_sub_f32 v74, v74, v21
v_sub_f32 v75, v75, v21
v_sub_f32 v76, v76, v21
v_sub_f32 v77, v77, v21
v_sub_f32 v78, v78, v21
v_sub_f32 v79, v79, v21
v_sub_f32 v96, v96, v21
v_sub_f32 v97, v97, v21
v_sub_f32 v98, v98, v21
v_sub_f32 v99, v99, v21
v_sub_f32 v100, v100, v21
v_sub_f32 v101, v101, v21
v_sub_f32 v102, v102, v21
v_sub_f32 v103, v103, v21
v_sub_f32 v104, v104, v21
v_sub_f32 v105, v105, v21
v_sub_f32 v106, v106, v21
v_sub_f32 v107, v107, v21
v_sub_f32 v108, v108, v21
v_sub_f32 v109, v109, v21
v_sub_f32 v110, v110, v21
v_sub_f32 v111, v111, v21
v_mov_b32 v2, v22
s_nop 1
v_permlane32_swap_b32 v2, v22
s_nop 1
v_max_f32 v22, v22, v2
v_max_f32 v22, 0, v22
v_exp_f32 v23, -v22
s_nop 0
v_mul_f32 v240, v240, v23
v_mul_f32 v241, v241, v23
v_mul_f32 v242, v242, v23
v_mul_f32 v243, v243, v23
v_mul_f32 v244, v244, v23
v_mul_f32 v245, v245, v23
v_mul_f32 v246, v246, v23
v_mul_f32 v247, v247, v23
v_mul_f32 v248, v248, v23
v_mul_f32 v249, v249, v23
v_mul_f32 v250, v250, v23
v_mul_f32 v251, v251, v23
v_mul_f32 v252, v252, v23
v_mul_f32 v253, v253, v23
v_mul_f32 v254, v254, v23
v_mul_f32 v255, v255, v23
v_sub_f32 v48, v48, v22
v_sub_f32 v49, v49, v22
v_sub_f32 v50, v50, v22
v_sub_f32 v51, v51, v22
v_sub_f32 v52, v52, v22
v_sub_f32 v53, v53, v22
v_sub_f32 v54, v54, v22
v_sub_f32 v55, v55, v22
v_sub_f32 v56, v56, v22
v_sub_f32 v57, v57, v22
v_sub_f32 v58, v58, v22
v_sub_f32 v59, v59, v22
v_sub_f32 v60, v60, v22
v_sub_f32 v61, v61, v22
v_sub_f32 v62, v62, v22
v_sub_f32 v63, v63, v22
v_sub_f32 v80, v80, v22
v_sub_f32 v81, v81, v22
v_sub_f32 v82, v82, v22
v_sub_f32 v83, v83, v22
v_sub_f32 v84, v84, v22
v_sub_f32 v85, v85, v22
v_sub_f32 v86, v86, v22
v_sub_f32 v87, v87, v22
v_sub_f32 v88, v88, v22
v_sub_f32 v89, v89, v22
v_sub_f32 v90, v90, v22
v_sub_f32 v91, v91, v22
v_sub_f32 v92, v92, v22
v_sub_f32 v93, v93, v22
v_sub_f32 v94, v94, v22
v_sub_f32 v95, v95, v22
v_sub_f32 v112, v112, v22
v_sub_f32 v113, v113, v22
v_sub_f32 v114, v114, v22
v_sub_f32 v115, v115, v22
v_sub_f32 v116, v116, v22
v_sub_f32 v117, v117, v22
v_sub_f32 v118, v118, v22
v_sub_f32 v119, v119, v22
v_sub_f32 v120, v120, v22
v_sub_f32 v121, v121, v22
v_sub_f32 v122, v122, v22
v_sub_f32 v123, v123, v22
v_sub_f32 v124, v124, v22
v_sub_f32 v125, v125, v22
v_sub_f32 v126, v126, v22
v_sub_f32 v127, v127, v22
s_nop 1
s_branch mega_kernelA_u3_rsret
mega_kernel_exit:
s_endpgm
.section .rodata,"a"
.p2align 6
.amdhsa_kernel concat_heads__softmax_full_mha__compressed_kv_cla__prompt_kernel
  .amdhsa_next_free_vgpr 512
  .amdhsa_next_free_sgpr 102
  .amdhsa_accum_offset 256
  .amdhsa_group_segment_fixed_size 0
  .amdhsa_kernarg_size 96
  .amdhsa_user_sgpr_count 2
  .amdhsa_user_sgpr_kernarg_segment_ptr 1
  .amdhsa_system_sgpr_workgroup_id_x 1
.end_amdhsa_kernel
```
